```python
import torch

def _softmax(x, axis=-1):
    return torch.softmax(x, dim=axis)

def _gelu(x):
    return torch.nn.functional.gelu(x, approximate='tanh')

def _silu(x):
    return torch.nn.functional.silu(x)

def _sigmoid(x):
    return torch.sigmoid(x)

def _layernorm(x, axis=-1, eps=1e-05):
    m = x.mean(dim=axis, keepdim=True)
    v = x.var(dim=axis, keepdim=True, unbiased=False)
    return (x - m) / torch.sqrt(v + eps)

def _scatter_add(tgt, idx, src, axis=0):
    return tgt.clone().index_add_(axis, idx, src)

def _segment_sum(src, seg, n):
    out = torch.zeros((n,) + src.shape[1:], dtype=src.dtype)
    return out.index_add_(0, seg, src)

def _pad(x, pw):
    flat = tuple((v for pair in reversed(pw) for v in pair))
    return torch.nn.functional.pad(x, flat)
kernel_name = 'adaLN_cond__compressed_kv_cla__dense_activation_squared_relu__prompt'

def setup_inputs():

    _w = lambda a: (lambda t: t.to(torch.bfloat16) if t.is_floating_point() else t)(torch.as_tensor(a))

    def _A_setup():
        B, H, Sq, Sk, D, M = (1, 32, 2048, 2048, 128, 640)
        Dc = 4 * D
        return {'x': _w((lambda *s: torch.randn(*s, dtype=torch.bfloat16) * 0.05)(B, Sq, M)), 'c_kv': _w((lambda *s: torch.randn(*s, dtype=torch.bfloat16) * 1.6)(B, Sk, Dc)), 'w_q': _w((lambda *s: torch.randn(*s, dtype=torch.bfloat16) * 0.8)(M, H, D) * M ** (-0.5)), 'w_uk': _w((lambda *s: torch.randn(*s, dtype=torch.bfloat16) * 0.8)(Dc, H, D) * Dc ** (-0.5)), 'w_uv': _w((lambda *s: torch.randn(*s, dtype=torch.bfloat16) * 1.6)(Dc, H, D) * Dc ** (-0.5)), 'w_o': _w((lambda *s: torch.randn(*s, dtype=torch.bfloat16) * 1.6)(H, D, M) * (H * D) ** (-0.5))}
    _A_in = _A_setup()

    def _B_setup():
        B, S, D, F = (1, 2048, 640, 1728)
        return {'x': _w((lambda *s: torch.randn(*s, dtype=torch.bfloat16) * 0.05)(B, S, D)), 'w1': _w((lambda *s: torch.randn(*s, dtype=torch.bfloat16) * 0.05)(D, F)), 'b1': _w((lambda *s: torch.randn(*s, dtype=torch.bfloat16) * 0.4)(F)), 'w2': _w((lambda *s: torch.randn(*s, dtype=torch.bfloat16) * 0.05)(F, D)), 'b2': _w((lambda *s: torch.randn(*s, dtype=torch.bfloat16) * 3.2)(D))}
    _B_in = _B_setup()
    return {'A_x': _A_in['x'], 'A_c_kv': _A_in['c_kv'], 'A_w_q': _A_in['w_q'], 'A_w_uk': _A_in['w_uk'], 'A_w_uv': _A_in['w_uv'], 'A_w_o': _A_in['w_o'], 'B_x': _B_in['x'], 'B_w1': _B_in['w1'], 'B_b1': _B_in['b1'], 'B_w2': _B_in['w2'], 'B_b2': _B_in['b2'], 'c': _w((lambda *s: torch.randn(*s, dtype=torch.bfloat16) * 0.1)(1, 640) * 8.0), 'w_mod': _w((lambda *s: torch.randn(*s, dtype=torch.bfloat16) * 0.1)(640, 6 * 640) * 640 ** (-0.5) * 8.0)}

def reference(A_x, A_c_kv, A_w_q, A_w_uk, A_w_uv, A_w_o, B_x, B_w1, B_b1, B_w2, B_b2, c, w_mod):

    def _A_ref(x, c_kv, w_q, w_uk, w_uv, w_o):
        B, Sq, M = (x.shape[0], x.shape[1], x.shape[2])
        Sk = c_kv.shape[1]
        H, D = (w_q.shape[1], w_q.shape[2])
        q = torch.einsum('bqm,mhd->bhqd', x, w_q)
        k = torch.einsum('bkc,chd->bhkd', c_kv, w_uk)
        v = torch.einsum('bkc,chd->bhkd', c_kv, w_uv)
        scores = torch.einsum('bhqd,bhkd->bhqk', q, k) * D ** (-0.5)
        off = Sk - Sq
        qi = torch.arange(Sq)[:, None]
        kj = torch.arange(Sk)[None, :]
        cmask = kj <= qi + off
        scores = torch.where(cmask[None, None], scores, -1000000000.0)
        p = _softmax(scores, axis=-1)
        ctx = torch.einsum('bhqk,bhkd->bhqd', p, v)
        return torch.einsum('bhqd,hdm->bqm', ctx, w_o)

    def _B_ref(x, w1, b1, w2, b2):
        h = torch.einsum('bsd,df->bsf', x, w1) + b1
        zero = torch.zeros_like(h)
        r = torch.where(h > zero, h, zero)
        h = r * r
        out = torch.einsum('bsf,fd->bsd', h, w2) + b2
        return out
    x = A_x
    mod = (_silu(c) @ w_mod).reshape(c.shape[0], 6, 1, -1)
    sa, ca, ga, sb, cb, gb = (mod[:, 0].clone(), mod[:, 1].clone(), mod[:, 2].clone(), mod[:, 3].clone(), mod[:, 4].clone(), mod[:, 5].clone())
    h = _layernorm(x, axis=-1) * (1 + ca) + sa
    x = x + ga * _A_ref(h, A_c_kv, A_w_q, A_w_uk, A_w_uv, A_w_o)
    h = _layernorm(x, axis=-1) * (1 + cb) + sb
    x = x + gb * _B_ref(h, B_w1, B_b1, B_w2, B_b2)
    return x
```

```asm
; @launch grid=(256,1,1) block=(256,1,1) lds=163840
.amdgcn_target "amdgcn-amd-amdhsa--gfx950"
.text
.globl adaLN_cond__compressed_kv_cla__dense_activation_squared_relu__prompt_kernel
.p2align 8
.type adaLN_cond__compressed_kv_cla__dense_activation_squared_relu__prompt_kernel,@function
adaLN_cond__compressed_kv_cla__dense_activation_squared_relu__prompt_kernel:
s_cmp_ge_u32 s2, 256
s_cbranch_scc1 Lend
s_load_dwordx16 s[36:51], s[0:1], 0
s_load_dwordx16 s[52:67], s[0:1], 64
v_lshrrev_b32 v128, 6, v0
v_and_b32 v220, 63, v0
v_readfirstlane_b32 s3, v128
s_and_b32 s4, s2, 7
s_lshl_b32 s4, s4, 2
s_lshr_b32 s5, s2, 3
s_and_b32 s5, s5, 3
s_add_u32 s4, s4, s5
s_lshr_b32 s5, s2, 5
s_getpc_b64 s[70:71]
Lpc1:
s_add_u32 s70, s70, Lcode0-Lpc1
s_addc_u32 s71, s71, 0
s_lshr_b32 s6, s2, 3
s_lshl_b32 s6, s6, 2
s_add_u32 s6, s6, s3
s_lshl_b32 s6, s6, 7
v_min_u32 v148, 6, v220
v_lshlrev_b32 v148, 14, v148
v_add_u32 v148, s6, v148
v_min_u32 v148, Lend-Lcode0, v148
v_mov_b32 v149, s71
v_add_co_u32 v148, vcc, s70, v148
s_nop 1
v_addc_co_u32 v149, vcc, 0, v149, vcc
global_load_dword v147, v[148:149], off
Lcode0:
v_lshlrev_b32 v216, 4, v220
v_lshrrev_b32 v129, 4, v220
s_mul_i32 s72, s2, 1093
s_lshr_b32 s72, s72, 16
s_mul_i32 s73, s72, 60
s_sub_u32 s73, s2, s73
v_and_b32 v130, 15, v220
v_min_u32 v130, 4, v130
v_lshlrev_b32 v130, 6, v130
v_lshl_add_u32 v130, v129, 4, v130
v_lshrrev_b32 v132, 3, v220
v_mul_u32_u24 v131, 7680, v132
v_and_b32 v133, 7, v220
v_lshl_add_u32 v131, v133, 4, v131
s_mul_i32 s74, s72, 160
s_mul_i32 s75, s3, 40
s_add_u32 s75, s75, s74
s_mul_i32 s75, s75, 7680
s_lshl_b32 s6, s73, 7
s_add_u32 s75, s75, s6
s_lshl_b32 s74, s74, 1
s_mul_i32 s76, s3, 5120
s_add_u32 s76, s76, 131072
v_lshlrev_b32 v132, 10, v132
v_xor_b32 v133, v133, v129
v_lshl_add_u32 v192, v133, 4, v132
v_xor_b32 v193, 64, v192
v_add_u32 v193, 7168, v193
v_add_u32 v194, 14336, v192
v_add_u32 v195, 14336, v193
v_lshrrev_b32 v133, 1, v220
v_and_b32 v133, 7, v133
v_xor_b32 v133, v133, v129
v_lshlrev_b32 v133, 5, v133
v_and_b32 v134, 1, v220
v_lshl_add_u32 v133, v134, 4, v133
v_lshl_add_u32 v196, v129, 13, v133
v_add_u32 v197, 31744, v196
v_xor_b32 v198, 128, v196
v_add_u32 v199, 95232, v198
v_add_u32 v198, 63488, v198
s_lshl_b32 s68, s5, 17
s_lshr_b32 s6, s3, 1
s_lshl_b32 s6, s6, 16
s_add_u32 s68, s68, s6
s_and_b32 s7, s3, 1
s_lshl_b32 s6, s7, 20
s_add_u32 s68, s68, s6
s_add_u32 s69, s68, 32768
s_lshl_b32 s70, s7, 18
s_lshl_b32 s6, s4, 8
s_add_u32 s70, s70, s6
s_add_u32 s71, s70, 131072
s_lshl_b32 s32, s3, 13
v_lshrrev_b32 v254, 2, v220
v_lshlrev_b32 v254, 10, v254
v_lshrrev_b32 v255, 3, v220
v_and_b32 v255, 1, v255
v_lshlrev_b32 v255, 7, v255
v_lshl_add_u32 v255, v129, 13, v255
v_and_b32 v134, 3, v220
v_lshl_add_u32 v144, v134, 7, v254
v_lshl_add_u32 v145, v134, 19, v255
s_lshl_b32 s34, s5, 17
s_bfe_u32 s6, s4, 0x10001
s_lshl_b32 s6, s6, 16
s_add_u32 s34, s34, s6
s_and_b32 s6, s4, 1
s_lshl_b32 s6, s6, 20
s_add_u32 s34, s34, s6
s_lshl_b32 s6, s3, 14
s_add_u32 s34, s34, s6
s_lshl_b32 s35, s5, 1
s_add_u32 s35, s35, s7
s_lshl_b32 s35, s35, 15
s_lshl_b32 s6, s4, 8
s_add_u32 s35, s35, s6
s_waitcnt lgkmcnt(0)
s_mov_b32 s8, s38
s_and_b32 s9, s39, 0xffff
s_mov_b32 s10, 2097152
s_mov_b32 s11, 0x20000
s_cmp_ge_u32 s3, 2
s_cselect_b32 s12, s44, s42
s_cselect_b32 s13, s45, s43
s_and_b32 s13, s13, 0xffff
s_mov_b32 s14, 4194304
s_mov_b32 s15, 0x20000
s_add_u32 m0, s32, 0
s_nop 0
buffer_load_dwordx4 v192, s[8:11], s68 offen offset:0 lds
buffer_load_dwordx4 v193, s[8:11], s68 offen offset:1024 lds
buffer_load_dwordx4 v194, s[8:11], s68 offen offset:2048 lds
buffer_load_dwordx4 v195, s[8:11], s68 offen offset:3072 lds
s_mov_b32 s24, s58
s_and_b32 s25, s59, 0xffff
s_mov_b32 s26, 1280
s_mov_b32 s27, 0x20000
s_mov_b32 s16, s60
s_and_b32 s17, s61, 0xffff
s_mov_b32 s18, 4915200
s_mov_b32 s19, 0x20000
buffer_load_dwordx4 v[136:139], v130, s[24:27], s74 offen
s_add_u32 m0, s76, 0
s_add_u32 s7, s75, 0
buffer_load_dwordx4 v131, s[16:19], s7 offen lds
s_add_u32 m0, s76, 1024
s_add_u32 s7, s75, 61440
buffer_load_dwordx4 v131, s[16:19], s7 offen lds
s_add_u32 m0, s76, 2048
s_add_u32 s7, s75, 122880
buffer_load_dwordx4 v131, s[16:19], s7 offen lds
s_add_u32 m0, s76, 3072
s_add_u32 s7, s75, 184320
buffer_load_dwordx4 v131, s[16:19], s7 offen lds
s_add_u32 m0, s76, 4096
s_add_u32 s7, s75, 245760
buffer_load_dwordx4 v131, s[16:19], s7 offen lds
s_add_u32 m0, s32, 4096
s_nop 0
buffer_load_dwordx4 v192, s[8:11], s69 offen offset:0 lds
buffer_load_dwordx4 v193, s[8:11], s69 offen offset:1024 lds
buffer_load_dwordx4 v194, s[8:11], s69 offen offset:2048 lds
buffer_load_dwordx4 v195, s[8:11], s69 offen offset:3072 lds
s_add_u32 s35, s35, 1572864
s_lshl_b32 s6, s5, 4
s_add_u32 s6, s6, s4
s_sub_u32 s7, 14, s5
s_lshl_b32 s7, s7, 4
s_add_u32 s7, s7, s4
s_cmp_lt_u32 s4, 16
s_cselect_b32 s6, s6, s7
s_lshl_b32 s6, s6, 1
s_and_b32 s7, s3, 1
s_add_u32 s6, s6, s7
s_mul_i32 s78, s6, 5120
v_and_b32 v134, 15, v220
v_lshrrev_b32 v135, 1, v134
v_xor_b32 v135, v135, v129
v_lshlrev_b32 v135, 4, v135
v_lshl_add_u32 v135, v134, 7, v135
s_and_b32 s7, s3, 1
s_lshl_b32 s6, s7, 14
v_add_u32 v200, s6, v135
v_xor_b32 v201, 64, v200
v_add_u32 v202, 65536, v200
v_add_u32 v203, 65536, v201
v_lshrrev_b32 v134, 2, v220
v_and_b32 v135, 3, v134
v_lshl_add_u32 v135, v129, 3, v135
v_and_b32 v142, 3, v220
v_lshlrev_b32 v142, 3, v142
v_lshl_add_u32 v143, v135, 7, v142
v_lshl_add_u32 v135, v135, 8, v142
v_and_b32 v134, 7, v134
v_lshl_add_u32 v135, v134, 5, v135
s_lshr_b32 s6, s3, 1
s_lshl_b32 s6, s6, 14
s_add_u32 s6, s6, 32768
v_add_u32 v135, s6, v135
v_xor_b32 v204, 0, v135
v_add_u32 v212, 65536, v204
v_xor_b32 v205, 32, v135
v_add_u32 v213, 65536, v205
v_xor_b32 v206, 64, v135
v_add_u32 v214, 65536, v206
v_xor_b32 v207, 96, v135
v_add_u32 v215, 65536, v207
v_xor_b32 v208, 128, v135
v_add_u32 v217, 65536, v208
v_xor_b32 v209, 160, v135
v_add_u32 v218, 65536, v209
v_xor_b32 v210, 192, v135
v_add_u32 v221, 65536, v210
v_xor_b32 v211, 224, v135
v_add_u32 v222, 65536, v211
s_cmp_ge_u32 s3, 2
s_mov_b32 s6, 33554432
s_cselect_b32 s6, 52428800, s6
s_add_u32 s28, s66, s6
s_addc_u32 s29, s67, 0
s_and_b32 s29, s29, 0xffff
s_mov_b32 s30, 17825792
s_mov_b32 s31, 0x20000
s_mul_i32 s33, s4, 525312
s_lshl_b32 s6, s5, 15
s_add_u32 s33, s33, s6
s_lshl_b32 s6, s7, 14
s_add_u32 s33, s33, s6
s_add_u32 s20, s66, 0
s_addc_u32 s21, s67, 0
s_and_b32 s21, s21, 0xffff
s_mov_b32 s22, 61440
s_mov_b32 s23, 0x20000
s_mul_i32 s79, s72, 15360
s_lshl_b32 s7, s73, 8
s_add_u32 s79, s79, s7
s_lshl_b32 s7, s3, 6
s_add_u32 s79, s79, s7
s_lshl_b32 s6, s3, 5
s_add_u32 s6, s6, 131072
v_add_u32 v143, s6, v143
s_sub_u32 s38, s2, 128
s_lshl_b32 s38, s38, 2
s_add_u32 s38, s38, s3
s_cmp_lt_u32 s38, 472
s_cselect_b32 s98, 8388608, 0
s_cselect_b32 s38, s38, 0
s_cmp_lt_u32 s38, 364
s_cbranch_scc1 Lrp_a
Lrp_w1:
s_sub_u32 s6, s38, 364
s_and_b32 s7, s6, 3
s_lshr_b32 s6, s6, 2
s_mul_i32 s48, s7, 552960
s_lshl_b32 s49, s6, 7
s_add_u32 s48, s48, s49
s_mul_i32 s49, s6, 81920
s_mul_i32 s7, s7, 5120
s_add_u32 s49, s49, s7
s_add_u32 s49, s49, 16777216
s_mov_b64 s[46:47], s[50:51]
s_mov_b32 s54, 110592
s_mov_b32 s55, 1024
s_mov_b32 s96, 3456
s_mov_b32 s97, 20480
s_branch Lrp_c
Lrp_a:
s_mov_b32 s97, 55296
s_mov_b32 s39, 19922944
s_cmp_lt_u32 s38, 256
s_cselect_b64 s[46:47], s[46:47], s[54:55]
s_cselect_b32 s97, 131072, s97
s_cselect_b32 s39, 10485760, s39
s_and_b32 s7, s38, 1
s_bfe_u32 s6, s38, 0x70001
s_mul_i32 s48, s6, 40960
s_mul_i32 s49, s7, 640
s_add_u32 s48, s48, s49
s_lshl_b32 s55, s97, 2
s_mul_i32 s49, s7, s55
s_mul_i32 s49, s49, 5
s_lshl_b32 s6, s6, 10
s_add_u32 s49, s49, s6
s_add_u32 s49, s49, s39
s_mov_b32 s54, 128
s_mov_b32 s96, 1280
Lrp_c:
s_add_u32 s46, s46, s48
s_addc_u32 s47, s47, 0
s_add_u32 s50, s66, s49
s_addc_u32 s51, s67, 0
s_mov_b64 exec, 0
s_cmp_eq_u32 s3, 0
s_cbranch_scc1 Lch0_0
s_cmp_eq_u32 s3, 1
s_cbranch_scc1 Lch0_1
s_cmp_eq_u32 s3, 2
s_cbranch_scc1 Lch0_2
s_branch Lch0_3
Lret0:
s_mov_b64 exec, -1
s_add_u32 m0, s32, 32768
s_nop 0
buffer_load_dwordx4 v196, s[12:15], s70 offen offset:0 lds
buffer_load_dwordx4 v197, s[12:15], s70 offen offset:1024 lds
buffer_load_dwordx4 v198, s[12:15], s70 offen offset:2048 lds
buffer_load_dwordx4 v199, s[12:15], s70 offen offset:3072 lds
s_add_u32 m0, s32, 36864
s_nop 0
buffer_load_dwordx4 v196, s[12:15], s71 offen offset:0 lds
buffer_load_dwordx4 v197, s[12:15], s71 offen offset:1024 lds
buffer_load_dwordx4 v198, s[12:15], s71 offen offset:2048 lds
buffer_load_dwordx4 v199, s[12:15], s71 offen offset:3072 lds
s_add_u32 s68, s68, 128
s_add_u32 s69, s69, 128
s_add_u32 s70, s70, 524288
s_add_u32 s71, s71, 524288
v_mov_b32 v223, 1
s_mul_i32 s6, s72, 20
s_add_u32 s6, s6, s73
s_lshl_b32 s6, s6, 8
s_add_u32 s6, s6, 262144
v_mul_u32_u24 v134, 20224, v129
v_add3_u32 v134, s6, v134, v216
v_mov_b32 v188, 0
v_mov_b32 v189, 0
v_mov_b32 v190, 0
v_mov_b32 v191, 0
s_cmp_lt_u32 s73, 20
s_cselect_b32 s77, 0, 128
s_cselect_b32 s6, 0, 1
s_or_b32 s6, s6, s3
s_lshr_b32 s7, s72, 2
s_or_b32 s6, s6, s7
s_cmp_lg_u32 s6, 0
s_cbranch_scc1 Lnozero
global_store_dwordx4 v134, v[188:191], s[66:67] sc1
Lnozero:
s_waitcnt vmcnt(17)
v_lshlrev_b32 v144, 16, v136
v_and_b32 v145, 0xffff0000, v136
s_add_u32 m0, s32, 65536
v_lshlrev_b32 v146, 16, v137
v_and_b32 v147, 0xffff0000, v137
buffer_load_dwordx4 v192, s[8:11], s68 offen offset:0 lds
v_lshlrev_b32 v148, 16, v138
v_and_b32 v149, 0xffff0000, v138
buffer_load_dwordx4 v193, s[8:11], s68 offen offset:1024 lds
v_lshlrev_b32 v150, 16, v139
v_and_b32 v151, 0xffff0000, v139
buffer_load_dwordx4 v194, s[8:11], s68 offen offset:2048 lds
v_mul_f32 v152, 0xbfb8aa3b, v144
v_mul_f32 v153, 0xbfb8aa3b, v145
buffer_load_dwordx4 v195, s[8:11], s68 offen offset:3072 lds
v_mul_f32 v154, 0xbfb8aa3b, v146
v_mul_f32 v155, 0xbfb8aa3b, v147
s_add_u32 m0, s32, 69632
v_mul_f32 v156, 0xbfb8aa3b, v148
v_mul_f32 v157, 0xbfb8aa3b, v149
buffer_load_dwordx4 v192, s[8:11], s69 offen offset:0 lds
v_mul_f32 v158, 0xbfb8aa3b, v150
v_mul_f32 v159, 0xbfb8aa3b, v151
buffer_load_dwordx4 v193, s[8:11], s69 offen offset:1024 lds
v_exp_f32 v152, v152
v_exp_f32 v153, v153
buffer_load_dwordx4 v194, s[8:11], s69 offen offset:2048 lds
v_exp_f32 v154, v154
v_exp_f32 v155, v155
buffer_load_dwordx4 v195, s[8:11], s69 offen offset:3072 lds
v_exp_f32 v156, v156
v_exp_f32 v157, v157
s_add_u32 m0, s32, 98304
v_exp_f32 v158, v158
v_exp_f32 v159, v159
buffer_load_dwordx4 v196, s[12:15], s70 offen offset:0 lds
v_add_f32 v152, 1.0, v152
v_add_f32 v153, 1.0, v153
buffer_load_dwordx4 v197, s[12:15], s70 offen offset:1024 lds
v_add_f32 v154, 1.0, v154
v_add_f32 v155, 1.0, v155
buffer_load_dwordx4 v198, s[12:15], s70 offen offset:2048 lds
v_add_f32 v156, 1.0, v156
v_add_f32 v157, 1.0, v157
buffer_load_dwordx4 v199, s[12:15], s70 offen offset:3072 lds
v_add_f32 v158, 1.0, v158
v_add_f32 v159, 1.0, v159
s_add_u32 m0, s32, 102400
v_rcp_f32 v152, v152
v_rcp_f32 v153, v153
buffer_load_dwordx4 v196, s[12:15], s71 offen offset:0 lds
v_rcp_f32 v154, v154
v_rcp_f32 v155, v155
buffer_load_dwordx4 v197, s[12:15], s71 offen offset:1024 lds
v_rcp_f32 v156, v156
v_rcp_f32 v157, v157
buffer_load_dwordx4 v198, s[12:15], s71 offen offset:2048 lds
v_rcp_f32 v158, v158
v_rcp_f32 v159, v159
buffer_load_dwordx4 v199, s[12:15], s71 offen offset:3072 lds
v_mul_f32 v152, v144, v152
v_mul_f32 v153, v145, v153
s_add_u32 s68, s68, 128
v_mul_f32 v154, v146, v154
v_mul_f32 v155, v147, v155
s_add_u32 s69, s69, 128
v_mul_f32 v156, v148, v156
v_mul_f32 v157, v149, v157
s_add_u32 s70, s70, 524288
v_mul_f32 v158, v150, v158
v_mul_f32 v159, v151, v159
s_add_u32 s71, s71, 524288
v_cvt_pk_bf16_f32 v136, v152, v153
v_cvt_pk_bf16_f32 v137, v154, v155
v_cvt_pk_bf16_f32 v138, v156, v157
v_cvt_pk_bf16_f32 v139, v158, v159
s_lshl_b32 s6, s3, 9
s_add_u32 s6, s6, 151552
v_add_u32 v130, s6, v130
ds_write_b128 v130, v[136:139]
v_lshl_add_u32 v130, v129, 4, s6
v_lshlrev_b32 v134, 2, v220
s_cmp_ge_u32 s3, 2
s_cbranch_scc1 LkvV
s_branch LkvK
.p2align 12
LkvK:
s_mov_b32 s24, s36
s_and_b32 s25, s37, 0xffff
s_mov_b32 s26, 2621440
s_mov_b32 s27, 0x20000
v_and_b32 v252, 3, v220
v_mul_u32_u24 v252, 1280, v252
v_lshrrev_b32 v253, 2, v220
v_lshl_add_u32 v252, v253, 4, v252
Lch0_0:
Lpad0:
s_cbranch_execz Lpad4
v_lshlrev_b32 v253, 5, v253
v_add_u32 v253, 131072, v253
s_waitcnt vmcnt(16) lgkmcnt(0)
s_barrier
ds_read_b128 a[224:227], v200 offset:0
ds_read_b128 a[228:231], v200 offset:2048
ds_read_b128 a[232:235], v200 offset:4096
ds_read_b128 a[236:239], v200 offset:6144
ds_read_b128 a[240:243], v200 offset:8192
ds_read_b128 a[244:247], v200 offset:10240
ds_read_b128 a[248:251], v200 offset:12288
ds_read_b128 a[252:255], v200 offset:14336
ds_read_b64_tr_b16 a[192:193], v204 offset:0
ds_read_b64_tr_b16 a[194:195], v204 offset:1024
ds_read_b64_tr_b16 a[196:197], v205 offset:0
ds_read_b64_tr_b16 a[198:199], v205 offset:1024
s_waitcnt lgkmcnt(4)
ds_read_b64_tr_b16 a[200:201], v206 offset:0
ds_read_b64_tr_b16 a[202:203], v206 offset:1024
ds_read_b64_tr_b16 a[204:205], v207 offset:0
ds_read_b64_tr_b16 a[206:207], v207 offset:1024
ds_read_b64_tr_b16 a[208:209], v208 offset:0
ds_read_b64_tr_b16 a[210:211], v208 offset:1024
ds_read_b64_tr_b16 a[212:213], v209 offset:0
ds_read_b64_tr_b16 a[214:215], v209 offset:1024
ds_read_b64_tr_b16 a[216:217], v210 offset:0
ds_read_b64_tr_b16 a[218:219], v210 offset:1024
ds_read_b64_tr_b16 a[220:221], v211 offset:0
ds_read_b64_tr_b16 a[222:223], v211 offset:1024
s_waitcnt lgkmcnt(0)
v_mfma_f32_16x16x32_bf16 v[0:3], a[192:195], a[224:227], 0
v_mfma_f32_16x16x32_bf16 v[4:7], a[196:199], a[224:227], 0
s_mov_b32 m0, 155648
ds_read_b128 v[144:147], v130 offset:0
ds_read_b64_tr_b16 v[164:165], v143 offset:0
v_mfma_f32_16x16x32_bf16 v[36:39], a[196:199], a[228:231], 0
buffer_load_dword v254, s[8:11], s34 offen offset:384 lds
v_mfma_f32_16x16x32_bf16 v[32:35], a[192:195], a[228:231], 0
ds_read_b64_tr_b16 v[166:167], v143 offset:512
ds_read_b128 v[148:151], v130 offset:64
v_mfma_f32_16x16x32_bf16 v[64:67], a[192:195], a[232:235], 0
ds_read_b64_tr_b16 v[168:169], v143 offset:4096
v_mfma_f32_16x16x32_bf16 v[68:71], a[196:199], a[232:235], 0
ds_read_b64_tr_b16 v[170:171], v143 offset:4608
ds_read_b128 v[152:155], v130 offset:128
v_mfma_f32_16x16x32_bf16 v[100:103], a[196:199], a[236:239], 0
ds_read_b64_tr_b16 v[172:173], v143 offset:8192
v_mfma_f32_16x16x32_bf16 v[96:99], a[192:195], a[236:239], 0
ds_read_b64_tr_b16 v[174:175], v143 offset:8704
ds_read_b128 v[156:159], v130 offset:192
v_mfma_f32_16x16x32_bf16 a[0:3], a[192:195], a[240:243], 0
buffer_load_dword v255, s[12:15], s35 offen lds
v_mfma_f32_16x16x32_bf16 a[4:7], a[196:199], a[240:243], 0
s_add_u32 s35, s35, 524288
ds_read_b64_tr_b16 v[176:177], v143 offset:12288
ds_read_b64_tr_b16 v[178:179], v143 offset:12800
v_mfma_f32_16x16x32_bf16 a[36:39], a[196:199], a[244:247], 0
ds_read_b128 v[160:163], v130 offset:256
v_mfma_f32_16x16x32_bf16 a[32:35], a[192:195], a[244:247], 0
ds_read_b64_tr_b16 v[180:181], v143 offset:16384
ds_read_b64_tr_b16 v[182:183], v143 offset:16896
v_mfma_f32_16x16x32_bf16 a[64:67], a[192:195], a[248:251], 0
v_mfma_f32_16x16x32_bf16 a[68:71], a[196:199], a[248:251], 0
v_mfma_f32_16x16x32_bf16 a[100:103], a[196:199], a[252:255], 0
v_mfma_f32_16x16x32_bf16 a[96:99], a[192:195], a[252:255], 0
v_mfma_f32_16x16x32_bf16 a[104:107], a[200:203], a[252:255], 0
v_mfma_f32_16x16x32_bf16 a[108:111], a[204:207], a[252:255], 0
s_waitcnt lgkmcnt(0)
v_mfma_f32_16x16x32_bf16 v[184:187], v[144:147], v[164:167], 0
v_mfma_f32_16x16x32_bf16 a[76:79], a[204:207], a[248:251], 0
v_mfma_f32_16x16x32_bf16 v[184:187], v[148:151], v[168:171], v[184:187]
v_mfma_f32_16x16x32_bf16 a[72:75], a[200:203], a[248:251], 0
v_mfma_f32_16x16x32_bf16 v[184:187], v[152:155], v[172:175], v[184:187]
v_mfma_f32_16x16x32_bf16 a[40:43], a[200:203], a[244:247], 0
v_mfma_f32_16x16x32_bf16 v[184:187], v[156:159], v[176:179], v[184:187]
v_mfma_f32_16x16x32_bf16 a[44:47], a[204:207], a[244:247], 0
v_mfma_f32_16x16x32_bf16 v[184:187], v[160:163], v[180:183], v[184:187]
v_mfma_f32_16x16x32_bf16 a[12:15], a[204:207], a[240:243], 0
ds_read_b128 a[160:163], v201 offset:0
ds_read_b128 a[164:167], v201 offset:2048
v_mfma_f32_16x16x32_bf16 a[8:11], a[200:203], a[240:243], 0
v_mfma_f32_16x16x32_bf16 v[104:107], a[200:203], a[236:239], 0
ds_read_b128 a[168:171], v201 offset:4096
ds_read_b128 a[172:175], v201 offset:6144
v_mfma_f32_16x16x32_bf16 v[108:111], a[204:207], a[236:239], 0
v_mfma_f32_16x16x32_bf16 v[76:79], a[204:207], a[232:235], 0
ds_read_b128 a[176:179], v201 offset:8192
ds_read_b128 a[180:183], v201 offset:10240
v_mfma_f32_16x16x32_bf16 v[72:75], a[200:203], a[232:235], 0
v_mfma_f32_16x16x32_bf16 v[40:43], a[200:203], a[228:231], 0
ds_read_b128 a[184:187], v201 offset:12288
ds_read_b128 a[188:191], v201 offset:14336
v_mfma_f32_16x16x32_bf16 v[44:47], a[204:207], a[228:231], 0
s_mov_b64 exec, 0xffff
buffer_store_dword v184, v134, s[20:23], s79 offen sc1
s_mov_b64 exec, -1
v_mfma_f32_16x16x32_bf16 v[12:15], a[204:207], a[224:227], 0
ds_read_b64_tr_b16 a[128:129], v204 offset:8192
ds_read_b64_tr_b16 a[130:131], v204 offset:9216
v_mfma_f32_16x16x32_bf16 v[8:11], a[200:203], a[224:227], 0
v_mfma_f32_16x16x32_bf16 v[16:19], a[208:211], a[224:227], 0
ds_read_b64_tr_b16 a[132:133], v205 offset:8192
ds_read_b64_tr_b16 a[134:135], v205 offset:9216
v_mfma_f32_16x16x32_bf16 v[20:23], a[212:215], a[224:227], 0
buffer_load_dwordx4 v[224:227], v252, s[24:27], s78 offen offset:0
v_mfma_f32_16x16x32_bf16 v[52:55], a[212:215], a[228:231], 0
v_mfma_f32_16x16x32_bf16 v[48:51], a[208:211], a[228:231], 0
ds_read_b64_tr_b16 a[136:137], v206 offset:8192
ds_read_b64_tr_b16 a[138:139], v206 offset:9216
v_mfma_f32_16x16x32_bf16 v[80:83], a[208:211], a[232:235], 0
v_mfma_f32_16x16x32_bf16 v[84:87], a[212:215], a[232:235], 0
buffer_load_dwordx4 v[228:231], v252, s[24:27], s78 offen offset:256
v_mfma_f32_16x16x32_bf16 v[116:119], a[212:215], a[236:239], 0
ds_read_b64_tr_b16 a[140:141], v207 offset:8192
ds_read_b64_tr_b16 a[142:143], v207 offset:9216
v_mfma_f32_16x16x32_bf16 v[112:115], a[208:211], a[236:239], 0
v_mfma_f32_16x16x32_bf16 a[16:19], a[208:211], a[240:243], 0
v_mfma_f32_16x16x32_bf16 a[20:23], a[212:215], a[240:243], 0
ds_read_b64_tr_b16 a[144:145], v208 offset:8192
ds_read_b64_tr_b16 a[146:147], v208 offset:9216
v_mfma_f32_16x16x32_bf16 a[52:55], a[212:215], a[244:247], 0
v_mfma_f32_16x16x32_bf16 a[48:51], a[208:211], a[244:247], 0
buffer_load_dwordx4 v[232:235], v252, s[24:27], s78 offen offset:512
v_mfma_f32_16x16x32_bf16 a[80:83], a[208:211], a[248:251], 0
ds_read_b64_tr_b16 a[148:149], v209 offset:8192
ds_read_b64_tr_b16 a[150:151], v209 offset:9216
v_mfma_f32_16x16x32_bf16 a[84:87], a[212:215], a[248:251], 0
v_mfma_f32_16x16x32_bf16 a[116:119], a[212:215], a[252:255], 0
v_mfma_f32_16x16x32_bf16 a[112:115], a[208:211], a[252:255], 0
ds_read_b64_tr_b16 a[152:153], v210 offset:8192
ds_read_b64_tr_b16 a[154:155], v210 offset:9216
v_mfma_f32_16x16x32_bf16 a[120:123], a[216:219], a[252:255], 0
v_mfma_f32_16x16x32_bf16 a[124:127], a[220:223], a[252:255], 0
v_mfma_f32_16x16x32_bf16 a[92:95], a[220:223], a[248:251], 0
buffer_load_dwordx4 v[236:239], v252, s[24:27], s78 offen offset:768
v_mfma_f32_16x16x32_bf16 a[88:91], a[216:219], a[248:251], 0
ds_read_b64_tr_b16 a[156:157], v211 offset:8192
ds_read_b64_tr_b16 a[158:159], v211 offset:9216
v_mfma_f32_16x16x32_bf16 a[56:59], a[216:219], a[244:247], 0
v_mfma_f32_16x16x32_bf16 a[60:63], a[220:223], a[244:247], 0
v_mfma_f32_16x16x32_bf16 a[28:31], a[220:223], a[240:243], 0
v_mfma_f32_16x16x32_bf16 a[24:27], a[216:219], a[240:243], 0
v_mfma_f32_16x16x32_bf16 v[120:123], a[216:219], a[236:239], 0
buffer_load_dwordx4 v[240:243], v252, s[24:27], s78 offen offset:1024
v_mfma_f32_16x16x32_bf16 v[124:127], a[220:223], a[236:239], 0
v_mfma_f32_16x16x32_bf16 v[92:95], a[220:223], a[232:235], 0
v_mfma_f32_16x16x32_bf16 v[88:91], a[216:219], a[232:235], 0
v_mfma_f32_16x16x32_bf16 v[56:59], a[216:219], a[228:231], 0
v_mfma_f32_16x16x32_bf16 v[60:63], a[220:223], a[228:231], 0
v_mfma_f32_16x16x32_bf16 v[28:31], a[220:223], a[224:227], 0
v_mfma_f32_16x16x32_bf16 v[24:27], a[216:219], a[224:227], 0
s_waitcnt vmcnt(5) lgkmcnt(0)
v_mfma_f32_16x16x32_bf16 v[0:3], a[128:131], a[160:163], v[0:3]
s_barrier
s_lshr_b32 s6, s72, 2
s_or_b32 s6, s6, s3
s_or_b32 s6, s6, s77
v_mov_b32 v251, s77
s_cmp_lg_u32 s6, 0
s_cbranch_scc1 Lnos1
s_mov_b64 exec, 1
global_atomic_add v251, v223, s[64:65] offset:0 sc1
s_mov_b64 exec, -1
Lnos1:
v_mfma_f32_16x16x32_bf16 v[4:7], a[132:135], a[160:163], v[4:7]
s_add_u32 m0, s32, 0
ds_read_b128 a[224:227], v202 offset:0
ds_read_b128 a[228:231], v202 offset:2048
v_mfma_f32_16x16x32_bf16 v[36:39], a[132:135], a[164:167], v[36:39]
buffer_load_dwordx4 v192, s[8:11], s68 offen offset:0 lds
v_mfma_f32_16x16x32_bf16 v[32:35], a[128:131], a[164:167], v[32:35]
v_mfma_f32_16x16x32_bf16 v[64:67], a[128:131], a[168:171], v[64:67]
buffer_load_dwordx4 v193, s[8:11], s68 offen offset:1024 lds
v_mfma_f32_16x16x32_bf16 v[68:71], a[132:135], a[168:171], v[68:71]
ds_read_b128 a[232:235], v202 offset:4096
ds_read_b128 a[236:239], v202 offset:6144
v_mfma_f32_16x16x32_bf16 v[100:103], a[132:135], a[172:175], v[100:103]
v_mfma_f32_16x16x32_bf16 v[96:99], a[128:131], a[172:175], v[96:99]
v_mfma_f32_16x16x32_bf16 a[0:3], a[128:131], a[176:179], a[0:3]
buffer_load_dwordx4 v194, s[8:11], s68 offen offset:2048 lds
v_mfma_f32_16x16x32_bf16 a[4:7], a[132:135], a[176:179], a[4:7]
ds_read_b128 a[240:243], v202 offset:8192
ds_read_b128 a[244:247], v202 offset:10240
v_mfma_f32_16x16x32_bf16 a[36:39], a[132:135], a[180:183], a[36:39]
v_mfma_f32_16x16x32_bf16 a[32:35], a[128:131], a[180:183], a[32:35]
v_mfma_f32_16x16x32_bf16 a[64:67], a[128:131], a[184:187], a[64:67]
buffer_load_dwordx4 v195, s[8:11], s68 offen offset:3072 lds
v_mfma_f32_16x16x32_bf16 a[68:71], a[132:135], a[184:187], a[68:71]
s_add_u32 m0, s32, 4096
ds_read_b128 a[248:251], v202 offset:12288
ds_read_b128 a[252:255], v202 offset:14336
v_mfma_f32_16x16x32_bf16 a[100:103], a[132:135], a[188:191], a[100:103]
v_mfma_f32_16x16x32_bf16 a[96:99], a[128:131], a[188:191], a[96:99]
ds_read_b64_tr_b16 a[192:193], v212 offset:0
ds_read_b64_tr_b16 a[194:195], v212 offset:1024
v_mfma_f32_16x16x32_bf16 a[104:107], a[136:139], a[188:191], a[104:107]
v_mfma_f32_16x16x32_bf16 a[108:111], a[140:143], a[188:191], a[108:111]
buffer_load_dwordx4 v192, s[8:11], s69 offen offset:0 lds
v_mfma_f32_16x16x32_bf16 a[76:79], a[140:143], a[184:187], a[76:79]
v_mfma_f32_16x16x32_bf16 a[72:75], a[136:139], a[184:187], a[72:75]
ds_read_b64_tr_b16 a[196:197], v213 offset:0
ds_read_b64_tr_b16 a[198:199], v213 offset:1024
v_mfma_f32_16x16x32_bf16 a[40:43], a[136:139], a[180:183], a[40:43]
v_mfma_f32_16x16x32_bf16 a[44:47], a[140:143], a[180:183], a[44:47]
buffer_load_dwordx4 v193, s[8:11], s69 offen offset:1024 lds
v_mfma_f32_16x16x32_bf16 a[12:15], a[140:143], a[176:179], a[12:15]
v_mfma_f32_16x16x32_bf16 a[8:11], a[136:139], a[176:179], a[8:11]
ds_read_b64_tr_b16 a[200:201], v214 offset:0
ds_read_b64_tr_b16 a[202:203], v214 offset:1024
v_mfma_f32_16x16x32_bf16 v[104:107], a[136:139], a[172:175], v[104:107]
v_mfma_f32_16x16x32_bf16 v[108:111], a[140:143], a[172:175], v[108:111]
buffer_load_dwordx4 v194, s[8:11], s69 offen offset:2048 lds
v_mfma_f32_16x16x32_bf16 v[76:79], a[140:143], a[168:171], v[76:79]
ds_read_b64_tr_b16 a[204:205], v215 offset:0
ds_read_b64_tr_b16 a[206:207], v215 offset:1024
v_mfma_f32_16x16x32_bf16 v[72:75], a[136:139], a[168:171], v[72:75]
v_mfma_f32_16x16x32_bf16 v[40:43], a[136:139], a[164:167], v[40:43]
v_mfma_f32_16x16x32_bf16 v[44:47], a[140:143], a[164:167], v[44:47]
v_mfma_f32_16x16x32_bf16 v[12:15], a[140:143], a[160:163], v[12:15]
buffer_load_dwordx4 v195, s[8:11], s69 offen offset:3072 lds
v_mfma_f32_16x16x32_bf16 v[8:11], a[136:139], a[160:163], v[8:11]
s_add_u32 m0, s32, 32768
ds_read_b64_tr_b16 a[208:209], v217 offset:0
ds_read_b64_tr_b16 a[210:211], v217 offset:1024
v_mfma_f32_16x16x32_bf16 v[16:19], a[144:147], a[160:163], v[16:19]
v_mfma_f32_16x16x32_bf16 v[20:23], a[148:151], a[160:163], v[20:23]
v_mfma_f32_16x16x32_bf16 v[52:55], a[148:151], a[164:167], v[52:55]
buffer_load_dwordx4 v196, s[12:15], s70 offen offset:0 lds
v_mfma_f32_16x16x32_bf16 v[48:51], a[144:147], a[164:167], v[48:51]
ds_read_b64_tr_b16 a[212:213], v218 offset:0
ds_read_b64_tr_b16 a[214:215], v218 offset:1024
v_mfma_f32_16x16x32_bf16 v[80:83], a[144:147], a[168:171], v[80:83]
v_mfma_f32_16x16x32_bf16 v[84:87], a[148:151], a[168:171], v[84:87]
ds_read_b64_tr_b16 a[216:217], v221 offset:0
ds_read_b64_tr_b16 a[218:219], v221 offset:1024
v_mfma_f32_16x16x32_bf16 v[116:119], a[148:151], a[172:175], v[116:119]
buffer_load_dwordx4 v197, s[12:15], s70 offen offset:1024 lds
v_mfma_f32_16x16x32_bf16 v[112:115], a[144:147], a[172:175], v[112:115]
v_mfma_f32_16x16x32_bf16 a[16:19], a[144:147], a[176:179], a[16:19]
v_mfma_f32_16x16x32_bf16 a[20:23], a[148:151], a[176:179], a[20:23]
ds_read_b64_tr_b16 a[220:221], v222 offset:0
ds_read_b64_tr_b16 a[222:223], v222 offset:1024
v_mfma_f32_16x16x32_bf16 a[52:55], a[148:151], a[180:183], a[52:55]
v_mfma_f32_16x16x32_bf16 a[48:51], a[144:147], a[180:183], a[48:51]
buffer_load_dwordx4 v198, s[12:15], s70 offen offset:2048 lds
v_mfma_f32_16x16x32_bf16 a[80:83], a[144:147], a[184:187], a[80:83]
v_mfma_f32_16x16x32_bf16 a[84:87], a[148:151], a[184:187], a[84:87]
v_mfma_f32_16x16x32_bf16 a[116:119], a[148:151], a[188:191], a[116:119]
v_mfma_f32_16x16x32_bf16 a[112:115], a[144:147], a[188:191], a[112:115]
buffer_load_dwordx4 v199, s[12:15], s70 offen offset:3072 lds
v_mfma_f32_16x16x32_bf16 a[120:123], a[152:155], a[188:191], a[120:123]
s_add_u32 m0, s32, 36864
v_mfma_f32_16x16x32_bf16 a[124:127], a[156:159], a[188:191], a[124:127]
v_mfma_f32_16x16x32_bf16 a[92:95], a[156:159], a[184:187], a[92:95]
v_mfma_f32_16x16x32_bf16 a[88:91], a[152:155], a[184:187], a[88:91]
buffer_load_dwordx4 v196, s[12:15], s71 offen offset:0 lds
v_mfma_f32_16x16x32_bf16 a[56:59], a[152:155], a[180:183], a[56:59]
v_mfma_f32_16x16x32_bf16 a[60:63], a[156:159], a[180:183], a[60:63]
v_mfma_f32_16x16x32_bf16 a[28:31], a[156:159], a[176:179], a[28:31]
v_mfma_f32_16x16x32_bf16 a[24:27], a[152:155], a[176:179], a[24:27]
v_mfma_f32_16x16x32_bf16 v[120:123], a[152:155], a[172:175], v[120:123]
buffer_load_dwordx4 v197, s[12:15], s71 offen offset:1024 lds
v_mfma_f32_16x16x32_bf16 v[124:127], a[156:159], a[172:175], v[124:127]
v_mfma_f32_16x16x32_bf16 v[92:95], a[156:159], a[168:171], v[92:95]
v_mfma_f32_16x16x32_bf16 v[88:91], a[152:155], a[168:171], v[88:91]
v_mfma_f32_16x16x32_bf16 v[56:59], a[152:155], a[164:167], v[56:59]
buffer_load_dwordx4 v198, s[12:15], s71 offen offset:2048 lds
v_mfma_f32_16x16x32_bf16 v[60:63], a[156:159], a[164:167], v[60:63]
v_mfma_f32_16x16x32_bf16 v[28:31], a[156:159], a[160:163], v[28:31]
v_mfma_f32_16x16x32_bf16 v[24:27], a[152:155], a[160:163], v[24:27]
s_waitcnt vmcnt(15) lgkmcnt(0)
v_mfma_f32_16x16x32_bf16 v[0:3], a[192:195], a[224:227], v[0:3]
v_mfma_f32_16x16x32_bf16 v[4:7], a[196:199], a[224:227], v[4:7]
buffer_load_dwordx4 v199, s[12:15], s71 offen offset:3072 lds
v_mfma_f32_16x16x32_bf16 v[36:39], a[196:199], a[228:231], v[36:39]
s_add_u32 s68, s68, 128
ds_read_b128 a[160:163], v203 offset:0
s_add_u32 s69, s69, 128
v_mfma_f32_16x16x32_bf16 v[32:35], a[192:195], a[228:231], v[32:35]
s_add_u32 s70, s70, 524288
v_lshlrev_b32 v128, 16, v224
v_and_b32 v129, 0xffff0000, v224
v_mfma_f32_16x16x32_bf16 v[64:67], a[192:195], a[232:235], v[64:67]
s_add_u32 s71, s71, 524288
ds_read_b128 a[164:167], v203 offset:2048
v_lshlrev_b32 v130, 16, v225
v_mfma_f32_16x16x32_bf16 v[68:71], a[196:199], a[232:235], v[68:71]
s_mov_b32 m0, 155648
v_and_b32 v131, 0xffff0000, v225
v_lshlrev_b32 v132, 16, v226
v_mfma_f32_16x16x32_bf16 v[100:103], a[196:199], a[236:239], v[100:103]
buffer_load_dword v254, s[8:11], s34 offen offset:512 lds
v_mfma_f32_16x16x32_bf16 v[96:99], a[192:195], a[236:239], v[96:99]
ds_read_b128 a[168:171], v203 offset:4096
v_and_b32 v133, 0xffff0000, v226
v_mfma_f32_16x16x32_bf16 a[0:3], a[192:195], a[240:243], a[0:3]
v_lshlrev_b32 v134, 16, v227
v_and_b32 v135, 0xffff0000, v227
v_mfma_f32_16x16x32_bf16 a[4:7], a[196:199], a[240:243], a[4:7]
ds_read_b128 a[172:175], v203 offset:6144
v_lshlrev_b32 v136, 16, v228
v_mfma_f32_16x16x32_bf16 a[36:39], a[196:199], a[244:247], a[36:39]
v_and_b32 v137, 0xffff0000, v228
v_lshlrev_b32 v138, 16, v229
v_mfma_f32_16x16x32_bf16 a[32:35], a[192:195], a[244:247], a[32:35]
ds_read_b128 a[176:179], v203 offset:8192
v_and_b32 v139, 0xffff0000, v229
v_mfma_f32_16x16x32_bf16 a[64:67], a[192:195], a[248:251], a[64:67]
v_lshlrev_b32 v140, 16, v230
v_and_b32 v141, 0xffff0000, v230
v_mfma_f32_16x16x32_bf16 a[68:71], a[196:199], a[248:251], a[68:71]
buffer_load_dword v255, s[12:15], s35 offen lds
v_mfma_f32_16x16x32_bf16 a[100:103], a[196:199], a[252:255], a[100:103]
s_add_u32 s35, s35, 524288
ds_read_b128 a[180:183], v203 offset:10240
v_lshlrev_b32 v142, 16, v231
v_mfma_f32_16x16x32_bf16 a[96:99], a[192:195], a[252:255], a[96:99]
v_and_b32 v143, 0xffff0000, v231
v_lshlrev_b32 v144, 16, v232
v_mfma_f32_16x16x32_bf16 a[104:107], a[200:203], a[252:255], a[104:107]
ds_read_b128 a[184:187], v203 offset:12288
v_and_b32 v145, 0xffff0000, v232
v_mfma_f32_16x16x32_bf16 a[108:111], a[204:207], a[252:255], a[108:111]
v_lshlrev_b32 v146, 16, v233
v_and_b32 v147, 0xffff0000, v233
v_mfma_f32_16x16x32_bf16 a[76:79], a[204:207], a[248:251], a[76:79]
ds_read_b128 a[188:191], v203 offset:14336
v_lshlrev_b32 v148, 16, v234
v_mfma_f32_16x16x32_bf16 a[72:75], a[200:203], a[248:251], a[72:75]
v_and_b32 v149, 0xffff0000, v234
v_lshlrev_b32 v150, 16, v235
v_mfma_f32_16x16x32_bf16 a[40:43], a[200:203], a[244:247], a[40:43]
ds_read_b64_tr_b16 a[128:129], v212 offset:8192
v_and_b32 v151, 0xffff0000, v235
v_mfma_f32_16x16x32_bf16 a[44:47], a[204:207], a[244:247], a[44:47]
v_lshlrev_b32 v152, 16, v236
v_and_b32 v153, 0xffff0000, v236
v_mfma_f32_16x16x32_bf16 a[12:15], a[204:207], a[240:243], a[12:15]
ds_read_b64_tr_b16 a[130:131], v212 offset:9216
v_lshlrev_b32 v154, 16, v237
v_mfma_f32_16x16x32_bf16 a[8:11], a[200:203], a[240:243], a[8:11]
v_and_b32 v155, 0xffff0000, v237
v_lshlrev_b32 v156, 16, v238
v_mfma_f32_16x16x32_bf16 v[104:107], a[200:203], a[236:239], v[104:107]
ds_read_b64_tr_b16 a[132:133], v213 offset:8192
v_and_b32 v157, 0xffff0000, v238
v_mfma_f32_16x16x32_bf16 v[108:111], a[204:207], a[236:239], v[108:111]
v_lshlrev_b32 v158, 16, v239
v_and_b32 v159, 0xffff0000, v239
v_mfma_f32_16x16x32_bf16 v[76:79], a[204:207], a[232:235], v[76:79]
ds_read_b64_tr_b16 a[134:135], v213 offset:9216
v_lshlrev_b32 v160, 16, v240
v_mfma_f32_16x16x32_bf16 v[72:75], a[200:203], a[232:235], v[72:75]
v_and_b32 v161, 0xffff0000, v240
v_lshlrev_b32 v162, 16, v241
v_mfma_f32_16x16x32_bf16 v[40:43], a[200:203], a[228:231], v[40:43]
ds_read_b64_tr_b16 a[136:137], v214 offset:8192
v_and_b32 v163, 0xffff0000, v241
v_mfma_f32_16x16x32_bf16 v[44:47], a[204:207], a[228:231], v[44:47]
ds_read_b64_tr_b16 a[138:139], v214 offset:9216
v_lshlrev_b32 v164, 16, v242
v_mfma_f32_16x16x32_bf16 v[12:15], a[204:207], a[224:227], v[12:15]
v_and_b32 v165, 0xffff0000, v242
v_lshlrev_b32 v166, 16, v243
v_mfma_f32_16x16x32_bf16 v[8:11], a[200:203], a[224:227], v[8:11]
ds_read_b64_tr_b16 a[140:141], v215 offset:8192
v_and_b32 v167, 0xffff0000, v243
v_mfma_f32_16x16x32_bf16 v[16:19], a[208:211], a[224:227], v[16:19]
v_add_f32 v248, v128, v129
v_add_f32 v248, v248, v130
v_mfma_f32_16x16x32_bf16 v[20:23], a[212:215], a[224:227], v[20:23]
ds_read_b64_tr_b16 a[142:143], v215 offset:9216
v_add_f32 v248, v248, v131
v_mfma_f32_16x16x32_bf16 v[52:55], a[212:215], a[228:231], v[52:55]
v_add_f32 v248, v248, v132
v_add_f32 v248, v248, v133
v_mfma_f32_16x16x32_bf16 v[48:51], a[208:211], a[228:231], v[48:51]
ds_read_b64_tr_b16 a[144:145], v217 offset:8192
v_add_f32 v248, v248, v134
v_mfma_f32_16x16x32_bf16 v[80:83], a[208:211], a[232:235], v[80:83]
v_add_f32 v248, v248, v135
v_add_f32 v248, v248, v136
v_mfma_f32_16x16x32_bf16 v[84:87], a[212:215], a[232:235], v[84:87]
v_add_f32 v248, v248, v137
v_add_f32 v248, v248, v138
v_mfma_f32_16x16x32_bf16 v[116:119], a[212:215], a[236:239], v[116:119]
ds_read_b64_tr_b16 a[146:147], v217 offset:9216
v_add_f32 v248, v248, v139
v_mfma_f32_16x16x32_bf16 v[112:115], a[208:211], a[236:239], v[112:115]
v_add_f32 v248, v248, v140
v_add_f32 v248, v248, v141
v_mfma_f32_16x16x32_bf16 a[16:19], a[208:211], a[240:243], a[16:19]
ds_read_b64_tr_b16 a[148:149], v218 offset:8192
v_add_f32 v248, v248, v142
v_mfma_f32_16x16x32_bf16 a[20:23], a[212:215], a[240:243], a[20:23]
ds_read_b64_tr_b16 a[150:151], v218 offset:9216
v_add_f32 v248, v248, v143
v_mfma_f32_16x16x32_bf16 a[52:55], a[212:215], a[244:247], a[52:55]
v_add_f32 v248, v248, v144
v_add_f32 v248, v248, v145
v_mfma_f32_16x16x32_bf16 a[48:51], a[208:211], a[244:247], a[48:51]
ds_read_b64_tr_b16 a[152:153], v221 offset:8192
v_add_f32 v248, v248, v146
v_mfma_f32_16x16x32_bf16 a[80:83], a[208:211], a[248:251], a[80:83]
v_add_f32 v248, v248, v147
v_add_f32 v248, v248, v148
v_mfma_f32_16x16x32_bf16 a[84:87], a[212:215], a[248:251], a[84:87]
ds_read_b64_tr_b16 a[154:155], v221 offset:9216
v_add_f32 v248, v248, v149
v_mfma_f32_16x16x32_bf16 a[116:119], a[212:215], a[252:255], a[116:119]
v_add_f32 v248, v248, v150
v_add_f32 v248, v248, v151
v_mfma_f32_16x16x32_bf16 a[112:115], a[208:211], a[252:255], a[112:115]
ds_read_b64_tr_b16 a[156:157], v222 offset:8192
v_add_f32 v248, v248, v152
v_mfma_f32_16x16x32_bf16 a[120:123], a[216:219], a[252:255], a[120:123]
v_add_f32 v248, v248, v153
v_add_f32 v248, v248, v154
v_mfma_f32_16x16x32_bf16 a[124:127], a[220:223], a[252:255], a[124:127]
ds_read_b64_tr_b16 a[158:159], v222 offset:9216
v_add_f32 v248, v248, v155
v_mfma_f32_16x16x32_bf16 a[92:95], a[220:223], a[248:251], a[92:95]
v_add_f32 v248, v248, v156
v_add_f32 v248, v248, v157
v_mfma_f32_16x16x32_bf16 a[88:91], a[216:219], a[248:251], a[88:91]
v_add_f32 v248, v248, v158
v_add_f32 v248, v248, v159
v_mfma_f32_16x16x32_bf16 a[56:59], a[216:219], a[244:247], a[56:59]
v_add_f32 v248, v248, v160
v_add_f32 v248, v248, v161
v_mfma_f32_16x16x32_bf16 a[60:63], a[220:223], a[244:247], a[60:63]
v_add_f32 v248, v248, v162
v_add_f32 v248, v248, v163
v_mfma_f32_16x16x32_bf16 a[28:31], a[220:223], a[240:243], a[28:31]
v_add_f32 v248, v248, v164
v_add_f32 v248, v248, v165
v_mfma_f32_16x16x32_bf16 a[24:27], a[216:219], a[240:243], a[24:27]
v_add_f32 v248, v248, v166
v_add_f32 v248, v248, v167
v_mfma_f32_16x16x32_bf16 v[120:123], a[216:219], a[236:239], v[120:123]
s_nop 1
v_add_f32_dpp v248, v248, v248 row_ror:4 row_mask:0xf bank_mask:0xf
v_mfma_f32_16x16x32_bf16 v[124:127], a[220:223], a[236:239], v[124:127]
s_nop 1
v_add_f32_dpp v248, v248, v248 row_ror:8 row_mask:0xf bank_mask:0xf
v_mfma_f32_16x16x32_bf16 v[92:95], a[220:223], a[232:235], v[92:95]
v_mov_b32 v250, v248
s_nop 1
v_mfma_f32_16x16x32_bf16 v[88:91], a[216:219], a[232:235], v[88:91]
v_permlane32_swap_b32 v248, v250
v_add_f32 v248, v248, v250
v_mfma_f32_16x16x32_bf16 v[56:59], a[216:219], a[228:231], v[56:59]
v_mov_b32 v250, v248
s_nop 1
v_mfma_f32_16x16x32_bf16 v[60:63], a[220:223], a[228:231], v[60:63]
v_permlane16_swap_b32 v248, v250
v_add_f32 v248, v248, v250
v_mfma_f32_16x16x32_bf16 v[28:31], a[220:223], a[224:227], v[28:31]
v_mul_f32 v248, 0x3acccccd, v248
v_mfma_f32_16x16x32_bf16 v[24:27], a[216:219], a[224:227], v[24:27]
s_waitcnt vmcnt(2) lgkmcnt(0)
v_mfma_f32_16x16x32_bf16 v[0:3], a[128:131], a[160:163], v[0:3]
s_barrier
v_mfma_f32_16x16x32_bf16 v[4:7], a[132:135], a[160:163], v[4:7]
s_add_u32 m0, s32, 65536
ds_read_b128 a[224:227], v200 offset:0
v_sub_f32 v128, v128, v248
v_mfma_f32_16x16x32_bf16 v[36:39], a[132:135], a[164:167], v[36:39]
buffer_load_dwordx4 v192, s[8:11], s68 offen offset:0 lds
v_mfma_f32_16x16x32_bf16 v[32:35], a[128:131], a[164:167], v[32:35]
ds_read_b128 a[228:231], v200 offset:2048
v_sub_f32 v129, v129, v248
v_mfma_f32_16x16x32_bf16 v[64:67], a[128:131], a[168:171], v[64:67]
buffer_load_dwordx4 v193, s[8:11], s68 offen offset:1024 lds
v_mfma_f32_16x16x32_bf16 v[68:71], a[132:135], a[168:171], v[68:71]
v_sub_f32 v130, v130, v248
v_sub_f32 v131, v131, v248
v_mfma_f32_16x16x32_bf16 v[100:103], a[132:135], a[172:175], v[100:103]
ds_read_b128 a[232:235], v200 offset:4096
v_sub_f32 v132, v132, v248
v_mfma_f32_16x16x32_bf16 v[96:99], a[128:131], a[172:175], v[96:99]
ds_read_b128 a[236:239], v200 offset:6144
v_sub_f32 v133, v133, v248
v_mfma_f32_16x16x32_bf16 a[0:3], a[128:131], a[176:179], a[0:3]
buffer_load_dwordx4 v194, s[8:11], s68 offen offset:2048 lds
v_mfma_f32_16x16x32_bf16 a[4:7], a[132:135], a[176:179], a[4:7]
v_sub_f32 v134, v134, v248
v_sub_f32 v135, v135, v248
v_mfma_f32_16x16x32_bf16 a[36:39], a[132:135], a[180:183], a[36:39]
ds_read_b128 a[240:243], v200 offset:8192
v_sub_f32 v136, v136, v248
v_mfma_f32_16x16x32_bf16 a[32:35], a[128:131], a[180:183], a[32:35]
ds_read_b128 a[244:247], v200 offset:10240
v_sub_f32 v137, v137, v248
v_mfma_f32_16x16x32_bf16 a[64:67], a[128:131], a[184:187], a[64:67]
buffer_load_dwordx4 v195, s[8:11], s68 offen offset:3072 lds
v_mfma_f32_16x16x32_bf16 a[68:71], a[132:135], a[184:187], a[68:71]
s_add_u32 m0, s32, 69632
v_sub_f32 v138, v138, v248
v_sub_f32 v139, v139, v248
v_mfma_f32_16x16x32_bf16 a[100:103], a[132:135], a[188:191], a[100:103]
ds_read_b128 a[248:251], v200 offset:12288
v_sub_f32 v140, v140, v248
v_mfma_f32_16x16x32_bf16 a[96:99], a[128:131], a[188:191], a[96:99]
ds_read_b128 a[252:255], v200 offset:14336
v_sub_f32 v141, v141, v248
v_mfma_f32_16x16x32_bf16 a[104:107], a[136:139], a[188:191], a[104:107]
ds_read_b64_tr_b16 a[192:193], v204 offset:0
v_sub_f32 v142, v142, v248
v_mfma_f32_16x16x32_bf16 a[108:111], a[140:143], a[188:191], a[108:111]
buffer_load_dwordx4 v192, s[8:11], s69 offen offset:0 lds
v_mfma_f32_16x16x32_bf16 a[76:79], a[140:143], a[184:187], a[76:79]
v_sub_f32 v143, v143, v248
v_sub_f32 v144, v144, v248
v_mfma_f32_16x16x32_bf16 a[72:75], a[136:139], a[184:187], a[72:75]
ds_read_b64_tr_b16 a[194:195], v204 offset:1024
v_sub_f32 v145, v145, v248
v_mfma_f32_16x16x32_bf16 a[40:43], a[136:139], a[180:183], a[40:43]
ds_read_b64_tr_b16 a[196:197], v205 offset:0
v_sub_f32 v146, v146, v248
v_mfma_f32_16x16x32_bf16 a[44:47], a[140:143], a[180:183], a[44:47]
buffer_load_dwordx4 v193, s[8:11], s69 offen offset:1024 lds
v_mfma_f32_16x16x32_bf16 a[12:15], a[140:143], a[176:179], a[12:15]
v_sub_f32 v147, v147, v248
v_sub_f32 v148, v148, v248
v_mfma_f32_16x16x32_bf16 a[8:11], a[136:139], a[176:179], a[8:11]
ds_read_b64_tr_b16 a[198:199], v205 offset:1024
v_sub_f32 v149, v149, v248
v_mfma_f32_16x16x32_bf16 v[104:107], a[136:139], a[172:175], v[104:107]
ds_read_b64_tr_b16 a[200:201], v206 offset:0
v_sub_f32 v150, v150, v248
v_mfma_f32_16x16x32_bf16 v[108:111], a[140:143], a[172:175], v[108:111]
buffer_load_dwordx4 v194, s[8:11], s69 offen offset:2048 lds
v_mfma_f32_16x16x32_bf16 v[76:79], a[140:143], a[168:171], v[76:79]
ds_read_b64_tr_b16 a[202:203], v206 offset:1024
v_sub_f32 v151, v151, v248
v_mfma_f32_16x16x32_bf16 v[72:75], a[136:139], a[168:171], v[72:75]
v_sub_f32 v152, v152, v248
v_sub_f32 v153, v153, v248
v_mfma_f32_16x16x32_bf16 v[40:43], a[136:139], a[164:167], v[40:43]
ds_read_b64_tr_b16 a[204:205], v207 offset:0
v_sub_f32 v154, v154, v248
v_mfma_f32_16x16x32_bf16 v[44:47], a[140:143], a[164:167], v[44:47]
ds_read_b64_tr_b16 a[206:207], v207 offset:1024
v_sub_f32 v155, v155, v248
v_mfma_f32_16x16x32_bf16 v[12:15], a[140:143], a[160:163], v[12:15]
buffer_load_dwordx4 v195, s[8:11], s69 offen offset:3072 lds
v_mfma_f32_16x16x32_bf16 v[8:11], a[136:139], a[160:163], v[8:11]
s_add_u32 m0, s32, 98304
v_sub_f32 v156, v156, v248
v_sub_f32 v157, v157, v248
v_mfma_f32_16x16x32_bf16 v[16:19], a[144:147], a[160:163], v[16:19]
ds_read_b64_tr_b16 a[208:209], v208 offset:0
v_sub_f32 v158, v158, v248
v_mfma_f32_16x16x32_bf16 v[20:23], a[148:151], a[160:163], v[20:23]
v_sub_f32 v159, v159, v248
v_sub_f32 v160, v160, v248
v_mfma_f32_16x16x32_bf16 v[52:55], a[148:151], a[164:167], v[52:55]
buffer_load_dwordx4 v196, s[12:15], s70 offen offset:0 lds
v_mfma_f32_16x16x32_bf16 v[48:51], a[144:147], a[164:167], v[48:51]
ds_read_b64_tr_b16 a[210:211], v208 offset:1024
v_sub_f32 v161, v161, v248
v_mfma_f32_16x16x32_bf16 v[80:83], a[144:147], a[168:171], v[80:83]
ds_read_b64_tr_b16 a[212:213], v209 offset:0
v_sub_f32 v162, v162, v248
v_mfma_f32_16x16x32_bf16 v[84:87], a[148:151], a[168:171], v[84:87]
ds_read_b64_tr_b16 a[214:215], v209 offset:1024
v_sub_f32 v163, v163, v248
v_mfma_f32_16x16x32_bf16 v[116:119], a[148:151], a[172:175], v[116:119]
buffer_load_dwordx4 v197, s[12:15], s70 offen offset:1024 lds
v_mfma_f32_16x16x32_bf16 v[112:115], a[144:147], a[172:175], v[112:115]
Lch0_1:
Lpad1:
s_cbranch_execz Lpad5
v_sub_f32 v164, v164, v248
v_sub_f32 v165, v165, v248
v_mfma_f32_16x16x32_bf16 a[16:19], a[144:147], a[176:179], a[16:19]
ds_read_b64_tr_b16 a[216:217], v210 offset:0
v_sub_f32 v166, v166, v248
v_mfma_f32_16x16x32_bf16 a[20:23], a[148:151], a[176:179], a[20:23]
ds_read_b64_tr_b16 a[218:219], v210 offset:1024
v_sub_f32 v167, v167, v248
v_mfma_f32_16x16x32_bf16 a[52:55], a[148:151], a[180:183], a[52:55]
v_mul_f32 v249, v128, v128
v_fmac_f32 v249, v129, v129
v_mfma_f32_16x16x32_bf16 a[48:51], a[144:147], a[180:183], a[48:51]
buffer_load_dwordx4 v198, s[12:15], s70 offen offset:2048 lds
v_mfma_f32_16x16x32_bf16 a[80:83], a[144:147], a[184:187], a[80:83]
ds_read_b64_tr_b16 a[220:221], v211 offset:0
v_fmac_f32 v249, v130, v130
v_mfma_f32_16x16x32_bf16 a[84:87], a[148:151], a[184:187], a[84:87]
ds_read_b64_tr_b16 a[222:223], v211 offset:1024
v_fmac_f32 v249, v131, v131
v_mfma_f32_16x16x32_bf16 a[116:119], a[148:151], a[188:191], a[116:119]
v_fmac_f32 v249, v132, v132
v_fmac_f32 v249, v133, v133
v_mfma_f32_16x16x32_bf16 a[112:115], a[144:147], a[188:191], a[112:115]
buffer_load_dwordx4 v199, s[12:15], s70 offen offset:3072 lds
v_mfma_f32_16x16x32_bf16 a[120:123], a[152:155], a[188:191], a[120:123]
s_add_u32 m0, s32, 102400
v_fmac_f32 v249, v134, v134
v_fmac_f32 v249, v135, v135
v_mfma_f32_16x16x32_bf16 a[124:127], a[156:159], a[188:191], a[124:127]
v_fmac_f32 v249, v136, v136
v_fmac_f32 v249, v137, v137
v_mfma_f32_16x16x32_bf16 a[92:95], a[156:159], a[184:187], a[92:95]
v_fmac_f32 v249, v138, v138
v_fmac_f32 v249, v139, v139
v_mfma_f32_16x16x32_bf16 a[88:91], a[152:155], a[184:187], a[88:91]
buffer_load_dwordx4 v196, s[12:15], s71 offen offset:0 lds
v_mfma_f32_16x16x32_bf16 a[56:59], a[152:155], a[180:183], a[56:59]
v_fmac_f32 v249, v140, v140
v_fmac_f32 v249, v141, v141
v_mfma_f32_16x16x32_bf16 a[60:63], a[156:159], a[180:183], a[60:63]
v_fmac_f32 v249, v142, v142
v_fmac_f32 v249, v143, v143
v_mfma_f32_16x16x32_bf16 a[28:31], a[156:159], a[176:179], a[28:31]
v_mfma_f32_16x16x32_bf16 a[24:27], a[152:155], a[176:179], a[24:27]
v_fmac_f32 v249, v144, v144
v_fmac_f32 v249, v145, v145
v_mfma_f32_16x16x32_bf16 v[120:123], a[152:155], a[172:175], v[120:123]
buffer_load_dwordx4 v197, s[12:15], s71 offen offset:1024 lds
v_mfma_f32_16x16x32_bf16 v[124:127], a[156:159], a[172:175], v[124:127]
v_fmac_f32 v249, v146, v146
v_fmac_f32 v249, v147, v147
v_mfma_f32_16x16x32_bf16 v[92:95], a[156:159], a[168:171], v[92:95]
v_mfma_f32_16x16x32_bf16 v[88:91], a[152:155], a[168:171], v[88:91]
v_mfma_f32_16x16x32_bf16 v[56:59], a[152:155], a[164:167], v[56:59]
buffer_load_dwordx4 v198, s[12:15], s71 offen offset:2048 lds
v_mfma_f32_16x16x32_bf16 v[60:63], a[156:159], a[164:167], v[60:63]
v_mfma_f32_16x16x32_bf16 v[28:31], a[156:159], a[160:163], v[28:31]
v_mfma_f32_16x16x32_bf16 v[24:27], a[152:155], a[160:163], v[24:27]
s_waitcnt lgkmcnt(0)
v_mfma_f32_16x16x32_bf16 v[0:3], a[192:195], a[224:227], v[0:3]
v_mfma_f32_16x16x32_bf16 v[4:7], a[196:199], a[224:227], v[4:7]
buffer_load_dwordx4 v199, s[12:15], s71 offen offset:3072 lds
v_mfma_f32_16x16x32_bf16 v[36:39], a[196:199], a[228:231], v[36:39]
s_add_u32 s68, s68, 128
ds_read_b128 a[160:163], v201 offset:0
s_add_u32 s69, s69, 128
v_mfma_f32_16x16x32_bf16 v[32:35], a[192:195], a[228:231], v[32:35]
s_add_u32 s70, s70, 524288
s_add_u32 s71, s71, 524288
v_fmac_f32 v249, v148, v148
v_mfma_f32_16x16x32_bf16 v[64:67], a[192:195], a[232:235], v[64:67]
s_mov_b32 m0, 155648
ds_read_b128 a[164:167], v201 offset:2048
v_fmac_f32 v249, v149, v149
v_mfma_f32_16x16x32_bf16 v[68:71], a[196:199], a[232:235], v[68:71]
buffer_load_dword v254, s[8:11], s34 offen offset:640 lds
v_mfma_f32_16x16x32_bf16 v[100:103], a[196:199], a[236:239], v[100:103]
v_fmac_f32 v249, v150, v150
v_fmac_f32 v249, v151, v151
v_mfma_f32_16x16x32_bf16 v[96:99], a[192:195], a[236:239], v[96:99]
ds_read_b128 a[168:171], v201 offset:4096
v_fmac_f32 v249, v152, v152
v_mfma_f32_16x16x32_bf16 a[0:3], a[192:195], a[240:243], a[0:3]
v_fmac_f32 v249, v153, v153
v_fmac_f32 v249, v154, v154
v_mfma_f32_16x16x32_bf16 a[4:7], a[196:199], a[240:243], a[4:7]
ds_read_b128 a[172:175], v201 offset:6144
v_fmac_f32 v249, v155, v155
v_mfma_f32_16x16x32_bf16 a[36:39], a[196:199], a[244:247], a[36:39]
v_fmac_f32 v249, v156, v156
v_fmac_f32 v249, v157, v157
v_mfma_f32_16x16x32_bf16 a[32:35], a[192:195], a[244:247], a[32:35]
ds_read_b128 a[176:179], v201 offset:8192
v_fmac_f32 v249, v158, v158
v_mfma_f32_16x16x32_bf16 a[64:67], a[192:195], a[248:251], a[64:67]
v_fmac_f32 v249, v159, v159
v_fmac_f32 v249, v160, v160
v_mfma_f32_16x16x32_bf16 a[68:71], a[196:199], a[248:251], a[68:71]
buffer_load_dword v255, s[12:15], s35 offen lds
v_mfma_f32_16x16x32_bf16 a[100:103], a[196:199], a[252:255], a[100:103]
s_add_u32 s35, s35, 524288
ds_read_b128 a[180:183], v201 offset:10240
v_fmac_f32 v249, v161, v161
v_mfma_f32_16x16x32_bf16 a[96:99], a[192:195], a[252:255], a[96:99]
v_fmac_f32 v249, v162, v162
v_fmac_f32 v249, v163, v163
v_mfma_f32_16x16x32_bf16 a[104:107], a[200:203], a[252:255], a[104:107]
ds_read_b128 a[184:187], v201 offset:12288
v_fmac_f32 v249, v164, v164
v_mfma_f32_16x16x32_bf16 a[108:111], a[204:207], a[252:255], a[108:111]
ds_read_b128 a[188:191], v201 offset:14336
v_fmac_f32 v249, v165, v165
v_mfma_f32_16x16x32_bf16 a[76:79], a[204:207], a[248:251], a[76:79]
v_fmac_f32 v249, v166, v166
v_fmac_f32 v249, v167, v167
v_mfma_f32_16x16x32_bf16 a[72:75], a[200:203], a[248:251], a[72:75]
ds_read_b64_tr_b16 a[128:129], v204 offset:8192
ds_read_b64_tr_b16 a[130:131], v204 offset:9216
v_mfma_f32_16x16x32_bf16 a[40:43], a[200:203], a[244:247], a[40:43]
s_nop 1
v_add_f32_dpp v249, v249, v249 row_ror:4 row_mask:0xf bank_mask:0xf
v_mfma_f32_16x16x32_bf16 a[44:47], a[204:207], a[244:247], a[44:47]
s_nop 1
v_add_f32_dpp v249, v249, v249 row_ror:8 row_mask:0xf bank_mask:0xf
v_mfma_f32_16x16x32_bf16 a[12:15], a[204:207], a[240:243], a[12:15]
v_mov_b32 v250, v249
s_nop 1
v_mfma_f32_16x16x32_bf16 a[8:11], a[200:203], a[240:243], a[8:11]
ds_read_b64_tr_b16 a[132:133], v205 offset:8192
ds_read_b64_tr_b16 a[134:135], v205 offset:9216
v_mfma_f32_16x16x32_bf16 v[104:107], a[200:203], a[236:239], v[104:107]
v_permlane32_swap_b32 v249, v250
v_add_f32 v249, v249, v250
v_mfma_f32_16x16x32_bf16 v[108:111], a[204:207], a[236:239], v[108:111]
v_mov_b32 v250, v249
s_nop 1
v_mfma_f32_16x16x32_bf16 v[76:79], a[204:207], a[232:235], v[76:79]
v_permlane16_swap_b32 v249, v250
v_add_f32 v249, v249, v250
v_mfma_f32_16x16x32_bf16 v[72:75], a[200:203], a[232:235], v[72:75]
ds_read_b64_tr_b16 a[136:137], v206 offset:8192
v_mov_b32 v250, 0x3727c5ac
v_mfma_f32_16x16x32_bf16 v[40:43], a[200:203], a[228:231], v[40:43]
ds_read_b64_tr_b16 a[138:139], v206 offset:9216
v_fmac_f32 v250, 0x3acccccd, v249
v_mfma_f32_16x16x32_bf16 v[44:47], a[204:207], a[228:231], v[44:47]
v_rsq_f32 v249, v250
s_nop 0
v_mfma_f32_16x16x32_bf16 v[12:15], a[204:207], a[224:227], v[12:15]
ds_read_b64_tr_b16 a[140:141], v207 offset:8192
v_mul_f32 v128, v249, v128
v_mfma_f32_16x16x32_bf16 v[8:11], a[200:203], a[224:227], v[8:11]
v_mul_f32 v129, v249, v129
v_mul_f32 v130, v249, v130
v_mfma_f32_16x16x32_bf16 v[16:19], a[208:211], a[224:227], v[16:19]
ds_read_b64_tr_b16 a[142:143], v207 offset:9216
v_mul_f32 v131, v249, v131
v_mfma_f32_16x16x32_bf16 v[20:23], a[212:215], a[224:227], v[20:23]
ds_read_b64_tr_b16 a[144:145], v208 offset:8192
v_mul_f32 v132, v249, v132
v_mfma_f32_16x16x32_bf16 v[52:55], a[212:215], a[228:231], v[52:55]
v_mul_f32 v133, v249, v133
v_mul_f32 v134, v249, v134
v_mfma_f32_16x16x32_bf16 v[48:51], a[208:211], a[228:231], v[48:51]
ds_read_b64_tr_b16 a[146:147], v208 offset:9216
v_mul_f32 v135, v249, v135
v_mfma_f32_16x16x32_bf16 v[80:83], a[208:211], a[232:235], v[80:83]
v_mul_f32 v136, v249, v136
v_mul_f32 v137, v249, v137
v_mfma_f32_16x16x32_bf16 v[84:87], a[212:215], a[232:235], v[84:87]
ds_read_b64_tr_b16 a[148:149], v209 offset:8192
v_mul_f32 v138, v249, v138
v_mfma_f32_16x16x32_bf16 v[116:119], a[212:215], a[236:239], v[116:119]
v_mul_f32 v139, v249, v139
v_mul_f32 v140, v249, v140
v_mfma_f32_16x16x32_bf16 v[112:115], a[208:211], a[236:239], v[112:115]
ds_read_b64_tr_b16 a[150:151], v209 offset:9216
v_mul_f32 v141, v249, v141
v_mfma_f32_16x16x32_bf16 a[16:19], a[208:211], a[240:243], a[16:19]
ds_read_b64_tr_b16 a[152:153], v210 offset:8192
v_mul_f32 v142, v249, v142
v_mfma_f32_16x16x32_bf16 a[20:23], a[212:215], a[240:243], a[20:23]
v_mul_f32 v143, v249, v143
v_mul_f32 v144, v249, v144
v_mfma_f32_16x16x32_bf16 a[52:55], a[212:215], a[244:247], a[52:55]
ds_read_b64_tr_b16 a[154:155], v210 offset:9216
v_mul_f32 v145, v249, v145
v_mfma_f32_16x16x32_bf16 a[48:51], a[208:211], a[244:247], a[48:51]
v_mul_f32 v146, v249, v146
v_mul_f32 v147, v249, v147
v_mfma_f32_16x16x32_bf16 a[80:83], a[208:211], a[248:251], a[80:83]
ds_read_b64_tr_b16 a[156:157], v211 offset:8192
v_mul_f32 v148, v249, v148
v_mfma_f32_16x16x32_bf16 a[84:87], a[212:215], a[248:251], a[84:87]
v_mul_f32 v149, v249, v149
v_mul_f32 v150, v249, v150
v_mfma_f32_16x16x32_bf16 a[116:119], a[212:215], a[252:255], a[116:119]
ds_read_b64_tr_b16 a[158:159], v211 offset:9216
v_mul_f32 v151, v249, v151
v_mfma_f32_16x16x32_bf16 a[112:115], a[208:211], a[252:255], a[112:115]
v_mul_f32 v152, v249, v152
v_mul_f32 v153, v249, v153
v_mfma_f32_16x16x32_bf16 a[120:123], a[216:219], a[252:255], a[120:123]
v_mul_f32 v154, v249, v154
v_mul_f32 v155, v249, v155
v_mfma_f32_16x16x32_bf16 a[124:127], a[220:223], a[252:255], a[124:127]
v_mul_f32 v156, v249, v156
v_mul_f32 v157, v249, v157
v_mfma_f32_16x16x32_bf16 a[92:95], a[220:223], a[248:251], a[92:95]
v_mul_f32 v158, v249, v158
v_mul_f32 v159, v249, v159
v_mfma_f32_16x16x32_bf16 a[88:91], a[216:219], a[248:251], a[88:91]
v_mul_f32 v160, v249, v160
v_mul_f32 v161, v249, v161
v_mfma_f32_16x16x32_bf16 a[56:59], a[216:219], a[244:247], a[56:59]
v_mul_f32 v162, v249, v162
v_mul_f32 v163, v249, v163
v_mfma_f32_16x16x32_bf16 a[60:63], a[220:223], a[244:247], a[60:63]
v_mul_f32 v164, v249, v164
v_mul_f32 v165, v249, v165
v_mfma_f32_16x16x32_bf16 a[28:31], a[220:223], a[240:243], a[28:31]
v_mul_f32 v166, v249, v166
v_mul_f32 v167, v249, v167
v_mfma_f32_16x16x32_bf16 a[24:27], a[216:219], a[240:243], a[24:27]
s_add_u32 s24, s66, 1048576
s_addc_u32 s25, s67, 0
v_mfma_f32_16x16x32_bf16 v[120:123], a[216:219], a[236:239], v[120:123]
s_and_b32 s25, s25, 0xffff
s_mov_b32 s26, 2621440
s_mov_b32 s27, 0x20000
v_mfma_f32_16x16x32_bf16 v[124:127], a[220:223], a[236:239], v[124:127]
s_add_u32 s79, s78, 4096
v_mfma_f32_16x16x32_bf16 v[92:95], a[220:223], a[232:235], v[92:95]
v_mfma_f32_16x16x32_bf16 v[88:91], a[216:219], a[232:235], v[88:91]
v_mfma_f32_16x16x32_bf16 v[56:59], a[216:219], a[228:231], v[56:59]
v_mfma_f32_16x16x32_bf16 v[60:63], a[220:223], a[228:231], v[60:63]
v_mfma_f32_16x16x32_bf16 v[28:31], a[220:223], a[224:227], v[28:31]
v_mfma_f32_16x16x32_bf16 v[24:27], a[216:219], a[224:227], v[24:27]
s_waitcnt vmcnt(2) lgkmcnt(0)
v_mfma_f32_16x16x32_bf16 v[0:3], a[128:131], a[160:163], v[0:3]
s_barrier
v_mfma_f32_16x16x32_bf16 v[4:7], a[132:135], a[160:163], v[4:7]
s_add_u32 m0, s32, 0
ds_read_b128 a[224:227], v202 offset:0
ds_read_b128 a[228:231], v202 offset:2048
v_mfma_f32_16x16x32_bf16 v[36:39], a[132:135], a[164:167], v[36:39]
buffer_load_dwordx4 v192, s[8:11], s68 offen offset:0 lds
v_mfma_f32_16x16x32_bf16 v[32:35], a[128:131], a[164:167], v[32:35]
v_mfma_f32_16x16x32_bf16 v[64:67], a[128:131], a[168:171], v[64:67]
buffer_load_dwordx4 v193, s[8:11], s68 offen offset:1024 lds
v_mfma_f32_16x16x32_bf16 v[68:71], a[132:135], a[168:171], v[68:71]
ds_read_b128 a[232:235], v202 offset:4096
ds_read_b128 a[236:239], v202 offset:6144
v_mfma_f32_16x16x32_bf16 v[100:103], a[132:135], a[172:175], v[100:103]
v_mfma_f32_16x16x32_bf16 v[96:99], a[128:131], a[172:175], v[96:99]
v_mfma_f32_16x16x32_bf16 a[0:3], a[128:131], a[176:179], a[0:3]
buffer_load_dwordx4 v194, s[8:11], s68 offen offset:2048 lds
v_mfma_f32_16x16x32_bf16 a[4:7], a[132:135], a[176:179], a[4:7]
ds_read_b128 a[240:243], v202 offset:8192
ds_read_b128 a[244:247], v202 offset:10240
v_mfma_f32_16x16x32_bf16 a[36:39], a[132:135], a[180:183], a[36:39]
v_mfma_f32_16x16x32_bf16 a[32:35], a[128:131], a[180:183], a[32:35]
v_mfma_f32_16x16x32_bf16 a[64:67], a[128:131], a[184:187], a[64:67]
buffer_load_dwordx4 v195, s[8:11], s68 offen offset:3072 lds
v_mfma_f32_16x16x32_bf16 a[68:71], a[132:135], a[184:187], a[68:71]
s_add_u32 m0, s32, 4096
ds_read_b128 a[248:251], v202 offset:12288
ds_read_b128 a[252:255], v202 offset:14336
v_mfma_f32_16x16x32_bf16 a[100:103], a[132:135], a[188:191], a[100:103]
v_mfma_f32_16x16x32_bf16 a[96:99], a[128:131], a[188:191], a[96:99]
ds_read_b64_tr_b16 a[192:193], v212 offset:0
ds_read_b64_tr_b16 a[194:195], v212 offset:1024
v_mfma_f32_16x16x32_bf16 a[104:107], a[136:139], a[188:191], a[104:107]
v_mfma_f32_16x16x32_bf16 a[108:111], a[140:143], a[188:191], a[108:111]
buffer_load_dwordx4 v192, s[8:11], s69 offen offset:0 lds
v_mfma_f32_16x16x32_bf16 a[76:79], a[140:143], a[184:187], a[76:79]
v_mfma_f32_16x16x32_bf16 a[72:75], a[136:139], a[184:187], a[72:75]
ds_read_b64_tr_b16 a[196:197], v213 offset:0
ds_read_b64_tr_b16 a[198:199], v213 offset:1024
v_mfma_f32_16x16x32_bf16 a[40:43], a[136:139], a[180:183], a[40:43]
v_mfma_f32_16x16x32_bf16 a[44:47], a[140:143], a[180:183], a[44:47]
buffer_load_dwordx4 v193, s[8:11], s69 offen offset:1024 lds
v_mfma_f32_16x16x32_bf16 a[12:15], a[140:143], a[176:179], a[12:15]
v_mfma_f32_16x16x32_bf16 a[8:11], a[136:139], a[176:179], a[8:11]
ds_read_b64_tr_b16 a[200:201], v214 offset:0
ds_read_b64_tr_b16 a[202:203], v214 offset:1024
v_mfma_f32_16x16x32_bf16 v[104:107], a[136:139], a[172:175], v[104:107]
v_mfma_f32_16x16x32_bf16 v[108:111], a[140:143], a[172:175], v[108:111]
buffer_load_dwordx4 v194, s[8:11], s69 offen offset:2048 lds
v_mfma_f32_16x16x32_bf16 v[76:79], a[140:143], a[168:171], v[76:79]
ds_read_b64_tr_b16 a[204:205], v215 offset:0
ds_read_b64_tr_b16 a[206:207], v215 offset:1024
v_mfma_f32_16x16x32_bf16 v[72:75], a[136:139], a[168:171], v[72:75]
v_mfma_f32_16x16x32_bf16 v[40:43], a[136:139], a[164:167], v[40:43]
v_mfma_f32_16x16x32_bf16 v[44:47], a[140:143], a[164:167], v[44:47]
v_mfma_f32_16x16x32_bf16 v[12:15], a[140:143], a[160:163], v[12:15]
buffer_load_dwordx4 v195, s[8:11], s69 offen offset:3072 lds
v_mfma_f32_16x16x32_bf16 v[8:11], a[136:139], a[160:163], v[8:11]
s_add_u32 m0, s32, 32768
ds_read_b64_tr_b16 a[208:209], v217 offset:0
ds_read_b64_tr_b16 a[210:211], v217 offset:1024
v_mfma_f32_16x16x32_bf16 v[16:19], a[144:147], a[160:163], v[16:19]
v_mfma_f32_16x16x32_bf16 v[20:23], a[148:151], a[160:163], v[20:23]
v_mfma_f32_16x16x32_bf16 v[52:55], a[148:151], a[164:167], v[52:55]
buffer_load_dwordx4 v196, s[12:15], s70 offen offset:0 lds
v_mfma_f32_16x16x32_bf16 v[48:51], a[144:147], a[164:167], v[48:51]
ds_read_b64_tr_b16 a[212:213], v218 offset:0
ds_read_b64_tr_b16 a[214:215], v218 offset:1024
v_mfma_f32_16x16x32_bf16 v[80:83], a[144:147], a[168:171], v[80:83]
v_mfma_f32_16x16x32_bf16 v[84:87], a[148:151], a[168:171], v[84:87]
ds_read_b64_tr_b16 a[216:217], v221 offset:0
ds_read_b64_tr_b16 a[218:219], v221 offset:1024
v_mfma_f32_16x16x32_bf16 v[116:119], a[148:151], a[172:175], v[116:119]
buffer_load_dwordx4 v197, s[12:15], s70 offen offset:1024 lds
v_mfma_f32_16x16x32_bf16 v[112:115], a[144:147], a[172:175], v[112:115]
v_mfma_f32_16x16x32_bf16 a[16:19], a[144:147], a[176:179], a[16:19]
v_mfma_f32_16x16x32_bf16 a[20:23], a[148:151], a[176:179], a[20:23]
ds_read_b64_tr_b16 a[220:221], v222 offset:0
ds_read_b64_tr_b16 a[222:223], v222 offset:1024
v_mfma_f32_16x16x32_bf16 a[52:55], a[148:151], a[180:183], a[52:55]
v_mfma_f32_16x16x32_bf16 a[48:51], a[144:147], a[180:183], a[48:51]
buffer_load_dwordx4 v198, s[12:15], s70 offen offset:2048 lds
v_mfma_f32_16x16x32_bf16 a[80:83], a[144:147], a[184:187], a[80:83]
v_mfma_f32_16x16x32_bf16 a[84:87], a[148:151], a[184:187], a[84:87]
v_mfma_f32_16x16x32_bf16 a[116:119], a[148:151], a[188:191], a[116:119]
v_mfma_f32_16x16x32_bf16 a[112:115], a[144:147], a[188:191], a[112:115]
buffer_load_dwordx4 v199, s[12:15], s70 offen offset:3072 lds
v_mfma_f32_16x16x32_bf16 a[120:123], a[152:155], a[188:191], a[120:123]
s_add_u32 m0, s32, 36864
v_mfma_f32_16x16x32_bf16 a[124:127], a[156:159], a[188:191], a[124:127]
v_mfma_f32_16x16x32_bf16 a[92:95], a[156:159], a[184:187], a[92:95]
v_mfma_f32_16x16x32_bf16 a[88:91], a[152:155], a[184:187], a[88:91]
buffer_load_dwordx4 v196, s[12:15], s71 offen offset:0 lds
v_mfma_f32_16x16x32_bf16 a[56:59], a[152:155], a[180:183], a[56:59]
v_mfma_f32_16x16x32_bf16 a[60:63], a[156:159], a[180:183], a[60:63]
v_mfma_f32_16x16x32_bf16 a[28:31], a[156:159], a[176:179], a[28:31]
v_mfma_f32_16x16x32_bf16 a[24:27], a[152:155], a[176:179], a[24:27]
v_mfma_f32_16x16x32_bf16 v[120:123], a[152:155], a[172:175], v[120:123]
buffer_load_dwordx4 v197, s[12:15], s71 offen offset:1024 lds
v_mfma_f32_16x16x32_bf16 v[124:127], a[156:159], a[172:175], v[124:127]
v_mfma_f32_16x16x32_bf16 v[92:95], a[156:159], a[168:171], v[92:95]
v_mfma_f32_16x16x32_bf16 v[88:91], a[152:155], a[168:171], v[88:91]
v_mfma_f32_16x16x32_bf16 v[56:59], a[152:155], a[164:167], v[56:59]
buffer_load_dwordx4 v198, s[12:15], s71 offen offset:2048 lds
v_mfma_f32_16x16x32_bf16 v[60:63], a[156:159], a[164:167], v[60:63]
v_mfma_f32_16x16x32_bf16 v[28:31], a[156:159], a[160:163], v[28:31]
v_mfma_f32_16x16x32_bf16 v[24:27], a[152:155], a[160:163], v[24:27]
s_waitcnt lgkmcnt(0)
v_mfma_f32_16x16x32_bf16 v[0:3], a[192:195], a[224:227], v[0:3]
v_mfma_f32_16x16x32_bf16 v[4:7], a[196:199], a[224:227], v[4:7]
buffer_load_dwordx4 v199, s[12:15], s71 offen offset:3072 lds
v_mfma_f32_16x16x32_bf16 v[36:39], a[196:199], a[228:231], v[36:39]
s_add_u32 s68, s68, 128
ds_read_b128 a[160:163], v203 offset:0
s_add_u32 s69, s69, 128
v_mfma_f32_16x16x32_bf16 v[32:35], a[192:195], a[228:231], v[32:35]
s_add_u32 s70, s70, 524288
ds_read_b128 a[164:167], v203 offset:2048
s_add_u32 s71, s71, 524288
v_mfma_f32_16x16x32_bf16 v[64:67], a[192:195], a[232:235], v[64:67]
s_mov_b32 m0, 155648
ds_read_b128 a[168:171], v203 offset:4096
v_mfma_f32_16x16x32_bf16 v[68:71], a[196:199], a[232:235], v[68:71]
buffer_load_dword v254, s[8:11], s34 offen offset:768 lds
v_mfma_f32_16x16x32_bf16 v[100:103], a[196:199], a[236:239], v[100:103]
ds_read_b128 a[172:175], v203 offset:6144
ds_read_b128 a[176:179], v203 offset:8192
v_mfma_f32_16x16x32_bf16 v[96:99], a[192:195], a[236:239], v[96:99]
v_mfma_f32_16x16x32_bf16 a[0:3], a[192:195], a[240:243], a[0:3]
v_mfma_f32_16x16x32_bf16 a[4:7], a[196:199], a[240:243], a[4:7]
v_mfma_f32_16x16x32_bf16 a[36:39], a[196:199], a[244:247], a[36:39]
ds_read_b128 a[180:183], v203 offset:10240
ds_read_b128 a[184:187], v203 offset:12288
v_mfma_f32_16x16x32_bf16 a[32:35], a[192:195], a[244:247], a[32:35]
v_mfma_f32_16x16x32_bf16 a[64:67], a[192:195], a[248:251], a[64:67]
v_mfma_f32_16x16x32_bf16 a[68:71], a[196:199], a[248:251], a[68:71]
buffer_load_dword v255, s[12:15], s35 offen lds
v_mfma_f32_16x16x32_bf16 a[100:103], a[196:199], a[252:255], a[100:103]
s_add_u32 s35, s35, 524288
ds_read_b128 a[188:191], v203 offset:14336
ds_read_b64_tr_b16 a[128:129], v212 offset:8192
v_mfma_f32_16x16x32_bf16 a[96:99], a[192:195], a[252:255], a[96:99]
v_mfma_f32_16x16x32_bf16 a[104:107], a[200:203], a[252:255], a[104:107]
v_mfma_f32_16x16x32_bf16 a[108:111], a[204:207], a[252:255], a[108:111]
ds_read_b64_tr_b16 a[130:131], v212 offset:9216
ds_read_b64_tr_b16 a[132:133], v213 offset:8192
v_mfma_f32_16x16x32_bf16 a[76:79], a[204:207], a[248:251], a[76:79]
v_mfma_f32_16x16x32_bf16 a[72:75], a[200:203], a[248:251], a[72:75]
v_mfma_f32_16x16x32_bf16 a[40:43], a[200:203], a[244:247], a[40:43]
v_mfma_f32_16x16x32_bf16 a[44:47], a[204:207], a[244:247], a[44:47]
ds_read_b64_tr_b16 a[134:135], v213 offset:9216
ds_read_b64_tr_b16 a[136:137], v214 offset:8192
v_mfma_f32_16x16x32_bf16 a[12:15], a[204:207], a[240:243], a[12:15]
v_mfma_f32_16x16x32_bf16 a[8:11], a[200:203], a[240:243], a[8:11]
v_mfma_f32_16x16x32_bf16 v[104:107], a[200:203], a[236:239], v[104:107]
ds_read_b64_tr_b16 a[138:139], v214 offset:9216
ds_read_b64_tr_b16 a[140:141], v215 offset:8192
v_mfma_f32_16x16x32_bf16 v[108:111], a[204:207], a[236:239], v[108:111]
v_mfma_f32_16x16x32_bf16 v[76:79], a[204:207], a[232:235], v[76:79]
v_mfma_f32_16x16x32_bf16 v[72:75], a[200:203], a[232:235], v[72:75]
v_mfma_f32_16x16x32_bf16 v[40:43], a[200:203], a[228:231], v[40:43]
ds_read_b64_tr_b16 a[142:143], v215 offset:9216
ds_read_b64_tr_b16 a[144:145], v217 offset:8192
v_mfma_f32_16x16x32_bf16 v[44:47], a[204:207], a[228:231], v[44:47]
v_mfma_f32_16x16x32_bf16 v[12:15], a[204:207], a[224:227], v[12:15]
v_mfma_f32_16x16x32_bf16 v[8:11], a[200:203], a[224:227], v[8:11]
v_mfma_f32_16x16x32_bf16 v[16:19], a[208:211], a[224:227], v[16:19]
ds_read_b64_tr_b16 a[146:147], v217 offset:9216
ds_read_b64_tr_b16 a[148:149], v218 offset:8192
v_mfma_f32_16x16x32_bf16 v[20:23], a[212:215], a[224:227], v[20:23]
v_mfma_f32_16x16x32_bf16 v[52:55], a[212:215], a[228:231], v[52:55]
v_mfma_f32_16x16x32_bf16 v[48:51], a[208:211], a[228:231], v[48:51]
ds_read_b64_tr_b16 a[150:151], v218 offset:9216
ds_read_b64_tr_b16 a[152:153], v221 offset:8192
v_mfma_f32_16x16x32_bf16 v[80:83], a[208:211], a[232:235], v[80:83]
v_mfma_f32_16x16x32_bf16 v[84:87], a[212:215], a[232:235], v[84:87]
v_mfma_f32_16x16x32_bf16 v[116:119], a[212:215], a[236:239], v[116:119]
v_mfma_f32_16x16x32_bf16 v[112:115], a[208:211], a[236:239], v[112:115]
ds_read_b64_tr_b16 a[154:155], v221 offset:9216
ds_read_b64_tr_b16 a[156:157], v222 offset:8192
v_mfma_f32_16x16x32_bf16 a[16:19], a[208:211], a[240:243], a[16:19]
v_mfma_f32_16x16x32_bf16 a[20:23], a[212:215], a[240:243], a[20:23]
v_mfma_f32_16x16x32_bf16 a[52:55], a[212:215], a[244:247], a[52:55]
v_mfma_f32_16x16x32_bf16 a[48:51], a[208:211], a[244:247], a[48:51]
ds_read_b64_tr_b16 a[158:159], v222 offset:9216
v_mfma_f32_16x16x32_bf16 a[80:83], a[208:211], a[248:251], a[80:83]
v_mfma_f32_16x16x32_bf16 a[84:87], a[212:215], a[248:251], a[84:87]
v_mfma_f32_16x16x32_bf16 a[116:119], a[212:215], a[252:255], a[116:119]
v_mfma_f32_16x16x32_bf16 a[112:115], a[208:211], a[252:255], a[112:115]
v_mfma_f32_16x16x32_bf16 a[120:123], a[216:219], a[252:255], a[120:123]
v_mfma_f32_16x16x32_bf16 a[124:127], a[220:223], a[252:255], a[124:127]
v_mfma_f32_16x16x32_bf16 a[92:95], a[220:223], a[248:251], a[92:95]
v_mfma_f32_16x16x32_bf16 a[88:91], a[216:219], a[248:251], a[88:91]
v_mfma_f32_16x16x32_bf16 a[56:59], a[216:219], a[244:247], a[56:59]
v_mfma_f32_16x16x32_bf16 a[60:63], a[220:223], a[244:247], a[60:63]
v_mfma_f32_16x16x32_bf16 a[28:31], a[220:223], a[240:243], a[28:31]
v_mfma_f32_16x16x32_bf16 a[24:27], a[216:219], a[240:243], a[24:27]
v_mfma_f32_16x16x32_bf16 v[120:123], a[216:219], a[236:239], v[120:123]
v_mfma_f32_16x16x32_bf16 v[124:127], a[220:223], a[236:239], v[124:127]
v_mfma_f32_16x16x32_bf16 v[92:95], a[220:223], a[232:235], v[92:95]
v_mfma_f32_16x16x32_bf16 v[88:91], a[216:219], a[232:235], v[88:91]
v_mfma_f32_16x16x32_bf16 v[56:59], a[216:219], a[228:231], v[56:59]
v_mfma_f32_16x16x32_bf16 v[60:63], a[220:223], a[228:231], v[60:63]
v_mfma_f32_16x16x32_bf16 v[28:31], a[220:223], a[224:227], v[28:31]
v_mfma_f32_16x16x32_bf16 v[24:27], a[216:219], a[224:227], v[24:27]
s_waitcnt vmcnt(2) lgkmcnt(0)
v_mfma_f32_16x16x32_bf16 v[0:3], a[128:131], a[160:163], v[0:3]
s_barrier
v_mfma_f32_16x16x32_bf16 v[4:7], a[132:135], a[160:163], v[4:7]
s_add_u32 m0, s32, 65536
ds_read_b128 a[224:227], v200 offset:0
ds_read_b128 v[168:171], v253 offset:0
v_mfma_f32_16x16x32_bf16 v[36:39], a[132:135], a[164:167], v[36:39]
buffer_load_dwordx4 v192, s[8:11], s68 offen offset:0 lds
v_mfma_f32_16x16x32_bf16 v[32:35], a[128:131], a[164:167], v[32:35]
ds_read_b128 a[228:231], v200 offset:2048
ds_read_b128 a[232:235], v200 offset:4096
v_mfma_f32_16x16x32_bf16 v[64:67], a[128:131], a[168:171], v[64:67]
buffer_load_dwordx4 v193, s[8:11], s68 offen offset:1024 lds
v_mfma_f32_16x16x32_bf16 v[68:71], a[132:135], a[168:171], v[68:71]
ds_read_b128 v[172:175], v253 offset:16
ds_read_b128 a[236:239], v200 offset:6144
v_mfma_f32_16x16x32_bf16 v[100:103], a[132:135], a[172:175], v[100:103]
v_mfma_f32_16x16x32_bf16 v[96:99], a[128:131], a[172:175], v[96:99]
v_mfma_f32_16x16x32_bf16 a[0:3], a[128:131], a[176:179], a[0:3]
buffer_load_dwordx4 v194, s[8:11], s68 offen offset:2048 lds
v_mfma_f32_16x16x32_bf16 a[4:7], a[132:135], a[176:179], a[4:7]
ds_read_b128 a[240:243], v200 offset:8192
ds_read_b128 a[244:247], v200 offset:10240
v_mfma_f32_16x16x32_bf16 a[36:39], a[132:135], a[180:183], a[36:39]
v_mfma_f32_16x16x32_bf16 a[32:35], a[128:131], a[180:183], a[32:35]
ds_read_b128 v[176:179], v253 offset:3072
ds_read_b128 a[248:251], v200 offset:12288
v_mfma_f32_16x16x32_bf16 a[64:67], a[128:131], a[184:187], a[64:67]
buffer_load_dwordx4 v195, s[8:11], s68 offen offset:3072 lds
v_mfma_f32_16x16x32_bf16 a[68:71], a[132:135], a[184:187], a[68:71]
s_add_u32 m0, s32, 69632
ds_read_b128 a[252:255], v200 offset:14336
ds_read_b64_tr_b16 a[192:193], v204 offset:0
v_mfma_f32_16x16x32_bf16 a[100:103], a[132:135], a[188:191], a[100:103]
v_mfma_f32_16x16x32_bf16 a[96:99], a[128:131], a[188:191], a[96:99]
ds_read_b128 v[180:183], v253 offset:3088
ds_read_b64_tr_b16 a[194:195], v204 offset:1024
v_mfma_f32_16x16x32_bf16 a[104:107], a[136:139], a[188:191], a[104:107]
v_mfma_f32_16x16x32_bf16 a[108:111], a[140:143], a[188:191], a[108:111]
buffer_load_dwordx4 v192, s[8:11], s69 offen offset:0 lds
v_mfma_f32_16x16x32_bf16 a[76:79], a[140:143], a[184:187], a[76:79]
v_mfma_f32_16x16x32_bf16 a[72:75], a[136:139], a[184:187], a[72:75]
ds_read_b64_tr_b16 a[196:197], v205 offset:0
ds_read_b128 v[184:187], v253 offset:512
v_mfma_f32_16x16x32_bf16 a[40:43], a[136:139], a[180:183], a[40:43]
v_mfma_f32_16x16x32_bf16 a[44:47], a[140:143], a[180:183], a[44:47]
buffer_load_dwordx4 v193, s[8:11], s69 offen offset:1024 lds
v_mfma_f32_16x16x32_bf16 a[12:15], a[140:143], a[176:179], a[12:15]
ds_read_b64_tr_b16 a[198:199], v205 offset:1024
ds_read_b64_tr_b16 a[200:201], v206 offset:0
v_mfma_f32_16x16x32_bf16 a[8:11], a[136:139], a[176:179], a[8:11]
v_mfma_f32_16x16x32_bf16 v[104:107], a[136:139], a[172:175], v[104:107]
ds_read_b64_tr_b16 a[202:203], v206 offset:1024
ds_read_b128 v[188:191], v253 offset:528
v_mfma_f32_16x16x32_bf16 v[108:111], a[140:143], a[172:175], v[108:111]
buffer_load_dwordx4 v194, s[8:11], s69 offen offset:2048 lds
v_mfma_f32_16x16x32_bf16 v[76:79], a[140:143], a[168:171], v[76:79]
ds_read_b64_tr_b16 a[204:205], v207 offset:0
ds_read_b64_tr_b16 a[206:207], v207 offset:1024
v_mfma_f32_16x16x32_bf16 v[72:75], a[136:139], a[168:171], v[72:75]
v_mfma_f32_16x16x32_bf16 v[40:43], a[136:139], a[164:167], v[40:43]
v_mfma_f32_16x16x32_bf16 v[44:47], a[140:143], a[164:167], v[44:47]
v_mfma_f32_16x16x32_bf16 v[12:15], a[140:143], a[160:163], v[12:15]
buffer_load_dwordx4 v195, s[8:11], s69 offen offset:3072 lds
v_mfma_f32_16x16x32_bf16 v[8:11], a[136:139], a[160:163], v[8:11]
s_add_u32 m0, s32, 98304
ds_read_b64_tr_b16 a[208:209], v208 offset:0
ds_read_b128 v[224:227], v253 offset:3584
v_mfma_f32_16x16x32_bf16 v[16:19], a[144:147], a[160:163], v[16:19]
ds_read_b64_tr_b16 a[210:211], v208 offset:1024
v_mfma_f32_16x16x32_bf16 v[20:23], a[148:151], a[160:163], v[20:23]
v_mfma_f32_16x16x32_bf16 v[52:55], a[148:151], a[164:167], v[52:55]
buffer_load_dwordx4 v196, s[12:15], s70 offen offset:0 lds
v_mfma_f32_16x16x32_bf16 v[48:51], a[144:147], a[164:167], v[48:51]
ds_read_b64_tr_b16 a[212:213], v209 offset:0
ds_read_b128 v[228:231], v253 offset:3600
v_mfma_f32_16x16x32_bf16 v[80:83], a[144:147], a[168:171], v[80:83]
ds_read_b64_tr_b16 a[214:215], v209 offset:1024
v_mfma_f32_16x16x32_bf16 v[84:87], a[148:151], a[168:171], v[84:87]
ds_read_b64_tr_b16 a[216:217], v210 offset:0
ds_read_b64_tr_b16 a[218:219], v210 offset:1024
v_mfma_f32_16x16x32_bf16 v[116:119], a[148:151], a[172:175], v[116:119]
buffer_load_dwordx4 v197, s[12:15], s70 offen offset:1024 lds
v_mfma_f32_16x16x32_bf16 v[112:115], a[144:147], a[172:175], v[112:115]
ds_read_b128 v[232:235], v253 offset:1024
ds_read_b64_tr_b16 a[220:221], v211 offset:0
v_mfma_f32_16x16x32_bf16 a[16:19], a[144:147], a[176:179], a[16:19]
v_mfma_f32_16x16x32_bf16 a[20:23], a[148:151], a[176:179], a[20:23]
v_mfma_f32_16x16x32_bf16 a[52:55], a[148:151], a[180:183], a[52:55]
v_mfma_f32_16x16x32_bf16 a[48:51], a[144:147], a[180:183], a[48:51]
buffer_load_dwordx4 v198, s[12:15], s70 offen offset:2048 lds
v_mfma_f32_16x16x32_bf16 a[80:83], a[144:147], a[184:187], a[80:83]
ds_read_b64_tr_b16 a[222:223], v211 offset:1024
ds_read_b128 v[236:239], v253 offset:1040
v_mfma_f32_16x16x32_bf16 a[84:87], a[148:151], a[184:187], a[84:87]
v_mfma_f32_16x16x32_bf16 a[116:119], a[148:151], a[188:191], a[116:119]
v_mfma_f32_16x16x32_bf16 a[112:115], a[144:147], a[188:191], a[112:115]
buffer_load_dwordx4 v199, s[12:15], s70 offen offset:3072 lds
v_mfma_f32_16x16x32_bf16 a[120:123], a[152:155], a[188:191], a[120:123]
s_add_u32 m0, s32, 102400
v_mfma_f32_16x16x32_bf16 a[124:127], a[156:159], a[188:191], a[124:127]
ds_read_b128 v[240:243], v253 offset:4096
ds_read_b128 v[244:247], v253 offset:4112
v_mfma_f32_16x16x32_bf16 a[92:95], a[156:159], a[184:187], a[92:95]
v_mfma_f32_16x16x32_bf16 a[88:91], a[152:155], a[184:187], a[88:91]
buffer_load_dwordx4 v196, s[12:15], s71 offen offset:0 lds
v_mfma_f32_16x16x32_bf16 a[56:59], a[152:155], a[180:183], a[56:59]
v_mfma_f32_16x16x32_bf16 a[60:63], a[156:159], a[180:183], a[60:63]
v_mfma_f32_16x16x32_bf16 a[28:31], a[156:159], a[176:179], a[28:31]
v_mfma_f32_16x16x32_bf16 a[24:27], a[152:155], a[176:179], a[24:27]
v_mfma_f32_16x16x32_bf16 v[120:123], a[152:155], a[172:175], v[120:123]
buffer_load_dwordx4 v197, s[12:15], s71 offen offset:1024 lds
v_mfma_f32_16x16x32_bf16 v[124:127], a[156:159], a[172:175], v[124:127]
v_mfma_f32_16x16x32_bf16 v[92:95], a[156:159], a[168:171], v[92:95]
v_mfma_f32_16x16x32_bf16 v[88:91], a[152:155], a[168:171], v[88:91]
v_mfma_f32_16x16x32_bf16 v[56:59], a[152:155], a[164:167], v[56:59]
buffer_load_dwordx4 v198, s[12:15], s71 offen offset:2048 lds
v_mfma_f32_16x16x32_bf16 v[60:63], a[156:159], a[164:167], v[60:63]
Lch0_2:
Lpad2:
s_cbranch_execz Lpad6
v_mfma_f32_16x16x32_bf16 v[28:31], a[156:159], a[160:163], v[28:31]
v_mfma_f32_16x16x32_bf16 v[24:27], a[152:155], a[160:163], v[24:27]
s_waitcnt lgkmcnt(0)
v_mfma_f32_16x16x32_bf16 v[0:3], a[192:195], a[224:227], v[0:3]
v_mfma_f32_16x16x32_bf16 v[4:7], a[196:199], a[224:227], v[4:7]
buffer_load_dwordx4 v199, s[12:15], s71 offen offset:3072 lds
v_mfma_f32_16x16x32_bf16 v[36:39], a[196:199], a[228:231], v[36:39]
s_add_u32 s68, s68, 128
ds_read_b128 a[160:163], v201 offset:0
s_add_u32 s69, s69, 128
v_mfma_f32_16x16x32_bf16 v[32:35], a[192:195], a[228:231], v[32:35]
s_add_u32 s70, s70, 524288
s_add_u32 s71, s71, 524288
v_fmac_f32 v168, v128, v176
v_mfma_f32_16x16x32_bf16 v[64:67], a[192:195], a[232:235], v[64:67]
s_mov_b32 m0, 155648
ds_read_b128 a[164:167], v201 offset:2048
v_fmac_f32 v169, v129, v177
v_mfma_f32_16x16x32_bf16 v[68:71], a[196:199], a[232:235], v[68:71]
buffer_load_dword v254, s[8:11], s34 offen offset:896 lds
v_mfma_f32_16x16x32_bf16 v[100:103], a[196:199], a[236:239], v[100:103]
ds_read_b128 a[168:171], v201 offset:4096
v_fmac_f32 v170, v130, v178
v_mfma_f32_16x16x32_bf16 v[96:99], a[192:195], a[236:239], v[96:99]
v_fmac_f32 v171, v131, v179
v_fmac_f32 v172, v132, v180
v_mfma_f32_16x16x32_bf16 a[0:3], a[192:195], a[240:243], a[0:3]
ds_read_b128 a[172:175], v201 offset:6144
v_fmac_f32 v173, v133, v181
v_mfma_f32_16x16x32_bf16 a[4:7], a[196:199], a[240:243], a[4:7]
ds_read_b128 a[176:179], v201 offset:8192
v_fmac_f32 v174, v134, v182
v_mfma_f32_16x16x32_bf16 a[36:39], a[196:199], a[244:247], a[36:39]
v_fmac_f32 v175, v135, v183
v_cvt_pk_bf16_f32 v128, v168, v169
v_mfma_f32_16x16x32_bf16 a[32:35], a[192:195], a[244:247], a[32:35]
ds_read_b128 a[180:183], v201 offset:10240
v_cvt_pk_bf16_f32 v129, v170, v171
v_mfma_f32_16x16x32_bf16 a[64:67], a[192:195], a[248:251], a[64:67]
ds_read_b128 a[184:187], v201 offset:12288
v_cvt_pk_bf16_f32 v130, v172, v173
v_mfma_f32_16x16x32_bf16 a[68:71], a[196:199], a[248:251], a[68:71]
buffer_load_dword v255, s[12:15], s35 offen lds
v_mfma_f32_16x16x32_bf16 a[100:103], a[196:199], a[252:255], a[100:103]
s_add_u32 s35, s35, 524288
ds_read_b128 a[188:191], v201 offset:14336
v_cvt_pk_bf16_f32 v131, v174, v175
v_mfma_f32_16x16x32_bf16 a[96:99], a[192:195], a[252:255], a[96:99]
buffer_store_dwordx4 v[128:131], v216, s[24:27], s78 offen offset:0 sc1
v_mfma_f32_16x16x32_bf16 a[104:107], a[200:203], a[252:255], a[104:107]
ds_read_b64_tr_b16 a[128:129], v204 offset:8192
v_fmac_f32 v184, v136, v224
v_mfma_f32_16x16x32_bf16 a[108:111], a[204:207], a[252:255], a[108:111]
v_fmac_f32 v185, v137, v225
v_fmac_f32 v186, v138, v226
v_mfma_f32_16x16x32_bf16 a[76:79], a[204:207], a[248:251], a[76:79]
ds_read_b64_tr_b16 a[130:131], v204 offset:9216
v_fmac_f32 v187, v139, v227
v_mfma_f32_16x16x32_bf16 a[72:75], a[200:203], a[248:251], a[72:75]
ds_read_b64_tr_b16 a[132:133], v205 offset:8192
v_fmac_f32 v188, v140, v228
v_mfma_f32_16x16x32_bf16 a[40:43], a[200:203], a[244:247], a[40:43]
ds_read_b64_tr_b16 a[134:135], v205 offset:9216
v_fmac_f32 v189, v141, v229
v_mfma_f32_16x16x32_bf16 a[44:47], a[204:207], a[244:247], a[44:47]
v_fmac_f32 v190, v142, v230
v_fmac_f32 v191, v143, v231
v_mfma_f32_16x16x32_bf16 a[12:15], a[204:207], a[240:243], a[12:15]
ds_read_b64_tr_b16 a[136:137], v206 offset:8192
v_cvt_pk_bf16_f32 v136, v184, v185
v_mfma_f32_16x16x32_bf16 a[8:11], a[200:203], a[240:243], a[8:11]
ds_read_b64_tr_b16 a[138:139], v206 offset:9216
v_cvt_pk_bf16_f32 v137, v186, v187
v_mfma_f32_16x16x32_bf16 v[104:107], a[200:203], a[236:239], v[104:107]
ds_read_b64_tr_b16 a[140:141], v207 offset:8192
v_cvt_pk_bf16_f32 v138, v188, v189
v_mfma_f32_16x16x32_bf16 v[108:111], a[204:207], a[236:239], v[108:111]
ds_read_b64_tr_b16 a[142:143], v207 offset:9216
v_cvt_pk_bf16_f32 v139, v190, v191
v_mfma_f32_16x16x32_bf16 v[76:79], a[204:207], a[232:235], v[76:79]
buffer_store_dwordx4 v[136:139], v216, s[24:27], s78 offen offset:1024 sc1
v_mfma_f32_16x16x32_bf16 v[72:75], a[200:203], a[232:235], v[72:75]
ds_read_b128 v[168:171], v253 offset:1536
ds_read_b64_tr_b16 a[144:145], v208 offset:8192
v_mfma_f32_16x16x32_bf16 v[40:43], a[200:203], a[228:231], v[40:43]
ds_read_b64_tr_b16 a[146:147], v208 offset:9216
v_mfma_f32_16x16x32_bf16 v[44:47], a[204:207], a[228:231], v[44:47]
ds_read_b128 v[172:175], v253 offset:1552
ds_read_b64_tr_b16 a[148:149], v209 offset:8192
v_mfma_f32_16x16x32_bf16 v[12:15], a[204:207], a[224:227], v[12:15]
ds_read_b64_tr_b16 a[150:151], v209 offset:9216
v_mfma_f32_16x16x32_bf16 v[8:11], a[200:203], a[224:227], v[8:11]
ds_read_b128 v[176:179], v253 offset:4608
ds_read_b64_tr_b16 a[152:153], v210 offset:8192
v_mfma_f32_16x16x32_bf16 v[16:19], a[208:211], a[224:227], v[16:19]
ds_read_b64_tr_b16 a[154:155], v210 offset:9216
v_mfma_f32_16x16x32_bf16 v[20:23], a[212:215], a[224:227], v[20:23]
ds_read_b128 v[180:183], v253 offset:4624
ds_read_b64_tr_b16 a[156:157], v211 offset:8192
v_mfma_f32_16x16x32_bf16 v[52:55], a[212:215], a[228:231], v[52:55]
ds_read_b64_tr_b16 a[158:159], v211 offset:9216
v_mfma_f32_16x16x32_bf16 v[48:51], a[208:211], a[228:231], v[48:51]
ds_read_b128 v[184:187], v253 offset:2048
v_mfma_f32_16x16x32_bf16 v[80:83], a[208:211], a[232:235], v[80:83]
ds_read_b128 v[188:191], v253 offset:2064
v_mfma_f32_16x16x32_bf16 v[84:87], a[212:215], a[232:235], v[84:87]
ds_read_b128 v[224:227], v253 offset:5120
v_mfma_f32_16x16x32_bf16 v[116:119], a[212:215], a[236:239], v[116:119]
ds_read_b128 v[228:231], v253 offset:5136
v_fmac_f32 v232, v144, v240
v_mfma_f32_16x16x32_bf16 v[112:115], a[208:211], a[236:239], v[112:115]
v_fmac_f32 v233, v145, v241
v_fmac_f32 v234, v146, v242
v_mfma_f32_16x16x32_bf16 a[16:19], a[208:211], a[240:243], a[16:19]
v_fmac_f32 v235, v147, v243
v_fmac_f32 v236, v148, v244
v_mfma_f32_16x16x32_bf16 a[20:23], a[212:215], a[240:243], a[20:23]
v_fmac_f32 v237, v149, v245
v_fmac_f32 v238, v150, v246
v_mfma_f32_16x16x32_bf16 a[52:55], a[212:215], a[244:247], a[52:55]
v_fmac_f32 v239, v151, v247
v_cvt_pk_bf16_f32 v144, v232, v233
v_mfma_f32_16x16x32_bf16 a[48:51], a[208:211], a[244:247], a[48:51]
v_cvt_pk_bf16_f32 v145, v234, v235
v_cvt_pk_bf16_f32 v146, v236, v237
v_mfma_f32_16x16x32_bf16 a[80:83], a[208:211], a[248:251], a[80:83]
v_cvt_pk_bf16_f32 v147, v238, v239
v_mfma_f32_16x16x32_bf16 a[84:87], a[212:215], a[248:251], a[84:87]
buffer_store_dwordx4 v[144:147], v216, s[24:27], s78 offen offset:2048 sc1
s_waitcnt lgkmcnt(0)
v_mfma_f32_16x16x32_bf16 a[116:119], a[212:215], a[252:255], a[116:119]
v_fmac_f32 v168, v152, v176
v_fmac_f32 v169, v153, v177
v_mfma_f32_16x16x32_bf16 a[112:115], a[208:211], a[252:255], a[112:115]
v_fmac_f32 v170, v154, v178
v_fmac_f32 v171, v155, v179
v_mfma_f32_16x16x32_bf16 a[120:123], a[216:219], a[252:255], a[120:123]
v_fmac_f32 v172, v156, v180
v_fmac_f32 v173, v157, v181
v_mfma_f32_16x16x32_bf16 a[124:127], a[220:223], a[252:255], a[124:127]
v_fmac_f32 v174, v158, v182
v_fmac_f32 v175, v159, v183
v_mfma_f32_16x16x32_bf16 a[92:95], a[220:223], a[248:251], a[92:95]
v_cvt_pk_bf16_f32 v152, v168, v169
v_cvt_pk_bf16_f32 v153, v170, v171
v_mfma_f32_16x16x32_bf16 a[88:91], a[216:219], a[248:251], a[88:91]
v_cvt_pk_bf16_f32 v154, v172, v173
v_cvt_pk_bf16_f32 v155, v174, v175
v_mfma_f32_16x16x32_bf16 a[56:59], a[216:219], a[244:247], a[56:59]
buffer_store_dwordx4 v[152:155], v216, s[24:27], s78 offen offset:3072 sc1
v_mfma_f32_16x16x32_bf16 a[60:63], a[220:223], a[244:247], a[60:63]
v_fmac_f32 v184, v160, v224
v_fmac_f32 v185, v161, v225
v_mfma_f32_16x16x32_bf16 a[28:31], a[220:223], a[240:243], a[28:31]
v_fmac_f32 v186, v162, v226
v_fmac_f32 v187, v163, v227
v_mfma_f32_16x16x32_bf16 a[24:27], a[216:219], a[240:243], a[24:27]
v_fmac_f32 v188, v164, v228
v_fmac_f32 v189, v165, v229
v_mfma_f32_16x16x32_bf16 v[120:123], a[216:219], a[236:239], v[120:123]
v_fmac_f32 v190, v166, v230
v_fmac_f32 v191, v167, v231
v_mfma_f32_16x16x32_bf16 v[124:127], a[220:223], a[236:239], v[124:127]
v_cvt_pk_bf16_f32 v160, v184, v185
v_cvt_pk_bf16_f32 v161, v186, v187
v_mfma_f32_16x16x32_bf16 v[92:95], a[220:223], a[232:235], v[92:95]
v_cvt_pk_bf16_f32 v162, v188, v189
v_cvt_pk_bf16_f32 v163, v190, v191
v_mfma_f32_16x16x32_bf16 v[88:91], a[216:219], a[232:235], v[88:91]
buffer_store_dwordx4 v[160:163], v216, s[24:27], s79 offen offset:0 sc1
v_mfma_f32_16x16x32_bf16 v[56:59], a[216:219], a[228:231], v[56:59]
v_mfma_f32_16x16x32_bf16 v[60:63], a[220:223], a[228:231], v[60:63]
v_mfma_f32_16x16x32_bf16 v[28:31], a[220:223], a[224:227], v[28:31]
v_mfma_f32_16x16x32_bf16 v[24:27], a[216:219], a[224:227], v[24:27]
s_waitcnt vmcnt(7) lgkmcnt(0)
v_mfma_f32_16x16x32_bf16 v[0:3], a[128:131], a[160:163], v[0:3]
s_barrier
v_mfma_f32_16x16x32_bf16 v[4:7], a[132:135], a[160:163], v[4:7]
s_add_u32 m0, s32, 0
ds_read_b128 a[224:227], v202 offset:0
ds_read_b128 a[228:231], v202 offset:2048
v_mfma_f32_16x16x32_bf16 v[36:39], a[132:135], a[164:167], v[36:39]
buffer_load_dwordx4 v192, s[8:11], s68 offen offset:0 lds
v_mfma_f32_16x16x32_bf16 v[32:35], a[128:131], a[164:167], v[32:35]
s_lshl_b32 s48, s5, 8
v_mfma_f32_16x16x32_bf16 v[64:67], a[128:131], a[168:171], v[64:67]
buffer_load_dwordx4 v193, s[8:11], s68 offen offset:1024 lds
v_mfma_f32_16x16x32_bf16 v[68:71], a[132:135], a[168:171], v[68:71]
s_add_u32 s48, s48, 262144
ds_read_b128 a[232:235], v202 offset:4096
v_mov_b32 v251, s48
v_mfma_f32_16x16x32_bf16 v[100:103], a[132:135], a[172:175], v[100:103]
ds_read_b128 a[236:239], v202 offset:6144
v_mfma_f32_16x16x32_bf16 v[96:99], a[128:131], a[172:175], v[96:99]
v_mfma_f32_16x16x32_bf16 a[0:3], a[128:131], a[176:179], a[0:3]
buffer_load_dwordx4 v194, s[8:11], s68 offen offset:2048 lds
v_mfma_f32_16x16x32_bf16 a[4:7], a[132:135], a[176:179], a[4:7]
ds_read_b128 a[240:243], v202 offset:8192
ds_read_b128 a[244:247], v202 offset:10240
v_mfma_f32_16x16x32_bf16 a[36:39], a[132:135], a[180:183], a[36:39]
v_mfma_f32_16x16x32_bf16 a[32:35], a[128:131], a[180:183], a[32:35]
v_mfma_f32_16x16x32_bf16 a[64:67], a[128:131], a[184:187], a[64:67]
buffer_load_dwordx4 v195, s[8:11], s68 offen offset:3072 lds
v_mfma_f32_16x16x32_bf16 a[68:71], a[132:135], a[184:187], a[68:71]
s_add_u32 m0, s32, 4096
ds_read_b128 a[248:251], v202 offset:12288
ds_read_b128 a[252:255], v202 offset:14336
v_mfma_f32_16x16x32_bf16 a[100:103], a[132:135], a[188:191], a[100:103]
v_mfma_f32_16x16x32_bf16 a[96:99], a[128:131], a[188:191], a[96:99]
ds_read_b64_tr_b16 a[192:193], v212 offset:0
ds_read_b64_tr_b16 a[194:195], v212 offset:1024
v_mfma_f32_16x16x32_bf16 a[104:107], a[136:139], a[188:191], a[104:107]
v_mfma_f32_16x16x32_bf16 a[108:111], a[140:143], a[188:191], a[108:111]
buffer_load_dwordx4 v192, s[8:11], s69 offen offset:0 lds
v_mfma_f32_16x16x32_bf16 a[76:79], a[140:143], a[184:187], a[76:79]
v_mfma_f32_16x16x32_bf16 a[72:75], a[136:139], a[184:187], a[72:75]
ds_read_b64_tr_b16 a[196:197], v213 offset:0
ds_read_b64_tr_b16 a[198:199], v213 offset:1024
v_mfma_f32_16x16x32_bf16 a[40:43], a[136:139], a[180:183], a[40:43]
v_mfma_f32_16x16x32_bf16 a[44:47], a[140:143], a[180:183], a[44:47]
buffer_load_dwordx4 v193, s[8:11], s69 offen offset:1024 lds
v_mfma_f32_16x16x32_bf16 a[12:15], a[140:143], a[176:179], a[12:15]
v_mfma_f32_16x16x32_bf16 a[8:11], a[136:139], a[176:179], a[8:11]
ds_read_b64_tr_b16 a[200:201], v214 offset:0
ds_read_b64_tr_b16 a[202:203], v214 offset:1024
v_mfma_f32_16x16x32_bf16 v[104:107], a[136:139], a[172:175], v[104:107]
v_mfma_f32_16x16x32_bf16 v[108:111], a[140:143], a[172:175], v[108:111]
buffer_load_dwordx4 v194, s[8:11], s69 offen offset:2048 lds
v_mfma_f32_16x16x32_bf16 v[76:79], a[140:143], a[168:171], v[76:79]
ds_read_b64_tr_b16 a[204:205], v215 offset:0
ds_read_b64_tr_b16 a[206:207], v215 offset:1024
v_mfma_f32_16x16x32_bf16 v[72:75], a[136:139], a[168:171], v[72:75]
v_mfma_f32_16x16x32_bf16 v[40:43], a[136:139], a[164:167], v[40:43]
v_mfma_f32_16x16x32_bf16 v[44:47], a[140:143], a[164:167], v[44:47]
v_mfma_f32_16x16x32_bf16 v[12:15], a[140:143], a[160:163], v[12:15]
buffer_load_dwordx4 v195, s[8:11], s69 offen offset:3072 lds
v_mfma_f32_16x16x32_bf16 v[8:11], a[136:139], a[160:163], v[8:11]
s_add_u32 m0, s32, 32768
ds_read_b64_tr_b16 a[208:209], v217 offset:0
ds_read_b64_tr_b16 a[210:211], v217 offset:1024
v_mfma_f32_16x16x32_bf16 v[16:19], a[144:147], a[160:163], v[16:19]
v_mfma_f32_16x16x32_bf16 v[20:23], a[148:151], a[160:163], v[20:23]
v_mfma_f32_16x16x32_bf16 v[52:55], a[148:151], a[164:167], v[52:55]
buffer_load_dwordx4 v196, s[12:15], s70 offen offset:0 lds
v_mfma_f32_16x16x32_bf16 v[48:51], a[144:147], a[164:167], v[48:51]
ds_read_b64_tr_b16 a[212:213], v218 offset:0
ds_read_b64_tr_b16 a[214:215], v218 offset:1024
v_mfma_f32_16x16x32_bf16 v[80:83], a[144:147], a[168:171], v[80:83]
v_mfma_f32_16x16x32_bf16 v[84:87], a[148:151], a[168:171], v[84:87]
ds_read_b64_tr_b16 a[216:217], v221 offset:0
ds_read_b64_tr_b16 a[218:219], v221 offset:1024
v_mfma_f32_16x16x32_bf16 v[116:119], a[148:151], a[172:175], v[116:119]
buffer_load_dwordx4 v197, s[12:15], s70 offen offset:1024 lds
v_mfma_f32_16x16x32_bf16 v[112:115], a[144:147], a[172:175], v[112:115]
v_mfma_f32_16x16x32_bf16 a[16:19], a[144:147], a[176:179], a[16:19]
v_mfma_f32_16x16x32_bf16 a[20:23], a[148:151], a[176:179], a[20:23]
ds_read_b64_tr_b16 a[220:221], v222 offset:0
ds_read_b64_tr_b16 a[222:223], v222 offset:1024
v_mfma_f32_16x16x32_bf16 a[52:55], a[148:151], a[180:183], a[52:55]
v_mfma_f32_16x16x32_bf16 a[48:51], a[144:147], a[180:183], a[48:51]
buffer_load_dwordx4 v198, s[12:15], s70 offen offset:2048 lds
v_mfma_f32_16x16x32_bf16 a[80:83], a[144:147], a[184:187], a[80:83]
v_mfma_f32_16x16x32_bf16 a[84:87], a[148:151], a[184:187], a[84:87]
v_mfma_f32_16x16x32_bf16 a[116:119], a[148:151], a[188:191], a[116:119]
v_mfma_f32_16x16x32_bf16 a[112:115], a[144:147], a[188:191], a[112:115]
buffer_load_dwordx4 v199, s[12:15], s70 offen offset:3072 lds
v_mfma_f32_16x16x32_bf16 a[120:123], a[152:155], a[188:191], a[120:123]
s_add_u32 m0, s32, 36864
v_mfma_f32_16x16x32_bf16 a[124:127], a[156:159], a[188:191], a[124:127]
v_mfma_f32_16x16x32_bf16 a[92:95], a[156:159], a[184:187], a[92:95]
v_mfma_f32_16x16x32_bf16 a[88:91], a[152:155], a[184:187], a[88:91]
buffer_load_dwordx4 v196, s[12:15], s71 offen offset:0 lds
v_mfma_f32_16x16x32_bf16 a[56:59], a[152:155], a[180:183], a[56:59]
v_mfma_f32_16x16x32_bf16 a[60:63], a[156:159], a[180:183], a[60:63]
v_mfma_f32_16x16x32_bf16 a[28:31], a[156:159], a[176:179], a[28:31]
v_mfma_f32_16x16x32_bf16 a[24:27], a[152:155], a[176:179], a[24:27]
v_mfma_f32_16x16x32_bf16 v[120:123], a[152:155], a[172:175], v[120:123]
buffer_load_dwordx4 v197, s[12:15], s71 offen offset:1024 lds
v_mfma_f32_16x16x32_bf16 v[124:127], a[156:159], a[172:175], v[124:127]
v_mfma_f32_16x16x32_bf16 v[92:95], a[156:159], a[168:171], v[92:95]
v_mfma_f32_16x16x32_bf16 v[88:91], a[152:155], a[168:171], v[88:91]
v_mfma_f32_16x16x32_bf16 v[56:59], a[152:155], a[164:167], v[56:59]
buffer_load_dwordx4 v198, s[12:15], s71 offen offset:2048 lds
v_mfma_f32_16x16x32_bf16 v[60:63], a[156:159], a[164:167], v[60:63]
v_mfma_f32_16x16x32_bf16 v[28:31], a[156:159], a[160:163], v[28:31]
v_mfma_f32_16x16x32_bf16 v[24:27], a[152:155], a[160:163], v[24:27]
s_waitcnt vmcnt(15) lgkmcnt(0)
v_mfma_f32_16x16x32_bf16 v[0:3], a[192:195], a[224:227], v[0:3]
s_barrier
s_cmp_lg_u32 s3, 0
s_cbranch_scc1 Larr2
s_mov_b64 exec, 1
global_atomic_add v251, v223, s[66:67] offset:0 sc1
s_mov_b64 exec, -1
Larr2:
v_mfma_f32_16x16x32_bf16 v[4:7], a[196:199], a[224:227], v[4:7]
buffer_load_dwordx4 v199, s[12:15], s71 offen offset:3072 lds
v_mfma_f32_16x16x32_bf16 v[36:39], a[196:199], a[228:231], v[36:39]
s_add_u32 s68, s68, 128
ds_read_b128 a[160:163], v203 offset:0
s_add_u32 s69, s69, 128
v_mfma_f32_16x16x32_bf16 v[32:35], a[192:195], a[228:231], v[32:35]
s_add_u32 s70, s70, 524288
ds_read_b128 a[164:167], v203 offset:2048
s_add_u32 s71, s71, 524288
v_mfma_f32_16x16x32_bf16 v[64:67], a[192:195], a[232:235], v[64:67]
s_mov_b32 s16, s40
ds_read_b128 a[168:171], v203 offset:4096
s_and_b32 s17, s41, 0xffff
v_mfma_f32_16x16x32_bf16 v[68:71], a[196:199], a[232:235], v[68:71]
s_mov_b32 s18, 5242880
s_mov_b32 s19, 0x20000
v_min_u32 v255, 39, v220
v_mfma_f32_16x16x32_bf16 v[100:103], a[196:199], a[236:239], v[100:103]
v_lshrrev_b32 v254, 1, v255
v_lshlrev_b32 v254, 13, v254
v_mfma_f32_16x16x32_bf16 v[96:99], a[192:195], a[236:239], v[96:99]
v_and_b32 v255, 1, v255
v_lshl_add_u32 v254, v255, 7, v254
v_mfma_f32_16x16x32_bf16 a[0:3], a[192:195], a[240:243], a[0:3]
s_lshl_b32 s35, s5, 2
ds_read_b128 a[172:175], v203 offset:6144
s_add_u32 s35, s35, s3
v_mfma_f32_16x16x32_bf16 a[4:7], a[196:199], a[240:243], a[4:7]
s_mul_i32 s35, s35, 163840
ds_read_b128 a[176:179], v203 offset:8192
s_lshl_b32 s7, s4, 8
v_mfma_f32_16x16x32_bf16 a[36:39], a[196:199], a[244:247], a[36:39]
s_add_u32 s35, s35, s7
ds_read_b128 a[180:183], v203 offset:10240
s_mov_b32 m0, 155648
v_mfma_f32_16x16x32_bf16 a[32:35], a[192:195], a[244:247], a[32:35]
buffer_load_dword v254, s[16:19], s35 offen lds
v_mfma_f32_16x16x32_bf16 a[64:67], a[192:195], a[248:251], a[64:67]
ds_read_b128 a[184:187], v203 offset:12288
ds_read_b128 a[188:191], v203 offset:14336
v_mfma_f32_16x16x32_bf16 a[68:71], a[196:199], a[248:251], a[68:71]
v_mfma_f32_16x16x32_bf16 a[100:103], a[196:199], a[252:255], a[100:103]
v_mfma_f32_16x16x32_bf16 a[96:99], a[192:195], a[252:255], a[96:99]
ds_read_b64_tr_b16 a[128:129], v212 offset:8192
ds_read_b64_tr_b16 a[130:131], v212 offset:9216
v_mfma_f32_16x16x32_bf16 a[104:107], a[200:203], a[252:255], a[104:107]
v_mfma_f32_16x16x32_bf16 a[108:111], a[204:207], a[252:255], a[108:111]
v_mfma_f32_16x16x32_bf16 a[76:79], a[204:207], a[248:251], a[76:79]
v_mfma_f32_16x16x32_bf16 a[72:75], a[200:203], a[248:251], a[72:75]
ds_read_b64_tr_b16 a[132:133], v213 offset:8192
ds_read_b64_tr_b16 a[134:135], v213 offset:9216
v_mfma_f32_16x16x32_bf16 a[40:43], a[200:203], a[244:247], a[40:43]
v_mfma_f32_16x16x32_bf16 a[44:47], a[204:207], a[244:247], a[44:47]
v_mfma_f32_16x16x32_bf16 a[12:15], a[204:207], a[240:243], a[12:15]
v_mfma_f32_16x16x32_bf16 a[8:11], a[200:203], a[240:243], a[8:11]
ds_read_b64_tr_b16 a[136:137], v214 offset:8192
ds_read_b64_tr_b16 a[138:139], v214 offset:9216
v_mfma_f32_16x16x32_bf16 v[104:107], a[200:203], a[236:239], v[104:107]
v_mfma_f32_16x16x32_bf16 v[108:111], a[204:207], a[236:239], v[108:111]
v_mfma_f32_16x16x32_bf16 v[76:79], a[204:207], a[232:235], v[76:79]
ds_read_b64_tr_b16 a[140:141], v215 offset:8192
ds_read_b64_tr_b16 a[142:143], v215 offset:9216
v_mfma_f32_16x16x32_bf16 v[72:75], a[200:203], a[232:235], v[72:75]
v_mfma_f32_16x16x32_bf16 v[40:43], a[200:203], a[228:231], v[40:43]
v_mfma_f32_16x16x32_bf16 v[44:47], a[204:207], a[228:231], v[44:47]
v_mfma_f32_16x16x32_bf16 v[12:15], a[204:207], a[224:227], v[12:15]
ds_read_b64_tr_b16 a[144:145], v217 offset:8192
ds_read_b64_tr_b16 a[146:147], v217 offset:9216
v_mfma_f32_16x16x32_bf16 v[8:11], a[200:203], a[224:227], v[8:11]
v_mfma_f32_16x16x32_bf16 v[16:19], a[208:211], a[224:227], v[16:19]
v_mfma_f32_16x16x32_bf16 v[20:23], a[212:215], a[224:227], v[20:23]
v_mfma_f32_16x16x32_bf16 v[52:55], a[212:215], a[228:231], v[52:55]
ds_read_b64_tr_b16 a[148:149], v218 offset:8192
ds_read_b64_tr_b16 a[150:151], v218 offset:9216
v_mfma_f32_16x16x32_bf16 v[48:51], a[208:211], a[228:231], v[48:51]
v_mfma_f32_16x16x32_bf16 v[80:83], a[208:211], a[232:235], v[80:83]
v_mfma_f32_16x16x32_bf16 v[84:87], a[212:215], a[232:235], v[84:87]
ds_read_b64_tr_b16 a[152:153], v221 offset:8192
ds_read_b64_tr_b16 a[154:155], v221 offset:9216
v_mfma_f32_16x16x32_bf16 v[116:119], a[212:215], a[236:239], v[116:119]
v_mfma_f32_16x16x32_bf16 v[112:115], a[208:211], a[236:239], v[112:115]
v_mfma_f32_16x16x32_bf16 a[16:19], a[208:211], a[240:243], a[16:19]
v_mfma_f32_16x16x32_bf16 a[20:23], a[212:215], a[240:243], a[20:23]
ds_read_b64_tr_b16 a[156:157], v222 offset:8192
ds_read_b64_tr_b16 a[158:159], v222 offset:9216
v_mfma_f32_16x16x32_bf16 a[52:55], a[212:215], a[244:247], a[52:55]
v_mfma_f32_16x16x32_bf16 a[48:51], a[208:211], a[244:247], a[48:51]
v_mfma_f32_16x16x32_bf16 a[80:83], a[208:211], a[248:251], a[80:83]
v_mfma_f32_16x16x32_bf16 a[84:87], a[212:215], a[248:251], a[84:87]
v_mfma_f32_16x16x32_bf16 a[116:119], a[212:215], a[252:255], a[116:119]
v_mfma_f32_16x16x32_bf16 a[112:115], a[208:211], a[252:255], a[112:115]
v_mfma_f32_16x16x32_bf16 a[120:123], a[216:219], a[252:255], a[120:123]
v_mfma_f32_16x16x32_bf16 a[124:127], a[220:223], a[252:255], a[124:127]
v_mfma_f32_16x16x32_bf16 a[92:95], a[220:223], a[248:251], a[92:95]
v_mfma_f32_16x16x32_bf16 a[88:91], a[216:219], a[248:251], a[88:91]
v_mfma_f32_16x16x32_bf16 a[56:59], a[216:219], a[244:247], a[56:59]
v_mfma_f32_16x16x32_bf16 a[60:63], a[220:223], a[244:247], a[60:63]
v_mfma_f32_16x16x32_bf16 a[28:31], a[220:223], a[240:243], a[28:31]
v_mfma_f32_16x16x32_bf16 a[24:27], a[216:219], a[240:243], a[24:27]
v_mfma_f32_16x16x32_bf16 v[120:123], a[216:219], a[236:239], v[120:123]
v_mfma_f32_16x16x32_bf16 v[124:127], a[220:223], a[236:239], v[124:127]
v_mfma_f32_16x16x32_bf16 v[92:95], a[220:223], a[232:235], v[92:95]
v_mfma_f32_16x16x32_bf16 v[88:91], a[216:219], a[232:235], v[88:91]
v_mfma_f32_16x16x32_bf16 v[56:59], a[216:219], a[228:231], v[56:59]
v_mfma_f32_16x16x32_bf16 v[60:63], a[220:223], a[228:231], v[60:63]
v_mfma_f32_16x16x32_bf16 v[28:31], a[220:223], a[224:227], v[28:31]
v_mfma_f32_16x16x32_bf16 v[24:27], a[216:219], a[224:227], v[24:27]
s_waitcnt vmcnt(1) lgkmcnt(0)
v_mfma_f32_16x16x32_bf16 v[0:3], a[128:131], a[160:163], v[0:3]
s_barrier
v_mfma_f32_16x16x32_bf16 v[4:7], a[132:135], a[160:163], v[4:7]
s_add_u32 m0, s32, 65536
ds_read_b128 a[224:227], v200 offset:0
ds_read_b128 a[228:231], v200 offset:2048
v_mfma_f32_16x16x32_bf16 v[36:39], a[132:135], a[164:167], v[36:39]
buffer_load_dwordx4 v192, s[8:11], s68 offen offset:0 lds
v_mfma_f32_16x16x32_bf16 v[32:35], a[128:131], a[164:167], v[32:35]
s_lshl_b32 s6, s2, 7
v_mfma_f32_16x16x32_bf16 v[64:67], a[128:131], a[168:171], v[64:67]
buffer_load_dwordx4 v193, s[8:11], s68 offen offset:1024 lds
v_mfma_f32_16x16x32_bf16 v[68:71], a[132:135], a[168:171], v[68:71]
s_add_u32 s6, s6, 288768
ds_read_b128 a[232:235], v200 offset:4096
ds_read_b128 a[236:239], v200 offset:6144
v_mfma_f32_16x16x32_bf16 v[100:103], a[132:135], a[172:175], v[100:103]
v_mfma_f32_16x16x32_bf16 v[96:99], a[128:131], a[172:175], v[96:99]
v_mfma_f32_16x16x32_bf16 a[0:3], a[128:131], a[176:179], a[0:3]
buffer_load_dwordx4 v194, s[8:11], s68 offen offset:2048 lds
v_mfma_f32_16x16x32_bf16 a[4:7], a[132:135], a[176:179], a[4:7]
ds_read_b128 a[240:243], v200 offset:8192
ds_read_b128 a[244:247], v200 offset:10240
v_mfma_f32_16x16x32_bf16 a[36:39], a[132:135], a[180:183], a[36:39]
v_mfma_f32_16x16x32_bf16 a[32:35], a[128:131], a[180:183], a[32:35]
v_mfma_f32_16x16x32_bf16 a[64:67], a[128:131], a[184:187], a[64:67]
buffer_load_dwordx4 v195, s[8:11], s68 offen offset:3072 lds
v_mfma_f32_16x16x32_bf16 a[68:71], a[132:135], a[184:187], a[68:71]
s_add_u32 m0, s32, 69632
ds_read_b128 a[248:251], v200 offset:12288
ds_read_b128 a[252:255], v200 offset:14336
v_mfma_f32_16x16x32_bf16 a[100:103], a[132:135], a[188:191], a[100:103]
v_mfma_f32_16x16x32_bf16 a[96:99], a[128:131], a[188:191], a[96:99]
ds_read_b64_tr_b16 a[192:193], v204 offset:0
ds_read_b64_tr_b16 a[194:195], v204 offset:1024
v_mfma_f32_16x16x32_bf16 a[104:107], a[136:139], a[188:191], a[104:107]
v_mfma_f32_16x16x32_bf16 a[108:111], a[140:143], a[188:191], a[108:111]
buffer_load_dwordx4 v192, s[8:11], s69 offen offset:0 lds
v_mfma_f32_16x16x32_bf16 a[76:79], a[140:143], a[184:187], a[76:79]
v_mfma_f32_16x16x32_bf16 a[72:75], a[136:139], a[184:187], a[72:75]
ds_read_b64_tr_b16 a[196:197], v205 offset:0
ds_read_b64_tr_b16 a[198:199], v205 offset:1024
v_mfma_f32_16x16x32_bf16 a[40:43], a[136:139], a[180:183], a[40:43]
v_mfma_f32_16x16x32_bf16 a[44:47], a[140:143], a[180:183], a[44:47]
buffer_load_dwordx4 v193, s[8:11], s69 offen offset:1024 lds
v_mfma_f32_16x16x32_bf16 a[12:15], a[140:143], a[176:179], a[12:15]
v_mfma_f32_16x16x32_bf16 a[8:11], a[136:139], a[176:179], a[8:11]
ds_read_b64_tr_b16 a[200:201], v206 offset:0
ds_read_b64_tr_b16 a[202:203], v206 offset:1024
v_mfma_f32_16x16x32_bf16 v[104:107], a[136:139], a[172:175], v[104:107]
s_cmp_eq_u32 s3, 0
s_cselect_b32 s6, s48, s6
v_mfma_f32_16x16x32_bf16 v[108:111], a[140:143], a[172:175], v[108:111]
buffer_load_dwordx4 v194, s[8:11], s69 offen offset:2048 lds
v_mfma_f32_16x16x32_bf16 v[76:79], a[140:143], a[168:171], v[76:79]
ds_read_b64_tr_b16 a[204:205], v207 offset:0
v_mov_b32 v253, s6
v_mfma_f32_16x16x32_bf16 v[72:75], a[136:139], a[168:171], v[72:75]
v_mfma_f32_16x16x32_bf16 v[40:43], a[136:139], a[164:167], v[40:43]
ds_read_b64_tr_b16 a[206:207], v207 offset:1024
ds_read_b64_tr_b16 a[208:209], v208 offset:0
v_mfma_f32_16x16x32_bf16 v[44:47], a[140:143], a[164:167], v[44:47]
v_mfma_f32_16x16x32_bf16 v[12:15], a[140:143], a[160:163], v[12:15]
buffer_load_dwordx4 v195, s[8:11], s69 offen offset:3072 lds
v_mfma_f32_16x16x32_bf16 v[8:11], a[136:139], a[160:163], v[8:11]
s_add_u32 m0, s32, 98304
v_mfma_f32_16x16x32_bf16 v[16:19], a[144:147], a[160:163], v[16:19]
ds_read_b64_tr_b16 a[210:211], v208 offset:1024
ds_read_b64_tr_b16 a[212:213], v209 offset:0
v_mfma_f32_16x16x32_bf16 v[20:23], a[148:151], a[160:163], v[20:23]
v_mfma_f32_16x16x32_bf16 v[52:55], a[148:151], a[164:167], v[52:55]
buffer_load_dwordx4 v196, s[12:15], s70 offen offset:0 lds
v_mfma_f32_16x16x32_bf16 v[48:51], a[144:147], a[164:167], v[48:51]
ds_read_b64_tr_b16 a[214:215], v209 offset:1024
ds_read_b64_tr_b16 a[216:217], v210 offset:0
v_mfma_f32_16x16x32_bf16 v[80:83], a[144:147], a[168:171], v[80:83]
v_mfma_f32_16x16x32_bf16 v[84:87], a[148:151], a[168:171], v[84:87]
v_mfma_f32_16x16x32_bf16 v[116:119], a[148:151], a[172:175], v[116:119]
buffer_load_dwordx4 v197, s[12:15], s70 offen offset:1024 lds
v_mfma_f32_16x16x32_bf16 v[112:115], a[144:147], a[172:175], v[112:115]
ds_read_b64_tr_b16 a[218:219], v210 offset:1024
ds_read_b64_tr_b16 a[220:221], v211 offset:0
v_mfma_f32_16x16x32_bf16 a[16:19], a[144:147], a[176:179], a[16:19]
v_mfma_f32_16x16x32_bf16 a[20:23], a[148:151], a[176:179], a[20:23]
v_mfma_f32_16x16x32_bf16 a[52:55], a[148:151], a[180:183], a[52:55]
v_mfma_f32_16x16x32_bf16 a[48:51], a[144:147], a[180:183], a[48:51]
buffer_load_dwordx4 v198, s[12:15], s70 offen offset:2048 lds
v_mfma_f32_16x16x32_bf16 a[80:83], a[144:147], a[184:187], a[80:83]
ds_read_b64_tr_b16 a[222:223], v211 offset:1024
v_mfma_f32_16x16x32_bf16 a[84:87], a[148:151], a[184:187], a[84:87]
v_mfma_f32_16x16x32_bf16 a[116:119], a[148:151], a[188:191], a[116:119]
v_mfma_f32_16x16x32_bf16 a[112:115], a[144:147], a[188:191], a[112:115]
buffer_load_dwordx4 v199, s[12:15], s70 offen offset:3072 lds
v_mfma_f32_16x16x32_bf16 a[120:123], a[152:155], a[188:191], a[120:123]
s_add_u32 m0, s32, 102400
v_mfma_f32_16x16x32_bf16 a[124:127], a[156:159], a[188:191], a[124:127]
v_mfma_f32_16x16x32_bf16 a[92:95], a[156:159], a[184:187], a[92:95]
v_mfma_f32_16x16x32_bf16 a[88:91], a[152:155], a[184:187], a[88:91]
buffer_load_dwordx4 v196, s[12:15], s71 offen offset:0 lds
v_mfma_f32_16x16x32_bf16 a[56:59], a[152:155], a[180:183], a[56:59]
v_mfma_f32_16x16x32_bf16 a[60:63], a[156:159], a[180:183], a[60:63]
v_mfma_f32_16x16x32_bf16 a[28:31], a[156:159], a[176:179], a[28:31]
v_mfma_f32_16x16x32_bf16 a[24:27], a[152:155], a[176:179], a[24:27]
v_mfma_f32_16x16x32_bf16 v[120:123], a[152:155], a[172:175], v[120:123]
buffer_load_dwordx4 v197, s[12:15], s71 offen offset:1024 lds
v_mfma_f32_16x16x32_bf16 v[124:127], a[156:159], a[172:175], v[124:127]
v_mfma_f32_16x16x32_bf16 v[92:95], a[156:159], a[168:171], v[92:95]
v_mfma_f32_16x16x32_bf16 v[88:91], a[152:155], a[168:171], v[88:91]
v_mfma_f32_16x16x32_bf16 v[56:59], a[152:155], a[164:167], v[56:59]
buffer_load_dwordx4 v198, s[12:15], s71 offen offset:2048 lds
v_mfma_f32_16x16x32_bf16 v[60:63], a[156:159], a[164:167], v[60:63]
v_mfma_f32_16x16x32_bf16 v[28:31], a[156:159], a[160:163], v[28:31]
v_mfma_f32_16x16x32_bf16 v[24:27], a[152:155], a[160:163], v[24:27]
s_waitcnt lgkmcnt(0)
v_mfma_f32_16x16x32_bf16 v[0:3], a[192:195], a[224:227], v[0:3]
v_mfma_f32_16x16x32_bf16 v[4:7], a[196:199], a[224:227], v[4:7]
buffer_load_dwordx4 v199, s[12:15], s71 offen offset:3072 lds
v_mfma_f32_16x16x32_bf16 v[36:39], a[196:199], a[228:231], v[36:39]
s_add_u32 s68, s68, 128
ds_read_b128 a[160:163], v201 offset:0
s_add_u32 s69, s69, 128
v_mfma_f32_16x16x32_bf16 v[32:35], a[192:195], a[228:231], v[32:35]
s_add_u32 s70, s70, 524288
ds_read_b128 a[164:167], v201 offset:2048
s_add_u32 s71, s71, 524288
v_mfma_f32_16x16x32_bf16 v[64:67], a[192:195], a[232:235], v[64:67]
s_add_u32 s76, s66, 1048576
s_addc_u32 s77, s67, 0
v_mfma_f32_16x16x32_bf16 v[68:71], a[196:199], a[232:235], v[68:71]
s_and_b32 s77, s77, 0xffff
ds_read_b128 a[168:171], v201 offset:4096
ds_read_b128 a[172:175], v201 offset:6144
v_mfma_f32_16x16x32_bf16 v[100:103], a[196:199], a[236:239], v[100:103]
s_mov_b32 s78, 2621440
v_mfma_f32_16x16x32_bf16 v[96:99], a[192:195], a[236:239], v[96:99]
s_mov_b32 s79, 0x20000
v_mfma_f32_16x16x32_bf16 a[0:3], a[192:195], a[240:243], a[0:3]
s_lshl_b32 s72, s5, 3
ds_read_b128 a[176:179], v201 offset:8192
ds_read_b128 a[180:183], v201 offset:10240
v_mfma_f32_16x16x32_bf16 a[4:7], a[196:199], a[240:243], a[4:7]
s_add_u32 s72, s72, s3
v_mfma_f32_16x16x32_bf16 a[36:39], a[196:199], a[244:247], a[36:39]
s_add_u32 s73, s72, 4
v_mfma_f32_16x16x32_bf16 a[32:35], a[192:195], a[244:247], a[32:35]
s_sub_u32 s74, 15, s5
v_mfma_f32_16x16x32_bf16 a[64:67], a[192:195], a[248:251], a[64:67]
s_lshl_b32 s74, s74, 3
ds_read_b128 a[184:187], v201 offset:12288
ds_read_b128 a[188:191], v201 offset:14336
Lch0_3:
Lpad3:
s_cbranch_execz Lpad7
v_mfma_f32_16x16x32_bf16 a[68:71], a[196:199], a[248:251], a[68:71]
s_add_u32 s74, s74, s3
v_mfma_f32_16x16x32_bf16 a[100:103], a[196:199], a[252:255], a[100:103]
s_add_u32 s75, s74, 4
v_mfma_f32_16x16x32_bf16 a[96:99], a[192:195], a[252:255], a[96:99]
s_mul_i32 s42, s72, 20480
ds_read_b64_tr_b16 a[128:129], v204 offset:8192
ds_read_b64_tr_b16 a[130:131], v204 offset:9216
v_mfma_f32_16x16x32_bf16 a[104:107], a[200:203], a[252:255], a[104:107]
s_mul_i32 s43, s73, 20480
v_mfma_f32_16x16x32_bf16 a[108:111], a[204:207], a[252:255], a[108:111]
s_mul_i32 s44, s74, 20480
v_mfma_f32_16x16x32_bf16 a[76:79], a[204:207], a[248:251], a[76:79]
s_mul_i32 s45, s75, 20480
v_mfma_f32_16x16x32_bf16 a[72:75], a[200:203], a[248:251], a[72:75]
s_lshl_b32 s58, s3, 16
ds_read_b64_tr_b16 a[132:133], v205 offset:8192
ds_read_b64_tr_b16 a[134:135], v205 offset:9216
v_mfma_f32_16x16x32_bf16 a[40:43], a[200:203], a[244:247], a[40:43]
s_lshl_b32 s59, s4, 8
v_mfma_f32_16x16x32_bf16 a[44:47], a[204:207], a[244:247], a[44:47]
s_add_u32 s58, s58, s59
v_mfma_f32_16x16x32_bf16 a[12:15], a[204:207], a[240:243], a[12:15]
s_lshl_b32 s59, s3, 11
v_mfma_f32_16x16x32_bf16 a[8:11], a[200:203], a[240:243], a[8:11]
s_and_b32 s61, s3, 1
ds_read_b64_tr_b16 a[136:137], v206 offset:8192
ds_read_b64_tr_b16 a[138:139], v206 offset:9216
v_mfma_f32_16x16x32_bf16 v[104:107], a[200:203], a[236:239], v[104:107]
s_lshl_b32 s61, s61, 7
v_mfma_f32_16x16x32_bf16 v[108:111], a[204:207], a[236:239], v[108:111]
v_mfma_f32_16x16x32_bf16 v[76:79], a[204:207], a[232:235], v[76:79]
ds_read_b64_tr_b16 a[140:141], v207 offset:8192
v_xor_b32 v196, s61, v196
v_mfma_f32_16x16x32_bf16 v[72:75], a[200:203], a[232:235], v[72:75]
v_mfma_f32_16x16x32_bf16 v[40:43], a[200:203], a[228:231], v[40:43]
ds_read_b64_tr_b16 a[142:143], v207 offset:9216
v_add_u32 v197, 31744, v196
v_mfma_f32_16x16x32_bf16 v[44:47], a[204:207], a[228:231], v[44:47]
v_mfma_f32_16x16x32_bf16 v[12:15], a[204:207], a[224:227], v[12:15]
ds_read_b64_tr_b16 a[144:145], v208 offset:8192
v_and_b32 v198, 3, v220
v_mfma_f32_16x16x32_bf16 v[8:11], a[200:203], a[224:227], v[8:11]
v_mfma_f32_16x16x32_bf16 v[16:19], a[208:211], a[224:227], v[16:19]
ds_read_b64_tr_b16 a[146:147], v208 offset:9216
v_lshlrev_b32 v198, 4, v198
v_mfma_f32_16x16x32_bf16 v[20:23], a[212:215], a[224:227], v[20:23]
v_mfma_f32_16x16x32_bf16 v[52:55], a[212:215], a[228:231], v[52:55]
ds_read_b64_tr_b16 a[148:149], v209 offset:8192
v_lshrrev_b32 v199, 4, v220
v_mfma_f32_16x16x32_bf16 v[48:51], a[208:211], a[228:231], v[48:51]
ds_read_b64_tr_b16 a[150:151], v209 offset:9216
v_lshl_add_u32 v198, v199, 6, v198
v_mfma_f32_16x16x32_bf16 v[80:83], a[208:211], a[232:235], v[80:83]
v_mfma_f32_16x16x32_bf16 v[84:87], a[212:215], a[232:235], v[84:87]
ds_read_b64_tr_b16 a[152:153], v210 offset:8192
v_bfe_u32 v199, v220, 2, 2
v_mfma_f32_16x16x32_bf16 v[116:119], a[212:215], a[236:239], v[116:119]
v_mfma_f32_16x16x32_bf16 v[112:115], a[208:211], a[236:239], v[112:115]
ds_read_b64_tr_b16 a[154:155], v210 offset:9216
v_mul_u32_u24 v199, 5120, v199
v_mfma_f32_16x16x32_bf16 a[16:19], a[208:211], a[240:243], a[16:19]
v_mfma_f32_16x16x32_bf16 a[20:23], a[212:215], a[240:243], a[20:23]
ds_read_b64_tr_b16 a[156:157], v211 offset:8192
v_add_u32 v198, v198, v199
v_mfma_f32_16x16x32_bf16 a[52:55], a[212:215], a[244:247], a[52:55]
v_mfma_f32_16x16x32_bf16 a[48:51], a[208:211], a[244:247], a[48:51]
ds_read_b64_tr_b16 a[158:159], v211 offset:9216
v_mfma_f32_16x16x32_bf16 a[80:83], a[208:211], a[248:251], a[80:83]
v_mfma_f32_16x16x32_bf16 a[84:87], a[212:215], a[248:251], a[84:87]
v_mfma_f32_16x16x32_bf16 a[116:119], a[212:215], a[252:255], a[116:119]
v_mfma_f32_16x16x32_bf16 a[112:115], a[208:211], a[252:255], a[112:115]
v_mfma_f32_16x16x32_bf16 a[120:123], a[216:219], a[252:255], a[120:123]
v_mfma_f32_16x16x32_bf16 a[124:127], a[220:223], a[252:255], a[124:127]
v_mfma_f32_16x16x32_bf16 a[92:95], a[220:223], a[248:251], a[92:95]
v_mfma_f32_16x16x32_bf16 a[88:91], a[216:219], a[248:251], a[88:91]
v_mfma_f32_16x16x32_bf16 a[56:59], a[216:219], a[244:247], a[56:59]
v_mfma_f32_16x16x32_bf16 a[60:63], a[220:223], a[244:247], a[60:63]
v_mfma_f32_16x16x32_bf16 a[28:31], a[220:223], a[240:243], a[28:31]
v_mfma_f32_16x16x32_bf16 a[24:27], a[216:219], a[240:243], a[24:27]
v_mfma_f32_16x16x32_bf16 v[120:123], a[216:219], a[236:239], v[120:123]
v_mfma_f32_16x16x32_bf16 v[124:127], a[220:223], a[236:239], v[124:127]
v_mfma_f32_16x16x32_bf16 v[92:95], a[220:223], a[232:235], v[92:95]
v_mfma_f32_16x16x32_bf16 v[88:91], a[216:219], a[232:235], v[88:91]
v_mfma_f32_16x16x32_bf16 v[56:59], a[216:219], a[228:231], v[56:59]
v_mfma_f32_16x16x32_bf16 v[60:63], a[220:223], a[228:231], v[60:63]
v_mfma_f32_16x16x32_bf16 v[28:31], a[220:223], a[224:227], v[28:31]
v_mfma_f32_16x16x32_bf16 v[24:27], a[216:219], a[224:227], v[24:27]
s_waitcnt vmcnt(0) lgkmcnt(0)
v_mfma_f32_16x16x32_bf16 v[0:3], a[128:131], a[160:163], v[0:3]
s_barrier
v_mfma_f32_16x16x32_bf16 v[4:7], a[132:135], a[160:163], v[4:7]
s_add_u32 m0, s59, 0
ds_read_b128 a[224:227], v202 offset:0
ds_read_b128 a[228:231], v202 offset:2048
v_mfma_f32_16x16x32_bf16 v[36:39], a[132:135], a[164:167], v[36:39]
buffer_load_dwordx4 v196, s[16:19], s58 offen offset:0 lds
v_mfma_f32_16x16x32_bf16 v[32:35], a[128:131], a[164:167], v[32:35]
v_mfma_f32_16x16x32_bf16 v[64:67], a[128:131], a[168:171], v[64:67]
buffer_load_dwordx4 v197, s[16:19], s58 offen offset:1024 lds
v_mfma_f32_16x16x32_bf16 v[68:71], a[132:135], a[168:171], v[68:71]
s_add_u32 s58, s58, 262144
ds_read_b128 a[232:235], v202 offset:4096
s_add_u32 m0, s59, 8192
v_mfma_f32_16x16x32_bf16 v[100:103], a[132:135], a[172:175], v[100:103]
ds_read_b128 a[236:239], v202 offset:6144
v_mfma_f32_16x16x32_bf16 v[96:99], a[128:131], a[172:175], v[96:99]
v_mfma_f32_16x16x32_bf16 a[0:3], a[128:131], a[176:179], a[0:3]
buffer_load_dwordx4 v196, s[16:19], s58 offen offset:0 lds
v_mfma_f32_16x16x32_bf16 a[4:7], a[132:135], a[176:179], a[4:7]
ds_read_b128 a[240:243], v202 offset:8192
ds_read_b128 a[244:247], v202 offset:10240
v_mfma_f32_16x16x32_bf16 a[36:39], a[132:135], a[180:183], a[36:39]
v_mfma_f32_16x16x32_bf16 a[32:35], a[128:131], a[180:183], a[32:35]
v_mfma_f32_16x16x32_bf16 a[64:67], a[128:131], a[184:187], a[64:67]
buffer_load_dwordx4 v197, s[16:19], s58 offen offset:1024 lds
v_mfma_f32_16x16x32_bf16 a[68:71], a[132:135], a[184:187], a[68:71]
s_add_u32 s58, s58, 262144
ds_read_b128 a[248:251], v202 offset:12288
s_add_u32 m0, s59, 16384
v_mfma_f32_16x16x32_bf16 a[100:103], a[132:135], a[188:191], a[100:103]
ds_read_b128 a[252:255], v202 offset:14336
v_mfma_f32_16x16x32_bf16 a[96:99], a[128:131], a[188:191], a[96:99]
ds_read_b64_tr_b16 a[192:193], v212 offset:0
ds_read_b64_tr_b16 a[194:195], v212 offset:1024
v_mfma_f32_16x16x32_bf16 a[104:107], a[136:139], a[188:191], a[104:107]
v_mfma_f32_16x16x32_bf16 a[108:111], a[140:143], a[188:191], a[108:111]
buffer_load_dwordx4 v196, s[16:19], s58 offen offset:0 lds
v_mfma_f32_16x16x32_bf16 a[76:79], a[140:143], a[184:187], a[76:79]
v_mfma_f32_16x16x32_bf16 a[72:75], a[136:139], a[184:187], a[72:75]
ds_read_b64_tr_b16 a[196:197], v213 offset:0
ds_read_b64_tr_b16 a[198:199], v213 offset:1024
v_mfma_f32_16x16x32_bf16 a[40:43], a[136:139], a[180:183], a[40:43]
v_mfma_f32_16x16x32_bf16 a[44:47], a[140:143], a[180:183], a[44:47]
buffer_load_dwordx4 v197, s[16:19], s58 offen offset:1024 lds
v_mfma_f32_16x16x32_bf16 a[12:15], a[140:143], a[176:179], a[12:15]
s_add_u32 s58, s58, 262144
ds_read_b64_tr_b16 a[200:201], v214 offset:0
s_add_u32 m0, s59, 24576
v_mfma_f32_16x16x32_bf16 a[8:11], a[136:139], a[176:179], a[8:11]
v_mfma_f32_16x16x32_bf16 v[104:107], a[136:139], a[172:175], v[104:107]
ds_read_b64_tr_b16 a[202:203], v214 offset:1024
ds_read_b64_tr_b16 a[204:205], v215 offset:0
v_mfma_f32_16x16x32_bf16 v[108:111], a[140:143], a[172:175], v[108:111]
buffer_load_dwordx4 v196, s[16:19], s58 offen offset:0 lds
v_mfma_f32_16x16x32_bf16 v[76:79], a[140:143], a[168:171], v[76:79]
v_mfma_f32_16x16x32_bf16 v[72:75], a[136:139], a[168:171], v[72:75]
v_mfma_f32_16x16x32_bf16 v[40:43], a[136:139], a[164:167], v[40:43]
ds_read_b64_tr_b16 a[206:207], v215 offset:1024
ds_read_b64_tr_b16 a[208:209], v217 offset:0
v_mfma_f32_16x16x32_bf16 v[44:47], a[140:143], a[164:167], v[44:47]
v_mfma_f32_16x16x32_bf16 v[12:15], a[140:143], a[160:163], v[12:15]
buffer_load_dwordx4 v197, s[16:19], s58 offen offset:1024 lds
v_mfma_f32_16x16x32_bf16 v[8:11], a[136:139], a[160:163], v[8:11]
s_add_u32 s58, s58, 262144
ds_read_b64_tr_b16 a[210:211], v217 offset:1024
s_add_u32 m0, s59, 32768
v_mfma_f32_16x16x32_bf16 v[16:19], a[144:147], a[160:163], v[16:19]
v_mfma_f32_16x16x32_bf16 v[20:23], a[148:151], a[160:163], v[20:23]
v_mfma_f32_16x16x32_bf16 v[52:55], a[148:151], a[164:167], v[52:55]
buffer_load_dwordx4 v196, s[16:19], s58 offen offset:0 lds
v_mfma_f32_16x16x32_bf16 v[48:51], a[144:147], a[164:167], v[48:51]
ds_read_b64_tr_b16 a[212:213], v218 offset:0
ds_read_b64_tr_b16 a[214:215], v218 offset:1024
v_mfma_f32_16x16x32_bf16 v[80:83], a[144:147], a[168:171], v[80:83]
v_mfma_f32_16x16x32_bf16 v[84:87], a[148:151], a[168:171], v[84:87]
ds_read_b64_tr_b16 a[216:217], v221 offset:0
ds_read_b64_tr_b16 a[218:219], v221 offset:1024
v_mfma_f32_16x16x32_bf16 v[116:119], a[148:151], a[172:175], v[116:119]
buffer_load_dwordx4 v197, s[16:19], s58 offen offset:1024 lds
v_mfma_f32_16x16x32_bf16 v[112:115], a[144:147], a[172:175], v[112:115]
s_add_u32 s58, s58, 262144
ds_read_b64_tr_b16 a[220:221], v222 offset:0
s_add_u32 m0, s59, 40960
v_mfma_f32_16x16x32_bf16 a[16:19], a[144:147], a[176:179], a[16:19]
v_mfma_f32_16x16x32_bf16 a[20:23], a[148:151], a[176:179], a[20:23]
v_mfma_f32_16x16x32_bf16 a[52:55], a[148:151], a[180:183], a[52:55]
v_mfma_f32_16x16x32_bf16 a[48:51], a[144:147], a[180:183], a[48:51]
buffer_load_dwordx4 v196, s[16:19], s58 offen offset:0 lds
v_mfma_f32_16x16x32_bf16 a[80:83], a[144:147], a[184:187], a[80:83]
ds_read_b64_tr_b16 a[222:223], v222 offset:1024
v_mfma_f32_16x16x32_bf16 a[84:87], a[148:151], a[184:187], a[84:87]
v_mfma_f32_16x16x32_bf16 a[116:119], a[148:151], a[188:191], a[116:119]
v_mfma_f32_16x16x32_bf16 a[112:115], a[144:147], a[188:191], a[112:115]
buffer_load_dwordx4 v197, s[16:19], s58 offen offset:1024 lds
v_mfma_f32_16x16x32_bf16 a[120:123], a[152:155], a[188:191], a[120:123]
s_add_u32 s58, s58, 262144
s_add_u32 m0, s59, 49152
v_mfma_f32_16x16x32_bf16 a[124:127], a[156:159], a[188:191], a[124:127]
v_mfma_f32_16x16x32_bf16 a[92:95], a[156:159], a[184:187], a[92:95]
v_mfma_f32_16x16x32_bf16 a[88:91], a[152:155], a[184:187], a[88:91]
buffer_load_dwordx4 v196, s[16:19], s58 offen offset:0 lds
v_mfma_f32_16x16x32_bf16 a[56:59], a[152:155], a[180:183], a[56:59]
v_mfma_f32_16x16x32_bf16 a[60:63], a[156:159], a[180:183], a[60:63]
v_mfma_f32_16x16x32_bf16 a[28:31], a[156:159], a[176:179], a[28:31]
v_mfma_f32_16x16x32_bf16 a[24:27], a[152:155], a[176:179], a[24:27]
v_mfma_f32_16x16x32_bf16 v[120:123], a[152:155], a[172:175], v[120:123]
buffer_load_dwordx4 v197, s[16:19], s58 offen offset:1024 lds
v_mfma_f32_16x16x32_bf16 v[124:127], a[156:159], a[172:175], v[124:127]
s_add_u32 s58, s58, 262144
v_mfma_f32_16x16x32_bf16 v[92:95], a[156:159], a[168:171], v[92:95]
v_mfma_f32_16x16x32_bf16 v[88:91], a[152:155], a[168:171], v[88:91]
v_mfma_f32_16x16x32_bf16 v[56:59], a[152:155], a[164:167], v[56:59]
v_mfma_f32_16x16x32_bf16 v[60:63], a[156:159], a[164:167], v[60:63]
v_mfma_f32_16x16x32_bf16 v[28:31], a[156:159], a[160:163], v[28:31]
v_mfma_f32_16x16x32_bf16 v[24:27], a[152:155], a[160:163], v[24:27]
s_waitcnt lgkmcnt(0)
v_mfma_f32_16x16x32_bf16 v[0:3], a[192:195], a[224:227], v[0:3]
v_mfma_f32_16x16x32_bf16 v[4:7], a[196:199], a[224:227], v[4:7]
s_add_u32 m0, s59, 57344
ds_read_b128 a[160:163], v203 offset:0
ds_read_b128 a[164:167], v203 offset:2048
v_mfma_f32_16x16x32_bf16 v[36:39], a[196:199], a[228:231], v[36:39]
buffer_load_dwordx4 v196, s[16:19], s58 offen offset:0 lds
v_mfma_f32_16x16x32_bf16 v[32:35], a[192:195], a[228:231], v[32:35]
ds_read_b128 a[168:171], v203 offset:4096
ds_read_b128 a[172:175], v203 offset:6144
v_mfma_f32_16x16x32_bf16 v[64:67], a[192:195], a[232:235], v[64:67]
buffer_load_dwordx4 v197, s[16:19], s58 offen offset:1024 lds
v_mfma_f32_16x16x32_bf16 v[68:71], a[196:199], a[232:235], v[68:71]
s_add_u32 s58, s58, 262144
ds_read_b64_tr_b16 a[128:129], v212 offset:8192
s_add_u32 m0, s59, 131072
v_mfma_f32_16x16x32_bf16 v[100:103], a[196:199], a[236:239], v[100:103]
ds_read_b64_tr_b16 a[130:131], v212 offset:9216
ds_read_b64_tr_b16 a[132:133], v213 offset:8192
v_mfma_f32_16x16x32_bf16 v[96:99], a[192:195], a[236:239], v[96:99]
v_mfma_f32_16x16x32_bf16 v[104:107], a[200:203], a[236:239], v[104:107]
buffer_load_dwordx4 v196, s[16:19], s58 offen offset:0 lds
v_mfma_f32_16x16x32_bf16 v[108:111], a[204:207], a[236:239], v[108:111]
ds_read_b64_tr_b16 a[134:135], v213 offset:9216
ds_read_b64_tr_b16 a[136:137], v214 offset:8192
v_mfma_f32_16x16x32_bf16 v[76:79], a[204:207], a[232:235], v[76:79]
ds_read_b64_tr_b16 a[138:139], v214 offset:9216
ds_read_b64_tr_b16 a[140:141], v215 offset:8192
v_mfma_f32_16x16x32_bf16 v[72:75], a[200:203], a[232:235], v[72:75]
v_mfma_f32_16x16x32_bf16 v[40:43], a[200:203], a[228:231], v[40:43]
buffer_load_dwordx4 v197, s[16:19], s58 offen offset:1024 lds
v_mfma_f32_16x16x32_bf16 v[44:47], a[204:207], a[228:231], v[44:47]
s_add_u32 s58, s58, 262144
ds_read_b64_tr_b16 a[142:143], v215 offset:9216
s_add_u32 m0, s59, 139264
v_mfma_f32_16x16x32_bf16 v[12:15], a[204:207], a[224:227], v[12:15]
ds_read_b64_tr_b16 a[144:145], v217 offset:8192
ds_read_b64_tr_b16 a[146:147], v217 offset:9216
v_mfma_f32_16x16x32_bf16 v[8:11], a[200:203], a[224:227], v[8:11]
ds_read_b64_tr_b16 a[148:149], v218 offset:8192
ds_read_b64_tr_b16 a[150:151], v218 offset:9216
v_mfma_f32_16x16x32_bf16 v[16:19], a[208:211], a[224:227], v[16:19]
v_mfma_f32_16x16x32_bf16 v[20:23], a[212:215], a[224:227], v[20:23]
buffer_load_dwordx4 v196, s[16:19], s58 offen offset:0 lds
v_mfma_f32_16x16x32_bf16 v[52:55], a[212:215], a[228:231], v[52:55]
ds_read_b64_tr_b16 a[152:153], v221 offset:8192
ds_read_b64_tr_b16 a[154:155], v221 offset:9216
v_mfma_f32_16x16x32_bf16 v[48:51], a[208:211], a[228:231], v[48:51]
ds_read_b64_tr_b16 a[156:157], v222 offset:8192
ds_read_b64_tr_b16 a[158:159], v222 offset:9216
v_mfma_f32_16x16x32_bf16 v[80:83], a[208:211], a[232:235], v[80:83]
v_mfma_f32_16x16x32_bf16 v[84:87], a[212:215], a[232:235], v[84:87]
buffer_load_dwordx4 v197, s[16:19], s58 offen offset:1024 lds
v_mfma_f32_16x16x32_bf16 v[116:119], a[212:215], a[236:239], v[116:119]
s_add_u32 s58, s58, 262144
v_mfma_f32_16x16x32_bf16 v[112:115], a[208:211], a[236:239], v[112:115]
v_mfma_f32_16x16x32_bf16 v[120:123], a[216:219], a[236:239], v[120:123]
v_mfma_f32_16x16x32_bf16 v[124:127], a[220:223], a[236:239], v[124:127]
global_load_dword v219, v253, s[66:67] sc1
v_mfma_f32_16x16x32_bf16 v[92:95], a[220:223], a[232:235], v[92:95]
s_add_u32 m0, s59, 147456
s_lshr_b32 s7, s3, 1
s_lshl_b32 s7, s7, 14
v_mfma_f32_16x16x32_bf16 v[88:91], a[216:219], a[232:235], v[88:91]
buffer_load_dwordx4 v196, s[16:19], s58 offen offset:0 lds
v_mfma_f32_16x16x32_bf16 v[56:59], a[216:219], a[228:231], v[56:59]
s_add_u32 s7, s7, 32768
v_subrev_u32 v204, s7, v204
v_subrev_u32 v205, s7, v205
v_mfma_f32_16x16x32_bf16 v[60:63], a[220:223], a[228:231], v[60:63]
v_subrev_u32 v206, s7, v206
v_subrev_u32 v207, s7, v207
v_mfma_f32_16x16x32_bf16 v[28:31], a[220:223], a[224:227], v[28:31]
v_mfma_f32_16x16x32_bf16 v[24:27], a[216:219], a[224:227], v[24:27]
s_waitcnt lgkmcnt(0)
v_mfma_f32_16x16x32_bf16 v[0:3], a[128:131], a[160:163], v[0:3]
buffer_load_dwordx4 v197, s[16:19], s58 offen offset:1024 lds
v_mfma_f32_16x16x32_bf16 v[4:7], a[132:135], a[160:163], v[4:7]
s_add_u32 s58, s58, 262144
ds_read_b128 a[176:179], v203 offset:8192
s_add_u32 m0, s59, 155648
v_mfma_f32_16x16x32_bf16 v[36:39], a[132:135], a[164:167], v[36:39]
v_mfma_f32_16x16x32_bf16 v[32:35], a[128:131], a[164:167], v[32:35]
buffer_load_dwordx4 v196, s[16:19], s58 offen offset:0 lds
v_mfma_f32_16x16x32_bf16 v[64:67], a[128:131], a[168:171], v[64:67]
ds_read_b128 a[180:183], v203 offset:10240
v_subrev_u32 v208, s7, v208
v_mfma_f32_16x16x32_bf16 v[68:71], a[132:135], a[168:171], v[68:71]
v_mfma_f32_16x16x32_bf16 v[100:103], a[132:135], a[172:175], v[100:103]
ds_read_b128 a[184:187], v203 offset:12288
v_subrev_u32 v209, s7, v209
v_mfma_f32_16x16x32_bf16 v[96:99], a[128:131], a[172:175], v[96:99]
buffer_load_dwordx4 v197, s[16:19], s58 offen offset:1024 lds
v_mfma_f32_16x16x32_bf16 v[104:107], a[136:139], a[172:175], v[104:107]
s_add_u32 s58, s58, 262144
v_mfma_f32_16x16x32_bf16 v[108:111], a[140:143], a[172:175], v[108:111]
ds_read_b128 a[188:191], v203 offset:14336
v_subrev_u32 v210, s7, v210
v_mfma_f32_16x16x32_bf16 v[76:79], a[140:143], a[168:171], v[76:79]
v_mfma_f32_16x16x32_bf16 v[72:75], a[136:139], a[168:171], v[72:75]
v_mfma_f32_16x16x32_bf16 v[40:43], a[136:139], a[164:167], v[40:43]
v_mfma_f32_16x16x32_bf16 v[44:47], a[140:143], a[164:167], v[44:47]
v_mfma_f32_16x16x32_bf16 v[12:15], a[140:143], a[160:163], v[12:15]
v_mfma_f32_16x16x32_bf16 v[8:11], a[136:139], a[160:163], v[8:11]
v_mfma_f32_16x16x32_bf16 v[16:19], a[144:147], a[160:163], v[16:19]
v_mfma_f32_16x16x32_bf16 v[20:23], a[148:151], a[160:163], v[20:23]
v_mfma_f32_16x16x32_bf16 v[52:55], a[148:151], a[164:167], v[52:55]
v_mfma_f32_16x16x32_bf16 v[48:51], a[144:147], a[164:167], v[48:51]
v_mfma_f32_16x16x32_bf16 v[80:83], a[144:147], a[168:171], v[80:83]
v_mfma_f32_16x16x32_bf16 v[84:87], a[148:151], a[168:171], v[84:87]
v_subrev_u32 v211, s7, v211
v_mfma_f32_16x16x32_bf16 v[116:119], a[148:151], a[172:175], v[116:119]
v_mfma_f32_16x16x32_bf16 v[112:115], a[144:147], a[172:175], v[112:115]
v_mfma_f32_16x16x32_bf16 v[120:123], a[152:155], a[172:175], v[120:123]
v_mfma_f32_16x16x32_bf16 v[124:127], a[156:159], a[172:175], v[124:127]
v_mfma_f32_16x16x32_bf16 v[92:95], a[156:159], a[168:171], v[92:95]
v_mfma_f32_16x16x32_bf16 v[88:91], a[152:155], a[168:171], v[88:91]
v_mfma_f32_16x16x32_bf16 v[56:59], a[152:155], a[164:167], v[56:59]
v_mfma_f32_16x16x32_bf16 v[60:63], a[156:159], a[164:167], v[60:63]
v_mfma_f32_16x16x32_bf16 v[28:31], a[156:159], a[160:163], v[28:31]
v_mfma_f32_16x16x32_bf16 v[24:27], a[152:155], a[160:163], v[24:27]
s_waitcnt vmcnt(4) lgkmcnt(0)
v_mfma_f32_16x16x32_bf16 a[0:3], a[192:195], a[240:243], a[0:3]
s_cmp_lg_u32 s3, 0
s_cbranch_scc1 Lnos2
v_cmp_gt_u32 vcc, 32, v219
s_mov_b32 s6, 0
s_cmp_eq_u64 vcc, 0
s_cbranch_scc1 Lok3
Lsp4:
s_sleep 5
global_load_dword v219, v253, s[66:67] sc1
s_waitcnt vmcnt(0)
v_cmp_gt_u32 vcc, 32, v219
s_add_u32 s6, s6, 1
s_cmp_gt_u32 s6, 200000
s_cbranch_scc1 Lok3
s_cmp_lg_u64 vcc, 0
s_cbranch_scc1 Lsp4
Lok3:
Lnos2:
s_barrier
v_mfma_f32_16x16x32_bf16 a[4:7], a[196:199], a[240:243], a[4:7]
buffer_load_dwordx4 v[224:227], v198, s[76:79], s42 offen offset:0 sc1
v_mfma_f32_16x16x32_bf16 a[36:39], a[196:199], a[244:247], a[36:39]
s_add_u32 s60, s33, 262144
v_mfma_f32_16x16x32_bf16 a[32:35], a[192:195], a[244:247], a[32:35]
buffer_load_dwordx4 v[228:231], v198, s[76:79], s43 offen offset:0 sc1
v_mfma_f32_16x16x32_bf16 a[64:67], a[192:195], a[248:251], a[64:67]
v_mfma_f32_16x16x32_bf16 a[68:71], a[196:199], a[248:251], a[68:71]
v_mfma_f32_16x16x32_bf16 a[100:103], a[196:199], a[252:255], a[100:103]
v_mfma_f32_16x16x32_bf16 a[96:99], a[192:195], a[252:255], a[96:99]
buffer_load_dwordx4 v[232:235], v198, s[76:79], s44 offen offset:0 sc1
v_mfma_f32_16x16x32_bf16 a[104:107], a[200:203], a[252:255], a[104:107]
v_cvt_pk_bf16_f32 v128, v0, v1
v_cvt_pk_bf16_f32 v129, v2, v3
v_mfma_f32_16x16x32_bf16 a[108:111], a[204:207], a[252:255], a[108:111]
v_cvt_pk_bf16_f32 v130, v4, v5
v_cvt_pk_bf16_f32 v131, v6, v7
v_mfma_f32_16x16x32_bf16 a[76:79], a[204:207], a[248:251], a[76:79]
v_cvt_pk_bf16_f32 v132, v8, v9
v_cvt_pk_bf16_f32 v133, v10, v11
v_mfma_f32_16x16x32_bf16 a[72:75], a[200:203], a[248:251], a[72:75]
buffer_load_dwordx4 v[236:239], v198, s[76:79], s45 offen offset:0 sc1
v_mfma_f32_16x16x32_bf16 a[40:43], a[200:203], a[244:247], a[40:43]
v_cvt_pk_bf16_f32 v134, v12, v13
v_cvt_pk_bf16_f32 v135, v14, v15
v_mfma_f32_16x16x32_bf16 a[44:47], a[204:207], a[244:247], a[44:47]
v_cvt_pk_bf16_f32 v136, v16, v17
v_cvt_pk_bf16_f32 v137, v18, v19
v_mfma_f32_16x16x32_bf16 a[12:15], a[204:207], a[240:243], a[12:15]
v_cvt_pk_bf16_f32 v138, v20, v21
v_cvt_pk_bf16_f32 v139, v22, v23
v_mfma_f32_16x16x32_bf16 a[8:11], a[200:203], a[240:243], a[8:11]
v_cvt_pk_bf16_f32 v140, v24, v25
v_cvt_pk_bf16_f32 v141, v26, v27
v_mfma_f32_16x16x32_bf16 a[16:19], a[208:211], a[240:243], a[16:19]
buffer_store_dwordx4 v[128:131], v216, s[28:31], s33 offen offset:0 sc1
v_mfma_f32_16x16x32_bf16 a[20:23], a[212:215], a[240:243], a[20:23]
v_cvt_pk_bf16_f32 v142, v28, v29
v_cvt_pk_bf16_f32 v143, v30, v31
v_mfma_f32_16x16x32_bf16 a[52:55], a[212:215], a[244:247], a[52:55]
v_cvt_pk_bf16_f32 v144, v32, v33
v_cvt_pk_bf16_f32 v145, v34, v35
v_mfma_f32_16x16x32_bf16 a[48:51], a[208:211], a[244:247], a[48:51]
v_cvt_pk_bf16_f32 v146, v36, v37
v_cvt_pk_bf16_f32 v147, v38, v39
v_mfma_f32_16x16x32_bf16 a[80:83], a[208:211], a[248:251], a[80:83]
v_cvt_pk_bf16_f32 v148, v40, v41
v_cvt_pk_bf16_f32 v149, v42, v43
v_mfma_f32_16x16x32_bf16 a[84:87], a[212:215], a[248:251], a[84:87]
v_cvt_pk_bf16_f32 v150, v44, v45
v_cvt_pk_bf16_f32 v151, v46, v47
v_mfma_f32_16x16x32_bf16 a[116:119], a[212:215], a[252:255], a[116:119]
buffer_load_dwordx4 v[240:243], v198, s[76:79], s42 offen offset:256 sc1
v_mfma_f32_16x16x32_bf16 a[112:115], a[208:211], a[252:255], a[112:115]
v_cvt_pk_bf16_f32 v152, v48, v49
v_cvt_pk_bf16_f32 v153, v50, v51
v_mfma_f32_16x16x32_bf16 a[120:123], a[216:219], a[252:255], a[120:123]
v_mfma_f32_16x16x32_bf16 a[124:127], a[220:223], a[252:255], a[124:127]
v_cvt_pk_bf16_f32 v154, v52, v53
v_cvt_pk_bf16_f32 v155, v54, v55
v_mfma_f32_16x16x32_bf16 a[92:95], a[220:223], a[248:251], a[92:95]
v_cvt_pk_bf16_f32 v156, v56, v57
v_cvt_pk_bf16_f32 v157, v58, v59
v_mfma_f32_16x16x32_bf16 a[88:91], a[216:219], a[248:251], a[88:91]
buffer_load_dwordx4 v[244:247], v198, s[76:79], s43 offen offset:256 sc1
v_mfma_f32_16x16x32_bf16 a[56:59], a[216:219], a[244:247], a[56:59]
v_cvt_pk_bf16_f32 v158, v60, v61
v_cvt_pk_bf16_f32 v159, v62, v63
v_mfma_f32_16x16x32_bf16 a[60:63], a[220:223], a[244:247], a[60:63]
v_mfma_f32_16x16x32_bf16 a[28:31], a[220:223], a[240:243], a[28:31]
v_cvt_pk_bf16_f32 v160, v64, v65
v_cvt_pk_bf16_f32 v161, v66, v67
v_mfma_f32_16x16x32_bf16 a[24:27], a[216:219], a[240:243], a[24:27]
buffer_store_dwordx4 v[132:135], v216, s[28:31], s33 offen offset:1024 sc1
v_mfma_f32_16x16x32_bf16 a[0:3], a[128:131], a[176:179], a[0:3]
ds_read_b64_tr_b16 a[192:193], v204 offset:0
v_cvt_pk_bf16_f32 v162, v68, v69
v_mfma_f32_16x16x32_bf16 a[4:7], a[132:135], a[176:179], a[4:7]
ds_read_b64_tr_b16 a[194:195], v204 offset:1024
v_cvt_pk_bf16_f32 v163, v70, v71
v_mfma_f32_16x16x32_bf16 a[36:39], a[132:135], a[180:183], a[36:39]
ds_read_b64_tr_b16 a[196:197], v205 offset:0
v_cvt_pk_bf16_f32 v164, v72, v73
v_mfma_f32_16x16x32_bf16 a[32:35], a[128:131], a[180:183], a[32:35]
ds_read_b64_tr_b16 a[198:199], v205 offset:1024
v_cvt_pk_bf16_f32 v165, v74, v75
v_mfma_f32_16x16x32_bf16 a[64:67], a[128:131], a[184:187], a[64:67]
ds_read_b64_tr_b16 a[200:201], v206 offset:0
v_cvt_pk_bf16_f32 v166, v76, v77
v_mfma_f32_16x16x32_bf16 a[68:71], a[132:135], a[184:187], a[68:71]
buffer_load_dwordx4 v[248:251], v198, s[76:79], s44 offen offset:256 sc1
v_mfma_f32_16x16x32_bf16 a[100:103], a[132:135], a[188:191], a[100:103]
ds_read_b64_tr_b16 a[202:203], v206 offset:1024
v_cvt_pk_bf16_f32 v167, v78, v79
v_mfma_f32_16x16x32_bf16 a[96:99], a[128:131], a[188:191], a[96:99]
v_cvt_pk_bf16_f32 v168, v80, v81
v_cvt_pk_bf16_f32 v169, v82, v83
v_mfma_f32_16x16x32_bf16 a[104:107], a[136:139], a[188:191], a[104:107]
ds_read_b64_tr_b16 a[204:205], v207 offset:0
v_cvt_pk_bf16_f32 v170, v84, v85
v_mfma_f32_16x16x32_bf16 a[108:111], a[140:143], a[188:191], a[108:111]
ds_read_b64_tr_b16 a[206:207], v207 offset:1024
v_cvt_pk_bf16_f32 v171, v86, v87
v_mfma_f32_16x16x32_bf16 a[76:79], a[140:143], a[184:187], a[76:79]
buffer_load_dwordx4 v[252:255], v198, s[76:79], s45 offen offset:256 sc1
v_mfma_f32_16x16x32_bf16 a[72:75], a[136:139], a[184:187], a[72:75]
ds_read_b64_tr_b16 a[208:209], v208 offset:0
v_cvt_pk_bf16_f32 v172, v88, v89
v_mfma_f32_16x16x32_bf16 a[40:43], a[136:139], a[180:183], a[40:43]
ds_read_b64_tr_b16 a[210:211], v208 offset:1024
v_cvt_pk_bf16_f32 v173, v90, v91
v_mfma_f32_16x16x32_bf16 a[44:47], a[140:143], a[180:183], a[44:47]
ds_read_b64_tr_b16 a[212:213], v209 offset:0
v_cvt_pk_bf16_f32 v174, v92, v93
v_mfma_f32_16x16x32_bf16 a[12:15], a[140:143], a[176:179], a[12:15]
buffer_store_dwordx4 v[136:139], v216, s[28:31], s33 offen offset:2048 sc1
v_mfma_f32_16x16x32_bf16 a[8:11], a[136:139], a[176:179], a[8:11]
v_cvt_pk_bf16_f32 v175, v94, v95
v_cvt_pk_bf16_f32 v176, v96, v97
v_mfma_f32_16x16x32_bf16 a[16:19], a[144:147], a[176:179], a[16:19]
ds_read_b64_tr_b16 a[214:215], v209 offset:1024
v_cvt_pk_bf16_f32 v177, v98, v99
v_mfma_f32_16x16x32_bf16 a[20:23], a[148:151], a[176:179], a[20:23]
ds_read_b64_tr_b16 a[216:217], v210 offset:0
v_cvt_pk_bf16_f32 v178, v100, v101
v_mfma_f32_16x16x32_bf16 a[52:55], a[148:151], a[180:183], a[52:55]
ds_read_b64_tr_b16 a[218:219], v210 offset:1024
v_cvt_pk_bf16_f32 v179, v102, v103
v_mfma_f32_16x16x32_bf16 a[48:51], a[144:147], a[180:183], a[48:51]
ds_read_b64_tr_b16 a[220:221], v211 offset:0
v_cvt_pk_bf16_f32 v180, v104, v105
v_mfma_f32_16x16x32_bf16 a[80:83], a[144:147], a[184:187], a[80:83]
ds_read_b64_tr_b16 a[222:223], v211 offset:1024
v_cvt_pk_bf16_f32 v181, v106, v107
v_mfma_f32_16x16x32_bf16 a[84:87], a[148:151], a[184:187], a[84:87]
buffer_store_dwordx4 v[140:143], v216, s[28:31], s33 offen offset:3072 sc1
v_mfma_f32_16x16x32_bf16 a[116:119], a[148:151], a[188:191], a[116:119]
s_add_u32 s33, s33, 4096
v_cvt_pk_bf16_f32 v182, v108, v109
v_cvt_pk_bf16_f32 v183, v110, v111
v_mfma_f32_16x16x32_bf16 a[112:115], a[144:147], a[188:191], a[112:115]
v_cvt_pk_bf16_f32 v184, v112, v113
v_cvt_pk_bf16_f32 v185, v114, v115
v_mfma_f32_16x16x32_bf16 a[120:123], a[152:155], a[188:191], a[120:123]
v_cvt_pk_bf16_f32 v186, v116, v117
v_cvt_pk_bf16_f32 v187, v118, v119
v_mfma_f32_16x16x32_bf16 a[124:127], a[156:159], a[188:191], a[124:127]
v_cvt_pk_bf16_f32 v188, v120, v121
v_cvt_pk_bf16_f32 v189, v122, v123
v_mfma_f32_16x16x32_bf16 a[92:95], a[156:159], a[184:187], a[92:95]
v_cvt_pk_bf16_f32 v190, v124, v125
v_cvt_pk_bf16_f32 v191, v126, v127
v_mfma_f32_16x16x32_bf16 a[88:91], a[152:155], a[184:187], a[88:91]
v_mfma_f32_16x16x32_bf16 a[56:59], a[152:155], a[180:183], a[56:59]
v_mfma_f32_16x16x32_bf16 a[60:63], a[156:159], a[180:183], a[60:63]
v_mfma_f32_16x16x32_bf16 a[28:31], a[156:159], a[176:179], a[28:31]
v_mfma_f32_16x16x32_bf16 a[24:27], a[152:155], a[176:179], a[24:27]
s_branch LphB
LkvV:
Lpad4:
s_cbranch_execz Lpad8
s_lshl_b32 s38, s2, 1
s_and_b32 s6, s3, 1
s_add_u32 s38, s38, s6
s_waitcnt vmcnt(16) lgkmcnt(0)
s_barrier
ds_read_b64_tr_b16 a[224:225], v204 offset:0
ds_read_b64_tr_b16 a[226:227], v204 offset:1024
ds_read_b64_tr_b16 a[228:229], v205 offset:0
ds_read_b64_tr_b16 a[230:231], v205 offset:1024
ds_read_b64_tr_b16 a[232:233], v206 offset:0
ds_read_b64_tr_b16 a[234:235], v206 offset:1024
ds_read_b64_tr_b16 a[236:237], v207 offset:0
ds_read_b64_tr_b16 a[238:239], v207 offset:1024
ds_read_b64_tr_b16 a[240:241], v208 offset:0
ds_read_b64_tr_b16 a[242:243], v208 offset:1024
ds_read_b64_tr_b16 a[244:245], v209 offset:0
ds_read_b64_tr_b16 a[246:247], v209 offset:1024
s_waitcnt lgkmcnt(4)
ds_read_b64_tr_b16 a[248:249], v210 offset:0
ds_read_b64_tr_b16 a[250:251], v210 offset:1024
ds_read_b64_tr_b16 a[252:253], v211 offset:0
ds_read_b64_tr_b16 a[254:255], v211 offset:1024
ds_read_b128 a[192:195], v200 offset:0
ds_read_b128 a[196:199], v200 offset:2048
ds_read_b128 a[200:203], v200 offset:4096
ds_read_b128 a[204:207], v200 offset:6144
ds_read_b128 a[208:211], v200 offset:8192
ds_read_b128 a[212:215], v200 offset:10240
ds_read_b128 a[216:219], v200 offset:12288
ds_read_b128 a[220:223], v200 offset:14336
s_waitcnt lgkmcnt(0)
v_mfma_f32_16x16x32_bf16 v[0:3], a[192:195], a[224:227], 0
Lpad5:
s_cbranch_execz Lpad9
v_mfma_f32_16x16x32_bf16 v[4:7], a[196:199], a[224:227], 0
s_mov_b32 m0, 155648
ds_read_b128 v[144:147], v130 offset:0
ds_read_b64_tr_b16 v[164:165], v143 offset:0
v_mfma_f32_16x16x32_bf16 v[12:15], a[196:199], a[228:231], 0
buffer_load_dword v254, s[8:11], s34 offen offset:384 lds
v_mfma_f32_16x16x32_bf16 v[8:11], a[192:195], a[228:231], 0
ds_read_b64_tr_b16 v[166:167], v143 offset:512
ds_read_b128 v[148:151], v130 offset:64
v_mfma_f32_16x16x32_bf16 v[16:19], a[192:195], a[232:235], 0
ds_read_b64_tr_b16 v[168:169], v143 offset:4096
v_mfma_f32_16x16x32_bf16 v[20:23], a[196:199], a[232:235], 0
ds_read_b64_tr_b16 v[170:171], v143 offset:4608
ds_read_b128 v[152:155], v130 offset:128
v_mfma_f32_16x16x32_bf16 v[28:31], a[196:199], a[236:239], 0
ds_read_b64_tr_b16 v[172:173], v143 offset:8192
v_mfma_f32_16x16x32_bf16 v[24:27], a[192:195], a[236:239], 0
ds_read_b64_tr_b16 v[174:175], v143 offset:8704
ds_read_b128 v[156:159], v130 offset:192
v_mfma_f32_16x16x32_bf16 v[32:35], a[192:195], a[240:243], 0
buffer_load_dword v255, s[12:15], s35 offen lds
v_mfma_f32_16x16x32_bf16 v[36:39], a[196:199], a[240:243], 0
s_add_u32 s35, s35, 524288
ds_read_b64_tr_b16 v[176:177], v143 offset:12288
ds_read_b64_tr_b16 v[178:179], v143 offset:12800
v_mfma_f32_16x16x32_bf16 v[44:47], a[196:199], a[244:247], 0
ds_read_b128 v[160:163], v130 offset:256
v_mfma_f32_16x16x32_bf16 v[40:43], a[192:195], a[244:247], 0
ds_read_b64_tr_b16 v[180:181], v143 offset:16384
ds_read_b64_tr_b16 v[182:183], v143 offset:16896
v_mfma_f32_16x16x32_bf16 v[48:51], a[192:195], a[248:251], 0
v_mfma_f32_16x16x32_bf16 v[52:55], a[196:199], a[248:251], 0
v_mfma_f32_16x16x32_bf16 v[60:63], a[196:199], a[252:255], 0
v_mfma_f32_16x16x32_bf16 v[56:59], a[192:195], a[252:255], 0
v_mfma_f32_16x16x32_bf16 v[120:123], a[200:203], a[252:255], 0
v_mfma_f32_16x16x32_bf16 v[124:127], a[204:207], a[252:255], 0
s_waitcnt lgkmcnt(0)
v_mfma_f32_16x16x32_bf16 v[184:187], v[144:147], v[164:167], 0
v_mfma_f32_16x16x32_bf16 v[116:119], a[204:207], a[248:251], 0
v_mfma_f32_16x16x32_bf16 v[184:187], v[148:151], v[168:171], v[184:187]
v_mfma_f32_16x16x32_bf16 v[112:115], a[200:203], a[248:251], 0
v_mfma_f32_16x16x32_bf16 v[184:187], v[152:155], v[172:175], v[184:187]
v_mfma_f32_16x16x32_bf16 v[104:107], a[200:203], a[244:247], 0
v_mfma_f32_16x16x32_bf16 v[184:187], v[156:159], v[176:179], v[184:187]
v_mfma_f32_16x16x32_bf16 v[108:111], a[204:207], a[244:247], 0
v_mfma_f32_16x16x32_bf16 v[184:187], v[160:163], v[180:183], v[184:187]
v_mfma_f32_16x16x32_bf16 v[100:103], a[204:207], a[240:243], 0
ds_read_b64_tr_b16 a[160:161], v204 offset:8192
ds_read_b64_tr_b16 a[162:163], v204 offset:9216
v_mfma_f32_16x16x32_bf16 v[96:99], a[200:203], a[240:243], 0
ds_read_b64_tr_b16 a[164:165], v205 offset:8192
ds_read_b64_tr_b16 a[166:167], v205 offset:9216
v_mfma_f32_16x16x32_bf16 v[88:91], a[200:203], a[236:239], 0
ds_read_b64_tr_b16 a[168:169], v206 offset:8192
ds_read_b64_tr_b16 a[170:171], v206 offset:9216
v_mfma_f32_16x16x32_bf16 v[92:95], a[204:207], a[236:239], 0
v_mfma_f32_16x16x32_bf16 v[84:87], a[204:207], a[232:235], 0
ds_read_b64_tr_b16 a[172:173], v207 offset:8192
ds_read_b64_tr_b16 a[174:175], v207 offset:9216
v_mfma_f32_16x16x32_bf16 v[80:83], a[200:203], a[232:235], 0
v_mfma_f32_16x16x32_bf16 v[72:75], a[200:203], a[228:231], 0
v_mfma_f32_16x16x32_bf16 v[76:79], a[204:207], a[228:231], 0
s_mov_b64 exec, 0xffff
buffer_store_dword v184, v134, s[20:23], s79 offen sc1
s_mov_b64 exec, -1
v_mfma_f32_16x16x32_bf16 v[68:71], a[204:207], a[224:227], 0
ds_read_b64_tr_b16 a[176:177], v208 offset:8192
ds_read_b64_tr_b16 a[178:179], v208 offset:9216
v_mfma_f32_16x16x32_bf16 v[64:67], a[200:203], a[224:227], 0
v_mfma_f32_16x16x32_bf16 a[0:3], a[208:211], a[224:227], 0
ds_read_b64_tr_b16 a[180:181], v209 offset:8192
ds_read_b64_tr_b16 a[182:183], v209 offset:9216
v_mfma_f32_16x16x32_bf16 a[4:7], a[212:215], a[224:227], 0
v_mfma_f32_16x16x32_bf16 a[12:15], a[212:215], a[228:231], 0
v_mfma_f32_16x16x32_bf16 a[8:11], a[208:211], a[228:231], 0
ds_read_b64_tr_b16 a[184:185], v210 offset:8192
ds_read_b64_tr_b16 a[186:187], v210 offset:9216
v_mfma_f32_16x16x32_bf16 a[16:19], a[208:211], a[232:235], 0
v_mfma_f32_16x16x32_bf16 a[20:23], a[212:215], a[232:235], 0
v_mfma_f32_16x16x32_bf16 a[28:31], a[212:215], a[236:239], 0
ds_read_b64_tr_b16 a[188:189], v211 offset:8192
ds_read_b64_tr_b16 a[190:191], v211 offset:9216
v_mfma_f32_16x16x32_bf16 a[24:27], a[208:211], a[236:239], 0
v_mfma_f32_16x16x32_bf16 a[32:35], a[208:211], a[240:243], 0
v_mfma_f32_16x16x32_bf16 a[36:39], a[212:215], a[240:243], 0
ds_read_b128 a[128:131], v201 offset:0
ds_read_b128 a[132:135], v201 offset:2048
v_mfma_f32_16x16x32_bf16 a[44:47], a[212:215], a[244:247], 0
v_mfma_f32_16x16x32_bf16 a[40:43], a[208:211], a[244:247], 0
v_mfma_f32_16x16x32_bf16 a[48:51], a[208:211], a[248:251], 0
ds_read_b128 a[136:139], v201 offset:4096
ds_read_b128 a[140:143], v201 offset:6144
v_mfma_f32_16x16x32_bf16 a[52:55], a[212:215], a[248:251], 0
v_mfma_f32_16x16x32_bf16 a[60:63], a[212:215], a[252:255], 0
v_mfma_f32_16x16x32_bf16 a[56:59], a[208:211], a[252:255], 0
ds_read_b128 a[144:147], v201 offset:8192
ds_read_b128 a[148:151], v201 offset:10240
v_mfma_f32_16x16x32_bf16 a[120:123], a[216:219], a[252:255], 0
v_mfma_f32_16x16x32_bf16 a[124:127], a[220:223], a[252:255], 0
v_mfma_f32_16x16x32_bf16 a[116:119], a[220:223], a[248:251], 0
ds_read_b128 a[152:155], v201 offset:12288
ds_read_b128 a[156:159], v201 offset:14336
v_mfma_f32_16x16x32_bf16 a[112:115], a[216:219], a[248:251], 0
v_mfma_f32_16x16x32_bf16 a[104:107], a[216:219], a[244:247], 0
v_mfma_f32_16x16x32_bf16 a[108:111], a[220:223], a[244:247], 0
v_mfma_f32_16x16x32_bf16 a[100:103], a[220:223], a[240:243], 0
v_mfma_f32_16x16x32_bf16 a[96:99], a[216:219], a[240:243], 0
v_mfma_f32_16x16x32_bf16 a[88:91], a[216:219], a[236:239], 0
v_mfma_f32_16x16x32_bf16 a[92:95], a[220:223], a[236:239], 0
v_mfma_f32_16x16x32_bf16 a[84:87], a[220:223], a[232:235], 0
v_mfma_f32_16x16x32_bf16 a[80:83], a[216:219], a[232:235], 0
v_mfma_f32_16x16x32_bf16 a[72:75], a[216:219], a[228:231], 0
v_mfma_f32_16x16x32_bf16 a[76:79], a[220:223], a[228:231], 0
v_mfma_f32_16x16x32_bf16 a[68:71], a[220:223], a[224:227], 0
v_mfma_f32_16x16x32_bf16 a[64:67], a[216:219], a[224:227], 0
s_waitcnt vmcnt(0) lgkmcnt(0)
v_mfma_f32_16x16x32_bf16 v[0:3], a[128:131], a[160:163], v[0:3]
s_barrier
v_mfma_f32_16x16x32_bf16 v[4:7], a[132:135], a[160:163], v[4:7]
s_add_u32 m0, s32, 0
ds_read_b64_tr_b16 a[224:225], v212 offset:0
ds_read_b64_tr_b16 a[226:227], v212 offset:1024
v_mfma_f32_16x16x32_bf16 v[12:15], a[132:135], a[164:167], v[12:15]
buffer_load_dwordx4 v192, s[8:11], s68 offen offset:0 lds
v_mfma_f32_16x16x32_bf16 v[8:11], a[128:131], a[164:167], v[8:11]
v_mfma_f32_16x16x32_bf16 v[16:19], a[128:131], a[168:171], v[16:19]
buffer_load_dwordx4 v193, s[8:11], s68 offen offset:1024 lds
v_mfma_f32_16x16x32_bf16 v[20:23], a[132:135], a[168:171], v[20:23]
ds_read_b64_tr_b16 a[228:229], v213 offset:0
ds_read_b64_tr_b16 a[230:231], v213 offset:1024
v_mfma_f32_16x16x32_bf16 v[28:31], a[132:135], a[172:175], v[28:31]
v_mfma_f32_16x16x32_bf16 v[24:27], a[128:131], a[172:175], v[24:27]
v_mfma_f32_16x16x32_bf16 v[32:35], a[128:131], a[176:179], v[32:35]
buffer_load_dwordx4 v194, s[8:11], s68 offen offset:2048 lds
v_mfma_f32_16x16x32_bf16 v[36:39], a[132:135], a[176:179], v[36:39]
ds_read_b64_tr_b16 a[232:233], v214 offset:0
ds_read_b64_tr_b16 a[234:235], v214 offset:1024
v_mfma_f32_16x16x32_bf16 v[44:47], a[132:135], a[180:183], v[44:47]
v_mfma_f32_16x16x32_bf16 v[40:43], a[128:131], a[180:183], v[40:43]
v_mfma_f32_16x16x32_bf16 v[48:51], a[128:131], a[184:187], v[48:51]
buffer_load_dwordx4 v195, s[8:11], s68 offen offset:3072 lds
v_mfma_f32_16x16x32_bf16 v[52:55], a[132:135], a[184:187], v[52:55]
s_add_u32 m0, s32, 4096
ds_read_b64_tr_b16 a[236:237], v215 offset:0
ds_read_b64_tr_b16 a[238:239], v215 offset:1024
v_mfma_f32_16x16x32_bf16 v[60:63], a[132:135], a[188:191], v[60:63]
v_mfma_f32_16x16x32_bf16 v[56:59], a[128:131], a[188:191], v[56:59]
ds_read_b64_tr_b16 a[240:241], v217 offset:0
ds_read_b64_tr_b16 a[242:243], v217 offset:1024
v_mfma_f32_16x16x32_bf16 v[120:123], a[136:139], a[188:191], v[120:123]
v_mfma_f32_16x16x32_bf16 v[124:127], a[140:143], a[188:191], v[124:127]
buffer_load_dwordx4 v192, s[8:11], s69 offen offset:0 lds
v_mfma_f32_16x16x32_bf16 v[116:119], a[140:143], a[184:187], v[116:119]
v_mfma_f32_16x16x32_bf16 v[112:115], a[136:139], a[184:187], v[112:115]
ds_read_b64_tr_b16 a[244:245], v218 offset:0
ds_read_b64_tr_b16 a[246:247], v218 offset:1024
v_mfma_f32_16x16x32_bf16 v[104:107], a[136:139], a[180:183], v[104:107]
v_mfma_f32_16x16x32_bf16 v[108:111], a[140:143], a[180:183], v[108:111]
buffer_load_dwordx4 v193, s[8:11], s69 offen offset:1024 lds
v_mfma_f32_16x16x32_bf16 v[100:103], a[140:143], a[176:179], v[100:103]
v_mfma_f32_16x16x32_bf16 v[96:99], a[136:139], a[176:179], v[96:99]
ds_read_b64_tr_b16 a[248:249], v221 offset:0
ds_read_b64_tr_b16 a[250:251], v221 offset:1024
v_mfma_f32_16x16x32_bf16 v[88:91], a[136:139], a[172:175], v[88:91]
v_mfma_f32_16x16x32_bf16 v[92:95], a[140:143], a[172:175], v[92:95]
buffer_load_dwordx4 v194, s[8:11], s69 offen offset:2048 lds
v_mfma_f32_16x16x32_bf16 v[84:87], a[140:143], a[168:171], v[84:87]
ds_read_b64_tr_b16 a[252:253], v222 offset:0
ds_read_b64_tr_b16 a[254:255], v222 offset:1024
v_mfma_f32_16x16x32_bf16 v[80:83], a[136:139], a[168:171], v[80:83]
v_mfma_f32_16x16x32_bf16 v[72:75], a[136:139], a[164:167], v[72:75]
v_mfma_f32_16x16x32_bf16 v[76:79], a[140:143], a[164:167], v[76:79]
v_mfma_f32_16x16x32_bf16 v[68:71], a[140:143], a[160:163], v[68:71]
buffer_load_dwordx4 v195, s[8:11], s69 offen offset:3072 lds
v_mfma_f32_16x16x32_bf16 v[64:67], a[136:139], a[160:163], v[64:67]
s_add_u32 m0, s32, 32768
ds_read_b128 a[192:195], v202 offset:0
ds_read_b128 a[196:199], v202 offset:2048
v_mfma_f32_16x16x32_bf16 a[0:3], a[144:147], a[160:163], a[0:3]
v_mfma_f32_16x16x32_bf16 a[4:7], a[148:151], a[160:163], a[4:7]
v_mfma_f32_16x16x32_bf16 a[12:15], a[148:151], a[164:167], a[12:15]
buffer_load_dwordx4 v196, s[12:15], s70 offen offset:0 lds
v_mfma_f32_16x16x32_bf16 a[8:11], a[144:147], a[164:167], a[8:11]
ds_read_b128 a[200:203], v202 offset:4096
ds_read_b128 a[204:207], v202 offset:6144
v_mfma_f32_16x16x32_bf16 a[16:19], a[144:147], a[168:171], a[16:19]
v_mfma_f32_16x16x32_bf16 a[20:23], a[148:151], a[168:171], a[20:23]
ds_read_b128 a[208:211], v202 offset:8192
ds_read_b128 a[212:215], v202 offset:10240
v_mfma_f32_16x16x32_bf16 a[28:31], a[148:151], a[172:175], a[28:31]
buffer_load_dwordx4 v197, s[12:15], s70 offen offset:1024 lds
v_mfma_f32_16x16x32_bf16 a[24:27], a[144:147], a[172:175], a[24:27]
v_mfma_f32_16x16x32_bf16 a[32:35], a[144:147], a[176:179], a[32:35]
v_mfma_f32_16x16x32_bf16 a[36:39], a[148:151], a[176:179], a[36:39]
ds_read_b128 a[216:219], v202 offset:12288
ds_read_b128 a[220:223], v202 offset:14336
v_mfma_f32_16x16x32_bf16 a[44:47], a[148:151], a[180:183], a[44:47]
v_mfma_f32_16x16x32_bf16 a[40:43], a[144:147], a[180:183], a[40:43]
buffer_load_dwordx4 v198, s[12:15], s70 offen offset:2048 lds
v_mfma_f32_16x16x32_bf16 a[48:51], a[144:147], a[184:187], a[48:51]
v_mfma_f32_16x16x32_bf16 a[52:55], a[148:151], a[184:187], a[52:55]
v_mfma_f32_16x16x32_bf16 a[60:63], a[148:151], a[188:191], a[60:63]
v_mfma_f32_16x16x32_bf16 a[56:59], a[144:147], a[188:191], a[56:59]
buffer_load_dwordx4 v199, s[12:15], s70 offen offset:3072 lds
v_mfma_f32_16x16x32_bf16 a[120:123], a[152:155], a[188:191], a[120:123]
s_add_u32 m0, s32, 36864
v_mfma_f32_16x16x32_bf16 a[124:127], a[156:159], a[188:191], a[124:127]
v_mfma_f32_16x16x32_bf16 a[116:119], a[156:159], a[184:187], a[116:119]
v_mfma_f32_16x16x32_bf16 a[112:115], a[152:155], a[184:187], a[112:115]
buffer_load_dwordx4 v196, s[12:15], s71 offen offset:0 lds
v_mfma_f32_16x16x32_bf16 a[104:107], a[152:155], a[180:183], a[104:107]
v_mfma_f32_16x16x32_bf16 a[108:111], a[156:159], a[180:183], a[108:111]
v_mfma_f32_16x16x32_bf16 a[100:103], a[156:159], a[176:179], a[100:103]
v_mfma_f32_16x16x32_bf16 a[96:99], a[152:155], a[176:179], a[96:99]
v_mfma_f32_16x16x32_bf16 a[88:91], a[152:155], a[172:175], a[88:91]
buffer_load_dwordx4 v197, s[12:15], s71 offen offset:1024 lds
v_mfma_f32_16x16x32_bf16 a[92:95], a[156:159], a[172:175], a[92:95]
v_mfma_f32_16x16x32_bf16 a[84:87], a[156:159], a[168:171], a[84:87]
v_mfma_f32_16x16x32_bf16 a[80:83], a[152:155], a[168:171], a[80:83]
v_mfma_f32_16x16x32_bf16 a[72:75], a[152:155], a[164:167], a[72:75]
buffer_load_dwordx4 v198, s[12:15], s71 offen offset:2048 lds
v_mfma_f32_16x16x32_bf16 a[76:79], a[156:159], a[164:167], a[76:79]
v_mfma_f32_16x16x32_bf16 a[68:71], a[156:159], a[160:163], a[68:71]
v_mfma_f32_16x16x32_bf16 a[64:67], a[152:155], a[160:163], a[64:67]
s_waitcnt lgkmcnt(0)
v_mfma_f32_16x16x32_bf16 v[0:3], a[192:195], a[224:227], v[0:3]
v_mfma_f32_16x16x32_bf16 v[4:7], a[196:199], a[224:227], v[4:7]
buffer_load_dwordx4 v199, s[12:15], s71 offen offset:3072 lds
v_mfma_f32_16x16x32_bf16 v[12:15], a[196:199], a[228:231], v[12:15]
s_add_u32 s68, s68, 128
ds_read_b64_tr_b16 a[160:161], v212 offset:8192
s_add_u32 s69, s69, 128
v_mfma_f32_16x16x32_bf16 v[8:11], a[192:195], a[228:231], v[8:11]
s_add_u32 s70, s70, 524288
s_add_u32 s71, s71, 524288
v_mov_b32 v251, 0
v_mfma_f32_16x16x32_bf16 v[16:19], a[192:195], a[232:235], v[16:19]
s_mov_b32 m0, 155648
ds_read_b64_tr_b16 a[162:163], v212 offset:9216
v_lshrrev_b32 v252, 5, v220
v_mfma_f32_16x16x32_bf16 v[20:23], a[196:199], a[232:235], v[20:23]
buffer_load_dword v254, s[8:11], s34 offen offset:512 lds
v_mfma_f32_16x16x32_bf16 v[28:31], a[196:199], a[236:239], v[28:31]
ds_read_b64_tr_b16 a[164:165], v213 offset:8192
v_lshl_add_u32 v252, v252, 30, v216
v_mfma_f32_16x16x32_bf16 v[24:27], a[192:195], a[236:239], v[24:27]
ds_read_b64_tr_b16 a[166:167], v213 offset:9216
ds_read_b64_tr_b16 a[168:169], v214 offset:8192
v_mfma_f32_16x16x32_bf16 v[32:35], a[192:195], a[240:243], v[32:35]
v_mfma_f32_16x16x32_bf16 v[36:39], a[196:199], a[240:243], v[36:39]
v_mfma_f32_16x16x32_bf16 v[44:47], a[196:199], a[244:247], v[44:47]
ds_read_b64_tr_b16 a[170:171], v214 offset:9216
ds_read_b64_tr_b16 a[172:173], v215 offset:8192
v_mfma_f32_16x16x32_bf16 v[40:43], a[192:195], a[244:247], v[40:43]
v_mfma_f32_16x16x32_bf16 v[48:51], a[192:195], a[248:251], v[48:51]
v_mfma_f32_16x16x32_bf16 v[52:55], a[196:199], a[248:251], v[52:55]
buffer_load_dword v255, s[12:15], s35 offen lds
v_mfma_f32_16x16x32_bf16 v[60:63], a[196:199], a[252:255], v[60:63]
s_add_u32 s35, s35, 524288
ds_read_b64_tr_b16 a[174:175], v215 offset:9216
ds_read_b64_tr_b16 a[176:177], v217 offset:8192
v_mfma_f32_16x16x32_bf16 v[56:59], a[192:195], a[252:255], v[56:59]
v_mfma_f32_16x16x32_bf16 v[120:123], a[200:203], a[252:255], v[120:123]
v_mfma_f32_16x16x32_bf16 v[124:127], a[204:207], a[252:255], v[124:127]
ds_read_b64_tr_b16 a[178:179], v217 offset:9216
ds_read_b64_tr_b16 a[180:181], v218 offset:8192
v_mfma_f32_16x16x32_bf16 v[116:119], a[204:207], a[248:251], v[116:119]
v_mfma_f32_16x16x32_bf16 v[112:115], a[200:203], a[248:251], v[112:115]
v_mfma_f32_16x16x32_bf16 v[104:107], a[200:203], a[244:247], v[104:107]
v_mfma_f32_16x16x32_bf16 v[108:111], a[204:207], a[244:247], v[108:111]
ds_read_b64_tr_b16 a[182:183], v218 offset:9216
ds_read_b64_tr_b16 a[184:185], v221 offset:8192
v_mfma_f32_16x16x32_bf16 v[100:103], a[204:207], a[240:243], v[100:103]
v_mfma_f32_16x16x32_bf16 v[96:99], a[200:203], a[240:243], v[96:99]
v_mfma_f32_16x16x32_bf16 v[88:91], a[200:203], a[236:239], v[88:91]
ds_read_b64_tr_b16 a[186:187], v221 offset:9216
ds_read_b64_tr_b16 a[188:189], v222 offset:8192
v_mfma_f32_16x16x32_bf16 v[92:95], a[204:207], a[236:239], v[92:95]
v_mfma_f32_16x16x32_bf16 v[84:87], a[204:207], a[232:235], v[84:87]
v_mfma_f32_16x16x32_bf16 v[80:83], a[200:203], a[232:235], v[80:83]
v_mfma_f32_16x16x32_bf16 v[72:75], a[200:203], a[228:231], v[72:75]
ds_read_b64_tr_b16 a[190:191], v222 offset:9216
ds_read_b128 a[128:131], v203 offset:0
v_mfma_f32_16x16x32_bf16 v[76:79], a[204:207], a[228:231], v[76:79]
v_mfma_f32_16x16x32_bf16 v[68:71], a[204:207], a[224:227], v[68:71]
v_mfma_f32_16x16x32_bf16 v[64:67], a[200:203], a[224:227], v[64:67]
v_mfma_f32_16x16x32_bf16 a[0:3], a[208:211], a[224:227], a[0:3]
ds_read_b128 a[132:135], v203 offset:2048
ds_read_b128 a[136:139], v203 offset:4096
v_mfma_f32_16x16x32_bf16 a[4:7], a[212:215], a[224:227], a[4:7]
v_mfma_f32_16x16x32_bf16 a[12:15], a[212:215], a[228:231], a[12:15]
v_mfma_f32_16x16x32_bf16 a[8:11], a[208:211], a[228:231], a[8:11]
ds_read_b128 a[140:143], v203 offset:6144
ds_read_b128 a[144:147], v203 offset:8192
v_mfma_f32_16x16x32_bf16 a[16:19], a[208:211], a[232:235], a[16:19]
v_mfma_f32_16x16x32_bf16 a[20:23], a[212:215], a[232:235], a[20:23]
v_mfma_f32_16x16x32_bf16 a[28:31], a[212:215], a[236:239], a[28:31]
v_mfma_f32_16x16x32_bf16 a[24:27], a[208:211], a[236:239], a[24:27]
ds_read_b128 a[148:151], v203 offset:10240
ds_read_b128 a[152:155], v203 offset:12288
v_mfma_f32_16x16x32_bf16 a[32:35], a[208:211], a[240:243], a[32:35]
v_mfma_f32_16x16x32_bf16 a[36:39], a[212:215], a[240:243], a[36:39]
v_mfma_f32_16x16x32_bf16 a[44:47], a[212:215], a[244:247], a[44:47]
v_mfma_f32_16x16x32_bf16 a[40:43], a[208:211], a[244:247], a[40:43]
ds_read_b128 a[156:159], v203 offset:14336
v_mfma_f32_16x16x32_bf16 a[48:51], a[208:211], a[248:251], a[48:51]
v_mfma_f32_16x16x32_bf16 a[52:55], a[212:215], a[248:251], a[52:55]
v_mfma_f32_16x16x32_bf16 a[60:63], a[212:215], a[252:255], a[60:63]
v_mfma_f32_16x16x32_bf16 a[56:59], a[208:211], a[252:255], a[56:59]
v_mfma_f32_16x16x32_bf16 a[120:123], a[216:219], a[252:255], a[120:123]
v_mfma_f32_16x16x32_bf16 a[124:127], a[220:223], a[252:255], a[124:127]
v_mfma_f32_16x16x32_bf16 a[116:119], a[220:223], a[248:251], a[116:119]
v_mfma_f32_16x16x32_bf16 a[112:115], a[216:219], a[248:251], a[112:115]
v_mfma_f32_16x16x32_bf16 a[104:107], a[216:219], a[244:247], a[104:107]
v_mfma_f32_16x16x32_bf16 a[108:111], a[220:223], a[244:247], a[108:111]
v_mfma_f32_16x16x32_bf16 a[100:103], a[220:223], a[240:243], a[100:103]
v_mfma_f32_16x16x32_bf16 a[96:99], a[216:219], a[240:243], a[96:99]
v_mfma_f32_16x16x32_bf16 a[88:91], a[216:219], a[236:239], a[88:91]
v_mfma_f32_16x16x32_bf16 a[92:95], a[220:223], a[236:239], a[92:95]
v_mfma_f32_16x16x32_bf16 a[84:87], a[220:223], a[232:235], a[84:87]
v_mfma_f32_16x16x32_bf16 a[80:83], a[216:219], a[232:235], a[80:83]
v_mfma_f32_16x16x32_bf16 a[72:75], a[216:219], a[228:231], a[72:75]
v_mfma_f32_16x16x32_bf16 a[76:79], a[220:223], a[228:231], a[76:79]
v_mfma_f32_16x16x32_bf16 a[68:71], a[220:223], a[224:227], a[68:71]
v_mfma_f32_16x16x32_bf16 a[64:67], a[216:219], a[224:227], a[64:67]
s_waitcnt vmcnt(2) lgkmcnt(0)
v_mfma_f32_16x16x32_bf16 v[0:3], a[128:131], a[160:163], v[0:3]
s_barrier
v_mfma_f32_16x16x32_bf16 v[4:7], a[132:135], a[160:163], v[4:7]
s_add_u32 m0, s32, 65536
ds_read_b64_tr_b16 a[224:225], v204 offset:0
ds_read_b64_tr_b16 a[226:227], v204 offset:1024
v_mfma_f32_16x16x32_bf16 v[12:15], a[132:135], a[164:167], v[12:15]
buffer_load_dwordx4 v192, s[8:11], s68 offen offset:0 lds
v_mfma_f32_16x16x32_bf16 v[8:11], a[128:131], a[164:167], v[8:11]
v_mfma_f32_16x16x32_bf16 v[16:19], a[128:131], a[168:171], v[16:19]
buffer_load_dwordx4 v193, s[8:11], s68 offen offset:1024 lds
v_mfma_f32_16x16x32_bf16 v[20:23], a[132:135], a[168:171], v[20:23]
ds_read_b64_tr_b16 a[228:229], v205 offset:0
ds_read_b64_tr_b16 a[230:231], v205 offset:1024
v_mfma_f32_16x16x32_bf16 v[28:31], a[132:135], a[172:175], v[28:31]
v_mfma_f32_16x16x32_bf16 v[24:27], a[128:131], a[172:175], v[24:27]
v_mfma_f32_16x16x32_bf16 v[32:35], a[128:131], a[176:179], v[32:35]
buffer_load_dwordx4 v194, s[8:11], s68 offen offset:2048 lds
v_mfma_f32_16x16x32_bf16 v[36:39], a[132:135], a[176:179], v[36:39]
ds_read_b64_tr_b16 a[232:233], v206 offset:0
ds_read_b64_tr_b16 a[234:235], v206 offset:1024
v_mfma_f32_16x16x32_bf16 v[44:47], a[132:135], a[180:183], v[44:47]
v_mfma_f32_16x16x32_bf16 v[40:43], a[128:131], a[180:183], v[40:43]
v_mfma_f32_16x16x32_bf16 v[48:51], a[128:131], a[184:187], v[48:51]
buffer_load_dwordx4 v195, s[8:11], s68 offen offset:3072 lds
v_mfma_f32_16x16x32_bf16 v[52:55], a[132:135], a[184:187], v[52:55]
s_add_u32 m0, s32, 69632
ds_read_b64_tr_b16 a[236:237], v207 offset:0
ds_read_b64_tr_b16 a[238:239], v207 offset:1024
v_mfma_f32_16x16x32_bf16 v[60:63], a[132:135], a[188:191], v[60:63]
v_mfma_f32_16x16x32_bf16 v[56:59], a[128:131], a[188:191], v[56:59]
ds_read_b64_tr_b16 a[240:241], v208 offset:0
ds_read_b64_tr_b16 a[242:243], v208 offset:1024
v_mfma_f32_16x16x32_bf16 v[120:123], a[136:139], a[188:191], v[120:123]
v_mfma_f32_16x16x32_bf16 v[124:127], a[140:143], a[188:191], v[124:127]
buffer_load_dwordx4 v192, s[8:11], s69 offen offset:0 lds
v_mfma_f32_16x16x32_bf16 v[116:119], a[140:143], a[184:187], v[116:119]
v_mfma_f32_16x16x32_bf16 v[112:115], a[136:139], a[184:187], v[112:115]
ds_read_b64_tr_b16 a[244:245], v209 offset:0
ds_read_b64_tr_b16 a[246:247], v209 offset:1024
v_mfma_f32_16x16x32_bf16 v[104:107], a[136:139], a[180:183], v[104:107]
v_mfma_f32_16x16x32_bf16 v[108:111], a[140:143], a[180:183], v[108:111]
buffer_load_dwordx4 v193, s[8:11], s69 offen offset:1024 lds
v_mfma_f32_16x16x32_bf16 v[100:103], a[140:143], a[176:179], v[100:103]
v_mfma_f32_16x16x32_bf16 v[96:99], a[136:139], a[176:179], v[96:99]
ds_read_b64_tr_b16 a[248:249], v210 offset:0
ds_read_b64_tr_b16 a[250:251], v210 offset:1024
v_mfma_f32_16x16x32_bf16 v[88:91], a[136:139], a[172:175], v[88:91]
v_mfma_f32_16x16x32_bf16 v[92:95], a[140:143], a[172:175], v[92:95]
buffer_load_dwordx4 v194, s[8:11], s69 offen offset:2048 lds
v_mfma_f32_16x16x32_bf16 v[84:87], a[140:143], a[168:171], v[84:87]
ds_read_b64_tr_b16 a[252:253], v211 offset:0
ds_read_b64_tr_b16 a[254:255], v211 offset:1024
v_mfma_f32_16x16x32_bf16 v[80:83], a[136:139], a[168:171], v[80:83]
v_mfma_f32_16x16x32_bf16 v[72:75], a[136:139], a[164:167], v[72:75]
v_mfma_f32_16x16x32_bf16 v[76:79], a[140:143], a[164:167], v[76:79]
v_mfma_f32_16x16x32_bf16 v[68:71], a[140:143], a[160:163], v[68:71]
buffer_load_dwordx4 v195, s[8:11], s69 offen offset:3072 lds
v_mfma_f32_16x16x32_bf16 v[64:67], a[136:139], a[160:163], v[64:67]
s_add_u32 m0, s32, 98304
ds_read_b128 a[192:195], v200 offset:0
ds_read_b128 a[196:199], v200 offset:2048
v_mfma_f32_16x16x32_bf16 a[0:3], a[144:147], a[160:163], a[0:3]
v_mfma_f32_16x16x32_bf16 a[4:7], a[148:151], a[160:163], a[4:7]
v_mfma_f32_16x16x32_bf16 a[12:15], a[148:151], a[164:167], a[12:15]
buffer_load_dwordx4 v196, s[12:15], s70 offen offset:0 lds
v_mfma_f32_16x16x32_bf16 a[8:11], a[144:147], a[164:167], a[8:11]
ds_read_b128 a[200:203], v200 offset:4096
ds_read_b128 a[204:207], v200 offset:6144
v_mfma_f32_16x16x32_bf16 a[16:19], a[144:147], a[168:171], a[16:19]
v_mfma_f32_16x16x32_bf16 a[20:23], a[148:151], a[168:171], a[20:23]
ds_read_b128 a[208:211], v200 offset:8192
ds_read_b128 a[212:215], v200 offset:10240
v_mfma_f32_16x16x32_bf16 a[28:31], a[148:151], a[172:175], a[28:31]
buffer_load_dwordx4 v197, s[12:15], s70 offen offset:1024 lds
v_mfma_f32_16x16x32_bf16 a[24:27], a[144:147], a[172:175], a[24:27]
v_mfma_f32_16x16x32_bf16 a[32:35], a[144:147], a[176:179], a[32:35]
v_mfma_f32_16x16x32_bf16 a[36:39], a[148:151], a[176:179], a[36:39]
ds_read_b128 a[216:219], v200 offset:12288
ds_read_b128 a[220:223], v200 offset:14336
v_mfma_f32_16x16x32_bf16 a[44:47], a[148:151], a[180:183], a[44:47]
v_mfma_f32_16x16x32_bf16 a[40:43], a[144:147], a[180:183], a[40:43]
buffer_load_dwordx4 v198, s[12:15], s70 offen offset:2048 lds
v_mfma_f32_16x16x32_bf16 a[48:51], a[144:147], a[184:187], a[48:51]
v_mfma_f32_16x16x32_bf16 a[52:55], a[148:151], a[184:187], a[52:55]
v_mfma_f32_16x16x32_bf16 a[60:63], a[148:151], a[188:191], a[60:63]
v_mfma_f32_16x16x32_bf16 a[56:59], a[144:147], a[188:191], a[56:59]
buffer_load_dwordx4 v199, s[12:15], s70 offen offset:3072 lds
v_mfma_f32_16x16x32_bf16 a[120:123], a[152:155], a[188:191], a[120:123]
s_add_u32 m0, s32, 102400
v_mfma_f32_16x16x32_bf16 a[124:127], a[156:159], a[188:191], a[124:127]
v_mfma_f32_16x16x32_bf16 a[116:119], a[156:159], a[184:187], a[116:119]
v_mfma_f32_16x16x32_bf16 a[112:115], a[152:155], a[184:187], a[112:115]
buffer_load_dwordx4 v196, s[12:15], s71 offen offset:0 lds
v_mfma_f32_16x16x32_bf16 a[104:107], a[152:155], a[180:183], a[104:107]
v_mfma_f32_16x16x32_bf16 a[108:111], a[156:159], a[180:183], a[108:111]
v_mfma_f32_16x16x32_bf16 a[100:103], a[156:159], a[176:179], a[100:103]
v_mfma_f32_16x16x32_bf16 a[96:99], a[152:155], a[176:179], a[96:99]
v_mfma_f32_16x16x32_bf16 a[88:91], a[152:155], a[172:175], a[88:91]
buffer_load_dwordx4 v197, s[12:15], s71 offen offset:1024 lds
v_mfma_f32_16x16x32_bf16 a[92:95], a[156:159], a[172:175], a[92:95]
v_mfma_f32_16x16x32_bf16 a[84:87], a[156:159], a[168:171], a[84:87]
v_mfma_f32_16x16x32_bf16 a[80:83], a[152:155], a[168:171], a[80:83]
v_mfma_f32_16x16x32_bf16 a[72:75], a[152:155], a[164:167], a[72:75]
buffer_load_dwordx4 v198, s[12:15], s71 offen offset:2048 lds
v_mfma_f32_16x16x32_bf16 a[76:79], a[156:159], a[164:167], a[76:79]
v_mfma_f32_16x16x32_bf16 a[68:71], a[156:159], a[160:163], a[68:71]
v_mfma_f32_16x16x32_bf16 a[64:67], a[152:155], a[160:163], a[64:67]
s_waitcnt lgkmcnt(0)
v_mfma_f32_16x16x32_bf16 v[0:3], a[192:195], a[224:227], v[0:3]
v_mfma_f32_16x16x32_bf16 v[4:7], a[196:199], a[224:227], v[4:7]
buffer_load_dwordx4 v199, s[12:15], s71 offen offset:3072 lds
v_mfma_f32_16x16x32_bf16 v[12:15], a[196:199], a[228:231], v[12:15]
s_add_u32 s68, s68, 128
ds_read_b64_tr_b16 a[160:161], v204 offset:8192
s_add_u32 s69, s69, 128
v_mfma_f32_16x16x32_bf16 v[8:11], a[192:195], a[228:231], v[8:11]
s_add_u32 s70, s70, 524288
ds_read_b64_tr_b16 a[162:163], v204 offset:9216
s_add_u32 s71, s71, 524288
v_mfma_f32_16x16x32_bf16 v[16:19], a[192:195], a[232:235], v[16:19]
s_mov_b32 m0, 155648
ds_read_b64_tr_b16 a[164:165], v205 offset:8192
ds_read_b64_tr_b16 a[166:167], v205 offset:9216
v_mfma_f32_16x16x32_bf16 v[20:23], a[196:199], a[232:235], v[20:23]
buffer_load_dword v254, s[8:11], s34 offen offset:640 lds
v_mfma_f32_16x16x32_bf16 v[28:31], a[196:199], a[236:239], v[28:31]
v_mfma_f32_16x16x32_bf16 v[24:27], a[192:195], a[236:239], v[24:27]
v_mfma_f32_16x16x32_bf16 v[32:35], a[192:195], a[240:243], v[32:35]
ds_read_b64_tr_b16 a[168:169], v206 offset:8192
ds_read_b64_tr_b16 a[170:171], v206 offset:9216
v_mfma_f32_16x16x32_bf16 v[36:39], a[196:199], a[240:243], v[36:39]
v_mfma_f32_16x16x32_bf16 v[44:47], a[196:199], a[244:247], v[44:47]
v_mfma_f32_16x16x32_bf16 v[40:43], a[192:195], a[244:247], v[40:43]
v_mfma_f32_16x16x32_bf16 v[48:51], a[192:195], a[248:251], v[48:51]
ds_read_b64_tr_b16 a[172:173], v207 offset:8192
ds_read_b64_tr_b16 a[174:175], v207 offset:9216
v_mfma_f32_16x16x32_bf16 v[52:55], a[196:199], a[248:251], v[52:55]
buffer_load_dword v255, s[12:15], s35 offen lds
v_mfma_f32_16x16x32_bf16 v[60:63], a[196:199], a[252:255], v[60:63]
s_add_u32 s35, s35, 524288
v_mfma_f32_16x16x32_bf16 v[56:59], a[192:195], a[252:255], v[56:59]
ds_read_b64_tr_b16 a[176:177], v208 offset:8192
ds_read_b64_tr_b16 a[178:179], v208 offset:9216
v_mfma_f32_16x16x32_bf16 v[120:123], a[200:203], a[252:255], v[120:123]
v_mfma_f32_16x16x32_bf16 v[124:127], a[204:207], a[252:255], v[124:127]
v_mfma_f32_16x16x32_bf16 v[116:119], a[204:207], a[248:251], v[116:119]
global_load_dword v219, v251, s[64:65] sc1
v_mfma_f32_16x16x32_bf16 v[112:115], a[200:203], a[248:251], v[112:115]
ds_read_b64_tr_b16 a[180:181], v209 offset:8192
ds_read_b64_tr_b16 a[182:183], v209 offset:9216
v_mfma_f32_16x16x32_bf16 v[104:107], a[200:203], a[244:247], v[104:107]
v_mfma_f32_16x16x32_bf16 v[108:111], a[204:207], a[244:247], v[108:111]
v_mfma_f32_16x16x32_bf16 v[100:103], a[204:207], a[240:243], v[100:103]
v_mfma_f32_16x16x32_bf16 v[96:99], a[200:203], a[240:243], v[96:99]
ds_read_b64_tr_b16 a[184:185], v210 offset:8192
ds_read_b64_tr_b16 a[186:187], v210 offset:9216
v_mfma_f32_16x16x32_bf16 v[88:91], a[200:203], a[236:239], v[88:91]
v_mfma_f32_16x16x32_bf16 v[92:95], a[204:207], a[236:239], v[92:95]
v_mfma_f32_16x16x32_bf16 v[84:87], a[204:207], a[232:235], v[84:87]
ds_read_b64_tr_b16 a[188:189], v211 offset:8192
ds_read_b64_tr_b16 a[190:191], v211 offset:9216
v_mfma_f32_16x16x32_bf16 v[80:83], a[200:203], a[232:235], v[80:83]
v_mfma_f32_16x16x32_bf16 v[72:75], a[200:203], a[228:231], v[72:75]
v_mfma_f32_16x16x32_bf16 v[76:79], a[204:207], a[228:231], v[76:79]
v_mfma_f32_16x16x32_bf16 v[68:71], a[204:207], a[224:227], v[68:71]
ds_read_b128 a[128:131], v201 offset:0
ds_read_b128 a[132:135], v201 offset:2048
v_mfma_f32_16x16x32_bf16 v[64:67], a[200:203], a[224:227], v[64:67]
v_mfma_f32_16x16x32_bf16 a[0:3], a[208:211], a[224:227], a[0:3]
v_mfma_f32_16x16x32_bf16 a[4:7], a[212:215], a[224:227], a[4:7]
v_mfma_f32_16x16x32_bf16 a[12:15], a[212:215], a[228:231], a[12:15]
ds_read_b128 a[136:139], v201 offset:4096
ds_read_b128 a[140:143], v201 offset:6144
v_mfma_f32_16x16x32_bf16 a[8:11], a[208:211], a[228:231], a[8:11]
v_mfma_f32_16x16x32_bf16 a[16:19], a[208:211], a[232:235], a[16:19]
v_mfma_f32_16x16x32_bf16 a[20:23], a[212:215], a[232:235], a[20:23]
ds_read_b128 a[144:147], v201 offset:8192
ds_read_b128 a[148:151], v201 offset:10240
v_mfma_f32_16x16x32_bf16 a[28:31], a[212:215], a[236:239], a[28:31]
v_mfma_f32_16x16x32_bf16 a[24:27], a[208:211], a[236:239], a[24:27]
v_mfma_f32_16x16x32_bf16 a[32:35], a[208:211], a[240:243], a[32:35]
v_mfma_f32_16x16x32_bf16 a[36:39], a[212:215], a[240:243], a[36:39]
ds_read_b128 a[152:155], v201 offset:12288
ds_read_b128 a[156:159], v201 offset:14336
v_mfma_f32_16x16x32_bf16 a[44:47], a[212:215], a[244:247], a[44:47]
Lpad6:
s_cbranch_execz Lpad10
v_mfma_f32_16x16x32_bf16 a[40:43], a[208:211], a[244:247], a[40:43]
v_mfma_f32_16x16x32_bf16 a[48:51], a[208:211], a[248:251], a[48:51]
v_mfma_f32_16x16x32_bf16 a[52:55], a[212:215], a[248:251], a[52:55]
v_mfma_f32_16x16x32_bf16 a[60:63], a[212:215], a[252:255], a[60:63]
v_mfma_f32_16x16x32_bf16 a[56:59], a[208:211], a[252:255], a[56:59]
v_mfma_f32_16x16x32_bf16 a[120:123], a[216:219], a[252:255], a[120:123]
v_mfma_f32_16x16x32_bf16 a[124:127], a[220:223], a[252:255], a[124:127]
v_mfma_f32_16x16x32_bf16 a[116:119], a[220:223], a[248:251], a[116:119]
v_mfma_f32_16x16x32_bf16 a[112:115], a[216:219], a[248:251], a[112:115]
v_mfma_f32_16x16x32_bf16 a[104:107], a[216:219], a[244:247], a[104:107]
v_mfma_f32_16x16x32_bf16 a[108:111], a[220:223], a[244:247], a[108:111]
v_mfma_f32_16x16x32_bf16 a[100:103], a[220:223], a[240:243], a[100:103]
v_mfma_f32_16x16x32_bf16 a[96:99], a[216:219], a[240:243], a[96:99]
v_mfma_f32_16x16x32_bf16 a[88:91], a[216:219], a[236:239], a[88:91]
v_mfma_f32_16x16x32_bf16 a[92:95], a[220:223], a[236:239], a[92:95]
v_mfma_f32_16x16x32_bf16 a[84:87], a[220:223], a[232:235], a[84:87]
v_mfma_f32_16x16x32_bf16 a[80:83], a[216:219], a[232:235], a[80:83]
v_mfma_f32_16x16x32_bf16 a[72:75], a[216:219], a[228:231], a[72:75]
v_mfma_f32_16x16x32_bf16 a[76:79], a[220:223], a[228:231], a[76:79]
v_mfma_f32_16x16x32_bf16 a[68:71], a[220:223], a[224:227], a[68:71]
v_mfma_f32_16x16x32_bf16 a[64:67], a[216:219], a[224:227], a[64:67]
s_waitcnt vmcnt(0) lgkmcnt(0)
v_mfma_f32_16x16x32_bf16 v[0:3], a[128:131], a[160:163], v[0:3]
s_barrier
v_cmp_gt_u32 vcc, 80, v219
s_mov_b32 s6, 0
s_cmp_eq_u64 vcc, 0
s_cbranch_scc1 Lok5
Lsp6:
s_sleep 5
global_load_dword v219, v251, s[64:65] sc1
s_waitcnt vmcnt(0)
v_cmp_gt_u32 vcc, 80, v219
s_add_u32 s6, s6, 1
s_cmp_gt_u32 s6, 200000
s_cbranch_scc1 Lok5
s_cmp_lg_u64 vcc, 0
s_cbranch_scc1 Lsp6
Lok5:
s_cmp_lg_u32 s3, 2
s_cbranch_scc1 Lnoreg
s_getreg_b32 s6, hwreg(HW_REG_XCC_ID, 0, 4)
s_cmp_lt_u32 s6, 8
s_cselect_b32 s48, 1, 0
s_mov_b32 s49, 0
s_lshl_b32 s7, s6, 2
s_lshl_b32 s7, s48, s7
v_mov_b32 v249, s7
s_lshl_b32 s7, s4, 8
s_add_u32 s7, s7, 264196
v_mov_b32 v250, s7
s_mov_b64 exec, 1
global_atomic_add v250, v249, s[66:67] offset:0 sc1
s_mov_b64 exec, -1
s_lshl_b32 s6, s6, 3
s_lshl_b64 s[48:49], s[48:49], s6
s_and_b32 s6, s2, 7
s_lshl_b32 s6, s6, 1
s_bfe_u32 s7, s2, 0x10003
s_add_u32 s6, s6, s7
s_lshl_b32 s6, s6, 8
s_add_u32 s6, s6, 280584
v_mov_b32 v249, s6
v_mov_b32 v250, s48
v_mov_b32 v251, s49
s_mov_b64 exec, 1
global_atomic_add_x2 v249, v[250:251], s[66:67] sc1
s_mov_b64 exec, -1
s_cmp_eq_u32 s77, 0
s_cbranch_scc1 Lnoreg
s_cmp_ge_u32 s73, 40
s_addc_u32 s6, s72, s72
s_lshl_b32 s6, s6, 8
s_add_u32 s6, s6, 321536
v_mov_b32 v248, s6
s_mov_b64 exec, 1
global_atomic_add v248, v223, s[66:67] offset:0 sc1
s_mov_b64 exec, -1
Lnoreg:
v_mfma_f32_16x16x32_bf16 v[4:7], a[132:135], a[160:163], v[4:7]
s_mul_i32 s48, s3, 2560
ds_read_b64_tr_b16 a[224:225], v212 offset:0
s_sub_u32 s48, s48, 5120
v_mfma_f32_16x16x32_bf16 v[12:15], a[132:135], a[164:167], v[12:15]
buffer_load_dwordx4 v[168:171], v216, s[20:23], s48 offen offset:0 sc1
v_mfma_f32_16x16x32_bf16 v[8:11], a[128:131], a[164:167], v[8:11]
buffer_load_dwordx4 v[172:175], v216, s[20:23], s48 offen offset:1024 sc1
v_mfma_f32_16x16x32_bf16 v[16:19], a[128:131], a[168:171], v[16:19]
buffer_load_dwordx4 v[176:179], v252, s[20:23], s48 offen offset:2048 sc1
v_mfma_f32_16x16x32_bf16 v[20:23], a[132:135], a[168:171], v[20:23]
s_add_u32 s48, s48, 15360
s_cmp_eq_u32 s3, 3
s_cselect_b32 s39, 1.0, 0
v_mfma_f32_16x16x32_bf16 v[28:31], a[132:135], a[172:175], v[28:31]
buffer_load_dwordx4 v[180:183], v216, s[20:23], s48 offen offset:0 sc1
v_mfma_f32_16x16x32_bf16 v[24:27], a[128:131], a[172:175], v[24:27]
s_mov_b32 s49, 0x3e0293ee
ds_read_b64_tr_b16 a[226:227], v212 offset:1024
ds_read_b64_tr_b16 a[228:229], v213 offset:0
v_mfma_f32_16x16x32_bf16 v[32:35], a[128:131], a[176:179], v[32:35]
buffer_load_dwordx4 v[184:187], v216, s[20:23], s48 offen offset:1024 sc1
v_mfma_f32_16x16x32_bf16 v[36:39], a[132:135], a[176:179], v[36:39]
s_mul_i32 s60, s3, 3072
ds_read_b64_tr_b16 a[230:231], v213 offset:1024
ds_read_b64_tr_b16 a[232:233], v214 offset:0
v_mfma_f32_16x16x32_bf16 v[44:47], a[132:135], a[180:183], v[44:47]
buffer_load_dwordx4 v[188:191], v252, s[20:23], s48 offen offset:2048 sc1
v_mfma_f32_16x16x32_bf16 v[40:43], a[128:131], a[180:183], v[40:43]
s_add_u32 s48, s48, 15360
ds_read_b64_tr_b16 a[234:235], v214 offset:1024
ds_read_b64_tr_b16 a[236:237], v215 offset:0
v_mfma_f32_16x16x32_bf16 v[48:51], a[128:131], a[184:187], v[48:51]
buffer_load_dwordx4 v[224:227], v216, s[20:23], s48 offen offset:0 sc1
v_mfma_f32_16x16x32_bf16 v[52:55], a[132:135], a[184:187], v[52:55]
s_add_u32 s60, s60, 124928
ds_read_b64_tr_b16 a[238:239], v215 offset:1024
v_add_u32 v251, s60, v216
v_mfma_f32_16x16x32_bf16 v[60:63], a[132:135], a[188:191], v[60:63]
v_mfma_f32_16x16x32_bf16 v[56:59], a[128:131], a[188:191], v[56:59]
buffer_load_dwordx4 v[228:231], v216, s[20:23], s48 offen offset:1024 sc1
v_mfma_f32_16x16x32_bf16 v[120:123], a[136:139], a[188:191], v[120:123]
ds_read_b64_tr_b16 a[240:241], v217 offset:0
ds_read_b64_tr_b16 a[242:243], v217 offset:1024
v_mfma_f32_16x16x32_bf16 v[124:127], a[140:143], a[188:191], v[124:127]
buffer_load_dwordx4 v[232:235], v252, s[20:23], s48 offen offset:2048 sc1
v_mfma_f32_16x16x32_bf16 v[116:119], a[140:143], a[184:187], v[116:119]
s_add_u32 s48, s48, 15360
v_mfma_f32_16x16x32_bf16 v[112:115], a[136:139], a[184:187], v[112:115]
buffer_load_dwordx4 v[236:239], v216, s[20:23], s48 offen offset:0 sc1
v_mfma_f32_16x16x32_bf16 v[104:107], a[136:139], a[180:183], v[104:107]
ds_read_b64_tr_b16 a[244:245], v218 offset:0
ds_read_b64_tr_b16 a[246:247], v218 offset:1024
v_mfma_f32_16x16x32_bf16 v[108:111], a[140:143], a[180:183], v[108:111]
buffer_load_dwordx4 v[240:243], v216, s[20:23], s48 offen offset:1024 sc1
v_mfma_f32_16x16x32_bf16 v[100:103], a[140:143], a[176:179], v[100:103]
v_mfma_f32_16x16x32_bf16 v[96:99], a[136:139], a[176:179], v[96:99]
buffer_load_dwordx4 v[244:247], v252, s[20:23], s48 offen offset:2048 sc1
v_mfma_f32_16x16x32_bf16 v[88:91], a[136:139], a[172:175], v[88:91]
s_add_u32 m0, s32, 0
ds_read_b64_tr_b16 a[248:249], v221 offset:0
ds_read_b64_tr_b16 a[250:251], v221 offset:1024
v_mfma_f32_16x16x32_bf16 v[92:95], a[140:143], a[172:175], v[92:95]
buffer_load_dwordx4 v192, s[8:11], s68 offen offset:0 lds
v_mfma_f32_16x16x32_bf16 v[84:87], a[140:143], a[168:171], v[84:87]
ds_read_b64_tr_b16 a[252:253], v222 offset:0
ds_read_b64_tr_b16 a[254:255], v222 offset:1024
v_mfma_f32_16x16x32_bf16 v[80:83], a[136:139], a[168:171], v[80:83]
v_mfma_f32_16x16x32_bf16 v[72:75], a[136:139], a[164:167], v[72:75]
v_mfma_f32_16x16x32_bf16 v[76:79], a[140:143], a[164:167], v[76:79]
v_mfma_f32_16x16x32_bf16 v[68:71], a[140:143], a[160:163], v[68:71]
buffer_load_dwordx4 v193, s[8:11], s68 offen offset:1024 lds
v_mfma_f32_16x16x32_bf16 v[64:67], a[136:139], a[160:163], v[64:67]
ds_read_b128 a[192:195], v202 offset:0
ds_read_b128 a[196:199], v202 offset:2048
v_mfma_f32_16x16x32_bf16 a[0:3], a[144:147], a[160:163], a[0:3]
v_mfma_f32_16x16x32_bf16 a[4:7], a[148:151], a[160:163], a[4:7]
v_mfma_f32_16x16x32_bf16 a[12:15], a[148:151], a[164:167], a[12:15]
buffer_load_dwordx4 v194, s[8:11], s68 offen offset:2048 lds
v_mfma_f32_16x16x32_bf16 a[8:11], a[144:147], a[164:167], a[8:11]
ds_read_b128 a[200:203], v202 offset:4096
ds_read_b128 a[204:207], v202 offset:6144
v_mfma_f32_16x16x32_bf16 a[16:19], a[144:147], a[168:171], a[16:19]
v_mfma_f32_16x16x32_bf16 a[20:23], a[148:151], a[168:171], a[20:23]
ds_read_b128 a[208:211], v202 offset:8192
ds_read_b128 a[212:215], v202 offset:10240
v_mfma_f32_16x16x32_bf16 a[28:31], a[148:151], a[172:175], a[28:31]
buffer_load_dwordx4 v195, s[8:11], s68 offen offset:3072 lds
v_mfma_f32_16x16x32_bf16 a[24:27], a[144:147], a[172:175], a[24:27]
s_add_u32 m0, s32, 4096
v_mfma_f32_16x16x32_bf16 a[32:35], a[144:147], a[176:179], a[32:35]
v_mfma_f32_16x16x32_bf16 a[36:39], a[148:151], a[176:179], a[36:39]
ds_read_b128 a[216:219], v202 offset:12288
ds_read_b128 a[220:223], v202 offset:14336
v_mfma_f32_16x16x32_bf16 a[44:47], a[148:151], a[180:183], a[44:47]
v_mfma_f32_16x16x32_bf16 a[40:43], a[144:147], a[180:183], a[40:43]
buffer_load_dwordx4 v192, s[8:11], s69 offen offset:0 lds
v_mfma_f32_16x16x32_bf16 a[48:51], a[144:147], a[184:187], a[48:51]
v_mfma_f32_16x16x32_bf16 a[52:55], a[148:151], a[184:187], a[52:55]
v_mfma_f32_16x16x32_bf16 a[60:63], a[148:151], a[188:191], a[60:63]
v_mfma_f32_16x16x32_bf16 a[56:59], a[144:147], a[188:191], a[56:59]
buffer_load_dwordx4 v193, s[8:11], s69 offen offset:1024 lds
v_mfma_f32_16x16x32_bf16 a[120:123], a[152:155], a[188:191], a[120:123]
v_mfma_f32_16x16x32_bf16 a[124:127], a[156:159], a[188:191], a[124:127]
v_mfma_f32_16x16x32_bf16 a[116:119], a[156:159], a[184:187], a[116:119]
v_mfma_f32_16x16x32_bf16 a[112:115], a[152:155], a[184:187], a[112:115]
buffer_load_dwordx4 v194, s[8:11], s69 offen offset:2048 lds
v_mfma_f32_16x16x32_bf16 a[104:107], a[152:155], a[180:183], a[104:107]
v_mfma_f32_16x16x32_bf16 a[108:111], a[156:159], a[180:183], a[108:111]
v_mfma_f32_16x16x32_bf16 a[100:103], a[156:159], a[176:179], a[100:103]
v_mfma_f32_16x16x32_bf16 a[96:99], a[152:155], a[176:179], a[96:99]
v_mfma_f32_16x16x32_bf16 a[88:91], a[152:155], a[172:175], a[88:91]
buffer_load_dwordx4 v195, s[8:11], s69 offen offset:3072 lds
v_mfma_f32_16x16x32_bf16 a[92:95], a[156:159], a[172:175], a[92:95]
s_add_u32 m0, s32, 32768
v_mfma_f32_16x16x32_bf16 a[84:87], a[156:159], a[168:171], a[84:87]
v_mfma_f32_16x16x32_bf16 a[80:83], a[152:155], a[168:171], a[80:83]
v_mfma_f32_16x16x32_bf16 a[72:75], a[152:155], a[164:167], a[72:75]
buffer_load_dwordx4 v196, s[12:15], s70 offen offset:0 lds
v_mfma_f32_16x16x32_bf16 a[76:79], a[156:159], a[164:167], a[76:79]
v_mfma_f32_16x16x32_bf16 a[68:71], a[156:159], a[160:163], a[68:71]
v_mfma_f32_16x16x32_bf16 a[64:67], a[152:155], a[160:163], a[64:67]
s_waitcnt vmcnt(9) lgkmcnt(0)
v_mfma_f32_16x16x32_bf16 v[0:3], a[192:195], a[224:227], v[0:3]
v_mfma_f32_16x16x32_bf16 v[4:7], a[196:199], a[224:227], v[4:7]
ds_read_b64_tr_b16 a[160:161], v212 offset:8192
buffer_load_dwordx4 v197, s[12:15], s70 offen offset:1024 lds
v_mfma_f32_16x16x32_bf16 v[12:15], a[196:199], a[228:231], v[12:15]
v_add_f32 v168, v168, v180
v_add_f32 v224, v224, v236
v_mfma_f32_16x16x32_bf16 v[8:11], a[192:195], a[228:231], v[8:11]
ds_read_b64_tr_b16 a[162:163], v212 offset:9216
v_add_f32 v168, v168, v224
v_add_f32 v169, v169, v181
v_mfma_f32_16x16x32_bf16 v[16:19], a[192:195], a[232:235], v[16:19]
v_add_f32 v225, v225, v237
v_add_f32 v169, v169, v225
v_mfma_f32_16x16x32_bf16 v[20:23], a[196:199], a[232:235], v[20:23]
ds_read_b64_tr_b16 a[164:165], v213 offset:8192
buffer_load_dwordx4 v198, s[12:15], s70 offen offset:2048 lds
v_mfma_f32_16x16x32_bf16 v[28:31], a[196:199], a[236:239], v[28:31]
v_add_f32 v170, v170, v182
v_add_f32 v226, v226, v238
v_mfma_f32_16x16x32_bf16 v[24:27], a[192:195], a[236:239], v[24:27]
ds_read_b64_tr_b16 a[166:167], v213 offset:9216
v_add_f32 v170, v170, v226
v_add_f32 v171, v171, v183
v_mfma_f32_16x16x32_bf16 v[32:35], a[192:195], a[240:243], v[32:35]
v_add_f32 v227, v227, v239
v_add_f32 v171, v171, v227
v_mfma_f32_16x16x32_bf16 v[36:39], a[196:199], a[240:243], v[36:39]
ds_read_b64_tr_b16 a[168:169], v214 offset:8192
buffer_load_dwordx4 v199, s[12:15], s70 offen offset:3072 lds
v_mfma_f32_16x16x32_bf16 v[44:47], a[196:199], a[244:247], v[44:47]
s_add_u32 m0, s32, 36864
v_cvt_pk_bf16_f32 v250, v168, v169
v_lshlrev_b32 v168, 16, v250
v_mfma_f32_16x16x32_bf16 v[40:43], a[192:195], a[244:247], v[40:43]
ds_read_b64_tr_b16 a[170:171], v214 offset:9216
v_and_b32 v169, 0xffff0000, v250
v_cvt_pk_bf16_f32 v250, v170, v171
v_mfma_f32_16x16x32_bf16 v[48:51], a[192:195], a[248:251], v[48:51]
v_lshlrev_b32 v170, 16, v250
v_and_b32 v171, 0xffff0000, v250
v_mfma_f32_16x16x32_bf16 v[52:55], a[196:199], a[248:251], v[52:55]
buffer_load_dwordx4 v196, s[12:15], s71 offen offset:0 lds
v_add_f32 v168, s39, v168
v_mfma_f32_16x16x32_bf16 v[60:63], a[196:199], a[252:255], v[60:63]
ds_read_b64_tr_b16 a[172:173], v215 offset:8192
v_add_f32 v169, s39, v169
v_mfma_f32_16x16x32_bf16 v[56:59], a[192:195], a[252:255], v[56:59]
ds_read_b64_tr_b16 a[174:175], v215 offset:9216
v_add_f32 v170, s39, v170
v_add_f32 v171, s39, v171
v_mfma_f32_16x16x32_bf16 v[120:123], a[200:203], a[252:255], v[120:123]
v_cvt_pk_bf16_f32 v250, v168, v169
v_lshlrev_b32 v168, 16, v250
v_mfma_f32_16x16x32_bf16 v[124:127], a[204:207], a[252:255], v[124:127]
ds_read_b64_tr_b16 a[176:177], v217 offset:8192
v_and_b32 v169, 0xffff0000, v250
v_cvt_pk_bf16_f32 v250, v170, v171
v_mfma_f32_16x16x32_bf16 v[116:119], a[204:207], a[248:251], v[116:119]
buffer_load_dwordx4 v197, s[12:15], s71 offen offset:1024 lds
v_mfma_f32_16x16x32_bf16 v[112:115], a[200:203], a[248:251], v[112:115]
ds_read_b64_tr_b16 a[178:179], v217 offset:9216
v_lshlrev_b32 v170, 16, v250
v_and_b32 v171, 0xffff0000, v250
v_mfma_f32_16x16x32_bf16 v[104:107], a[200:203], a[244:247], v[104:107]
v_mul_f32 v168, s49, v168
v_mul_f32 v169, s49, v169
v_mfma_f32_16x16x32_bf16 v[108:111], a[204:207], a[244:247], v[108:111]
ds_read_b64_tr_b16 a[180:181], v218 offset:8192
v_mul_f32 v170, s49, v170
v_mul_f32 v171, s49, v171
v_mfma_f32_16x16x32_bf16 v[100:103], a[204:207], a[240:243], v[100:103]
buffer_load_dwordx4 v198, s[12:15], s71 offen offset:2048 lds
v_mfma_f32_16x16x32_bf16 v[96:99], a[200:203], a[240:243], v[96:99]
ds_write_b128 v251, v[168:171] offset:0
v_add_f32 v172, v172, v184
v_add_f32 v228, v228, v240
v_mfma_f32_16x16x32_bf16 v[88:91], a[200:203], a[236:239], v[88:91]
ds_read_b64_tr_b16 a[182:183], v218 offset:9216
v_add_f32 v172, v172, v228
v_mfma_f32_16x16x32_bf16 v[92:95], a[204:207], a[236:239], v[92:95]
ds_read_b64_tr_b16 a[184:185], v221 offset:8192
v_add_f32 v173, v173, v185
v_add_f32 v229, v229, v241
v_mfma_f32_16x16x32_bf16 v[84:87], a[204:207], a[232:235], v[84:87]
buffer_load_dwordx4 v199, s[12:15], s71 offen offset:3072 lds
v_mfma_f32_16x16x32_bf16 v[80:83], a[200:203], a[232:235], v[80:83]
s_add_u32 s68, s68, 128
v_add_f32 v173, v173, v229
s_add_u32 s69, s69, 128
v_add_f32 v174, v174, v186
v_mfma_f32_16x16x32_bf16 v[72:75], a[200:203], a[228:231], v[72:75]
s_add_u32 s70, s70, 524288
ds_read_b64_tr_b16 a[186:187], v221 offset:9216
v_add_f32 v230, v230, v242
v_mfma_f32_16x16x32_bf16 v[76:79], a[204:207], a[228:231], v[76:79]
s_add_u32 s71, s71, 524288
v_add_f32 v174, v174, v230
s_mov_b32 m0, 155648
v_add_f32 v175, v175, v187
v_mfma_f32_16x16x32_bf16 v[68:71], a[204:207], a[224:227], v[68:71]
ds_read_b64_tr_b16 a[188:189], v222 offset:8192
v_add_f32 v231, v231, v243
v_mfma_f32_16x16x32_bf16 v[64:67], a[200:203], a[224:227], v[64:67]
buffer_load_dword v254, s[8:11], s34 offen offset:768 lds
v_add_f32 v175, v175, v231
v_mfma_f32_16x16x32_bf16 a[0:3], a[208:211], a[224:227], a[0:3]
v_cvt_pk_bf16_f32 v250, v172, v173
v_lshlrev_b32 v172, 16, v250
v_mfma_f32_16x16x32_bf16 a[4:7], a[212:215], a[224:227], a[4:7]
ds_read_b64_tr_b16 a[190:191], v222 offset:9216
v_and_b32 v173, 0xffff0000, v250
v_cvt_pk_bf16_f32 v250, v174, v175
v_mfma_f32_16x16x32_bf16 a[12:15], a[212:215], a[228:231], a[12:15]
ds_read_b128 a[128:131], v203 offset:0
v_lshlrev_b32 v174, 16, v250
v_mfma_f32_16x16x32_bf16 a[8:11], a[208:211], a[228:231], a[8:11]
v_and_b32 v175, 0xffff0000, v250
v_add_f32 v172, s39, v172
v_mfma_f32_16x16x32_bf16 a[16:19], a[208:211], a[232:235], a[16:19]
ds_read_b128 a[132:135], v203 offset:2048
v_add_f32 v173, s39, v173
v_mfma_f32_16x16x32_bf16 a[20:23], a[212:215], a[232:235], a[20:23]
v_add_f32 v174, s39, v174
v_add_f32 v175, s39, v175
v_mfma_f32_16x16x32_bf16 a[28:31], a[212:215], a[236:239], a[28:31]
v_cvt_pk_bf16_f32 v250, v172, v173
v_lshlrev_b32 v172, 16, v250
v_mfma_f32_16x16x32_bf16 a[24:27], a[208:211], a[236:239], a[24:27]
buffer_load_dword v255, s[12:15], s35 offen lds
v_mfma_f32_16x16x32_bf16 a[32:35], a[208:211], a[240:243], a[32:35]
s_add_u32 s35, s35, 524288
ds_read_b128 a[136:139], v203 offset:4096
v_and_b32 v173, 0xffff0000, v250
v_mfma_f32_16x16x32_bf16 a[36:39], a[212:215], a[240:243], a[36:39]
ds_read_b128 a[140:143], v203 offset:6144
v_cvt_pk_bf16_f32 v250, v174, v175
v_mfma_f32_16x16x32_bf16 a[44:47], a[212:215], a[244:247], a[44:47]
v_lshlrev_b32 v174, 16, v250
v_and_b32 v175, 0xffff0000, v250
v_mfma_f32_16x16x32_bf16 a[40:43], a[208:211], a[244:247], a[40:43]
ds_read_b128 a[144:147], v203 offset:8192
v_mul_f32 v172, s49, v172
v_mfma_f32_16x16x32_bf16 a[48:51], a[208:211], a[248:251], a[48:51]
v_mul_f32 v173, s49, v173
v_mul_f32 v174, s49, v174
v_mfma_f32_16x16x32_bf16 a[52:55], a[212:215], a[248:251], a[52:55]
ds_read_b128 a[148:151], v203 offset:10240
v_mul_f32 v175, s49, v175
v_mfma_f32_16x16x32_bf16 a[60:63], a[212:215], a[252:255], a[60:63]
ds_write_b128 v251, v[172:175] offset:1024
v_add_f32 v176, v176, v188
v_mfma_f32_16x16x32_bf16 a[56:59], a[208:211], a[252:255], a[56:59]
v_add_f32 v232, v232, v244
v_add_f32 v176, v176, v232
v_mfma_f32_16x16x32_bf16 a[120:123], a[216:219], a[252:255], a[120:123]
ds_read_b128 a[152:155], v203 offset:12288
v_add_f32 v177, v177, v189
v_mfma_f32_16x16x32_bf16 a[124:127], a[220:223], a[252:255], a[124:127]
v_add_f32 v233, v233, v245
v_add_f32 v177, v177, v233
v_mfma_f32_16x16x32_bf16 a[116:119], a[220:223], a[248:251], a[116:119]
ds_read_b128 a[156:159], v203 offset:14336
v_add_f32 v178, v178, v190
v_mfma_f32_16x16x32_bf16 a[112:115], a[216:219], a[248:251], a[112:115]
v_add_f32 v234, v234, v246
v_add_f32 v178, v178, v234
v_mfma_f32_16x16x32_bf16 a[104:107], a[216:219], a[244:247], a[104:107]
v_add_f32 v179, v179, v191
v_add_f32 v235, v235, v247
v_mfma_f32_16x16x32_bf16 a[108:111], a[220:223], a[244:247], a[108:111]
v_add_f32 v179, v179, v235
v_cvt_pk_bf16_f32 v250, v176, v177
v_mfma_f32_16x16x32_bf16 a[100:103], a[220:223], a[240:243], a[100:103]
v_lshlrev_b32 v176, 16, v250
v_and_b32 v177, 0xffff0000, v250
v_mfma_f32_16x16x32_bf16 a[96:99], a[216:219], a[240:243], a[96:99]
v_cvt_pk_bf16_f32 v250, v178, v179
v_lshlrev_b32 v178, 16, v250
v_mfma_f32_16x16x32_bf16 a[88:91], a[216:219], a[236:239], a[88:91]
v_and_b32 v179, 0xffff0000, v250
v_add_f32 v176, s39, v176
v_mfma_f32_16x16x32_bf16 a[92:95], a[220:223], a[236:239], a[92:95]
v_add_f32 v177, s39, v177
v_add_f32 v178, s39, v178
v_mfma_f32_16x16x32_bf16 a[84:87], a[220:223], a[232:235], a[84:87]
v_add_f32 v179, s39, v179
v_cvt_pk_bf16_f32 v250, v176, v177
v_mfma_f32_16x16x32_bf16 a[80:83], a[216:219], a[232:235], a[80:83]
v_lshlrev_b32 v176, 16, v250
v_and_b32 v177, 0xffff0000, v250
v_mfma_f32_16x16x32_bf16 a[72:75], a[216:219], a[228:231], a[72:75]
v_cvt_pk_bf16_f32 v250, v178, v179
v_lshlrev_b32 v178, 16, v250
v_mfma_f32_16x16x32_bf16 a[76:79], a[220:223], a[228:231], a[76:79]
v_and_b32 v179, 0xffff0000, v250
v_mul_f32 v176, s49, v176
v_mfma_f32_16x16x32_bf16 a[68:71], a[220:223], a[224:227], a[68:71]
v_mul_f32 v177, s49, v177
v_mul_f32 v178, s49, v178
v_mfma_f32_16x16x32_bf16 a[64:67], a[216:219], a[224:227], a[64:67]
v_mul_f32 v179, s49, v179
ds_write_b128 v251, v[176:179] offset:2048
s_waitcnt vmcnt(2) lgkmcnt(0)
v_mfma_f32_16x16x32_bf16 v[0:3], a[128:131], a[160:163], v[0:3]
s_barrier
v_mfma_f32_16x16x32_bf16 v[4:7], a[132:135], a[160:163], v[4:7]
s_add_u32 m0, s32, 65536
ds_read_b64_tr_b16 a[224:225], v204 offset:0
ds_read_b64_tr_b16 a[226:227], v204 offset:1024
v_mfma_f32_16x16x32_bf16 v[12:15], a[132:135], a[164:167], v[12:15]
buffer_load_dwordx4 v192, s[8:11], s68 offen offset:0 lds
v_mfma_f32_16x16x32_bf16 v[8:11], a[128:131], a[164:167], v[8:11]
v_mfma_f32_16x16x32_bf16 v[16:19], a[128:131], a[168:171], v[16:19]
buffer_load_dwordx4 v193, s[8:11], s68 offen offset:1024 lds
v_mfma_f32_16x16x32_bf16 v[20:23], a[132:135], a[168:171], v[20:23]
ds_read_b64_tr_b16 a[228:229], v205 offset:0
ds_read_b64_tr_b16 a[230:231], v205 offset:1024
v_mfma_f32_16x16x32_bf16 v[28:31], a[132:135], a[172:175], v[28:31]
v_mfma_f32_16x16x32_bf16 v[24:27], a[128:131], a[172:175], v[24:27]
v_mfma_f32_16x16x32_bf16 v[32:35], a[128:131], a[176:179], v[32:35]
buffer_load_dwordx4 v194, s[8:11], s68 offen offset:2048 lds
v_mfma_f32_16x16x32_bf16 v[36:39], a[132:135], a[176:179], v[36:39]
ds_read_b64_tr_b16 a[232:233], v206 offset:0
ds_read_b64_tr_b16 a[234:235], v206 offset:1024
v_mfma_f32_16x16x32_bf16 v[44:47], a[132:135], a[180:183], v[44:47]
v_mfma_f32_16x16x32_bf16 v[40:43], a[128:131], a[180:183], v[40:43]
v_mfma_f32_16x16x32_bf16 v[48:51], a[128:131], a[184:187], v[48:51]
buffer_load_dwordx4 v195, s[8:11], s68 offen offset:3072 lds
v_mfma_f32_16x16x32_bf16 v[52:55], a[132:135], a[184:187], v[52:55]
s_add_u32 m0, s32, 69632
ds_read_b64_tr_b16 a[236:237], v207 offset:0
ds_read_b64_tr_b16 a[238:239], v207 offset:1024
v_mfma_f32_16x16x32_bf16 v[60:63], a[132:135], a[188:191], v[60:63]
v_mfma_f32_16x16x32_bf16 v[56:59], a[128:131], a[188:191], v[56:59]
ds_read_b64_tr_b16 a[240:241], v208 offset:0
ds_read_b64_tr_b16 a[242:243], v208 offset:1024
v_mfma_f32_16x16x32_bf16 v[120:123], a[136:139], a[188:191], v[120:123]
v_mfma_f32_16x16x32_bf16 v[124:127], a[140:143], a[188:191], v[124:127]
buffer_load_dwordx4 v192, s[8:11], s69 offen offset:0 lds
v_mfma_f32_16x16x32_bf16 v[116:119], a[140:143], a[184:187], v[116:119]
v_mfma_f32_16x16x32_bf16 v[112:115], a[136:139], a[184:187], v[112:115]
ds_read_b64_tr_b16 a[244:245], v209 offset:0
ds_read_b64_tr_b16 a[246:247], v209 offset:1024
v_mfma_f32_16x16x32_bf16 v[104:107], a[136:139], a[180:183], v[104:107]
v_mfma_f32_16x16x32_bf16 v[108:111], a[140:143], a[180:183], v[108:111]
buffer_load_dwordx4 v193, s[8:11], s69 offen offset:1024 lds
v_mfma_f32_16x16x32_bf16 v[100:103], a[140:143], a[176:179], v[100:103]
v_mfma_f32_16x16x32_bf16 v[96:99], a[136:139], a[176:179], v[96:99]
ds_read_b64_tr_b16 a[248:249], v210 offset:0
ds_read_b64_tr_b16 a[250:251], v210 offset:1024
v_mfma_f32_16x16x32_bf16 v[88:91], a[136:139], a[172:175], v[88:91]
v_mfma_f32_16x16x32_bf16 v[92:95], a[140:143], a[172:175], v[92:95]
buffer_load_dwordx4 v194, s[8:11], s69 offen offset:2048 lds
v_mfma_f32_16x16x32_bf16 v[84:87], a[140:143], a[168:171], v[84:87]
ds_read_b64_tr_b16 a[252:253], v211 offset:0
ds_read_b64_tr_b16 a[254:255], v211 offset:1024
v_mfma_f32_16x16x32_bf16 v[80:83], a[136:139], a[168:171], v[80:83]
v_mfma_f32_16x16x32_bf16 v[72:75], a[136:139], a[164:167], v[72:75]
v_mfma_f32_16x16x32_bf16 v[76:79], a[140:143], a[164:167], v[76:79]
v_mfma_f32_16x16x32_bf16 v[68:71], a[140:143], a[160:163], v[68:71]
buffer_load_dwordx4 v195, s[8:11], s69 offen offset:3072 lds
v_mfma_f32_16x16x32_bf16 v[64:67], a[136:139], a[160:163], v[64:67]
s_add_u32 m0, s32, 98304
ds_read_b128 a[192:195], v200 offset:0
ds_read_b128 a[196:199], v200 offset:2048
v_mfma_f32_16x16x32_bf16 a[0:3], a[144:147], a[160:163], a[0:3]
v_mfma_f32_16x16x32_bf16 a[4:7], a[148:151], a[160:163], a[4:7]
v_mfma_f32_16x16x32_bf16 a[12:15], a[148:151], a[164:167], a[12:15]
buffer_load_dwordx4 v196, s[12:15], s70 offen offset:0 lds
v_mfma_f32_16x16x32_bf16 a[8:11], a[144:147], a[164:167], a[8:11]
ds_read_b128 a[200:203], v200 offset:4096
ds_read_b128 a[204:207], v200 offset:6144
v_mfma_f32_16x16x32_bf16 a[16:19], a[144:147], a[168:171], a[16:19]
v_mfma_f32_16x16x32_bf16 a[20:23], a[148:151], a[168:171], a[20:23]
ds_read_b128 a[208:211], v200 offset:8192
ds_read_b128 a[212:215], v200 offset:10240
v_mfma_f32_16x16x32_bf16 a[28:31], a[148:151], a[172:175], a[28:31]
buffer_load_dwordx4 v197, s[12:15], s70 offen offset:1024 lds
v_mfma_f32_16x16x32_bf16 a[24:27], a[144:147], a[172:175], a[24:27]
v_mfma_f32_16x16x32_bf16 a[32:35], a[144:147], a[176:179], a[32:35]
v_mfma_f32_16x16x32_bf16 a[36:39], a[148:151], a[176:179], a[36:39]
ds_read_b128 a[216:219], v200 offset:12288
ds_read_b128 a[220:223], v200 offset:14336
v_mfma_f32_16x16x32_bf16 a[44:47], a[148:151], a[180:183], a[44:47]
v_mfma_f32_16x16x32_bf16 a[40:43], a[144:147], a[180:183], a[40:43]
buffer_load_dwordx4 v198, s[12:15], s70 offen offset:2048 lds
v_mfma_f32_16x16x32_bf16 a[48:51], a[144:147], a[184:187], a[48:51]
v_mfma_f32_16x16x32_bf16 a[52:55], a[148:151], a[184:187], a[52:55]
v_mfma_f32_16x16x32_bf16 a[60:63], a[148:151], a[188:191], a[60:63]
v_mfma_f32_16x16x32_bf16 a[56:59], a[144:147], a[188:191], a[56:59]
buffer_load_dwordx4 v199, s[12:15], s70 offen offset:3072 lds
v_mfma_f32_16x16x32_bf16 a[120:123], a[152:155], a[188:191], a[120:123]
s_add_u32 m0, s32, 102400
v_mfma_f32_16x16x32_bf16 a[124:127], a[156:159], a[188:191], a[124:127]
v_mfma_f32_16x16x32_bf16 a[116:119], a[156:159], a[184:187], a[116:119]
v_mfma_f32_16x16x32_bf16 a[112:115], a[152:155], a[184:187], a[112:115]
buffer_load_dwordx4 v196, s[12:15], s71 offen offset:0 lds
v_mfma_f32_16x16x32_bf16 a[104:107], a[152:155], a[180:183], a[104:107]
v_mfma_f32_16x16x32_bf16 a[108:111], a[156:159], a[180:183], a[108:111]
v_mfma_f32_16x16x32_bf16 a[100:103], a[156:159], a[176:179], a[100:103]
v_mfma_f32_16x16x32_bf16 a[96:99], a[152:155], a[176:179], a[96:99]
v_mfma_f32_16x16x32_bf16 a[88:91], a[152:155], a[172:175], a[88:91]
buffer_load_dwordx4 v197, s[12:15], s71 offen offset:1024 lds
v_mfma_f32_16x16x32_bf16 a[92:95], a[156:159], a[172:175], a[92:95]
v_mfma_f32_16x16x32_bf16 a[84:87], a[156:159], a[168:171], a[84:87]
v_mfma_f32_16x16x32_bf16 a[80:83], a[152:155], a[168:171], a[80:83]
v_mfma_f32_16x16x32_bf16 a[72:75], a[152:155], a[164:167], a[72:75]
buffer_load_dwordx4 v198, s[12:15], s71 offen offset:2048 lds
v_mfma_f32_16x16x32_bf16 a[76:79], a[156:159], a[164:167], a[76:79]
v_mfma_f32_16x16x32_bf16 a[68:71], a[156:159], a[160:163], a[68:71]
v_mfma_f32_16x16x32_bf16 a[64:67], a[152:155], a[160:163], a[64:67]
s_waitcnt lgkmcnt(0)
v_mfma_f32_16x16x32_bf16 v[0:3], a[192:195], a[224:227], v[0:3]
v_mfma_f32_16x16x32_bf16 v[4:7], a[196:199], a[224:227], v[4:7]
buffer_load_dwordx4 v199, s[12:15], s71 offen offset:3072 lds
v_mfma_f32_16x16x32_bf16 v[12:15], a[196:199], a[228:231], v[12:15]
s_add_u32 s68, s68, 128
ds_read_b64_tr_b16 a[160:161], v204 offset:8192
s_add_u32 s69, s69, 128
v_mfma_f32_16x16x32_bf16 v[8:11], a[192:195], a[228:231], v[8:11]
s_add_u32 s70, s70, 524288
s_add_u32 s71, s71, 524288
v_and_b32 v251, 7, v220
v_mfma_f32_16x16x32_bf16 v[16:19], a[192:195], a[232:235], v[16:19]
s_mov_b32 m0, 155648
ds_read_b64_tr_b16 a[162:163], v204 offset:9216
ds_read_b64_tr_b16 a[164:165], v205 offset:8192
v_mfma_f32_16x16x32_bf16 v[20:23], a[196:199], a[232:235], v[20:23]
buffer_load_dword v254, s[8:11], s34 offen offset:896 lds
v_mfma_f32_16x16x32_bf16 v[28:31], a[196:199], a[236:239], v[28:31]
s_lshl_b32 s6, s2, 7
ds_read_b64_tr_b16 a[166:167], v205 offset:9216
ds_read_b64_tr_b16 a[168:169], v206 offset:8192
v_mfma_f32_16x16x32_bf16 v[24:27], a[192:195], a[236:239], v[24:27]
s_add_u32 s6, s6, 288768
v_mfma_f32_16x16x32_bf16 v[32:35], a[192:195], a[240:243], v[32:35]
v_mfma_f32_16x16x32_bf16 v[36:39], a[196:199], a[240:243], v[36:39]
v_mfma_f32_16x16x32_bf16 v[44:47], a[196:199], a[244:247], v[44:47]
ds_read_b64_tr_b16 a[170:171], v206 offset:9216
ds_read_b64_tr_b16 a[172:173], v207 offset:8192
v_mfma_f32_16x16x32_bf16 v[40:43], a[192:195], a[244:247], v[40:43]
v_mfma_f32_16x16x32_bf16 v[48:51], a[192:195], a[248:251], v[48:51]
v_mfma_f32_16x16x32_bf16 v[52:55], a[196:199], a[248:251], v[52:55]
buffer_load_dword v255, s[12:15], s35 offen lds
v_mfma_f32_16x16x32_bf16 v[60:63], a[196:199], a[252:255], v[60:63]
s_add_u32 s35, s35, 524288
ds_read_b64_tr_b16 a[174:175], v207 offset:9216
ds_read_b64_tr_b16 a[176:177], v208 offset:8192
v_mfma_f32_16x16x32_bf16 v[56:59], a[192:195], a[252:255], v[56:59]
v_mfma_f32_16x16x32_bf16 v[120:123], a[200:203], a[252:255], v[120:123]
v_mfma_f32_16x16x32_bf16 v[124:127], a[204:207], a[252:255], v[124:127]
ds_read_b64_tr_b16 a[178:179], v208 offset:9216
ds_read_b64_tr_b16 a[180:181], v209 offset:8192
v_mfma_f32_16x16x32_bf16 v[116:119], a[204:207], a[248:251], v[116:119]
v_mfma_f32_16x16x32_bf16 v[112:115], a[200:203], a[248:251], v[112:115]
v_mfma_f32_16x16x32_bf16 v[104:107], a[200:203], a[244:247], v[104:107]
v_mfma_f32_16x16x32_bf16 v[108:111], a[204:207], a[244:247], v[108:111]
ds_read_b64_tr_b16 a[182:183], v209 offset:9216
ds_read_b64_tr_b16 a[184:185], v210 offset:8192
v_mfma_f32_16x16x32_bf16 v[100:103], a[204:207], a[240:243], v[100:103]
v_mfma_f32_16x16x32_bf16 v[96:99], a[200:203], a[240:243], v[96:99]
v_mfma_f32_16x16x32_bf16 v[88:91], a[200:203], a[236:239], v[88:91]
ds_read_b64_tr_b16 a[186:187], v210 offset:9216
ds_read_b64_tr_b16 a[188:189], v211 offset:8192
v_mfma_f32_16x16x32_bf16 v[92:95], a[204:207], a[236:239], v[92:95]
s_cmp_lt_u32 s38, 10
s_cselect_b32 s6, 321536, s6
s_cselect_b32 s7, 8, 2
v_mfma_f32_16x16x32_bf16 v[84:87], a[204:207], a[232:235], v[84:87]
v_mfma_f32_16x16x32_bf16 v[80:83], a[200:203], a[232:235], v[80:83]
v_mfma_f32_16x16x32_bf16 v[72:75], a[200:203], a[228:231], v[72:75]
ds_read_b64_tr_b16 a[190:191], v211 offset:9216
v_lshlrev_b32 v251, s7, v251
v_mfma_f32_16x16x32_bf16 v[76:79], a[204:207], a[228:231], v[76:79]
v_mfma_f32_16x16x32_bf16 v[68:71], a[204:207], a[224:227], v[68:71]
Lpad7:
s_cbranch_execz Lpad11
ds_read_b128 a[128:131], v201 offset:0
v_add_u32 v251, s6, v251
v_mfma_f32_16x16x32_bf16 v[64:67], a[200:203], a[224:227], v[64:67]
v_mfma_f32_16x16x32_bf16 a[0:3], a[208:211], a[224:227], a[0:3]
ds_read_b128 a[132:135], v201 offset:2048
ds_read_b128 a[136:139], v201 offset:4096
v_mfma_f32_16x16x32_bf16 a[4:7], a[212:215], a[224:227], a[4:7]
v_mfma_f32_16x16x32_bf16 a[12:15], a[212:215], a[228:231], a[12:15]
v_mfma_f32_16x16x32_bf16 a[8:11], a[208:211], a[228:231], a[8:11]
ds_read_b128 a[140:143], v201 offset:6144
ds_read_b128 a[144:147], v201 offset:8192
v_mfma_f32_16x16x32_bf16 a[16:19], a[208:211], a[232:235], a[16:19]
v_mfma_f32_16x16x32_bf16 a[20:23], a[212:215], a[232:235], a[20:23]
v_mfma_f32_16x16x32_bf16 a[28:31], a[212:215], a[236:239], a[28:31]
v_mfma_f32_16x16x32_bf16 a[24:27], a[208:211], a[236:239], a[24:27]
ds_read_b128 a[148:151], v201 offset:10240
ds_read_b128 a[152:155], v201 offset:12288
v_mfma_f32_16x16x32_bf16 a[32:35], a[208:211], a[240:243], a[32:35]
v_mfma_f32_16x16x32_bf16 a[36:39], a[212:215], a[240:243], a[36:39]
v_mfma_f32_16x16x32_bf16 a[44:47], a[212:215], a[244:247], a[44:47]
v_mfma_f32_16x16x32_bf16 a[40:43], a[208:211], a[244:247], a[40:43]
ds_read_b128 a[156:159], v201 offset:14336
v_mfma_f32_16x16x32_bf16 a[48:51], a[208:211], a[248:251], a[48:51]
v_mfma_f32_16x16x32_bf16 a[52:55], a[212:215], a[248:251], a[52:55]
v_mfma_f32_16x16x32_bf16 a[60:63], a[212:215], a[252:255], a[60:63]
v_mfma_f32_16x16x32_bf16 a[56:59], a[208:211], a[252:255], a[56:59]
v_mfma_f32_16x16x32_bf16 a[120:123], a[216:219], a[252:255], a[120:123]
v_mfma_f32_16x16x32_bf16 a[124:127], a[220:223], a[252:255], a[124:127]
v_mfma_f32_16x16x32_bf16 a[116:119], a[220:223], a[248:251], a[116:119]
v_mfma_f32_16x16x32_bf16 a[112:115], a[216:219], a[248:251], a[112:115]
v_mfma_f32_16x16x32_bf16 a[104:107], a[216:219], a[244:247], a[104:107]
v_mfma_f32_16x16x32_bf16 a[108:111], a[220:223], a[244:247], a[108:111]
v_mfma_f32_16x16x32_bf16 a[100:103], a[220:223], a[240:243], a[100:103]
v_mfma_f32_16x16x32_bf16 a[96:99], a[216:219], a[240:243], a[96:99]
v_mfma_f32_16x16x32_bf16 a[88:91], a[216:219], a[236:239], a[88:91]
v_mfma_f32_16x16x32_bf16 a[92:95], a[220:223], a[236:239], a[92:95]
v_mfma_f32_16x16x32_bf16 a[84:87], a[220:223], a[232:235], a[84:87]
v_mfma_f32_16x16x32_bf16 a[80:83], a[216:219], a[232:235], a[80:83]
v_mfma_f32_16x16x32_bf16 a[72:75], a[216:219], a[228:231], a[72:75]
v_mfma_f32_16x16x32_bf16 a[76:79], a[220:223], a[228:231], a[76:79]
v_mfma_f32_16x16x32_bf16 a[68:71], a[220:223], a[224:227], a[68:71]
v_mfma_f32_16x16x32_bf16 a[64:67], a[216:219], a[224:227], a[64:67]
s_waitcnt vmcnt(2) lgkmcnt(0)
v_mfma_f32_16x16x32_bf16 v[0:3], a[128:131], a[160:163], v[0:3]
s_barrier
v_mfma_f32_16x16x32_bf16 v[4:7], a[132:135], a[160:163], v[4:7]
s_add_u32 m0, s32, 0
ds_read_b64_tr_b16 a[224:225], v212 offset:0
ds_read_b64_tr_b16 a[226:227], v212 offset:1024
v_mfma_f32_16x16x32_bf16 v[12:15], a[132:135], a[164:167], v[12:15]
buffer_load_dwordx4 v192, s[8:11], s68 offen offset:0 lds
v_mfma_f32_16x16x32_bf16 v[8:11], a[128:131], a[164:167], v[8:11]
v_mfma_f32_16x16x32_bf16 v[16:19], a[128:131], a[168:171], v[16:19]
buffer_load_dwordx4 v193, s[8:11], s68 offen offset:1024 lds
v_mfma_f32_16x16x32_bf16 v[20:23], a[132:135], a[168:171], v[20:23]
ds_read_b64_tr_b16 a[228:229], v213 offset:0
ds_read_b64_tr_b16 a[230:231], v213 offset:1024
v_mfma_f32_16x16x32_bf16 v[28:31], a[132:135], a[172:175], v[28:31]
v_mfma_f32_16x16x32_bf16 v[24:27], a[128:131], a[172:175], v[24:27]
v_mfma_f32_16x16x32_bf16 v[32:35], a[128:131], a[176:179], v[32:35]
buffer_load_dwordx4 v194, s[8:11], s68 offen offset:2048 lds
v_mfma_f32_16x16x32_bf16 v[36:39], a[132:135], a[176:179], v[36:39]
ds_read_b64_tr_b16 a[232:233], v214 offset:0
ds_read_b64_tr_b16 a[234:235], v214 offset:1024
v_mfma_f32_16x16x32_bf16 v[44:47], a[132:135], a[180:183], v[44:47]
v_mfma_f32_16x16x32_bf16 v[40:43], a[128:131], a[180:183], v[40:43]
v_mfma_f32_16x16x32_bf16 v[48:51], a[128:131], a[184:187], v[48:51]
buffer_load_dwordx4 v195, s[8:11], s68 offen offset:3072 lds
v_mfma_f32_16x16x32_bf16 v[52:55], a[132:135], a[184:187], v[52:55]
s_add_u32 m0, s32, 4096
ds_read_b64_tr_b16 a[236:237], v215 offset:0
ds_read_b64_tr_b16 a[238:239], v215 offset:1024
v_mfma_f32_16x16x32_bf16 v[60:63], a[132:135], a[188:191], v[60:63]
v_mfma_f32_16x16x32_bf16 v[56:59], a[128:131], a[188:191], v[56:59]
ds_read_b64_tr_b16 a[240:241], v217 offset:0
ds_read_b64_tr_b16 a[242:243], v217 offset:1024
v_mfma_f32_16x16x32_bf16 v[120:123], a[136:139], a[188:191], v[120:123]
v_mfma_f32_16x16x32_bf16 v[124:127], a[140:143], a[188:191], v[124:127]
buffer_load_dwordx4 v192, s[8:11], s69 offen offset:0 lds
v_mfma_f32_16x16x32_bf16 v[116:119], a[140:143], a[184:187], v[116:119]
v_mfma_f32_16x16x32_bf16 v[112:115], a[136:139], a[184:187], v[112:115]
ds_read_b64_tr_b16 a[244:245], v218 offset:0
ds_read_b64_tr_b16 a[246:247], v218 offset:1024
v_mfma_f32_16x16x32_bf16 v[104:107], a[136:139], a[180:183], v[104:107]
v_mfma_f32_16x16x32_bf16 v[108:111], a[140:143], a[180:183], v[108:111]
buffer_load_dwordx4 v193, s[8:11], s69 offen offset:1024 lds
v_mfma_f32_16x16x32_bf16 v[100:103], a[140:143], a[176:179], v[100:103]
v_mfma_f32_16x16x32_bf16 v[96:99], a[136:139], a[176:179], v[96:99]
ds_read_b64_tr_b16 a[248:249], v221 offset:0
ds_read_b64_tr_b16 a[250:251], v221 offset:1024
v_mfma_f32_16x16x32_bf16 v[88:91], a[136:139], a[172:175], v[88:91]
v_mfma_f32_16x16x32_bf16 v[92:95], a[140:143], a[172:175], v[92:95]
buffer_load_dwordx4 v194, s[8:11], s69 offen offset:2048 lds
v_mfma_f32_16x16x32_bf16 v[84:87], a[140:143], a[168:171], v[84:87]
ds_read_b64_tr_b16 a[252:253], v222 offset:0
ds_read_b64_tr_b16 a[254:255], v222 offset:1024
v_mfma_f32_16x16x32_bf16 v[80:83], a[136:139], a[168:171], v[80:83]
v_mfma_f32_16x16x32_bf16 v[72:75], a[136:139], a[164:167], v[72:75]
v_mfma_f32_16x16x32_bf16 v[76:79], a[140:143], a[164:167], v[76:79]
v_mfma_f32_16x16x32_bf16 v[68:71], a[140:143], a[160:163], v[68:71]
buffer_load_dwordx4 v195, s[8:11], s69 offen offset:3072 lds
v_mfma_f32_16x16x32_bf16 v[64:67], a[136:139], a[160:163], v[64:67]
s_add_u32 m0, s32, 32768
ds_read_b128 a[192:195], v202 offset:0
ds_read_b128 a[196:199], v202 offset:2048
v_mfma_f32_16x16x32_bf16 a[0:3], a[144:147], a[160:163], a[0:3]
v_mfma_f32_16x16x32_bf16 a[4:7], a[148:151], a[160:163], a[4:7]
v_mfma_f32_16x16x32_bf16 a[12:15], a[148:151], a[164:167], a[12:15]
buffer_load_dwordx4 v196, s[12:15], s70 offen offset:0 lds
v_mfma_f32_16x16x32_bf16 a[8:11], a[144:147], a[164:167], a[8:11]
ds_read_b128 a[200:203], v202 offset:4096
ds_read_b128 a[204:207], v202 offset:6144
v_mfma_f32_16x16x32_bf16 a[16:19], a[144:147], a[168:171], a[16:19]
v_mfma_f32_16x16x32_bf16 a[20:23], a[148:151], a[168:171], a[20:23]
ds_read_b128 a[208:211], v202 offset:8192
ds_read_b128 a[212:215], v202 offset:10240
v_mfma_f32_16x16x32_bf16 a[28:31], a[148:151], a[172:175], a[28:31]
buffer_load_dwordx4 v197, s[12:15], s70 offen offset:1024 lds
v_mfma_f32_16x16x32_bf16 a[24:27], a[144:147], a[172:175], a[24:27]
v_mfma_f32_16x16x32_bf16 a[32:35], a[144:147], a[176:179], a[32:35]
v_mfma_f32_16x16x32_bf16 a[36:39], a[148:151], a[176:179], a[36:39]
ds_read_b128 a[216:219], v202 offset:12288
ds_read_b128 a[220:223], v202 offset:14336
v_mfma_f32_16x16x32_bf16 a[44:47], a[148:151], a[180:183], a[44:47]
v_mfma_f32_16x16x32_bf16 a[40:43], a[144:147], a[180:183], a[40:43]
buffer_load_dwordx4 v198, s[12:15], s70 offen offset:2048 lds
v_mfma_f32_16x16x32_bf16 a[48:51], a[144:147], a[184:187], a[48:51]
v_mfma_f32_16x16x32_bf16 a[52:55], a[148:151], a[184:187], a[52:55]
v_mfma_f32_16x16x32_bf16 a[60:63], a[148:151], a[188:191], a[60:63]
v_mfma_f32_16x16x32_bf16 a[56:59], a[144:147], a[188:191], a[56:59]
buffer_load_dwordx4 v199, s[12:15], s70 offen offset:3072 lds
v_mfma_f32_16x16x32_bf16 a[120:123], a[152:155], a[188:191], a[120:123]
s_add_u32 m0, s32, 36864
v_mfma_f32_16x16x32_bf16 a[124:127], a[156:159], a[188:191], a[124:127]
v_mfma_f32_16x16x32_bf16 a[116:119], a[156:159], a[184:187], a[116:119]
v_mfma_f32_16x16x32_bf16 a[112:115], a[152:155], a[184:187], a[112:115]
buffer_load_dwordx4 v196, s[12:15], s71 offen offset:0 lds
v_mfma_f32_16x16x32_bf16 a[104:107], a[152:155], a[180:183], a[104:107]
v_mfma_f32_16x16x32_bf16 a[108:111], a[156:159], a[180:183], a[108:111]
v_mfma_f32_16x16x32_bf16 a[100:103], a[156:159], a[176:179], a[100:103]
v_mfma_f32_16x16x32_bf16 a[96:99], a[152:155], a[176:179], a[96:99]
v_mfma_f32_16x16x32_bf16 a[88:91], a[152:155], a[172:175], a[88:91]
buffer_load_dwordx4 v197, s[12:15], s71 offen offset:1024 lds
v_mfma_f32_16x16x32_bf16 a[92:95], a[156:159], a[172:175], a[92:95]
v_mfma_f32_16x16x32_bf16 a[84:87], a[156:159], a[168:171], a[84:87]
v_mfma_f32_16x16x32_bf16 a[80:83], a[152:155], a[168:171], a[80:83]
v_mfma_f32_16x16x32_bf16 a[72:75], a[152:155], a[164:167], a[72:75]
buffer_load_dwordx4 v198, s[12:15], s71 offen offset:2048 lds
v_mfma_f32_16x16x32_bf16 a[76:79], a[156:159], a[164:167], a[76:79]
v_mfma_f32_16x16x32_bf16 a[68:71], a[156:159], a[160:163], a[68:71]
v_mfma_f32_16x16x32_bf16 a[64:67], a[152:155], a[160:163], a[64:67]
s_waitcnt lgkmcnt(0)
v_mfma_f32_16x16x32_bf16 v[0:3], a[192:195], a[224:227], v[0:3]
s_barrier
v_mfma_f32_16x16x32_bf16 v[4:7], a[196:199], a[224:227], v[4:7]
buffer_load_dwordx4 v199, s[12:15], s71 offen offset:3072 lds
v_mfma_f32_16x16x32_bf16 v[12:15], a[196:199], a[228:231], v[12:15]
s_add_u32 s68, s68, 128
ds_read_b64_tr_b16 a[160:161], v212 offset:8192
s_add_u32 s69, s69, 128
v_mfma_f32_16x16x32_bf16 v[8:11], a[192:195], a[228:231], v[8:11]
s_add_u32 s70, s70, 524288
ds_read_b64_tr_b16 a[162:163], v212 offset:9216
s_add_u32 s71, s71, 524288
v_mfma_f32_16x16x32_bf16 v[16:19], a[192:195], a[232:235], v[16:19]
ds_read_b64_tr_b16 a[164:165], v213 offset:8192
ds_read_b64_tr_b16 a[166:167], v213 offset:9216
v_mfma_f32_16x16x32_bf16 v[20:23], a[196:199], a[232:235], v[20:23]
global_load_dword v219, v251, s[66:67] sc1
v_mfma_f32_16x16x32_bf16 v[28:31], a[196:199], a[236:239], v[28:31]
s_mov_b32 s16, s40
ds_read_b64_tr_b16 a[168:169], v214 offset:8192
s_and_b32 s17, s41, 0xffff
v_mfma_f32_16x16x32_bf16 v[24:27], a[192:195], a[236:239], v[24:27]
s_mov_b32 s18, 5242880
s_mov_b32 s19, 0x20000
v_min_u32 v255, 39, v220
v_mfma_f32_16x16x32_bf16 v[32:35], a[192:195], a[240:243], v[32:35]
v_lshrrev_b32 v254, 1, v255
v_lshlrev_b32 v254, 13, v254
v_mfma_f32_16x16x32_bf16 v[36:39], a[196:199], a[240:243], v[36:39]
v_and_b32 v255, 1, v255
v_lshl_add_u32 v254, v255, 7, v254
v_mfma_f32_16x16x32_bf16 v[44:47], a[196:199], a[244:247], v[44:47]
s_lshl_b32 s35, s5, 2
ds_read_b64_tr_b16 a[170:171], v214 offset:9216
s_add_u32 s35, s35, s3
v_mfma_f32_16x16x32_bf16 v[40:43], a[192:195], a[244:247], v[40:43]
s_mul_i32 s35, s35, 163840
ds_read_b64_tr_b16 a[172:173], v215 offset:8192
s_lshl_b32 s7, s4, 8
v_mfma_f32_16x16x32_bf16 v[48:51], a[192:195], a[248:251], v[48:51]
s_add_u32 s35, s35, s7
ds_read_b64_tr_b16 a[174:175], v215 offset:9216
s_mov_b32 m0, 155648
v_mfma_f32_16x16x32_bf16 v[52:55], a[196:199], a[248:251], v[52:55]
buffer_load_dword v254, s[16:19], s35 offen lds
v_mfma_f32_16x16x32_bf16 v[60:63], a[196:199], a[252:255], v[60:63]
v_mfma_f32_16x16x32_bf16 v[56:59], a[192:195], a[252:255], v[56:59]
ds_read_b64_tr_b16 a[176:177], v217 offset:8192
ds_read_b64_tr_b16 a[178:179], v217 offset:9216
v_mfma_f32_16x16x32_bf16 v[120:123], a[200:203], a[252:255], v[120:123]
v_mfma_f32_16x16x32_bf16 v[124:127], a[204:207], a[252:255], v[124:127]
v_mfma_f32_16x16x32_bf16 v[116:119], a[204:207], a[248:251], v[116:119]
v_mfma_f32_16x16x32_bf16 v[112:115], a[200:203], a[248:251], v[112:115]
ds_read_b64_tr_b16 a[180:181], v218 offset:8192
ds_read_b64_tr_b16 a[182:183], v218 offset:9216
v_mfma_f32_16x16x32_bf16 v[104:107], a[200:203], a[244:247], v[104:107]
v_mfma_f32_16x16x32_bf16 v[108:111], a[204:207], a[244:247], v[108:111]
v_mfma_f32_16x16x32_bf16 v[100:103], a[204:207], a[240:243], v[100:103]
v_mfma_f32_16x16x32_bf16 v[96:99], a[200:203], a[240:243], v[96:99]
ds_read_b64_tr_b16 a[184:185], v221 offset:8192
ds_read_b64_tr_b16 a[186:187], v221 offset:9216
v_mfma_f32_16x16x32_bf16 v[88:91], a[200:203], a[236:239], v[88:91]
v_mfma_f32_16x16x32_bf16 v[92:95], a[204:207], a[236:239], v[92:95]
v_mfma_f32_16x16x32_bf16 v[84:87], a[204:207], a[232:235], v[84:87]
ds_read_b64_tr_b16 a[188:189], v222 offset:8192
ds_read_b64_tr_b16 a[190:191], v222 offset:9216
v_mfma_f32_16x16x32_bf16 v[80:83], a[200:203], a[232:235], v[80:83]
v_mfma_f32_16x16x32_bf16 v[72:75], a[200:203], a[228:231], v[72:75]
v_mfma_f32_16x16x32_bf16 v[76:79], a[204:207], a[228:231], v[76:79]
v_mfma_f32_16x16x32_bf16 v[68:71], a[204:207], a[224:227], v[68:71]
ds_read_b128 a[128:131], v203 offset:0
ds_read_b128 a[132:135], v203 offset:2048
v_mfma_f32_16x16x32_bf16 v[64:67], a[200:203], a[224:227], v[64:67]
v_mfma_f32_16x16x32_bf16 a[0:3], a[208:211], a[224:227], a[0:3]
v_mfma_f32_16x16x32_bf16 a[4:7], a[212:215], a[224:227], a[4:7]
v_mfma_f32_16x16x32_bf16 a[12:15], a[212:215], a[228:231], a[12:15]
ds_read_b128 a[136:139], v203 offset:4096
ds_read_b128 a[140:143], v203 offset:6144
v_mfma_f32_16x16x32_bf16 a[8:11], a[208:211], a[228:231], a[8:11]
v_mfma_f32_16x16x32_bf16 a[16:19], a[208:211], a[232:235], a[16:19]
v_mfma_f32_16x16x32_bf16 a[20:23], a[212:215], a[232:235], a[20:23]
ds_read_b128 a[144:147], v203 offset:8192
ds_read_b128 a[148:151], v203 offset:10240
v_mfma_f32_16x16x32_bf16 a[28:31], a[212:215], a[236:239], a[28:31]
v_mfma_f32_16x16x32_bf16 a[24:27], a[208:211], a[236:239], a[24:27]
v_mfma_f32_16x16x32_bf16 a[32:35], a[208:211], a[240:243], a[32:35]
v_mfma_f32_16x16x32_bf16 a[36:39], a[212:215], a[240:243], a[36:39]
ds_read_b128 a[152:155], v203 offset:12288
ds_read_b128 a[156:159], v203 offset:14336
v_mfma_f32_16x16x32_bf16 a[44:47], a[212:215], a[244:247], a[44:47]
v_mfma_f32_16x16x32_bf16 a[40:43], a[208:211], a[244:247], a[40:43]
v_mfma_f32_16x16x32_bf16 a[48:51], a[208:211], a[248:251], a[48:51]
v_mfma_f32_16x16x32_bf16 a[52:55], a[212:215], a[248:251], a[52:55]
v_mfma_f32_16x16x32_bf16 a[60:63], a[212:215], a[252:255], a[60:63]
v_mfma_f32_16x16x32_bf16 a[56:59], a[208:211], a[252:255], a[56:59]
v_mfma_f32_16x16x32_bf16 a[120:123], a[216:219], a[252:255], a[120:123]
v_mfma_f32_16x16x32_bf16 a[124:127], a[220:223], a[252:255], a[124:127]
v_mfma_f32_16x16x32_bf16 a[116:119], a[220:223], a[248:251], a[116:119]
v_mfma_f32_16x16x32_bf16 a[112:115], a[216:219], a[248:251], a[112:115]
v_mfma_f32_16x16x32_bf16 a[104:107], a[216:219], a[244:247], a[104:107]
v_mfma_f32_16x16x32_bf16 a[108:111], a[220:223], a[244:247], a[108:111]
v_mfma_f32_16x16x32_bf16 a[100:103], a[220:223], a[240:243], a[100:103]
v_mfma_f32_16x16x32_bf16 a[96:99], a[216:219], a[240:243], a[96:99]
v_mfma_f32_16x16x32_bf16 a[88:91], a[216:219], a[236:239], a[88:91]
v_mfma_f32_16x16x32_bf16 a[92:95], a[220:223], a[236:239], a[92:95]
v_mfma_f32_16x16x32_bf16 a[84:87], a[220:223], a[232:235], a[84:87]
v_mfma_f32_16x16x32_bf16 a[80:83], a[216:219], a[232:235], a[80:83]
v_mfma_f32_16x16x32_bf16 a[72:75], a[216:219], a[228:231], a[72:75]
v_mfma_f32_16x16x32_bf16 a[76:79], a[220:223], a[228:231], a[76:79]
v_mfma_f32_16x16x32_bf16 a[68:71], a[220:223], a[224:227], a[68:71]
v_mfma_f32_16x16x32_bf16 a[64:67], a[216:219], a[224:227], a[64:67]
s_waitcnt vmcnt(1) lgkmcnt(0)
v_mfma_f32_16x16x32_bf16 v[0:3], a[128:131], a[160:163], v[0:3]
s_barrier
s_cmp_ge_u32 s38, 10
s_cbranch_scc1 Lfinskip
v_cmp_gt_u32 vcc, 20, v219
s_mov_b32 s6, 0
s_cmp_eq_u64 vcc, 0
s_cbranch_scc1 Lok7
Lsp8:
s_sleep 2
global_load_dword v219, v251, s[66:67] sc1
s_waitcnt vmcnt(0)
v_cmp_gt_u32 vcc, 20, v219
s_add_u32 s6, s6, 1
s_cmp_gt_u32 s6, 200000
s_cbranch_scc1 Lok7
s_cmp_lg_u64 vcc, 0
s_cbranch_scc1 Lsp8
Lok7:
Lfinskip:
v_mfma_f32_16x16x32_bf16 v[4:7], a[132:135], a[160:163], v[4:7]
s_add_u32 m0, s32, 65536
ds_read_b64_tr_b16 a[224:225], v204 offset:0
ds_read_b64_tr_b16 a[226:227], v204 offset:1024
v_mfma_f32_16x16x32_bf16 v[12:15], a[132:135], a[164:167], v[12:15]
buffer_load_dwordx4 v192, s[8:11], s68 offen offset:0 lds
v_mfma_f32_16x16x32_bf16 v[8:11], a[128:131], a[164:167], v[8:11]
v_mfma_f32_16x16x32_bf16 v[16:19], a[128:131], a[168:171], v[16:19]
buffer_load_dwordx4 v193, s[8:11], s68 offen offset:1024 lds
v_mfma_f32_16x16x32_bf16 v[20:23], a[132:135], a[168:171], v[20:23]
ds_read_b64_tr_b16 a[228:229], v205 offset:0
ds_read_b64_tr_b16 a[230:231], v205 offset:1024
v_mfma_f32_16x16x32_bf16 v[28:31], a[132:135], a[172:175], v[28:31]
v_mfma_f32_16x16x32_bf16 v[24:27], a[128:131], a[172:175], v[24:27]
v_mfma_f32_16x16x32_bf16 v[32:35], a[128:131], a[176:179], v[32:35]
buffer_load_dwordx4 v194, s[8:11], s68 offen offset:2048 lds
v_mfma_f32_16x16x32_bf16 v[36:39], a[132:135], a[176:179], v[36:39]
ds_read_b64_tr_b16 a[232:233], v206 offset:0
ds_read_b64_tr_b16 a[234:235], v206 offset:1024
v_mfma_f32_16x16x32_bf16 v[44:47], a[132:135], a[180:183], v[44:47]
v_mfma_f32_16x16x32_bf16 v[40:43], a[128:131], a[180:183], v[40:43]
v_mfma_f32_16x16x32_bf16 v[48:51], a[128:131], a[184:187], v[48:51]
buffer_load_dwordx4 v195, s[8:11], s68 offen offset:3072 lds
v_mfma_f32_16x16x32_bf16 v[52:55], a[132:135], a[184:187], v[52:55]
s_add_u32 m0, s32, 69632
ds_read_b64_tr_b16 a[236:237], v207 offset:0
ds_read_b64_tr_b16 a[238:239], v207 offset:1024
v_mfma_f32_16x16x32_bf16 v[60:63], a[132:135], a[188:191], v[60:63]
v_mfma_f32_16x16x32_bf16 v[56:59], a[128:131], a[188:191], v[56:59]
ds_read_b64_tr_b16 a[240:241], v208 offset:0
ds_read_b64_tr_b16 a[242:243], v208 offset:1024
v_mfma_f32_16x16x32_bf16 v[120:123], a[136:139], a[188:191], v[120:123]
v_mfma_f32_16x16x32_bf16 v[124:127], a[140:143], a[188:191], v[124:127]
buffer_load_dwordx4 v192, s[8:11], s69 offen offset:0 lds
v_mfma_f32_16x16x32_bf16 v[116:119], a[140:143], a[184:187], v[116:119]
v_mfma_f32_16x16x32_bf16 v[112:115], a[136:139], a[184:187], v[112:115]
ds_read_b64_tr_b16 a[244:245], v209 offset:0
ds_read_b64_tr_b16 a[246:247], v209 offset:1024
v_mfma_f32_16x16x32_bf16 v[104:107], a[136:139], a[180:183], v[104:107]
v_mfma_f32_16x16x32_bf16 v[108:111], a[140:143], a[180:183], v[108:111]
buffer_load_dwordx4 v193, s[8:11], s69 offen offset:1024 lds
v_mfma_f32_16x16x32_bf16 v[100:103], a[140:143], a[176:179], v[100:103]
v_mfma_f32_16x16x32_bf16 v[96:99], a[136:139], a[176:179], v[96:99]
ds_read_b64_tr_b16 a[248:249], v210 offset:0
ds_read_b64_tr_b16 a[250:251], v210 offset:1024
v_mfma_f32_16x16x32_bf16 v[88:91], a[136:139], a[172:175], v[88:91]
v_mfma_f32_16x16x32_bf16 v[92:95], a[140:143], a[172:175], v[92:95]
buffer_load_dwordx4 v194, s[8:11], s69 offen offset:2048 lds
v_mfma_f32_16x16x32_bf16 v[84:87], a[140:143], a[168:171], v[84:87]
ds_read_b64_tr_b16 a[252:253], v211 offset:0
ds_read_b64_tr_b16 a[254:255], v211 offset:1024
v_mfma_f32_16x16x32_bf16 v[80:83], a[136:139], a[168:171], v[80:83]
v_mfma_f32_16x16x32_bf16 v[72:75], a[136:139], a[164:167], v[72:75]
v_mfma_f32_16x16x32_bf16 v[76:79], a[140:143], a[164:167], v[76:79]
v_mfma_f32_16x16x32_bf16 v[68:71], a[140:143], a[160:163], v[68:71]
buffer_load_dwordx4 v195, s[8:11], s69 offen offset:3072 lds
v_mfma_f32_16x16x32_bf16 v[64:67], a[136:139], a[160:163], v[64:67]
s_add_u32 m0, s32, 98304
ds_read_b128 a[192:195], v200 offset:0
ds_read_b128 a[196:199], v200 offset:2048
v_mfma_f32_16x16x32_bf16 a[0:3], a[144:147], a[160:163], a[0:3]
v_mfma_f32_16x16x32_bf16 a[4:7], a[148:151], a[160:163], a[4:7]
v_mfma_f32_16x16x32_bf16 a[12:15], a[148:151], a[164:167], a[12:15]
buffer_load_dwordx4 v196, s[12:15], s70 offen offset:0 lds
v_mfma_f32_16x16x32_bf16 a[8:11], a[144:147], a[164:167], a[8:11]
ds_read_b128 a[200:203], v200 offset:4096
ds_read_b128 a[204:207], v200 offset:6144
v_mfma_f32_16x16x32_bf16 a[16:19], a[144:147], a[168:171], a[16:19]
v_mfma_f32_16x16x32_bf16 a[20:23], a[148:151], a[168:171], a[20:23]
ds_read_b128 a[208:211], v200 offset:8192
ds_read_b128 a[212:215], v200 offset:10240
v_mfma_f32_16x16x32_bf16 a[28:31], a[148:151], a[172:175], a[28:31]
buffer_load_dwordx4 v197, s[12:15], s70 offen offset:1024 lds
v_mfma_f32_16x16x32_bf16 a[24:27], a[144:147], a[172:175], a[24:27]
v_mfma_f32_16x16x32_bf16 a[32:35], a[144:147], a[176:179], a[32:35]
v_mfma_f32_16x16x32_bf16 a[36:39], a[148:151], a[176:179], a[36:39]
ds_read_b128 a[216:219], v200 offset:12288
ds_read_b128 a[220:223], v200 offset:14336
v_mfma_f32_16x16x32_bf16 a[44:47], a[148:151], a[180:183], a[44:47]
v_mfma_f32_16x16x32_bf16 a[40:43], a[144:147], a[180:183], a[40:43]
buffer_load_dwordx4 v198, s[12:15], s70 offen offset:2048 lds
v_mfma_f32_16x16x32_bf16 a[48:51], a[144:147], a[184:187], a[48:51]
v_mfma_f32_16x16x32_bf16 a[52:55], a[148:151], a[184:187], a[52:55]
v_mfma_f32_16x16x32_bf16 a[60:63], a[148:151], a[188:191], a[60:63]
v_mfma_f32_16x16x32_bf16 a[56:59], a[144:147], a[188:191], a[56:59]
buffer_load_dwordx4 v199, s[12:15], s70 offen offset:3072 lds
v_mfma_f32_16x16x32_bf16 a[120:123], a[152:155], a[188:191], a[120:123]
s_add_u32 m0, s32, 102400
v_mfma_f32_16x16x32_bf16 a[124:127], a[156:159], a[188:191], a[124:127]
v_mfma_f32_16x16x32_bf16 a[116:119], a[156:159], a[184:187], a[116:119]
v_mfma_f32_16x16x32_bf16 a[112:115], a[152:155], a[184:187], a[112:115]
buffer_load_dwordx4 v196, s[12:15], s71 offen offset:0 lds
v_mfma_f32_16x16x32_bf16 a[104:107], a[152:155], a[180:183], a[104:107]
v_mfma_f32_16x16x32_bf16 a[108:111], a[156:159], a[180:183], a[108:111]
v_mfma_f32_16x16x32_bf16 a[100:103], a[156:159], a[176:179], a[100:103]
v_mfma_f32_16x16x32_bf16 a[96:99], a[152:155], a[176:179], a[96:99]
v_mfma_f32_16x16x32_bf16 a[88:91], a[152:155], a[172:175], a[88:91]
buffer_load_dwordx4 v197, s[12:15], s71 offen offset:1024 lds
v_mfma_f32_16x16x32_bf16 a[92:95], a[156:159], a[172:175], a[92:95]
v_mfma_f32_16x16x32_bf16 a[84:87], a[156:159], a[168:171], a[84:87]
v_mfma_f32_16x16x32_bf16 a[80:83], a[152:155], a[168:171], a[80:83]
v_mfma_f32_16x16x32_bf16 a[72:75], a[152:155], a[164:167], a[72:75]
buffer_load_dwordx4 v198, s[12:15], s71 offen offset:2048 lds
v_mfma_f32_16x16x32_bf16 a[76:79], a[156:159], a[164:167], a[76:79]
v_mfma_f32_16x16x32_bf16 a[68:71], a[156:159], a[160:163], a[68:71]
v_mfma_f32_16x16x32_bf16 a[64:67], a[152:155], a[160:163], a[64:67]
s_waitcnt lgkmcnt(0)
v_mfma_f32_16x16x32_bf16 v[0:3], a[192:195], a[224:227], v[0:3]
v_mfma_f32_16x16x32_bf16 v[4:7], a[196:199], a[224:227], v[4:7]
buffer_load_dwordx4 v199, s[12:15], s71 offen offset:3072 lds
v_mfma_f32_16x16x32_bf16 v[12:15], a[196:199], a[228:231], v[12:15]
s_add_u32 s68, s68, 128
ds_read_b64_tr_b16 a[160:161], v204 offset:8192
s_add_u32 s69, s69, 128
v_mfma_f32_16x16x32_bf16 v[8:11], a[192:195], a[228:231], v[8:11]
s_add_u32 s70, s70, 524288
ds_read_b64_tr_b16 a[162:163], v204 offset:9216
s_add_u32 s71, s71, 524288
v_mfma_f32_16x16x32_bf16 v[16:19], a[192:195], a[232:235], v[16:19]
s_cmp_lt_u32 s38, 10
s_cselect_b32 s22, s22, 0
v_mfma_f32_16x16x32_bf16 v[20:23], a[196:199], a[232:235], v[20:23]
s_lshl_b32 s48, s38, 10
ds_read_b64_tr_b16 a[164:165], v205 offset:8192
s_add_u32 s48, s48, 5120
v_mfma_f32_16x16x32_bf16 v[28:31], a[196:199], a[236:239], v[28:31]
s_mov_b32 s49, s48
s_add_u32 s76, s66, 1048576
s_addc_u32 s77, s67, 0
v_mfma_f32_16x16x32_bf16 v[24:27], a[192:195], a[236:239], v[24:27]
buffer_load_dwordx4 v[168:171], v216, s[20:23], s49 offen sc1
v_mfma_f32_16x16x32_bf16 v[32:35], a[192:195], a[240:243], v[32:35]
s_add_u32 s49, s49, 15360
ds_read_b64_tr_b16 a[166:167], v205 offset:9216
s_and_b32 s77, s77, 0xffff
v_mfma_f32_16x16x32_bf16 v[36:39], a[196:199], a[240:243], v[36:39]
buffer_load_dwordx4 v[172:175], v216, s[20:23], s49 offen sc1
v_mfma_f32_16x16x32_bf16 v[44:47], a[196:199], a[244:247], v[44:47]
s_add_u32 s49, s49, 15360
ds_read_b64_tr_b16 a[168:169], v206 offset:8192
s_mov_b32 s78, 2621440
v_mfma_f32_16x16x32_bf16 v[40:43], a[192:195], a[244:247], v[40:43]
s_mov_b32 s79, 0x20000
ds_read_b64_tr_b16 a[170:171], v206 offset:9216
ds_read_b64_tr_b16 a[172:173], v207 offset:8192
v_mfma_f32_16x16x32_bf16 v[48:51], a[192:195], a[248:251], v[48:51]
s_lshl_b32 s72, s5, 3
ds_read_b64_tr_b16 a[174:175], v207 offset:9216
s_add_u32 s72, s72, s3
v_mfma_f32_16x16x32_bf16 v[52:55], a[196:199], a[248:251], v[52:55]
buffer_load_dwordx4 v[176:179], v216, s[20:23], s49 offen sc1
v_mfma_f32_16x16x32_bf16 v[60:63], a[196:199], a[252:255], v[60:63]
s_add_u32 s49, s49, 15360
ds_read_b64_tr_b16 a[176:177], v208 offset:8192
s_add_u32 s73, s72, 4
v_mfma_f32_16x16x32_bf16 v[56:59], a[192:195], a[252:255], v[56:59]
s_sub_u32 s74, 15, s5
v_mfma_f32_16x16x32_bf16 v[120:123], a[200:203], a[252:255], v[120:123]
s_lshl_b32 s74, s74, 3
v_mfma_f32_16x16x32_bf16 v[124:127], a[204:207], a[252:255], v[124:127]
s_add_u32 s74, s74, s3
ds_read_b64_tr_b16 a[178:179], v208 offset:9216
ds_read_b64_tr_b16 a[180:181], v209 offset:8192
v_mfma_f32_16x16x32_bf16 v[116:119], a[204:207], a[248:251], v[116:119]
buffer_load_dwordx4 v[180:183], v216, s[20:23], s49 offen sc1
v_mfma_f32_16x16x32_bf16 v[112:115], a[200:203], a[248:251], v[112:115]
s_add_u32 s49, s49, 15360
v_mfma_f32_16x16x32_bf16 v[104:107], a[200:203], a[244:247], v[104:107]
s_add_u32 s75, s74, 4
v_mfma_f32_16x16x32_bf16 v[108:111], a[204:207], a[244:247], v[108:111]
s_mul_i32 s42, s72, 20480
ds_read_b64_tr_b16 a[182:183], v209 offset:9216
ds_read_b64_tr_b16 a[184:185], v210 offset:8192
v_mfma_f32_16x16x32_bf16 v[100:103], a[204:207], a[240:243], v[100:103]
s_mul_i32 s43, s73, 20480
v_mfma_f32_16x16x32_bf16 v[96:99], a[200:203], a[240:243], v[96:99]
s_mul_i32 s44, s74, 20480
v_mfma_f32_16x16x32_bf16 v[88:91], a[200:203], a[236:239], v[88:91]
s_mul_i32 s45, s75, 20480
ds_read_b64_tr_b16 a[186:187], v210 offset:9216
ds_read_b64_tr_b16 a[188:189], v211 offset:8192
v_mfma_f32_16x16x32_bf16 v[92:95], a[204:207], a[236:239], v[92:95]
s_lshl_b32 s58, s3, 16
v_mfma_f32_16x16x32_bf16 v[84:87], a[204:207], a[232:235], v[84:87]
s_lshl_b32 s59, s4, 8
v_mfma_f32_16x16x32_bf16 v[80:83], a[200:203], a[232:235], v[80:83]
s_add_u32 s58, s58, s59
v_mfma_f32_16x16x32_bf16 v[72:75], a[200:203], a[228:231], v[72:75]
s_lshl_b32 s59, s3, 11
ds_read_b64_tr_b16 a[190:191], v211 offset:9216
ds_read_b128 a[128:131], v201 offset:0
v_mfma_f32_16x16x32_bf16 v[76:79], a[204:207], a[228:231], v[76:79]
s_and_b32 s61, s3, 1
v_mfma_f32_16x16x32_bf16 v[68:71], a[204:207], a[224:227], v[68:71]
s_lshl_b32 s61, s61, 7
v_mfma_f32_16x16x32_bf16 v[64:67], a[200:203], a[224:227], v[64:67]
v_mfma_f32_16x16x32_bf16 a[0:3], a[208:211], a[224:227], a[0:3]
ds_read_b128 a[132:135], v201 offset:2048
v_xor_b32 v196, s61, v196
v_mfma_f32_16x16x32_bf16 a[4:7], a[212:215], a[224:227], a[4:7]
v_mfma_f32_16x16x32_bf16 a[12:15], a[212:215], a[228:231], a[12:15]
ds_read_b128 a[136:139], v201 offset:4096
v_add_u32 v197, 31744, v196
v_mfma_f32_16x16x32_bf16 a[8:11], a[208:211], a[228:231], a[8:11]
ds_read_b128 a[140:143], v201 offset:6144
v_and_b32 v198, 3, v220
v_mfma_f32_16x16x32_bf16 a[16:19], a[208:211], a[232:235], a[16:19]
v_mfma_f32_16x16x32_bf16 a[20:23], a[212:215], a[232:235], a[20:23]
ds_read_b128 a[144:147], v201 offset:8192
v_lshlrev_b32 v198, 4, v198
v_mfma_f32_16x16x32_bf16 a[28:31], a[212:215], a[236:239], a[28:31]
v_mfma_f32_16x16x32_bf16 a[24:27], a[208:211], a[236:239], a[24:27]
ds_read_b128 a[148:151], v201 offset:10240
v_lshrrev_b32 v199, 4, v220
v_mfma_f32_16x16x32_bf16 a[32:35], a[208:211], a[240:243], a[32:35]
v_mfma_f32_16x16x32_bf16 a[36:39], a[212:215], a[240:243], a[36:39]
ds_read_b128 a[152:155], v201 offset:12288
v_lshl_add_u32 v198, v199, 6, v198
v_mfma_f32_16x16x32_bf16 a[44:47], a[212:215], a[244:247], a[44:47]
v_mfma_f32_16x16x32_bf16 a[40:43], a[208:211], a[244:247], a[40:43]
ds_read_b128 a[156:159], v201 offset:14336
v_bfe_u32 v199, v220, 2, 2
v_mfma_f32_16x16x32_bf16 a[48:51], a[208:211], a[248:251], a[48:51]
v_mfma_f32_16x16x32_bf16 a[52:55], a[212:215], a[248:251], a[52:55]
v_mfma_f32_16x16x32_bf16 a[60:63], a[212:215], a[252:255], a[60:63]
v_mfma_f32_16x16x32_bf16 a[56:59], a[208:211], a[252:255], a[56:59]
v_mfma_f32_16x16x32_bf16 a[120:123], a[216:219], a[252:255], a[120:123]
v_mfma_f32_16x16x32_bf16 a[124:127], a[220:223], a[252:255], a[124:127]
v_mfma_f32_16x16x32_bf16 a[116:119], a[220:223], a[248:251], a[116:119]
v_mfma_f32_16x16x32_bf16 a[112:115], a[216:219], a[248:251], a[112:115]
v_mfma_f32_16x16x32_bf16 a[104:107], a[216:219], a[244:247], a[104:107]
v_mfma_f32_16x16x32_bf16 a[108:111], a[220:223], a[244:247], a[108:111]
v_mfma_f32_16x16x32_bf16 a[100:103], a[220:223], a[240:243], a[100:103]
v_mfma_f32_16x16x32_bf16 a[96:99], a[216:219], a[240:243], a[96:99]
v_mul_u32_u24 v199, 5120, v199
v_add_u32 v198, v198, v199
v_mfma_f32_16x16x32_bf16 a[88:91], a[216:219], a[236:239], a[88:91]
v_mfma_f32_16x16x32_bf16 a[92:95], a[220:223], a[236:239], a[92:95]
v_mfma_f32_16x16x32_bf16 a[84:87], a[220:223], a[232:235], a[84:87]
v_mfma_f32_16x16x32_bf16 a[80:83], a[216:219], a[232:235], a[80:83]
v_mfma_f32_16x16x32_bf16 a[72:75], a[216:219], a[228:231], a[72:75]
v_mfma_f32_16x16x32_bf16 a[76:79], a[220:223], a[228:231], a[76:79]
v_mfma_f32_16x16x32_bf16 a[68:71], a[220:223], a[224:227], a[68:71]
v_mfma_f32_16x16x32_bf16 a[64:67], a[216:219], a[224:227], a[64:67]
s_waitcnt vmcnt(0) lgkmcnt(0)
v_mfma_f32_16x16x32_bf16 v[0:3], a[128:131], a[160:163], v[0:3]
s_barrier
v_mfma_f32_16x16x32_bf16 v[4:7], a[132:135], a[160:163], v[4:7]
s_add_u32 m0, s59, 0
ds_read_b64_tr_b16 a[224:225], v212 offset:0
v_add_f32 v168, v168, v172
v_mfma_f32_16x16x32_bf16 v[12:15], a[132:135], a[164:167], v[12:15]
buffer_load_dwordx4 v196, s[16:19], s58 offen offset:0 lds
v_mfma_f32_16x16x32_bf16 v[8:11], a[128:131], a[164:167], v[8:11]
ds_read_b64_tr_b16 a[226:227], v212 offset:1024
v_add_f32 v176, v176, v180
v_mfma_f32_16x16x32_bf16 v[16:19], a[128:131], a[168:171], v[16:19]
buffer_load_dwordx4 v197, s[16:19], s58 offen offset:1024 lds
v_mfma_f32_16x16x32_bf16 v[20:23], a[132:135], a[168:171], v[20:23]
s_add_u32 s58, s58, 262144
s_add_u32 m0, s59, 8192
v_add_f32 v168, v168, v176
v_mfma_f32_16x16x32_bf16 v[28:31], a[132:135], a[172:175], v[28:31]
Lpad8:
s_cbranch_execz Lpad12
ds_read_b64_tr_b16 a[228:229], v213 offset:0
v_add_f32 v169, v169, v173
v_mfma_f32_16x16x32_bf16 v[24:27], a[128:131], a[172:175], v[24:27]
v_add_f32 v177, v177, v181
v_add_f32 v169, v169, v177
v_mfma_f32_16x16x32_bf16 v[32:35], a[128:131], a[176:179], v[32:35]
buffer_load_dwordx4 v196, s[16:19], s58 offen offset:0 lds
v_mfma_f32_16x16x32_bf16 v[36:39], a[132:135], a[176:179], v[36:39]
ds_read_b64_tr_b16 a[230:231], v213 offset:1024
v_add_f32 v170, v170, v174
v_mfma_f32_16x16x32_bf16 v[44:47], a[132:135], a[180:183], v[44:47]
ds_read_b64_tr_b16 a[232:233], v214 offset:0
v_add_f32 v178, v178, v182
v_mfma_f32_16x16x32_bf16 v[40:43], a[128:131], a[180:183], v[40:43]
v_add_f32 v170, v170, v178
v_add_f32 v171, v171, v175
v_mfma_f32_16x16x32_bf16 v[48:51], a[128:131], a[184:187], v[48:51]
buffer_load_dwordx4 v197, s[16:19], s58 offen offset:1024 lds
v_mfma_f32_16x16x32_bf16 v[52:55], a[132:135], a[184:187], v[52:55]
s_add_u32 s58, s58, 262144
ds_read_b64_tr_b16 a[234:235], v214 offset:1024
s_add_u32 m0, s59, 16384
v_mfma_f32_16x16x32_bf16 v[60:63], a[132:135], a[188:191], v[60:63]
v_add_f32 v179, v179, v183
v_add_f32 v171, v171, v179
v_mfma_f32_16x16x32_bf16 v[56:59], a[128:131], a[188:191], v[56:59]
ds_read_b64_tr_b16 a[236:237], v215 offset:0
v_cvt_pk_bf16_f32 v165, v168, v169
v_mfma_f32_16x16x32_bf16 v[120:123], a[136:139], a[188:191], v[120:123]
ds_read_b64_tr_b16 a[238:239], v215 offset:1024
v_lshlrev_b32 v168, 16, v165
v_mfma_f32_16x16x32_bf16 v[124:127], a[140:143], a[188:191], v[124:127]
buffer_load_dwordx4 v196, s[16:19], s58 offen offset:0 lds
v_mfma_f32_16x16x32_bf16 v[116:119], a[140:143], a[184:187], v[116:119]
ds_read_b64_tr_b16 a[240:241], v217 offset:0
v_and_b32 v169, 0xffff0000, v165
v_mfma_f32_16x16x32_bf16 v[112:115], a[136:139], a[184:187], v[112:115]
v_cvt_pk_bf16_f32 v165, v170, v171
v_lshlrev_b32 v170, 16, v165
v_mfma_f32_16x16x32_bf16 v[104:107], a[136:139], a[180:183], v[104:107]
ds_read_b64_tr_b16 a[242:243], v217 offset:1024
v_and_b32 v171, 0xffff0000, v165
v_mfma_f32_16x16x32_bf16 v[108:111], a[140:143], a[180:183], v[108:111]
buffer_load_dwordx4 v197, s[16:19], s58 offen offset:1024 lds
v_mfma_f32_16x16x32_bf16 v[100:103], a[140:143], a[176:179], v[100:103]
s_add_u32 s58, s58, 262144
ds_read_b64_tr_b16 a[244:245], v218 offset:0
s_add_u32 m0, s59, 24576
v_mfma_f32_16x16x32_bf16 v[96:99], a[136:139], a[176:179], v[96:99]
s_lshl_b32 s49, s38, 6
s_sub_u32 s49, s49, 160
v_add_u32 v184, s49, v220
v_mfma_f32_16x16x32_bf16 v[88:91], a[136:139], a[172:175], v[88:91]
ds_read_b64_tr_b16 a[246:247], v218 offset:1024
v_subrev_u32 v185, 160, v184
v_mfma_f32_16x16x32_bf16 v[92:95], a[140:143], a[172:175], v[92:95]
buffer_load_dwordx4 v196, s[16:19], s58 offen offset:0 lds
v_mfma_f32_16x16x32_bf16 v[84:87], a[140:143], a[168:171], v[84:87]
ds_read_b64_tr_b16 a[248:249], v221 offset:0
v_cmp_gt_u32 vcc, 160, v185
v_mfma_f32_16x16x32_bf16 v[80:83], a[136:139], a[168:171], v[80:83]
s_nop 1
v_cndmask_b32 v186, 0, 1.0, vcc
v_mfma_f32_16x16x32_bf16 v[72:75], a[136:139], a[164:167], v[72:75]
ds_read_b64_tr_b16 a[250:251], v221 offset:1024
v_cndmask_b32 v185, v184, v185, vcc
v_mfma_f32_16x16x32_bf16 v[76:79], a[140:143], a[164:167], v[76:79]
ds_read_b64_tr_b16 a[252:253], v222 offset:0
v_mov_b32 v187, 1280
v_mfma_f32_16x16x32_bf16 v[68:71], a[140:143], a[160:163], v[68:71]
buffer_load_dwordx4 v197, s[16:19], s58 offen offset:1024 lds
v_mfma_f32_16x16x32_bf16 v[64:67], a[136:139], a[160:163], v[64:67]
s_add_u32 s58, s58, 262144
s_add_u32 m0, s59, 32768
v_cndmask_b32 v187, v187, 0, vcc
v_mfma_f32_16x16x32_bf16 a[0:3], a[144:147], a[160:163], a[0:3]
ds_read_b64_tr_b16 a[254:255], v222 offset:1024
v_add_f32 v168, v186, v168
v_mfma_f32_16x16x32_bf16 a[4:7], a[148:151], a[160:163], a[4:7]
ds_read_b128 a[192:195], v202 offset:0
v_add_f32 v169, v186, v169
v_mfma_f32_16x16x32_bf16 a[12:15], a[148:151], a[164:167], a[12:15]
buffer_load_dwordx4 v196, s[16:19], s58 offen offset:0 lds
v_mfma_f32_16x16x32_bf16 a[8:11], a[144:147], a[164:167], a[8:11]
v_add_f32 v170, v186, v170
v_add_f32 v171, v186, v171
v_mfma_f32_16x16x32_bf16 a[16:19], a[144:147], a[168:171], a[16:19]
ds_read_b128 a[196:199], v202 offset:2048
v_cvt_pk_bf16_f32 v188, v168, v169
v_mfma_f32_16x16x32_bf16 a[20:23], a[148:151], a[168:171], a[20:23]
v_cvt_pk_bf16_f32 v189, v170, v171
v_lshlrev_b32 v168, 16, v188
v_mfma_f32_16x16x32_bf16 a[28:31], a[148:151], a[172:175], a[28:31]
buffer_load_dwordx4 v197, s[16:19], s58 offen offset:1024 lds
v_mfma_f32_16x16x32_bf16 a[24:27], a[144:147], a[172:175], a[24:27]
s_add_u32 s58, s58, 262144
ds_read_b128 a[200:203], v202 offset:4096
s_add_u32 m0, s59, 40960
v_mfma_f32_16x16x32_bf16 a[32:35], a[144:147], a[176:179], a[32:35]
ds_read_b128 a[204:207], v202 offset:6144
v_and_b32 v169, 0xffff0000, v188
v_mfma_f32_16x16x32_bf16 a[36:39], a[148:151], a[176:179], a[36:39]
v_lshlrev_b32 v170, 16, v189
v_and_b32 v171, 0xffff0000, v189
v_mfma_f32_16x16x32_bf16 a[44:47], a[148:151], a[180:183], a[44:47]
ds_read_b128 a[208:211], v202 offset:8192
v_lshrrev_b32 v190, 3, v185
v_mfma_f32_16x16x32_bf16 a[40:43], a[144:147], a[180:183], a[40:43]
buffer_load_dwordx4 v196, s[16:19], s58 offen offset:0 lds
v_mfma_f32_16x16x32_bf16 a[48:51], a[144:147], a[184:187], a[48:51]
ds_read_b128 a[212:215], v202 offset:10240
v_lshl_add_u32 v187, v190, 6, v187
v_mfma_f32_16x16x32_bf16 a[52:55], a[148:151], a[184:187], a[52:55]
v_and_b32 v190, 3, v185
v_lshl_add_u32 v187, v190, 4, v187
v_mfma_f32_16x16x32_bf16 a[60:63], a[148:151], a[188:191], a[60:63]
ds_read_b128 a[216:219], v202 offset:12288
v_and_b32 v190, 4, v185
v_mfma_f32_16x16x32_bf16 a[56:59], a[144:147], a[188:191], a[56:59]
buffer_load_dwordx4 v197, s[16:19], s58 offen offset:1024 lds
v_mfma_f32_16x16x32_bf16 a[120:123], a[152:155], a[188:191], a[120:123]
s_add_u32 s58, s58, 262144
s_add_u32 m0, s59, 49152
v_lshl_add_u32 v187, v190, 1, v187
v_mfma_f32_16x16x32_bf16 a[124:127], a[156:159], a[188:191], a[124:127]
ds_read_b128 a[220:223], v202 offset:14336
v_add_u32 v187, 15360, v187
v_mfma_f32_16x16x32_bf16 a[116:119], a[156:159], a[184:187], a[116:119]
v_mov_b32 v190, 320
v_cmp_gt_u32 vcc, v190, v184
v_mfma_f32_16x16x32_bf16 a[112:115], a[152:155], a[184:187], a[112:115]
buffer_load_dwordx4 v196, s[16:19], s58 offen offset:0 lds
v_mfma_f32_16x16x32_bf16 a[104:107], a[152:155], a[180:183], a[104:107]
s_nop 1
v_cndmask_b32 v187, -1, v187, vcc
v_mfma_f32_16x16x32_bf16 a[108:111], a[156:159], a[180:183], a[108:111]
s_add_u32 s20, s66, 65536
s_addc_u32 s21, s67, 0
v_mfma_f32_16x16x32_bf16 a[100:103], a[156:159], a[176:179], a[100:103]
s_and_b32 s21, s21, 0xffff
s_mov_b32 s22, 17920
s_mov_b32 s23, 0x20000
v_mfma_f32_16x16x32_bf16 a[96:99], a[152:155], a[176:179], a[96:99]
s_cmp_lt_u32 s38, 10
s_cselect_b32 s22, s22, 0
v_mfma_f32_16x16x32_bf16 a[88:91], a[152:155], a[172:175], a[88:91]
buffer_load_dwordx4 v197, s[16:19], s58 offen offset:1024 lds
v_mfma_f32_16x16x32_bf16 a[92:95], a[156:159], a[172:175], a[92:95]
s_add_u32 s58, s58, 262144
v_mfma_f32_16x16x32_bf16 a[84:87], a[156:159], a[168:171], a[84:87]
buffer_store_dwordx4 v[168:171], v216, s[20:23], s48 offen sc1
v_mfma_f32_16x16x32_bf16 a[80:83], a[152:155], a[168:171], a[80:83]
buffer_store_dwordx2 v[188:189], v187, s[20:23], 0 offen sc1
v_mfma_f32_16x16x32_bf16 a[72:75], a[152:155], a[164:167], a[72:75]
v_mfma_f32_16x16x32_bf16 a[76:79], a[156:159], a[164:167], a[76:79]
v_mfma_f32_16x16x32_bf16 a[68:71], a[156:159], a[160:163], a[68:71]
v_mfma_f32_16x16x32_bf16 a[64:67], a[152:155], a[160:163], a[64:67]
s_waitcnt lgkmcnt(0)
v_mfma_f32_16x16x32_bf16 v[0:3], a[192:195], a[224:227], v[0:3]
v_mfma_f32_16x16x32_bf16 v[4:7], a[196:199], a[224:227], v[4:7]
s_add_u32 m0, s59, 57344
ds_read_b64_tr_b16 a[160:161], v212 offset:8192
ds_read_b64_tr_b16 a[162:163], v212 offset:9216
v_mfma_f32_16x16x32_bf16 v[12:15], a[196:199], a[228:231], v[12:15]
buffer_load_dwordx4 v196, s[16:19], s58 offen offset:0 lds
v_mfma_f32_16x16x32_bf16 v[8:11], a[192:195], a[228:231], v[8:11]
ds_read_b64_tr_b16 a[164:165], v213 offset:8192
ds_read_b64_tr_b16 a[166:167], v213 offset:9216
v_mfma_f32_16x16x32_bf16 v[16:19], a[192:195], a[232:235], v[16:19]
buffer_load_dwordx4 v197, s[16:19], s58 offen offset:1024 lds
v_mfma_f32_16x16x32_bf16 v[20:23], a[196:199], a[232:235], v[20:23]
s_add_u32 s58, s58, 262144
ds_read_b64_tr_b16 a[168:169], v214 offset:8192
s_add_u32 m0, s59, 131072
v_mfma_f32_16x16x32_bf16 v[28:31], a[196:199], a[236:239], v[28:31]
ds_read_b64_tr_b16 a[170:171], v214 offset:9216
ds_read_b64_tr_b16 a[172:173], v215 offset:8192
v_mfma_f32_16x16x32_bf16 v[24:27], a[192:195], a[236:239], v[24:27]
v_mfma_f32_16x16x32_bf16 v[32:35], a[192:195], a[240:243], v[32:35]
buffer_load_dwordx4 v196, s[16:19], s58 offen offset:0 lds
v_mfma_f32_16x16x32_bf16 v[36:39], a[196:199], a[240:243], v[36:39]
ds_read_b64_tr_b16 a[174:175], v215 offset:9216
ds_read_b64_tr_b16 a[176:177], v217 offset:8192
v_mfma_f32_16x16x32_bf16 v[44:47], a[196:199], a[244:247], v[44:47]
ds_read_b64_tr_b16 a[178:179], v217 offset:9216
ds_read_b64_tr_b16 a[180:181], v218 offset:8192
v_mfma_f32_16x16x32_bf16 v[40:43], a[192:195], a[244:247], v[40:43]
v_mfma_f32_16x16x32_bf16 v[48:51], a[192:195], a[248:251], v[48:51]
buffer_load_dwordx4 v197, s[16:19], s58 offen offset:1024 lds
v_mfma_f32_16x16x32_bf16 v[52:55], a[196:199], a[248:251], v[52:55]
s_add_u32 s58, s58, 262144
ds_read_b64_tr_b16 a[182:183], v218 offset:9216
s_add_u32 m0, s59, 139264
v_mfma_f32_16x16x32_bf16 v[60:63], a[196:199], a[252:255], v[60:63]
ds_read_b64_tr_b16 a[184:185], v221 offset:8192
ds_read_b64_tr_b16 a[186:187], v221 offset:9216
v_mfma_f32_16x16x32_bf16 v[56:59], a[192:195], a[252:255], v[56:59]
ds_read_b64_tr_b16 a[188:189], v222 offset:8192
ds_read_b64_tr_b16 a[190:191], v222 offset:9216
v_mfma_f32_16x16x32_bf16 v[120:123], a[200:203], a[252:255], v[120:123]
v_mfma_f32_16x16x32_bf16 v[124:127], a[204:207], a[252:255], v[124:127]
buffer_load_dwordx4 v196, s[16:19], s58 offen offset:0 lds
v_mfma_f32_16x16x32_bf16 v[116:119], a[204:207], a[248:251], v[116:119]
ds_read_b128 a[128:131], v203 offset:0
ds_read_b128 a[132:135], v203 offset:2048
v_mfma_f32_16x16x32_bf16 v[112:115], a[200:203], a[248:251], v[112:115]
v_mfma_f32_16x16x32_bf16 v[104:107], a[200:203], a[244:247], v[104:107]
ds_read_b128 a[136:139], v203 offset:4096
ds_read_b128 a[140:143], v203 offset:6144
v_mfma_f32_16x16x32_bf16 v[108:111], a[204:207], a[244:247], v[108:111]
buffer_load_dwordx4 v197, s[16:19], s58 offen offset:1024 lds
v_mfma_f32_16x16x32_bf16 v[100:103], a[204:207], a[240:243], v[100:103]
s_add_u32 s58, s58, 262144
s_add_u32 m0, s59, 147456
v_mfma_f32_16x16x32_bf16 v[96:99], a[200:203], a[240:243], v[96:99]
v_mfma_f32_16x16x32_bf16 v[88:91], a[200:203], a[236:239], v[88:91]
v_mfma_f32_16x16x32_bf16 v[92:95], a[204:207], a[236:239], v[92:95]
buffer_load_dwordx4 v196, s[16:19], s58 offen offset:0 lds
v_mfma_f32_16x16x32_bf16 v[84:87], a[204:207], a[232:235], v[84:87]
s_lshr_b32 s7, s3, 1
s_lshl_b32 s7, s7, 14
s_add_u32 s7, s7, 32768
v_mfma_f32_16x16x32_bf16 v[80:83], a[200:203], a[232:235], v[80:83]
v_subrev_u32 v204, s7, v204
v_subrev_u32 v205, s7, v205
v_mfma_f32_16x16x32_bf16 v[72:75], a[200:203], a[228:231], v[72:75]
v_subrev_u32 v206, s7, v206
v_subrev_u32 v207, s7, v207
v_mfma_f32_16x16x32_bf16 v[76:79], a[204:207], a[228:231], v[76:79]
v_mfma_f32_16x16x32_bf16 v[68:71], a[204:207], a[224:227], v[68:71]
buffer_load_dwordx4 v197, s[16:19], s58 offen offset:1024 lds
v_mfma_f32_16x16x32_bf16 v[64:67], a[200:203], a[224:227], v[64:67]
s_waitcnt lgkmcnt(0)
ds_read_b128 a[144:147], v203 offset:8192
s_add_u32 s58, s58, 262144
v_mfma_f32_16x16x32_bf16 v[0:3], a[128:131], a[160:163], v[0:3]
s_add_u32 m0, s59, 155648
v_mfma_f32_16x16x32_bf16 v[4:7], a[132:135], a[160:163], v[4:7]
v_mfma_f32_16x16x32_bf16 v[12:15], a[132:135], a[164:167], v[12:15]
buffer_load_dwordx4 v196, s[16:19], s58 offen offset:0 lds
v_mfma_f32_16x16x32_bf16 v[8:11], a[128:131], a[164:167], v[8:11]
ds_read_b128 a[148:151], v203 offset:10240
v_subrev_u32 v208, s7, v208
v_mfma_f32_16x16x32_bf16 v[16:19], a[128:131], a[168:171], v[16:19]
v_mfma_f32_16x16x32_bf16 v[20:23], a[132:135], a[168:171], v[20:23]
v_mfma_f32_16x16x32_bf16 v[28:31], a[132:135], a[172:175], v[28:31]
buffer_load_dwordx4 v197, s[16:19], s58 offen offset:1024 lds
v_mfma_f32_16x16x32_bf16 v[24:27], a[128:131], a[172:175], v[24:27]
s_add_u32 s58, s58, 262144
ds_read_b128 a[152:155], v203 offset:12288
v_subrev_u32 v209, s7, v209
v_mfma_f32_16x16x32_bf16 v[32:35], a[128:131], a[176:179], v[32:35]
v_mfma_f32_16x16x32_bf16 v[36:39], a[132:135], a[176:179], v[36:39]
ds_read_b128 a[156:159], v203 offset:14336
v_subrev_u32 v210, s7, v210
v_mfma_f32_16x16x32_bf16 v[44:47], a[132:135], a[180:183], v[44:47]
v_mfma_f32_16x16x32_bf16 v[40:43], a[128:131], a[180:183], v[40:43]
v_mfma_f32_16x16x32_bf16 v[48:51], a[128:131], a[184:187], v[48:51]
v_mfma_f32_16x16x32_bf16 v[52:55], a[132:135], a[184:187], v[52:55]
v_mfma_f32_16x16x32_bf16 v[60:63], a[132:135], a[188:191], v[60:63]
v_mfma_f32_16x16x32_bf16 v[56:59], a[128:131], a[188:191], v[56:59]
v_mfma_f32_16x16x32_bf16 v[120:123], a[136:139], a[188:191], v[120:123]
v_mfma_f32_16x16x32_bf16 v[124:127], a[140:143], a[188:191], v[124:127]
v_mfma_f32_16x16x32_bf16 v[116:119], a[140:143], a[184:187], v[116:119]
v_mfma_f32_16x16x32_bf16 v[112:115], a[136:139], a[184:187], v[112:115]
v_mfma_f32_16x16x32_bf16 v[104:107], a[136:139], a[180:183], v[104:107]
v_mfma_f32_16x16x32_bf16 v[108:111], a[140:143], a[180:183], v[108:111]
v_subrev_u32 v211, s7, v211
v_mfma_f32_16x16x32_bf16 v[100:103], a[140:143], a[176:179], v[100:103]
v_mfma_f32_16x16x32_bf16 v[96:99], a[136:139], a[176:179], v[96:99]
v_mfma_f32_16x16x32_bf16 v[88:91], a[136:139], a[172:175], v[88:91]
v_mfma_f32_16x16x32_bf16 v[92:95], a[140:143], a[172:175], v[92:95]
v_mfma_f32_16x16x32_bf16 v[84:87], a[140:143], a[168:171], v[84:87]
v_mfma_f32_16x16x32_bf16 v[80:83], a[136:139], a[168:171], v[80:83]
v_mfma_f32_16x16x32_bf16 v[72:75], a[136:139], a[164:167], v[72:75]
v_mfma_f32_16x16x32_bf16 v[76:79], a[140:143], a[164:167], v[76:79]
v_mfma_f32_16x16x32_bf16 v[68:71], a[140:143], a[160:163], v[68:71]
v_mfma_f32_16x16x32_bf16 v[64:67], a[136:139], a[160:163], v[64:67]
s_waitcnt vmcnt(24) lgkmcnt(0)
v_mfma_f32_16x16x32_bf16 a[0:3], a[208:211], a[224:227], a[0:3]
s_barrier
v_mfma_f32_16x16x32_bf16 a[4:7], a[212:215], a[224:227], a[4:7]
buffer_load_dwordx4 v[224:227], v198, s[76:79], s42 offen offset:0 sc1
v_mfma_f32_16x16x32_bf16 a[12:15], a[212:215], a[228:231], a[12:15]
s_add_u32 s60, s33, 262144
v_mfma_f32_16x16x32_bf16 a[8:11], a[208:211], a[228:231], a[8:11]
buffer_load_dwordx4 v[228:231], v198, s[76:79], s43 offen offset:0 sc1
v_mfma_f32_16x16x32_bf16 a[16:19], a[208:211], a[232:235], a[16:19]
v_mfma_f32_16x16x32_bf16 a[20:23], a[212:215], a[232:235], a[20:23]
v_mfma_f32_16x16x32_bf16 a[28:31], a[212:215], a[236:239], a[28:31]
v_mfma_f32_16x16x32_bf16 a[24:27], a[208:211], a[236:239], a[24:27]
buffer_load_dwordx4 v[232:235], v198, s[76:79], s44 offen offset:0 sc1
v_mfma_f32_16x16x32_bf16 a[32:35], a[208:211], a[240:243], a[32:35]
v_cvt_pk_bf16_f32 v128, v0, v1
v_cvt_pk_bf16_f32 v129, v2, v3
v_mfma_f32_16x16x32_bf16 a[36:39], a[212:215], a[240:243], a[36:39]
v_cvt_pk_bf16_f32 v130, v4, v5
v_cvt_pk_bf16_f32 v131, v6, v7
v_mfma_f32_16x16x32_bf16 a[44:47], a[212:215], a[244:247], a[44:47]
v_cvt_pk_bf16_f32 v132, v8, v9
v_cvt_pk_bf16_f32 v133, v10, v11
v_mfma_f32_16x16x32_bf16 a[40:43], a[208:211], a[244:247], a[40:43]
buffer_load_dwordx4 v[236:239], v198, s[76:79], s45 offen offset:0 sc1
v_mfma_f32_16x16x32_bf16 a[48:51], a[208:211], a[248:251], a[48:51]
v_cvt_pk_bf16_f32 v134, v12, v13
v_cvt_pk_bf16_f32 v135, v14, v15
v_mfma_f32_16x16x32_bf16 a[52:55], a[212:215], a[248:251], a[52:55]
v_cvt_pk_bf16_f32 v136, v16, v17
v_cvt_pk_bf16_f32 v137, v18, v19
v_mfma_f32_16x16x32_bf16 a[60:63], a[212:215], a[252:255], a[60:63]
v_cvt_pk_bf16_f32 v138, v20, v21
v_cvt_pk_bf16_f32 v139, v22, v23
v_mfma_f32_16x16x32_bf16 a[56:59], a[208:211], a[252:255], a[56:59]
v_cvt_pk_bf16_f32 v140, v24, v25
v_cvt_pk_bf16_f32 v141, v26, v27
v_mfma_f32_16x16x32_bf16 a[120:123], a[216:219], a[252:255], a[120:123]
buffer_store_dwordx4 v[128:131], v216, s[28:31], s33 offen offset:0 sc1
v_mfma_f32_16x16x32_bf16 a[124:127], a[220:223], a[252:255], a[124:127]
v_cvt_pk_bf16_f32 v142, v28, v29
v_cvt_pk_bf16_f32 v143, v30, v31
v_mfma_f32_16x16x32_bf16 a[116:119], a[220:223], a[248:251], a[116:119]
v_cvt_pk_bf16_f32 v144, v32, v33
v_cvt_pk_bf16_f32 v145, v34, v35
v_mfma_f32_16x16x32_bf16 a[112:115], a[216:219], a[248:251], a[112:115]
v_cvt_pk_bf16_f32 v146, v36, v37
v_cvt_pk_bf16_f32 v147, v38, v39
v_mfma_f32_16x16x32_bf16 a[104:107], a[216:219], a[244:247], a[104:107]
v_cvt_pk_bf16_f32 v148, v40, v41
v_cvt_pk_bf16_f32 v149, v42, v43
v_mfma_f32_16x16x32_bf16 a[108:111], a[220:223], a[244:247], a[108:111]
v_cvt_pk_bf16_f32 v150, v44, v45
v_cvt_pk_bf16_f32 v151, v46, v47
v_mfma_f32_16x16x32_bf16 a[100:103], a[220:223], a[240:243], a[100:103]
buffer_load_dwordx4 v[240:243], v198, s[76:79], s42 offen offset:256 sc1
v_mfma_f32_16x16x32_bf16 a[96:99], a[216:219], a[240:243], a[96:99]
v_cvt_pk_bf16_f32 v152, v48, v49
v_cvt_pk_bf16_f32 v153, v50, v51
v_mfma_f32_16x16x32_bf16 a[88:91], a[216:219], a[236:239], a[88:91]
v_mfma_f32_16x16x32_bf16 a[92:95], a[220:223], a[236:239], a[92:95]
v_cvt_pk_bf16_f32 v154, v52, v53
v_cvt_pk_bf16_f32 v155, v54, v55
v_mfma_f32_16x16x32_bf16 a[84:87], a[220:223], a[232:235], a[84:87]
v_cvt_pk_bf16_f32 v156, v56, v57
v_cvt_pk_bf16_f32 v157, v58, v59
v_mfma_f32_16x16x32_bf16 a[80:83], a[216:219], a[232:235], a[80:83]
buffer_load_dwordx4 v[244:247], v198, s[76:79], s43 offen offset:256 sc1
v_mfma_f32_16x16x32_bf16 a[72:75], a[216:219], a[228:231], a[72:75]
v_cvt_pk_bf16_f32 v158, v60, v61
v_cvt_pk_bf16_f32 v159, v62, v63
v_mfma_f32_16x16x32_bf16 a[76:79], a[220:223], a[228:231], a[76:79]
v_mfma_f32_16x16x32_bf16 a[68:71], a[220:223], a[224:227], a[68:71]
v_cvt_pk_bf16_f32 v160, v64, v65
v_cvt_pk_bf16_f32 v161, v66, v67
v_mfma_f32_16x16x32_bf16 a[64:67], a[216:219], a[224:227], a[64:67]
buffer_store_dwordx4 v[132:135], v216, s[28:31], s33 offen offset:1024 sc1
v_mfma_f32_16x16x32_bf16 a[0:3], a[144:147], a[160:163], a[0:3]
ds_read_b64_tr_b16 a[192:193], v204 offset:0
v_cvt_pk_bf16_f32 v162, v68, v69
v_mfma_f32_16x16x32_bf16 a[4:7], a[148:151], a[160:163], a[4:7]
ds_read_b64_tr_b16 a[194:195], v204 offset:1024
v_cvt_pk_bf16_f32 v163, v70, v71
v_mfma_f32_16x16x32_bf16 a[12:15], a[148:151], a[164:167], a[12:15]
ds_read_b64_tr_b16 a[196:197], v205 offset:0
v_cvt_pk_bf16_f32 v164, v72, v73
v_mfma_f32_16x16x32_bf16 a[8:11], a[144:147], a[164:167], a[8:11]
ds_read_b64_tr_b16 a[198:199], v205 offset:1024
v_cvt_pk_bf16_f32 v165, v74, v75
v_mfma_f32_16x16x32_bf16 a[16:19], a[144:147], a[168:171], a[16:19]
ds_read_b64_tr_b16 a[200:201], v206 offset:0
v_cvt_pk_bf16_f32 v166, v76, v77
v_mfma_f32_16x16x32_bf16 a[20:23], a[148:151], a[168:171], a[20:23]
buffer_load_dwordx4 v[248:251], v198, s[76:79], s44 offen offset:256 sc1
v_mfma_f32_16x16x32_bf16 a[28:31], a[148:151], a[172:175], a[28:31]
ds_read_b64_tr_b16 a[202:203], v206 offset:1024
v_cvt_pk_bf16_f32 v167, v78, v79
v_mfma_f32_16x16x32_bf16 a[24:27], a[144:147], a[172:175], a[24:27]
v_cvt_pk_bf16_f32 v168, v80, v81
v_cvt_pk_bf16_f32 v169, v82, v83
v_mfma_f32_16x16x32_bf16 a[32:35], a[144:147], a[176:179], a[32:35]
ds_read_b64_tr_b16 a[204:205], v207 offset:0
v_cvt_pk_bf16_f32 v170, v84, v85
v_mfma_f32_16x16x32_bf16 a[36:39], a[148:151], a[176:179], a[36:39]
ds_read_b64_tr_b16 a[206:207], v207 offset:1024
v_cvt_pk_bf16_f32 v171, v86, v87
v_mfma_f32_16x16x32_bf16 a[44:47], a[148:151], a[180:183], a[44:47]
buffer_load_dwordx4 v[252:255], v198, s[76:79], s45 offen offset:256 sc1
v_mfma_f32_16x16x32_bf16 a[40:43], a[144:147], a[180:183], a[40:43]
ds_read_b64_tr_b16 a[208:209], v208 offset:0
v_cvt_pk_bf16_f32 v172, v88, v89
v_mfma_f32_16x16x32_bf16 a[48:51], a[144:147], a[184:187], a[48:51]
ds_read_b64_tr_b16 a[210:211], v208 offset:1024
v_cvt_pk_bf16_f32 v173, v90, v91
v_mfma_f32_16x16x32_bf16 a[52:55], a[148:151], a[184:187], a[52:55]
ds_read_b64_tr_b16 a[212:213], v209 offset:0
v_cvt_pk_bf16_f32 v174, v92, v93
v_mfma_f32_16x16x32_bf16 a[60:63], a[148:151], a[188:191], a[60:63]
buffer_store_dwordx4 v[136:139], v216, s[28:31], s33 offen offset:2048 sc1
v_mfma_f32_16x16x32_bf16 a[56:59], a[144:147], a[188:191], a[56:59]
v_cvt_pk_bf16_f32 v175, v94, v95
v_cvt_pk_bf16_f32 v176, v96, v97
v_mfma_f32_16x16x32_bf16 a[120:123], a[152:155], a[188:191], a[120:123]
ds_read_b64_tr_b16 a[214:215], v209 offset:1024
v_cvt_pk_bf16_f32 v177, v98, v99
v_mfma_f32_16x16x32_bf16 a[124:127], a[156:159], a[188:191], a[124:127]
ds_read_b64_tr_b16 a[216:217], v210 offset:0
v_cvt_pk_bf16_f32 v178, v100, v101
v_mfma_f32_16x16x32_bf16 a[116:119], a[156:159], a[184:187], a[116:119]
ds_read_b64_tr_b16 a[218:219], v210 offset:1024
v_cvt_pk_bf16_f32 v179, v102, v103
v_mfma_f32_16x16x32_bf16 a[112:115], a[152:155], a[184:187], a[112:115]
ds_read_b64_tr_b16 a[220:221], v211 offset:0
v_cvt_pk_bf16_f32 v180, v104, v105
v_mfma_f32_16x16x32_bf16 a[104:107], a[152:155], a[180:183], a[104:107]
ds_read_b64_tr_b16 a[222:223], v211 offset:1024
v_cvt_pk_bf16_f32 v181, v106, v107
v_mfma_f32_16x16x32_bf16 a[108:111], a[156:159], a[180:183], a[108:111]
buffer_store_dwordx4 v[140:143], v216, s[28:31], s33 offen offset:3072 sc1
v_mfma_f32_16x16x32_bf16 a[100:103], a[156:159], a[176:179], a[100:103]
s_add_u32 s33, s33, 4096
v_cvt_pk_bf16_f32 v182, v108, v109
v_cvt_pk_bf16_f32 v183, v110, v111
v_mfma_f32_16x16x32_bf16 a[96:99], a[152:155], a[176:179], a[96:99]
v_cvt_pk_bf16_f32 v184, v112, v113
v_cvt_pk_bf16_f32 v185, v114, v115
v_mfma_f32_16x16x32_bf16 a[88:91], a[152:155], a[172:175], a[88:91]
v_cvt_pk_bf16_f32 v186, v116, v117
v_cvt_pk_bf16_f32 v187, v118, v119
v_mfma_f32_16x16x32_bf16 a[92:95], a[156:159], a[172:175], a[92:95]
v_cvt_pk_bf16_f32 v188, v120, v121
v_cvt_pk_bf16_f32 v189, v122, v123
v_mfma_f32_16x16x32_bf16 a[84:87], a[156:159], a[168:171], a[84:87]
v_cvt_pk_bf16_f32 v190, v124, v125
v_cvt_pk_bf16_f32 v191, v126, v127
v_mfma_f32_16x16x32_bf16 a[80:83], a[152:155], a[168:171], a[80:83]
v_mfma_f32_16x16x32_bf16 a[72:75], a[152:155], a[164:167], a[72:75]
v_mfma_f32_16x16x32_bf16 a[76:79], a[156:159], a[164:167], a[76:79]
v_mfma_f32_16x16x32_bf16 a[68:71], a[156:159], a[160:163], a[68:71]
v_mfma_f32_16x16x32_bf16 a[64:67], a[152:155], a[160:163], a[64:67]
LphB:
Lpad9:
s_cbranch_execz Lret0
s_lshl_b32 s6, s4, 8
s_add_u32 s6, s6, 264192
v_mov_b32 v221, s6
s_waitcnt vmcnt(8) lgkmcnt(0)
v_mfma_f32_16x16x32_bf16 v[0:3], a[192:195], v[224:227], 0
s_barrier
v_mfma_f32_16x16x32_bf16 v[4:7], a[196:199], v[224:227], 0
ds_read_b64_tr_b16 a[224:225], v204 offset:8192
ds_read_b64_tr_b16 a[226:227], v204 offset:9216
v_mfma_f32_16x16x32_bf16 v[36:39], a[196:199], v[228:231], 0
buffer_load_dwordx4 a[160:163], v198, s[76:79], s42 offen offset:512 sc1
v_mfma_f32_16x16x32_bf16 v[32:35], a[192:195], v[228:231], 0
ds_read_b64_tr_b16 a[228:229], v205 offset:8192
ds_read_b64_tr_b16 a[230:231], v205 offset:9216
v_mfma_f32_16x16x32_bf16 v[64:67], a[192:195], v[232:235], 0
buffer_load_dwordx4 a[164:167], v198, s[76:79], s43 offen offset:512 sc1
v_mfma_f32_16x16x32_bf16 v[68:71], a[196:199], v[232:235], 0
ds_read_b64_tr_b16 a[232:233], v206 offset:8192
ds_read_b64_tr_b16 a[234:235], v206 offset:9216
v_mfma_f32_16x16x32_bf16 v[100:103], a[196:199], v[236:239], 0
v_mfma_f32_16x16x32_bf16 v[96:99], a[192:195], v[236:239], 0
ds_read_b64_tr_b16 a[236:237], v207 offset:8192
ds_read_b64_tr_b16 a[238:239], v207 offset:9216
v_mfma_f32_16x16x32_bf16 v[104:107], a[200:203], v[236:239], 0
buffer_load_dwordx4 a[168:171], v198, s[76:79], s44 offen offset:512 sc1
v_mfma_f32_16x16x32_bf16 v[108:111], a[204:207], v[236:239], 0
v_mfma_f32_16x16x32_bf16 v[76:79], a[204:207], v[232:235], 0
ds_read_b64_tr_b16 a[240:241], v208 offset:8192
ds_read_b64_tr_b16 a[242:243], v208 offset:9216
v_mfma_f32_16x16x32_bf16 v[72:75], a[200:203], v[232:235], 0
v_mfma_f32_16x16x32_bf16 v[40:43], a[200:203], v[228:231], 0
buffer_load_dwordx4 a[172:175], v198, s[76:79], s45 offen offset:512 sc1
v_mfma_f32_16x16x32_bf16 v[44:47], a[204:207], v[228:231], 0
ds_read_b64_tr_b16 a[244:245], v209 offset:8192
ds_read_b64_tr_b16 a[246:247], v209 offset:9216
v_mfma_f32_16x16x32_bf16 v[12:15], a[204:207], v[224:227], 0
ds_read_b64_tr_b16 a[248:249], v210 offset:8192
ds_read_b64_tr_b16 a[250:251], v210 offset:9216
v_mfma_f32_16x16x32_bf16 v[8:11], a[200:203], v[224:227], 0
v_mfma_f32_16x16x32_bf16 v[16:19], a[208:211], v[224:227], 0
ds_read_b64_tr_b16 a[252:253], v211 offset:8192
ds_read_b64_tr_b16 a[254:255], v211 offset:9216
v_mfma_f32_16x16x32_bf16 v[20:23], a[212:215], v[224:227], 0
buffer_load_dwordx4 a[176:179], v198, s[76:79], s42 offen offset:768 sc1
v_mfma_f32_16x16x32_bf16 v[52:55], a[212:215], v[228:231], 0
v_mfma_f32_16x16x32_bf16 v[48:51], a[208:211], v[228:231], 0
v_mfma_f32_16x16x32_bf16 v[80:83], a[208:211], v[232:235], 0
v_mfma_f32_16x16x32_bf16 v[84:87], a[212:215], v[232:235], 0
buffer_load_dwordx4 a[180:183], v198, s[76:79], s43 offen offset:768 sc1
v_mfma_f32_16x16x32_bf16 v[116:119], a[212:215], v[236:239], 0
v_mfma_f32_16x16x32_bf16 v[112:115], a[208:211], v[236:239], 0
v_mfma_f32_16x16x32_bf16 v[120:123], a[216:219], v[236:239], 0
v_mfma_f32_16x16x32_bf16 v[124:127], a[220:223], v[236:239], 0
buffer_load_dwordx4 a[184:187], v198, s[76:79], s44 offen offset:768 sc1
v_mfma_f32_16x16x32_bf16 v[92:95], a[220:223], v[232:235], 0
v_mfma_f32_16x16x32_bf16 v[88:91], a[216:219], v[232:235], 0
v_mfma_f32_16x16x32_bf16 v[56:59], a[216:219], v[228:231], 0
v_mfma_f32_16x16x32_bf16 v[60:63], a[220:223], v[228:231], 0
v_mfma_f32_16x16x32_bf16 v[28:31], a[220:223], v[224:227], 0
buffer_load_dwordx4 a[188:191], v198, s[76:79], s45 offen offset:768 sc1
v_mfma_f32_16x16x32_bf16 v[24:27], a[216:219], v[224:227], 0
s_waitcnt vmcnt(10) lgkmcnt(0)
v_mfma_f32_16x16x32_bf16 v[0:3], a[224:227], v[240:243], v[0:3]
v_mfma_f32_16x16x32_bf16 v[4:7], a[228:231], v[240:243], v[4:7]
ds_read_b64_tr_b16 a[192:193], v204 offset:16384
ds_read_b64_tr_b16 a[194:195], v204 offset:17408
v_mfma_f32_16x16x32_bf16 v[36:39], a[228:231], v[244:247], v[36:39]
buffer_load_dwordx4 a[128:131], v198, s[76:79], s42 offen offset:1024 sc1
v_mfma_f32_16x16x32_bf16 v[32:35], a[224:227], v[244:247], v[32:35]
ds_read_b64_tr_b16 a[196:197], v205 offset:16384
ds_read_b64_tr_b16 a[198:199], v205 offset:17408
v_mfma_f32_16x16x32_bf16 v[64:67], a[224:227], v[248:251], v[64:67]
v_mfma_f32_16x16x32_bf16 v[68:71], a[228:231], v[248:251], v[68:71]
ds_read_b64_tr_b16 a[200:201], v206 offset:16384
ds_read_b64_tr_b16 a[202:203], v206 offset:17408
v_mfma_f32_16x16x32_bf16 v[100:103], a[228:231], v[252:255], v[100:103]
buffer_store_dwordx4 v[144:147], v216, s[28:31], s33 offen offset:0 sc1
v_mfma_f32_16x16x32_bf16 v[96:99], a[224:227], v[252:255], v[96:99]
ds_read_b64_tr_b16 a[204:205], v207 offset:16384
ds_read_b64_tr_b16 a[206:207], v207 offset:17408
v_mfma_f32_16x16x32_bf16 v[104:107], a[232:235], v[252:255], v[104:107]
v_mfma_f32_16x16x32_bf16 v[108:111], a[236:239], v[252:255], v[108:111]
v_mfma_f32_16x16x32_bf16 v[76:79], a[236:239], v[248:251], v[76:79]
ds_read_b64_tr_b16 a[208:209], v208 offset:16384
ds_read_b64_tr_b16 a[210:211], v208 offset:17408
v_mfma_f32_16x16x32_bf16 v[72:75], a[232:235], v[248:251], v[72:75]
v_mfma_f32_16x16x32_bf16 v[40:43], a[232:235], v[244:247], v[40:43]
ds_read_b64_tr_b16 a[212:213], v209 offset:16384
ds_read_b64_tr_b16 a[214:215], v209 offset:17408
v_mfma_f32_16x16x32_bf16 v[44:47], a[236:239], v[244:247], v[44:47]
buffer_load_dwordx4 a[132:135], v198, s[76:79], s43 offen offset:1024 sc1
v_mfma_f32_16x16x32_bf16 v[12:15], a[236:239], v[240:243], v[12:15]
ds_read_b64_tr_b16 a[216:217], v210 offset:16384
ds_read_b64_tr_b16 a[218:219], v210 offset:17408
v_mfma_f32_16x16x32_bf16 v[8:11], a[232:235], v[240:243], v[8:11]
Lpad10:
s_cbranch_execz Lret0
v_mfma_f32_16x16x32_bf16 v[16:19], a[240:243], v[240:243], v[16:19]
ds_read_b64_tr_b16 a[220:221], v211 offset:16384
ds_read_b64_tr_b16 a[222:223], v211 offset:17408
v_mfma_f32_16x16x32_bf16 v[20:23], a[244:247], v[240:243], v[20:23]
buffer_load_dwordx4 a[136:139], v198, s[76:79], s44 offen offset:1024 sc1
v_mfma_f32_16x16x32_bf16 v[52:55], a[244:247], v[244:247], v[52:55]
v_mfma_f32_16x16x32_bf16 v[48:51], a[240:243], v[244:247], v[48:51]
v_mfma_f32_16x16x32_bf16 v[80:83], a[240:243], v[248:251], v[80:83]
v_mfma_f32_16x16x32_bf16 v[84:87], a[244:247], v[248:251], v[84:87]
v_mfma_f32_16x16x32_bf16 v[116:119], a[244:247], v[252:255], v[116:119]
buffer_load_dwordx4 a[140:143], v198, s[76:79], s45 offen offset:1024 sc1
v_mfma_f32_16x16x32_bf16 v[112:115], a[240:243], v[252:255], v[112:115]
v_mfma_f32_16x16x32_bf16 v[120:123], a[248:251], v[252:255], v[120:123]
v_mfma_f32_16x16x32_bf16 v[124:127], a[252:255], v[252:255], v[124:127]
v_mfma_f32_16x16x32_bf16 v[92:95], a[252:255], v[248:251], v[92:95]
buffer_load_dwordx4 a[144:147], v198, s[76:79], s42 offen offset:1280 sc1
v_mfma_f32_16x16x32_bf16 v[88:91], a[248:251], v[248:251], v[88:91]
v_mfma_f32_16x16x32_bf16 v[56:59], a[248:251], v[244:247], v[56:59]
v_mfma_f32_16x16x32_bf16 v[60:63], a[252:255], v[244:247], v[60:63]
v_mfma_f32_16x16x32_bf16 v[28:31], a[252:255], v[240:243], v[28:31]
buffer_load_dwordx4 a[148:151], v198, s[76:79], s43 offen offset:1280 sc1
v_mfma_f32_16x16x32_bf16 v[24:27], a[248:251], v[240:243], v[24:27]
buffer_load_dwordx4 a[152:155], v198, s[76:79], s44 offen offset:1280 sc1
buffer_load_dwordx4 a[156:159], v198, s[76:79], s45 offen offset:1280 sc1
s_waitcnt vmcnt(13) lgkmcnt(0)
v_mfma_f32_16x16x32_bf16 v[0:3], a[192:195], a[160:163], v[0:3]
s_barrier
v_mfma_f32_16x16x32_bf16 v[4:7], a[196:199], a[160:163], v[4:7]
ds_read_b64_tr_b16 a[224:225], v204 offset:24576
ds_read_b64_tr_b16 a[226:227], v204 offset:25600
v_mfma_f32_16x16x32_bf16 v[36:39], a[196:199], a[164:167], v[36:39]
buffer_load_dwordx4 v[224:227], v198, s[76:79], s42 offen offset:1536 sc1
v_mfma_f32_16x16x32_bf16 v[32:35], a[192:195], a[164:167], v[32:35]
ds_read_b64_tr_b16 a[228:229], v205 offset:24576
ds_read_b64_tr_b16 a[230:231], v205 offset:25600
v_mfma_f32_16x16x32_bf16 v[64:67], a[192:195], a[168:171], v[64:67]
v_mfma_f32_16x16x32_bf16 v[68:71], a[196:199], a[168:171], v[68:71]
ds_read_b64_tr_b16 a[232:233], v206 offset:24576
ds_read_b64_tr_b16 a[234:235], v206 offset:25600
v_mfma_f32_16x16x32_bf16 v[100:103], a[196:199], a[172:175], v[100:103]
v_mfma_f32_16x16x32_bf16 v[96:99], a[192:195], a[172:175], v[96:99]
buffer_store_dwordx4 v[148:151], v216, s[28:31], s33 offen offset:1024 sc1
v_mfma_f32_16x16x32_bf16 v[104:107], a[200:203], a[172:175], v[104:107]
v_accvgpr_read_b32 v192, a0
v_accvgpr_read_b32 v193, a1
v_mfma_f32_16x16x32_bf16 v[108:111], a[204:207], a[172:175], v[108:111]
v_accvgpr_read_b32 v194, a2
v_accvgpr_read_b32 v195, a3
v_mfma_f32_16x16x32_bf16 v[76:79], a[204:207], a[168:171], v[76:79]
ds_read_b64_tr_b16 a[236:237], v207 offset:24576
v_cvt_pk_bf16_f32 v200, v192, v193
v_mfma_f32_16x16x32_bf16 v[72:75], a[200:203], a[168:171], v[72:75]
ds_read_b64_tr_b16 a[238:239], v207 offset:25600
v_cvt_pk_bf16_f32 v201, v194, v195
v_mfma_f32_16x16x32_bf16 v[40:43], a[200:203], a[164:167], v[40:43]
ds_read_b64_tr_b16 a[240:241], v208 offset:24576
v_accvgpr_read_b32 v192, a4
v_mfma_f32_16x16x32_bf16 v[44:47], a[204:207], a[164:167], v[44:47]
buffer_load_dwordx4 v[228:231], v198, s[76:79], s43 offen offset:1536 sc1
v_mfma_f32_16x16x32_bf16 v[12:15], a[204:207], a[160:163], v[12:15]
ds_read_b64_tr_b16 a[242:243], v208 offset:25600
v_accvgpr_read_b32 v193, a5
v_mfma_f32_16x16x32_bf16 v[8:11], a[200:203], a[160:163], v[8:11]
ds_read_b64_tr_b16 a[244:245], v209 offset:24576
v_accvgpr_read_b32 v194, a6
v_mfma_f32_16x16x32_bf16 v[16:19], a[208:211], a[160:163], v[16:19]
ds_read_b64_tr_b16 a[246:247], v209 offset:25600
v_accvgpr_read_b32 v195, a7
v_mfma_f32_16x16x32_bf16 v[20:23], a[212:215], a[160:163], v[20:23]
ds_read_b64_tr_b16 a[248:249], v210 offset:24576
v_cvt_pk_bf16_f32 v202, v192, v193
v_mfma_f32_16x16x32_bf16 v[52:55], a[212:215], a[164:167], v[52:55]
ds_read_b64_tr_b16 a[250:251], v210 offset:25600
v_cvt_pk_bf16_f32 v203, v194, v195
v_mfma_f32_16x16x32_bf16 v[48:51], a[208:211], a[164:167], v[48:51]
buffer_load_dwordx4 v[232:235], v198, s[76:79], s44 offen offset:1536 sc1
v_mfma_f32_16x16x32_bf16 v[80:83], a[208:211], a[168:171], v[80:83]
ds_read_b64_tr_b16 a[252:253], v211 offset:24576
ds_read_b64_tr_b16 a[254:255], v211 offset:25600
v_mfma_f32_16x16x32_bf16 v[84:87], a[212:215], a[168:171], v[84:87]
v_mfma_f32_16x16x32_bf16 v[116:119], a[212:215], a[172:175], v[116:119]
buffer_store_dwordx4 v[200:203], v216, s[28:31], s60 offen offset:0 sc1
v_mfma_f32_16x16x32_bf16 v[112:115], a[208:211], a[172:175], v[112:115]
v_accvgpr_write_b32 a0, 0
v_accvgpr_write_b32 a1, 0
v_mfma_f32_16x16x32_bf16 v[120:123], a[216:219], a[172:175], v[120:123]
v_accvgpr_write_b32 a2, 0
v_accvgpr_write_b32 a3, 0
v_mfma_f32_16x16x32_bf16 v[124:127], a[220:223], a[172:175], v[124:127]
v_accvgpr_write_b32 a4, 0
v_accvgpr_write_b32 a5, 0
v_mfma_f32_16x16x32_bf16 v[92:95], a[220:223], a[168:171], v[92:95]
v_accvgpr_write_b32 a6, 0
v_accvgpr_write_b32 a7, 0
v_mfma_f32_16x16x32_bf16 v[88:91], a[216:219], a[168:171], v[88:91]
v_mfma_f32_16x16x32_bf16 v[56:59], a[216:219], a[164:167], v[56:59]
buffer_load_dwordx4 v[236:239], v198, s[76:79], s45 offen offset:1536 sc1
v_mfma_f32_16x16x32_bf16 v[60:63], a[220:223], a[164:167], v[60:63]
v_mfma_f32_16x16x32_bf16 v[28:31], a[220:223], a[160:163], v[28:31]
v_mfma_f32_16x16x32_bf16 v[24:27], a[216:219], a[160:163], v[24:27]
s_waitcnt vmcnt(15) lgkmcnt(0)
v_mfma_f32_16x16x32_bf16 v[0:3], a[224:227], a[176:179], v[0:3]
v_mfma_f32_16x16x32_bf16 v[4:7], a[228:231], a[176:179], v[4:7]
ds_read_b64_tr_b16 a[192:193], v204 offset:32768
ds_read_b64_tr_b16 a[194:195], v204 offset:33792
v_mfma_f32_16x16x32_bf16 v[36:39], a[228:231], a[180:183], v[36:39]
buffer_load_dwordx4 a[160:163], v198, s[76:79], s42 offen offset:1792 sc1
v_mfma_f32_16x16x32_bf16 v[32:35], a[224:227], a[180:183], v[32:35]
ds_read_b64_tr_b16 a[196:197], v205 offset:32768
ds_read_b64_tr_b16 a[198:199], v205 offset:33792
v_mfma_f32_16x16x32_bf16 v[64:67], a[224:227], a[184:187], v[64:67]
v_mfma_f32_16x16x32_bf16 v[68:71], a[228:231], a[184:187], v[68:71]
buffer_store_dwordx4 v[152:155], v216, s[28:31], s33 offen offset:2048 sc1
v_mfma_f32_16x16x32_bf16 v[100:103], a[228:231], a[188:191], v[100:103]
ds_read_b64_tr_b16 a[200:201], v206 offset:32768
ds_read_b64_tr_b16 a[202:203], v206 offset:33792
v_mfma_f32_16x16x32_bf16 v[96:99], a[224:227], a[188:191], v[96:99]
ds_read_b64_tr_b16 a[204:205], v207 offset:32768
ds_read_b64_tr_b16 a[206:207], v207 offset:33792
v_mfma_f32_16x16x32_bf16 v[104:107], a[232:235], a[188:191], v[104:107]
v_mfma_f32_16x16x32_bf16 v[108:111], a[236:239], a[188:191], v[108:111]
v_mfma_f32_16x16x32_bf16 v[76:79], a[236:239], a[184:187], v[76:79]
ds_read_b64_tr_b16 a[208:209], v208 offset:32768
ds_read_b64_tr_b16 a[210:211], v208 offset:33792
v_mfma_f32_16x16x32_bf16 v[72:75], a[232:235], a[184:187], v[72:75]
v_mfma_f32_16x16x32_bf16 v[40:43], a[232:235], a[180:183], v[40:43]
buffer_load_dwordx4 a[164:167], v198, s[76:79], s43 offen offset:1792 sc1
v_mfma_f32_16x16x32_bf16 v[44:47], a[236:239], a[180:183], v[44:47]
ds_read_b64_tr_b16 a[212:213], v209 offset:32768
ds_read_b64_tr_b16 a[214:215], v209 offset:33792
v_mfma_f32_16x16x32_bf16 v[12:15], a[236:239], a[176:179], v[12:15]
ds_read_b64_tr_b16 a[216:217], v210 offset:32768
ds_read_b64_tr_b16 a[218:219], v210 offset:33792
v_mfma_f32_16x16x32_bf16 v[8:11], a[232:235], a[176:179], v[8:11]
v_mfma_f32_16x16x32_bf16 v[16:19], a[240:243], a[176:179], v[16:19]
buffer_load_dwordx4 a[168:171], v198, s[76:79], s44 offen offset:1792 sc1
v_mfma_f32_16x16x32_bf16 v[20:23], a[244:247], a[176:179], v[20:23]
ds_read_b64_tr_b16 a[220:221], v211 offset:32768
ds_read_b64_tr_b16 a[222:223], v211 offset:33792
v_mfma_f32_16x16x32_bf16 v[52:55], a[244:247], a[180:183], v[52:55]
v_mfma_f32_16x16x32_bf16 v[48:51], a[240:243], a[180:183], v[48:51]
v_mfma_f32_16x16x32_bf16 v[80:83], a[240:243], a[184:187], v[80:83]
v_mfma_f32_16x16x32_bf16 v[84:87], a[244:247], a[184:187], v[84:87]
v_mfma_f32_16x16x32_bf16 v[116:119], a[244:247], a[188:191], v[116:119]
buffer_load_dwordx4 a[172:175], v198, s[76:79], s45 offen offset:1792 sc1
v_mfma_f32_16x16x32_bf16 v[112:115], a[240:243], a[188:191], v[112:115]
v_mfma_f32_16x16x32_bf16 v[120:123], a[248:251], a[188:191], v[120:123]
v_mfma_f32_16x16x32_bf16 v[124:127], a[252:255], a[188:191], v[124:127]
v_mfma_f32_16x16x32_bf16 v[92:95], a[252:255], a[184:187], v[92:95]
v_mfma_f32_16x16x32_bf16 v[88:91], a[248:251], a[184:187], v[88:91]
v_mfma_f32_16x16x32_bf16 v[56:59], a[248:251], a[180:183], v[56:59]
v_mfma_f32_16x16x32_bf16 v[60:63], a[252:255], a[180:183], v[60:63]
v_mfma_f32_16x16x32_bf16 v[28:31], a[252:255], a[176:179], v[28:31]
v_mfma_f32_16x16x32_bf16 v[24:27], a[248:251], a[176:179], v[24:27]
s_waitcnt vmcnt(15) lgkmcnt(0)
v_mfma_f32_16x16x32_bf16 v[0:3], a[192:195], a[128:131], v[0:3]
s_barrier
v_mfma_f32_16x16x32_bf16 v[4:7], a[196:199], a[128:131], v[4:7]
s_add_u32 m0, s59, 65536
ds_read_b64_tr_b16 a[224:225], v204 offset:40960
ds_read_b64_tr_b16 a[226:227], v204 offset:41984
v_mfma_f32_16x16x32_bf16 v[36:39], a[196:199], a[132:135], v[36:39]
buffer_store_dwordx4 v[156:159], v216, s[28:31], s33 offen offset:3072 sc1
v_mfma_f32_16x16x32_bf16 v[32:35], a[192:195], a[132:135], v[32:35]
s_add_u32 s33, s33, 4096
ds_read_b64_tr_b16 a[228:229], v205 offset:40960
v_accvgpr_read_b32 v192, a8
v_mfma_f32_16x16x32_bf16 v[64:67], a[192:195], a[136:139], v[64:67]
ds_read_b64_tr_b16 a[230:231], v205 offset:41984
v_accvgpr_read_b32 v193, a9
v_mfma_f32_16x16x32_bf16 v[68:71], a[196:199], a[136:139], v[68:71]
ds_read_b64_tr_b16 a[232:233], v206 offset:40960
v_accvgpr_read_b32 v194, a10
v_mfma_f32_16x16x32_bf16 v[100:103], a[196:199], a[140:143], v[100:103]
buffer_load_dwordx4 v196, s[16:19], s58 offen offset:0 lds
v_mfma_f32_16x16x32_bf16 v[96:99], a[192:195], a[140:143], v[96:99]
ds_read_b64_tr_b16 a[234:235], v206 offset:41984
v_accvgpr_read_b32 v195, a11
v_mfma_f32_16x16x32_bf16 v[104:107], a[200:203], a[140:143], v[104:107]
ds_read_b64_tr_b16 a[236:237], v207 offset:40960
v_cvt_pk_bf16_f32 v212, v192, v193
v_mfma_f32_16x16x32_bf16 v[108:111], a[204:207], a[140:143], v[108:111]
ds_read_b64_tr_b16 a[238:239], v207 offset:41984
v_cvt_pk_bf16_f32 v213, v194, v195
v_mfma_f32_16x16x32_bf16 v[76:79], a[204:207], a[136:139], v[76:79]
buffer_load_dwordx4 v197, s[16:19], s58 offen offset:1024 lds
v_mfma_f32_16x16x32_bf16 v[72:75], a[200:203], a[136:139], v[72:75]
s_add_u32 s58, s58, 262144
ds_read_b64_tr_b16 a[240:241], v208 offset:40960
v_accvgpr_read_b32 v192, a12
v_mfma_f32_16x16x32_bf16 v[40:43], a[200:203], a[132:135], v[40:43]
ds_read_b64_tr_b16 a[242:243], v208 offset:41984
v_accvgpr_read_b32 v193, a13
v_mfma_f32_16x16x32_bf16 v[44:47], a[204:207], a[132:135], v[44:47]
ds_read_b64_tr_b16 a[244:245], v209 offset:40960
v_accvgpr_read_b32 v194, a14
v_mfma_f32_16x16x32_bf16 v[12:15], a[204:207], a[128:131], v[12:15]
ds_read_b64_tr_b16 a[246:247], v209 offset:41984
v_accvgpr_read_b32 v195, a15
v_mfma_f32_16x16x32_bf16 v[8:11], a[200:203], a[128:131], v[8:11]
buffer_load_dwordx4 a[176:179], v198, s[76:79], s42 offen offset:2048 sc1
v_mfma_f32_16x16x32_bf16 v[16:19], a[208:211], a[128:131], v[16:19]
ds_read_b64_tr_b16 a[248:249], v210 offset:40960
v_cvt_pk_bf16_f32 v214, v192, v193
v_mfma_f32_16x16x32_bf16 v[20:23], a[212:215], a[128:131], v[20:23]
ds_read_b64_tr_b16 a[250:251], v210 offset:41984
v_cvt_pk_bf16_f32 v215, v194, v195
v_mfma_f32_16x16x32_bf16 v[52:55], a[212:215], a[132:135], v[52:55]
ds_read_b64_tr_b16 a[252:253], v211 offset:40960
ds_read_b64_tr_b16 a[254:255], v211 offset:41984
v_mfma_f32_16x16x32_bf16 v[48:51], a[208:211], a[132:135], v[48:51]
buffer_load_dwordx4 a[180:183], v198, s[76:79], s43 offen offset:2048 sc1
v_mfma_f32_16x16x32_bf16 v[80:83], a[208:211], a[136:139], v[80:83]
v_mfma_f32_16x16x32_bf16 v[84:87], a[212:215], a[136:139], v[84:87]
v_mfma_f32_16x16x32_bf16 v[116:119], a[212:215], a[140:143], v[116:119]
v_mfma_f32_16x16x32_bf16 v[112:115], a[208:211], a[140:143], v[112:115]
buffer_store_dwordx4 v[212:215], v216, s[28:31], s60 offen offset:1024 sc1
v_mfma_f32_16x16x32_bf16 v[120:123], a[216:219], a[140:143], v[120:123]
v_accvgpr_write_b32 a8, 0
v_accvgpr_write_b32 a9, 0
v_mfma_f32_16x16x32_bf16 v[124:127], a[220:223], a[140:143], v[124:127]
v_accvgpr_write_b32 a10, 0
v_accvgpr_write_b32 a11, 0
v_mfma_f32_16x16x32_bf16 v[92:95], a[220:223], a[136:139], v[92:95]
v_accvgpr_write_b32 a12, 0
v_accvgpr_write_b32 a13, 0
v_mfma_f32_16x16x32_bf16 v[88:91], a[216:219], a[136:139], v[88:91]
v_accvgpr_write_b32 a14, 0
v_accvgpr_write_b32 a15, 0
v_mfma_f32_16x16x32_bf16 v[56:59], a[216:219], a[132:135], v[56:59]
v_mfma_f32_16x16x32_bf16 v[60:63], a[220:223], a[132:135], v[60:63]
v_mfma_f32_16x16x32_bf16 v[28:31], a[220:223], a[128:131], v[28:31]
buffer_load_dwordx4 a[184:187], v198, s[76:79], s44 offen offset:2048 sc1
v_mfma_f32_16x16x32_bf16 v[24:27], a[216:219], a[128:131], v[24:27]
buffer_load_dwordx4 a[188:191], v198, s[76:79], s45 offen offset:2048 sc1
global_load_dword v222, v221, s[66:67] offset:4 sc1
s_waitcnt vmcnt(20) lgkmcnt(0)
v_mfma_f32_16x16x32_bf16 v[0:3], a[224:227], a[144:147], v[0:3]
v_mfma_f32_16x16x32_bf16 v[4:7], a[228:231], a[144:147], v[4:7]
s_add_u32 m0, s59, 73728
ds_read_b64_tr_b16 a[192:193], v204 offset:49152
ds_read_b64_tr_b16 a[194:195], v204 offset:50176
v_mfma_f32_16x16x32_bf16 v[36:39], a[228:231], a[148:151], v[36:39]
buffer_store_dwordx4 v[160:163], v216, s[28:31], s33 offen offset:0 sc1
v_mfma_f32_16x16x32_bf16 v[32:35], a[224:227], a[148:151], v[32:35]
ds_read_b64_tr_b16 a[196:197], v205 offset:49152
ds_read_b64_tr_b16 a[198:199], v205 offset:50176
v_mfma_f32_16x16x32_bf16 v[64:67], a[224:227], a[152:155], v[64:67]
v_mfma_f32_16x16x32_bf16 v[68:71], a[228:231], a[152:155], v[68:71]
ds_read_b64_tr_b16 a[200:201], v206 offset:49152
ds_read_b64_tr_b16 a[202:203], v206 offset:50176
v_mfma_f32_16x16x32_bf16 v[100:103], a[228:231], a[156:159], v[100:103]
v_mfma_f32_16x16x32_bf16 v[96:99], a[224:227], a[156:159], v[96:99]
ds_read_b64_tr_b16 a[204:205], v207 offset:49152
ds_read_b64_tr_b16 a[206:207], v207 offset:50176
v_mfma_f32_16x16x32_bf16 v[104:107], a[232:235], a[156:159], v[104:107]
v_mfma_f32_16x16x32_bf16 v[108:111], a[236:239], a[156:159], v[108:111]
buffer_load_dwordx4 v196, s[16:19], s58 offen offset:0 lds
v_mfma_f32_16x16x32_bf16 v[76:79], a[236:239], a[152:155], v[76:79]
ds_read_b64_tr_b16 a[208:209], v208 offset:49152
ds_read_b64_tr_b16 a[210:211], v208 offset:50176
v_mfma_f32_16x16x32_bf16 v[72:75], a[232:235], a[152:155], v[72:75]
v_mfma_f32_16x16x32_bf16 v[40:43], a[232:235], a[148:151], v[40:43]
ds_read_b64_tr_b16 a[212:213], v209 offset:49152
ds_read_b64_tr_b16 a[214:215], v209 offset:50176
v_mfma_f32_16x16x32_bf16 v[44:47], a[236:239], a[148:151], v[44:47]
buffer_load_dwordx4 v197, s[16:19], s58 offen offset:1024 lds
v_mfma_f32_16x16x32_bf16 v[12:15], a[236:239], a[144:147], v[12:15]
s_add_u32 s58, s58, 262144
ds_read_b64_tr_b16 a[216:217], v210 offset:49152
ds_read_b64_tr_b16 a[218:219], v210 offset:50176
v_mfma_f32_16x16x32_bf16 v[8:11], a[232:235], a[144:147], v[8:11]
v_mfma_f32_16x16x32_bf16 v[16:19], a[240:243], a[144:147], v[16:19]
ds_read_b64_tr_b16 a[220:221], v211 offset:49152
ds_read_b64_tr_b16 a[222:223], v211 offset:50176
v_mfma_f32_16x16x32_bf16 v[20:23], a[244:247], a[144:147], v[20:23]
buffer_load_dwordx4 v[240:243], v198, s[76:79], s42 offen offset:2304 sc1
v_mfma_f32_16x16x32_bf16 v[52:55], a[244:247], a[148:151], v[52:55]
v_mfma_f32_16x16x32_bf16 v[48:51], a[240:243], a[148:151], v[48:51]
v_mfma_f32_16x16x32_bf16 v[80:83], a[240:243], a[152:155], v[80:83]
v_mfma_f32_16x16x32_bf16 v[84:87], a[244:247], a[152:155], v[84:87]
v_mfma_f32_16x16x32_bf16 v[116:119], a[244:247], a[156:159], v[116:119]
buffer_load_dwordx4 v[244:247], v198, s[76:79], s43 offen offset:2304 sc1
v_mfma_f32_16x16x32_bf16 v[112:115], a[240:243], a[156:159], v[112:115]
v_mfma_f32_16x16x32_bf16 v[120:123], a[248:251], a[156:159], v[120:123]
v_mfma_f32_16x16x32_bf16 v[124:127], a[252:255], a[156:159], v[124:127]
v_mfma_f32_16x16x32_bf16 v[92:95], a[252:255], a[152:155], v[92:95]
buffer_load_dwordx4 v[248:251], v198, s[76:79], s44 offen offset:2304 sc1
v_mfma_f32_16x16x32_bf16 v[88:91], a[248:251], a[152:155], v[88:91]
v_mfma_f32_16x16x32_bf16 v[56:59], a[248:251], a[148:151], v[56:59]
v_mfma_f32_16x16x32_bf16 v[60:63], a[252:255], a[148:151], v[60:63]
v_mfma_f32_16x16x32_bf16 v[28:31], a[252:255], a[144:147], v[28:31]
buffer_load_dwordx4 v[252:255], v198, s[76:79], s45 offen offset:2304 sc1
v_mfma_f32_16x16x32_bf16 v[24:27], a[248:251], a[144:147], v[24:27]
s_waitcnt vmcnt(21) lgkmcnt(0)
v_mfma_f32_16x16x32_bf16 v[0:3], a[192:195], v[224:227], v[0:3]
s_barrier
v_mfma_f32_16x16x32_bf16 v[4:7], a[196:199], v[224:227], v[4:7]
s_add_u32 m0, s59, 81920
ds_read_b64_tr_b16 a[224:225], v204 offset:57344
ds_read_b64_tr_b16 a[226:227], v204 offset:58368
v_mfma_f32_16x16x32_bf16 v[36:39], a[196:199], v[228:231], v[36:39]
buffer_store_dwordx4 v[164:167], v216, s[28:31], s33 offen offset:1024 sc1
v_mfma_f32_16x16x32_bf16 v[32:35], a[192:195], v[228:231], v[32:35]
ds_read_b64_tr_b16 a[228:229], v205 offset:57344
v_accvgpr_read_b32 v192, a16
v_mfma_f32_16x16x32_bf16 v[64:67], a[192:195], v[232:235], v[64:67]
ds_read_b64_tr_b16 a[230:231], v205 offset:58368
v_accvgpr_read_b32 v193, a17
v_mfma_f32_16x16x32_bf16 v[68:71], a[196:199], v[232:235], v[68:71]
ds_read_b64_tr_b16 a[232:233], v206 offset:57344
v_accvgpr_read_b32 v194, a18
v_mfma_f32_16x16x32_bf16 v[100:103], a[196:199], v[236:239], v[100:103]
ds_read_b64_tr_b16 a[234:235], v206 offset:58368
v_accvgpr_read_b32 v195, a19
v_mfma_f32_16x16x32_bf16 v[96:99], a[192:195], v[236:239], v[96:99]
ds_read_b64_tr_b16 a[236:237], v207 offset:57344
v_cvt_pk_bf16_f32 v200, v192, v193
v_mfma_f32_16x16x32_bf16 v[104:107], a[200:203], v[236:239], v[104:107]
ds_read_b64_tr_b16 a[238:239], v207 offset:58368
v_cvt_pk_bf16_f32 v201, v194, v195
v_mfma_f32_16x16x32_bf16 v[108:111], a[204:207], v[236:239], v[108:111]
buffer_load_dwordx4 v196, s[16:19], s58 offen offset:0 lds
v_mfma_f32_16x16x32_bf16 v[76:79], a[204:207], v[232:235], v[76:79]
ds_read_b64_tr_b16 a[240:241], v208 offset:57344
v_accvgpr_read_b32 v192, a20
v_mfma_f32_16x16x32_bf16 v[72:75], a[200:203], v[232:235], v[72:75]
ds_read_b64_tr_b16 a[242:243], v208 offset:58368
v_accvgpr_read_b32 v193, a21
v_mfma_f32_16x16x32_bf16 v[40:43], a[200:203], v[228:231], v[40:43]
ds_read_b64_tr_b16 a[244:245], v209 offset:57344
v_accvgpr_read_b32 v194, a22
v_mfma_f32_16x16x32_bf16 v[44:47], a[204:207], v[228:231], v[44:47]
buffer_load_dwordx4 v197, s[16:19], s58 offen offset:1024 lds
v_mfma_f32_16x16x32_bf16 v[12:15], a[204:207], v[224:227], v[12:15]
s_add_u32 s58, s58, 262144
ds_read_b64_tr_b16 a[246:247], v209 offset:58368
v_accvgpr_read_b32 v195, a23
v_mfma_f32_16x16x32_bf16 v[8:11], a[200:203], v[224:227], v[8:11]
ds_read_b64_tr_b16 a[248:249], v210 offset:57344
v_cvt_pk_bf16_f32 v202, v192, v193
v_mfma_f32_16x16x32_bf16 v[16:19], a[208:211], v[224:227], v[16:19]
ds_read_b64_tr_b16 a[250:251], v210 offset:58368
v_cvt_pk_bf16_f32 v203, v194, v195
v_mfma_f32_16x16x32_bf16 v[20:23], a[212:215], v[224:227], v[20:23]
ds_read_b64_tr_b16 a[252:253], v211 offset:57344
ds_read_b64_tr_b16 a[254:255], v211 offset:58368
v_mfma_f32_16x16x32_bf16 v[52:55], a[212:215], v[228:231], v[52:55]
buffer_load_dwordx4 a[128:131], v198, s[76:79], s42 offen offset:2560 sc1
v_mfma_f32_16x16x32_bf16 v[48:51], a[208:211], v[228:231], v[48:51]
v_mfma_f32_16x16x32_bf16 v[80:83], a[208:211], v[232:235], v[80:83]
v_mfma_f32_16x16x32_bf16 v[84:87], a[212:215], v[232:235], v[84:87]
v_mfma_f32_16x16x32_bf16 v[116:119], a[212:215], v[236:239], v[116:119]
buffer_load_dwordx4 a[132:135], v198, s[76:79], s43 offen offset:2560 sc1
v_mfma_f32_16x16x32_bf16 v[112:115], a[208:211], v[236:239], v[112:115]
v_mfma_f32_16x16x32_bf16 v[120:123], a[216:219], v[236:239], v[120:123]
v_mfma_f32_16x16x32_bf16 v[124:127], a[220:223], v[236:239], v[124:127]
v_mfma_f32_16x16x32_bf16 v[92:95], a[220:223], v[232:235], v[92:95]
buffer_store_dwordx4 v[200:203], v216, s[28:31], s60 offen offset:2048 sc1
v_mfma_f32_16x16x32_bf16 v[88:91], a[216:219], v[232:235], v[88:91]
v_accvgpr_write_b32 a16, 0
v_accvgpr_write_b32 a17, 0
v_mfma_f32_16x16x32_bf16 v[56:59], a[216:219], v[228:231], v[56:59]
v_accvgpr_write_b32 a18, 0
v_accvgpr_write_b32 a19, 0
v_mfma_f32_16x16x32_bf16 v[60:63], a[220:223], v[228:231], v[60:63]
v_accvgpr_write_b32 a20, 0
v_accvgpr_write_b32 a21, 0
v_mfma_f32_16x16x32_bf16 v[28:31], a[220:223], v[224:227], v[28:31]
v_accvgpr_write_b32 a22, 0
v_accvgpr_write_b32 a23, 0
v_mfma_f32_16x16x32_bf16 v[24:27], a[216:219], v[224:227], v[24:27]
buffer_load_dwordx4 a[136:139], v198, s[76:79], s44 offen offset:2560 sc1
buffer_load_dwordx4 a[140:143], v198, s[76:79], s45 offen offset:2560 sc1
s_waitcnt vmcnt(24) lgkmcnt(0)
v_mfma_f32_16x16x32_bf16 v[0:3], a[224:227], a[160:163], v[0:3]
v_mfma_f32_16x16x32_bf16 v[4:7], a[228:231], a[160:163], v[4:7]
s_add_u32 m0, s59, 90112
v_add_u32 v204, 131072, v204
ds_read_b64_tr_b16 a[192:193], v204 offset:0
v_mfma_f32_16x16x32_bf16 v[36:39], a[228:231], a[164:167], v[36:39]
buffer_store_dwordx4 v[168:171], v216, s[28:31], s33 offen offset:2048 sc1
v_mfma_f32_16x16x32_bf16 v[32:35], a[224:227], a[164:167], v[32:35]
ds_read_b64_tr_b16 a[194:195], v204 offset:1024
v_add_u32 v205, 131072, v205
v_mfma_f32_16x16x32_bf16 v[64:67], a[224:227], a[168:171], v[64:67]
ds_read_b64_tr_b16 a[196:197], v205 offset:0
ds_read_b64_tr_b16 a[198:199], v205 offset:1024
v_mfma_f32_16x16x32_bf16 v[68:71], a[228:231], a[168:171], v[68:71]
v_add_u32 v206, 131072, v206
ds_read_b64_tr_b16 a[200:201], v206 offset:0
v_mfma_f32_16x16x32_bf16 v[100:103], a[228:231], a[172:175], v[100:103]
v_mfma_f32_16x16x32_bf16 v[96:99], a[224:227], a[172:175], v[96:99]
buffer_load_dwordx4 v196, s[16:19], s58 offen offset:0 lds
v_mfma_f32_16x16x32_bf16 v[104:107], a[232:235], a[172:175], v[104:107]
ds_read_b64_tr_b16 a[202:203], v206 offset:1024
v_add_u32 v207, 131072, v207
v_mfma_f32_16x16x32_bf16 v[108:111], a[236:239], a[172:175], v[108:111]
ds_read_b64_tr_b16 a[204:205], v207 offset:0
ds_read_b64_tr_b16 a[206:207], v207 offset:1024
v_mfma_f32_16x16x32_bf16 v[76:79], a[236:239], a[168:171], v[76:79]
v_add_u32 v208, 131072, v208
ds_read_b64_tr_b16 a[208:209], v208 offset:0
v_mfma_f32_16x16x32_bf16 v[72:75], a[232:235], a[168:171], v[72:75]
ds_read_b64_tr_b16 a[210:211], v208 offset:1024
v_add_u32 v209, 131072, v209
v_mfma_f32_16x16x32_bf16 v[40:43], a[232:235], a[164:167], v[40:43]
buffer_load_dwordx4 v197, s[16:19], s58 offen offset:1024 lds
v_mfma_f32_16x16x32_bf16 v[44:47], a[236:239], a[164:167], v[44:47]
s_add_u32 s58, s58, 262144
ds_read_b64_tr_b16 a[212:213], v209 offset:0
ds_read_b64_tr_b16 a[214:215], v209 offset:1024
v_mfma_f32_16x16x32_bf16 v[12:15], a[236:239], a[160:163], v[12:15]
v_add_u32 v210, 131072, v210
ds_read_b64_tr_b16 a[216:217], v210 offset:0
v_mfma_f32_16x16x32_bf16 v[8:11], a[232:235], a[160:163], v[8:11]
v_mfma_f32_16x16x32_bf16 v[16:19], a[240:243], a[160:163], v[16:19]
buffer_load_dwordx4 a[144:147], v198, s[76:79], s42 offen offset:2816 sc1
v_mfma_f32_16x16x32_bf16 v[20:23], a[244:247], a[160:163], v[20:23]
ds_read_b64_tr_b16 a[218:219], v210 offset:1024
v_add_u32 v211, 131072, v211
v_mfma_f32_16x16x32_bf16 v[52:55], a[244:247], a[164:167], v[52:55]
ds_read_b64_tr_b16 a[220:221], v211 offset:0
ds_read_b64_tr_b16 a[222:223], v211 offset:1024
v_mfma_f32_16x16x32_bf16 v[48:51], a[240:243], a[164:167], v[48:51]
v_mfma_f32_16x16x32_bf16 v[80:83], a[240:243], a[168:171], v[80:83]
buffer_load_dwordx4 a[148:151], v198, s[76:79], s43 offen offset:2816 sc1
v_mfma_f32_16x16x32_bf16 v[84:87], a[244:247], a[168:171], v[84:87]
v_mfma_f32_16x16x32_bf16 v[116:119], a[244:247], a[172:175], v[116:119]
v_mfma_f32_16x16x32_bf16 v[112:115], a[240:243], a[172:175], v[112:115]
v_mfma_f32_16x16x32_bf16 v[120:123], a[248:251], a[172:175], v[120:123]
buffer_load_dwordx4 a[152:155], v198, s[76:79], s44 offen offset:2816 sc1
v_mfma_f32_16x16x32_bf16 v[124:127], a[252:255], a[172:175], v[124:127]
v_mfma_f32_16x16x32_bf16 v[92:95], a[252:255], a[168:171], v[92:95]
v_mfma_f32_16x16x32_bf16 v[88:91], a[248:251], a[168:171], v[88:91]
v_mfma_f32_16x16x32_bf16 v[56:59], a[248:251], a[164:167], v[56:59]
v_mfma_f32_16x16x32_bf16 v[60:63], a[252:255], a[164:167], v[60:63]
buffer_load_dwordx4 a[156:159], v198, s[76:79], s45 offen offset:2816 sc1
v_mfma_f32_16x16x32_bf16 v[28:31], a[252:255], a[160:163], v[28:31]
v_mfma_f32_16x16x32_bf16 v[24:27], a[248:251], a[160:163], v[24:27]
s_waitcnt vmcnt(23) lgkmcnt(0)
v_mfma_f32_16x16x32_bf16 v[0:3], a[192:195], a[176:179], v[0:3]
s_barrier
v_mfma_f32_16x16x32_bf16 v[4:7], a[196:199], a[176:179], v[4:7]
s_add_u32 m0, s59, 98304
ds_read_b64_tr_b16 a[224:225], v204 offset:8192
ds_read_b64_tr_b16 a[226:227], v204 offset:9216
v_mfma_f32_16x16x32_bf16 v[36:39], a[196:199], a[180:183], v[36:39]
buffer_store_dwordx4 v[172:175], v216, s[28:31], s33 offen offset:3072 sc1
v_mfma_f32_16x16x32_bf16 v[32:35], a[192:195], a[180:183], v[32:35]
s_add_u32 s33, s33, 4096
ds_read_b64_tr_b16 a[228:229], v205 offset:8192
v_accvgpr_read_b32 v192, a24
v_mfma_f32_16x16x32_bf16 v[64:67], a[192:195], a[184:187], v[64:67]
ds_read_b64_tr_b16 a[230:231], v205 offset:9216
v_accvgpr_read_b32 v193, a25
v_mfma_f32_16x16x32_bf16 v[68:71], a[196:199], a[184:187], v[68:71]
ds_read_b64_tr_b16 a[232:233], v206 offset:8192
v_accvgpr_read_b32 v194, a26
v_mfma_f32_16x16x32_bf16 v[100:103], a[196:199], a[188:191], v[100:103]
ds_read_b64_tr_b16 a[234:235], v206 offset:9216
v_accvgpr_read_b32 v195, a27
v_mfma_f32_16x16x32_bf16 v[96:99], a[192:195], a[188:191], v[96:99]
ds_read_b64_tr_b16 a[236:237], v207 offset:8192
v_cvt_pk_bf16_f32 v212, v192, v193
v_mfma_f32_16x16x32_bf16 v[104:107], a[200:203], a[188:191], v[104:107]
buffer_load_dwordx4 v196, s[16:19], s58 offen offset:0 lds
v_mfma_f32_16x16x32_bf16 v[108:111], a[204:207], a[188:191], v[108:111]
ds_read_b64_tr_b16 a[238:239], v207 offset:9216
v_cvt_pk_bf16_f32 v213, v194, v195
v_mfma_f32_16x16x32_bf16 v[76:79], a[204:207], a[184:187], v[76:79]
ds_read_b64_tr_b16 a[240:241], v208 offset:8192
v_accvgpr_read_b32 v192, a28
v_mfma_f32_16x16x32_bf16 v[72:75], a[200:203], a[184:187], v[72:75]
ds_read_b64_tr_b16 a[242:243], v208 offset:9216
v_accvgpr_read_b32 v193, a29
v_mfma_f32_16x16x32_bf16 v[40:43], a[200:203], a[180:183], v[40:43]
buffer_load_dwordx4 v197, s[16:19], s58 offen offset:1024 lds
v_mfma_f32_16x16x32_bf16 v[44:47], a[204:207], a[180:183], v[44:47]
s_add_u32 s58, s58, 262144
ds_read_b64_tr_b16 a[244:245], v209 offset:8192
v_accvgpr_read_b32 v194, a30
v_mfma_f32_16x16x32_bf16 v[12:15], a[204:207], a[176:179], v[12:15]
ds_read_b64_tr_b16 a[246:247], v209 offset:9216
v_accvgpr_read_b32 v195, a31
v_mfma_f32_16x16x32_bf16 v[8:11], a[200:203], a[176:179], v[8:11]
ds_read_b64_tr_b16 a[248:249], v210 offset:8192
v_cvt_pk_bf16_f32 v214, v192, v193
v_mfma_f32_16x16x32_bf16 v[16:19], a[208:211], a[176:179], v[16:19]
buffer_load_dwordx4 a[160:163], v198, s[76:79], s42 offen offset:3072 sc1
v_mfma_f32_16x16x32_bf16 v[20:23], a[212:215], a[176:179], v[20:23]
ds_read_b64_tr_b16 a[250:251], v210 offset:9216
v_cvt_pk_bf16_f32 v215, v194, v195
v_mfma_f32_16x16x32_bf16 v[52:55], a[212:215], a[180:183], v[52:55]
ds_read_b64_tr_b16 a[252:253], v211 offset:8192
ds_read_b64_tr_b16 a[254:255], v211 offset:9216
v_mfma_f32_16x16x32_bf16 v[48:51], a[208:211], a[180:183], v[48:51]
v_mfma_f32_16x16x32_bf16 v[80:83], a[208:211], a[184:187], v[80:83]
v_mfma_f32_16x16x32_bf16 v[84:87], a[212:215], a[184:187], v[84:87]
buffer_load_dwordx4 a[164:167], v198, s[76:79], s43 offen offset:3072 sc1
v_mfma_f32_16x16x32_bf16 v[116:119], a[212:215], a[188:191], v[116:119]
v_mfma_f32_16x16x32_bf16 v[112:115], a[208:211], a[188:191], v[112:115]
v_mfma_f32_16x16x32_bf16 v[120:123], a[216:219], a[188:191], v[120:123]
v_mfma_f32_16x16x32_bf16 v[124:127], a[220:223], a[188:191], v[124:127]
buffer_store_dwordx4 v[212:215], v216, s[28:31], s60 offen offset:3072 sc1
v_mfma_f32_16x16x32_bf16 v[92:95], a[220:223], a[184:187], v[92:95]
s_add_u32 s60, s60, 4096
v_accvgpr_write_b32 a24, 0
v_accvgpr_write_b32 a25, 0
v_mfma_f32_16x16x32_bf16 v[88:91], a[216:219], a[184:187], v[88:91]
v_accvgpr_write_b32 a26, 0
v_accvgpr_write_b32 a27, 0
v_mfma_f32_16x16x32_bf16 v[56:59], a[216:219], a[180:183], v[56:59]
v_accvgpr_write_b32 a28, 0
v_accvgpr_write_b32 a29, 0
v_mfma_f32_16x16x32_bf16 v[60:63], a[220:223], a[180:183], v[60:63]
v_accvgpr_write_b32 a30, 0
v_accvgpr_write_b32 a31, 0
v_mfma_f32_16x16x32_bf16 v[28:31], a[220:223], a[176:179], v[28:31]
Lpad11:
s_cbranch_execz Lret0
v_mfma_f32_16x16x32_bf16 v[24:27], a[216:219], a[176:179], v[24:27]
buffer_load_dwordx4 a[168:171], v198, s[76:79], s44 offen offset:3072 sc1
buffer_load_dwordx4 a[172:175], v198, s[76:79], s45 offen offset:3072 sc1
s_waitcnt vmcnt(23) lgkmcnt(0)
v_mfma_f32_16x16x32_bf16 v[0:3], a[224:227], v[240:243], v[0:3]
v_mfma_f32_16x16x32_bf16 v[4:7], a[228:231], v[240:243], v[4:7]
s_add_u32 m0, s59, 106496
ds_read_b64_tr_b16 a[192:193], v204 offset:16384
ds_read_b64_tr_b16 a[194:195], v204 offset:17408
v_mfma_f32_16x16x32_bf16 v[36:39], a[228:231], v[244:247], v[36:39]
v_mfma_f32_16x16x32_bf16 v[32:35], a[224:227], v[244:247], v[32:35]
ds_read_b64_tr_b16 a[196:197], v205 offset:16384
ds_read_b64_tr_b16 a[198:199], v205 offset:17408
v_mfma_f32_16x16x32_bf16 v[64:67], a[224:227], v[248:251], v[64:67]
buffer_store_dwordx4 v[176:179], v216, s[28:31], s33 offen offset:0 sc1
v_mfma_f32_16x16x32_bf16 v[68:71], a[228:231], v[248:251], v[68:71]
ds_read_b64_tr_b16 a[200:201], v206 offset:16384
ds_read_b64_tr_b16 a[202:203], v206 offset:17408
v_mfma_f32_16x16x32_bf16 v[100:103], a[228:231], v[252:255], v[100:103]
v_mfma_f32_16x16x32_bf16 v[96:99], a[224:227], v[252:255], v[96:99]
ds_read_b64_tr_b16 a[204:205], v207 offset:16384
ds_read_b64_tr_b16 a[206:207], v207 offset:17408
v_mfma_f32_16x16x32_bf16 v[104:107], a[232:235], v[252:255], v[104:107]
v_mfma_f32_16x16x32_bf16 v[108:111], a[236:239], v[252:255], v[108:111]
v_mfma_f32_16x16x32_bf16 v[76:79], a[236:239], v[248:251], v[76:79]
buffer_load_dwordx4 v196, s[16:19], s58 offen offset:0 lds
v_mfma_f32_16x16x32_bf16 v[72:75], a[232:235], v[248:251], v[72:75]
ds_read_b64_tr_b16 a[208:209], v208 offset:16384
ds_read_b64_tr_b16 a[210:211], v208 offset:17408
v_mfma_f32_16x16x32_bf16 v[40:43], a[232:235], v[244:247], v[40:43]
ds_read_b64_tr_b16 a[212:213], v209 offset:16384
ds_read_b64_tr_b16 a[214:215], v209 offset:17408
v_mfma_f32_16x16x32_bf16 v[44:47], a[236:239], v[244:247], v[44:47]
v_mfma_f32_16x16x32_bf16 v[12:15], a[236:239], v[240:243], v[12:15]
buffer_load_dwordx4 v197, s[16:19], s58 offen offset:1024 lds
v_mfma_f32_16x16x32_bf16 v[8:11], a[232:235], v[240:243], v[8:11]
s_add_u32 s58, s58, 262144
ds_read_b64_tr_b16 a[216:217], v210 offset:16384
ds_read_b64_tr_b16 a[218:219], v210 offset:17408
v_mfma_f32_16x16x32_bf16 v[16:19], a[240:243], v[240:243], v[16:19]
ds_read_b64_tr_b16 a[220:221], v211 offset:16384
ds_read_b64_tr_b16 a[222:223], v211 offset:17408
v_mfma_f32_16x16x32_bf16 v[20:23], a[244:247], v[240:243], v[20:23]
v_mfma_f32_16x16x32_bf16 v[52:55], a[244:247], v[244:247], v[52:55]
v_mfma_f32_16x16x32_bf16 v[48:51], a[240:243], v[244:247], v[48:51]
buffer_load_dwordx4 a[176:179], v198, s[76:79], s42 offen offset:3328 sc1
v_mfma_f32_16x16x32_bf16 v[80:83], a[240:243], v[248:251], v[80:83]
v_mfma_f32_16x16x32_bf16 v[84:87], a[244:247], v[248:251], v[84:87]
v_mfma_f32_16x16x32_bf16 v[116:119], a[244:247], v[252:255], v[116:119]
v_mfma_f32_16x16x32_bf16 v[112:115], a[240:243], v[252:255], v[112:115]
buffer_load_dwordx4 a[180:183], v198, s[76:79], s43 offen offset:3328 sc1
v_mfma_f32_16x16x32_bf16 v[120:123], a[248:251], v[252:255], v[120:123]
v_mfma_f32_16x16x32_bf16 v[124:127], a[252:255], v[252:255], v[124:127]
v_mfma_f32_16x16x32_bf16 v[92:95], a[252:255], v[248:251], v[92:95]
v_mfma_f32_16x16x32_bf16 v[88:91], a[248:251], v[248:251], v[88:91]
buffer_load_dwordx4 a[184:187], v198, s[76:79], s44 offen offset:3328 sc1
v_mfma_f32_16x16x32_bf16 v[56:59], a[248:251], v[244:247], v[56:59]
v_mfma_f32_16x16x32_bf16 v[60:63], a[252:255], v[244:247], v[60:63]
v_mfma_f32_16x16x32_bf16 v[28:31], a[252:255], v[240:243], v[28:31]
v_mfma_f32_16x16x32_bf16 v[24:27], a[248:251], v[240:243], v[24:27]
buffer_load_dwordx4 a[188:191], v198, s[76:79], s45 offen offset:3328 sc1
s_waitcnt vmcnt(22) lgkmcnt(0)
v_mfma_f32_16x16x32_bf16 v[0:3], a[192:195], a[128:131], v[0:3]
s_barrier
v_mfma_f32_16x16x32_bf16 v[4:7], a[196:199], a[128:131], v[4:7]
s_add_u32 m0, s59, 114688
ds_read_b64_tr_b16 a[224:225], v204 offset:24576
ds_read_b64_tr_b16 a[226:227], v204 offset:25600
v_mfma_f32_16x16x32_bf16 v[36:39], a[196:199], a[132:135], v[36:39]
buffer_store_dwordx4 v[180:183], v216, s[28:31], s33 offen offset:1024 sc1
v_mfma_f32_16x16x32_bf16 v[32:35], a[192:195], a[132:135], v[32:35]
s_getreg_b32 s6, hwreg(HW_REG_XCC_ID, 0, 4)
ds_read_b64_tr_b16 a[228:229], v205 offset:24576
v_readfirstlane_b32 s7, v222
v_mfma_f32_16x16x32_bf16 v[64:67], a[192:195], a[136:139], v[64:67]
s_lshl_b32 s6, s6, 2
ds_read_b64_tr_b16 a[230:231], v205 offset:25600
ds_read_b64_tr_b16 a[232:233], v206 offset:24576
v_mfma_f32_16x16x32_bf16 v[68:71], a[196:199], a[136:139], v[68:71]
s_lshl_b32 s6, 8, s6
v_mfma_f32_16x16x32_bf16 v[100:103], a[196:199], a[140:143], v[100:103]
buffer_load_dwordx4 v196, s[16:19], s58 offen offset:0 lds
v_mfma_f32_16x16x32_bf16 v[96:99], a[192:195], a[140:143], v[96:99]
ds_read_b64_tr_b16 a[234:235], v206 offset:25600
ds_read_b64_tr_b16 a[236:237], v207 offset:24576
v_mfma_f32_16x16x32_bf16 v[104:107], a[200:203], a[140:143], v[104:107]
ds_read_b64_tr_b16 a[238:239], v207 offset:25600
ds_read_b64_tr_b16 a[240:241], v208 offset:24576
v_mfma_f32_16x16x32_bf16 v[108:111], a[204:207], a[140:143], v[108:111]
v_mfma_f32_16x16x32_bf16 v[76:79], a[204:207], a[136:139], v[76:79]
v_mfma_f32_16x16x32_bf16 v[72:75], a[200:203], a[136:139], v[72:75]
buffer_load_dwordx4 v197, s[16:19], s58 offen offset:1024 lds
v_mfma_f32_16x16x32_bf16 v[40:43], a[200:203], a[132:135], v[40:43]
s_add_u32 s58, s58, 262144
ds_read_b64_tr_b16 a[242:243], v208 offset:25600
ds_read_b64_tr_b16 a[244:245], v209 offset:24576
v_mfma_f32_16x16x32_bf16 v[44:47], a[204:207], a[132:135], v[44:47]
ds_read_b64_tr_b16 a[246:247], v209 offset:25600
ds_read_b64_tr_b16 a[248:249], v210 offset:24576
v_mfma_f32_16x16x32_bf16 v[12:15], a[204:207], a[128:131], v[12:15]
s_cmp_eq_u32 s6, s7
s_cselect_b32 s39, 1, 0
v_mfma_f32_16x16x32_bf16 v[8:11], a[200:203], a[128:131], v[8:11]
buffer_load_dwordx4 v[240:243], v198, s[76:79], s42 offen offset:3584 sc1
v_mfma_f32_16x16x32_bf16 v[16:19], a[208:211], a[128:131], v[16:19]
ds_read_b64_tr_b16 a[250:251], v210 offset:25600
v_and_b32 v222, 7, v220
v_mfma_f32_16x16x32_bf16 v[20:23], a[212:215], a[128:131], v[20:23]
ds_read_b64_tr_b16 a[252:253], v211 offset:24576
v_lshl_add_u32 v222, v222, 2, v221
v_mfma_f32_16x16x32_bf16 v[52:55], a[212:215], a[132:135], v[52:55]
ds_read_b64_tr_b16 a[254:255], v211 offset:25600
v_add_u32 v222, 128, v222
v_mfma_f32_16x16x32_bf16 v[48:51], a[208:211], a[132:135], v[48:51]
buffer_store_dwordx4 v[184:187], v216, s[28:31], s33 offen offset:2048 sc1
v_mfma_f32_16x16x32_bf16 v[80:83], a[208:211], a[136:139], v[80:83]
v_mfma_f32_16x16x32_bf16 v[84:87], a[212:215], a[136:139], v[84:87]
v_mfma_f32_16x16x32_bf16 v[116:119], a[212:215], a[140:143], v[116:119]
v_mfma_f32_16x16x32_bf16 v[112:115], a[208:211], a[140:143], v[112:115]
v_mfma_f32_16x16x32_bf16 v[120:123], a[216:219], a[140:143], v[120:123]
v_mfma_f32_16x16x32_bf16 v[124:127], a[220:223], a[140:143], v[124:127]
v_mfma_f32_16x16x32_bf16 v[92:95], a[220:223], a[136:139], v[92:95]
buffer_load_dwordx4 v[244:247], v198, s[76:79], s43 offen offset:3584 sc1
v_mfma_f32_16x16x32_bf16 v[88:91], a[216:219], a[136:139], v[88:91]
v_mfma_f32_16x16x32_bf16 v[56:59], a[216:219], a[132:135], v[56:59]
v_mfma_f32_16x16x32_bf16 v[60:63], a[220:223], a[132:135], v[60:63]
v_mfma_f32_16x16x32_bf16 v[28:31], a[220:223], a[128:131], v[28:31]
buffer_load_dwordx4 v[248:251], v198, s[76:79], s44 offen offset:3584 sc1
v_mfma_f32_16x16x32_bf16 v[24:27], a[216:219], a[128:131], v[24:27]
buffer_load_dwordx4 v[252:255], v198, s[76:79], s45 offen offset:3584 sc1
s_waitcnt vmcnt(23) lgkmcnt(0)
v_mfma_f32_16x16x32_bf16 v[0:3], a[224:227], a[144:147], v[0:3]
v_mfma_f32_16x16x32_bf16 v[4:7], a[228:231], a[144:147], v[4:7]
s_add_u32 m0, s59, 122880
v_subrev_u32 v204, 65536, v204
ds_read_b64_tr_b16 a[192:193], v204 offset:0
v_mfma_f32_16x16x32_bf16 v[36:39], a[228:231], a[148:151], v[36:39]
buffer_store_dwordx4 v[188:191], v216, s[28:31], s33 offen offset:3072 sc1
v_mfma_f32_16x16x32_bf16 v[32:35], a[224:227], a[148:151], v[32:35]
s_add_u32 s33, s33, 4096
ds_read_b64_tr_b16 a[194:195], v204 offset:1024
v_subrev_u32 v205, 65536, v205
v_mfma_f32_16x16x32_bf16 v[64:67], a[224:227], a[152:155], v[64:67]
ds_read_b64_tr_b16 a[196:197], v205 offset:0
v_accvgpr_read_b32 v192, a32
v_mfma_f32_16x16x32_bf16 v[68:71], a[228:231], a[152:155], v[68:71]
ds_read_b64_tr_b16 a[198:199], v205 offset:1024
v_subrev_u32 v206, 65536, v206
v_mfma_f32_16x16x32_bf16 v[100:103], a[228:231], a[156:159], v[100:103]
ds_read_b64_tr_b16 a[200:201], v206 offset:0
v_accvgpr_read_b32 v193, a33
v_mfma_f32_16x16x32_bf16 v[96:99], a[224:227], a[156:159], v[96:99]
ds_read_b64_tr_b16 a[202:203], v206 offset:1024
v_accvgpr_read_b32 v194, a34
v_mfma_f32_16x16x32_bf16 v[104:107], a[232:235], a[156:159], v[104:107]
v_subrev_u32 v207, 65536, v207
v_accvgpr_read_b32 v195, a35
v_mfma_f32_16x16x32_bf16 v[108:111], a[236:239], a[156:159], v[108:111]
buffer_load_dwordx4 v196, s[16:19], s58 offen offset:0 lds
v_mfma_f32_16x16x32_bf16 v[76:79], a[236:239], a[152:155], v[76:79]
ds_read_b64_tr_b16 a[204:205], v207 offset:0
v_cvt_pk_bf16_f32 v200, v192, v193
v_mfma_f32_16x16x32_bf16 v[72:75], a[232:235], a[152:155], v[72:75]
ds_read_b64_tr_b16 a[206:207], v207 offset:1024
v_cvt_pk_bf16_f32 v201, v194, v195
v_mfma_f32_16x16x32_bf16 v[40:43], a[232:235], a[148:151], v[40:43]
v_subrev_u32 v208, 65536, v208
ds_read_b64_tr_b16 a[208:209], v208 offset:0
v_mfma_f32_16x16x32_bf16 v[44:47], a[236:239], a[148:151], v[44:47]
buffer_load_dwordx4 v197, s[16:19], s58 offen offset:1024 lds
v_mfma_f32_16x16x32_bf16 v[12:15], a[236:239], a[144:147], v[12:15]
s_add_u32 s58, s58, 262144
ds_read_b64_tr_b16 a[210:211], v208 offset:1024
v_accvgpr_read_b32 v192, a36
v_mfma_f32_16x16x32_bf16 v[8:11], a[232:235], a[144:147], v[8:11]
v_subrev_u32 v209, 65536, v209
v_accvgpr_read_b32 v193, a37
v_mfma_f32_16x16x32_bf16 v[16:19], a[240:243], a[144:147], v[16:19]
ds_read_b64_tr_b16 a[212:213], v209 offset:0
v_accvgpr_read_b32 v194, a38
v_mfma_f32_16x16x32_bf16 v[20:23], a[244:247], a[144:147], v[20:23]
buffer_load_dwordx4 v[224:227], v198, s[76:79], s42 offen offset:3840 sc1
v_mfma_f32_16x16x32_bf16 v[52:55], a[244:247], a[148:151], v[52:55]
s_add_u32 s42, s42, 4096
ds_read_b64_tr_b16 a[214:215], v209 offset:1024
v_subrev_u32 v210, 65536, v210
v_mfma_f32_16x16x32_bf16 v[48:51], a[240:243], a[148:151], v[48:51]
ds_read_b64_tr_b16 a[216:217], v210 offset:0
v_accvgpr_read_b32 v195, a39
v_mfma_f32_16x16x32_bf16 v[80:83], a[240:243], a[152:155], v[80:83]
ds_read_b64_tr_b16 a[218:219], v210 offset:1024
v_cvt_pk_bf16_f32 v202, v192, v193
v_mfma_f32_16x16x32_bf16 v[84:87], a[244:247], a[152:155], v[84:87]
v_subrev_u32 v211, 65536, v211
v_cvt_pk_bf16_f32 v203, v194, v195
v_mfma_f32_16x16x32_bf16 v[116:119], a[244:247], a[156:159], v[116:119]
buffer_load_dwordx4 v[228:231], v198, s[76:79], s43 offen offset:3840 sc1
v_mfma_f32_16x16x32_bf16 v[112:115], a[240:243], a[156:159], v[112:115]
s_add_u32 s43, s43, 4096
ds_read_b64_tr_b16 a[220:221], v211 offset:0
ds_read_b64_tr_b16 a[222:223], v211 offset:1024
v_mfma_f32_16x16x32_bf16 v[120:123], a[248:251], a[156:159], v[120:123]
v_mfma_f32_16x16x32_bf16 v[124:127], a[252:255], a[156:159], v[124:127]
v_mfma_f32_16x16x32_bf16 v[92:95], a[252:255], a[152:155], v[92:95]
buffer_store_dwordx4 v[200:203], v216, s[28:31], s60 offen offset:0 sc1
v_mfma_f32_16x16x32_bf16 v[88:91], a[248:251], a[152:155], v[88:91]
v_accvgpr_write_b32 a32, 0
v_accvgpr_write_b32 a33, 0
v_mfma_f32_16x16x32_bf16 v[56:59], a[248:251], a[148:151], v[56:59]
v_accvgpr_write_b32 a34, 0
v_accvgpr_write_b32 a35, 0
v_mfma_f32_16x16x32_bf16 v[60:63], a[252:255], a[148:151], v[60:63]
v_accvgpr_write_b32 a36, 0
v_accvgpr_write_b32 a37, 0
v_mfma_f32_16x16x32_bf16 v[28:31], a[252:255], a[144:147], v[28:31]
v_accvgpr_write_b32 a38, 0
v_accvgpr_write_b32 a39, 0
v_mfma_f32_16x16x32_bf16 v[24:27], a[248:251], a[144:147], v[24:27]
buffer_load_dwordx4 v[232:235], v198, s[76:79], s44 offen offset:3840 sc1
s_add_u32 s44, s44, 4096
buffer_load_dwordx4 v[236:239], v198, s[76:79], s45 offen offset:3840 sc1
s_add_u32 s45, s45, 4096
s_waitcnt vmcnt(23) lgkmcnt(0)
v_mfma_f32_16x16x32_bf16 v[0:3], a[192:195], a[160:163], v[0:3]
s_barrier
v_mfma_f32_16x16x32_bf16 v[4:7], a[196:199], a[160:163], v[4:7]
s_mul_i32 s6, s4, 525312
ds_read_b64_tr_b16 a[224:225], v204 offset:8192
v_accvgpr_read_b32 v192, a40
v_mfma_f32_16x16x32_bf16 v[36:39], a[196:199], a[164:167], v[36:39]
buffer_load_dwordx4 a[128:131], v198, s[76:79], s42 offen offset:0 sc1
v_mfma_f32_16x16x32_bf16 v[32:35], a[192:195], a[164:167], v[32:35]
s_add_u32 s7, s6, 33554432
ds_read_b64_tr_b16 a[226:227], v204 offset:9216
v_accvgpr_read_b32 v193, a41
v_mfma_f32_16x16x32_bf16 v[64:67], a[192:195], a[168:171], v[64:67]
ds_read_b64_tr_b16 a[228:229], v205 offset:8192
v_accvgpr_read_b32 v194, a42
v_mfma_f32_16x16x32_bf16 v[68:71], a[196:199], a[168:171], v[68:71]
s_add_u32 s8, s66, s7
s_addc_u32 s9, s67, 0
v_mfma_f32_16x16x32_bf16 v[100:103], a[196:199], a[172:175], v[100:103]
s_and_b32 s9, s9, 0xffff
ds_read_b64_tr_b16 a[230:231], v205 offset:9216
v_accvgpr_read_b32 v195, a43
v_mfma_f32_16x16x32_bf16 v[96:99], a[192:195], a[172:175], v[96:99]
s_sub_u32 s7, 16, s5
ds_read_b64_tr_b16 a[232:233], v206 offset:8192
v_cvt_pk_bf16_f32 v212, v192, v193
v_mfma_f32_16x16x32_bf16 v[104:107], a[200:203], a[172:175], v[104:107]
s_lshl_b32 s10, s7, 15
ds_read_b64_tr_b16 a[234:235], v206 offset:9216
v_cvt_pk_bf16_f32 v213, v194, v195
v_mfma_f32_16x16x32_bf16 v[108:111], a[204:207], a[172:175], v[108:111]
s_mov_b32 s11, 0x20000
ds_read_b64_tr_b16 a[236:237], v207 offset:8192
v_accvgpr_read_b32 v192, a44
v_mfma_f32_16x16x32_bf16 v[76:79], a[204:207], a[168:171], v[76:79]
s_add_u32 s7, s6, 52396032
ds_read_b64_tr_b16 a[238:239], v207 offset:9216
v_accvgpr_read_b32 v193, a45
v_mfma_f32_16x16x32_bf16 v[72:75], a[200:203], a[168:171], v[72:75]
buffer_load_dwordx4 a[132:135], v198, s[76:79], s43 offen offset:0 sc1
v_mfma_f32_16x16x32_bf16 v[40:43], a[200:203], a[164:167], v[40:43]
ds_read_b64_tr_b16 a[240:241], v208 offset:8192
v_accvgpr_read_b32 v194, a46
v_mfma_f32_16x16x32_bf16 v[44:47], a[204:207], a[164:167], v[44:47]
ds_read_b64_tr_b16 a[242:243], v208 offset:9216
v_accvgpr_read_b32 v195, a47
v_mfma_f32_16x16x32_bf16 v[12:15], a[204:207], a[160:163], v[12:15]
ds_read_b64_tr_b16 a[244:245], v209 offset:8192
v_cvt_pk_bf16_f32 v214, v192, v193
v_mfma_f32_16x16x32_bf16 v[8:11], a[200:203], a[160:163], v[8:11]
ds_read_b64_tr_b16 a[246:247], v209 offset:9216
v_cvt_pk_bf16_f32 v215, v194, v195
v_mfma_f32_16x16x32_bf16 v[16:19], a[208:211], a[160:163], v[16:19]
s_add_u32 s12, s66, s7
s_addc_u32 s13, s67, 0
v_mfma_f32_16x16x32_bf16 v[20:23], a[212:215], a[160:163], v[20:23]
s_and_b32 s13, s13, 0xffff
ds_read_b64_tr_b16 a[248:249], v210 offset:8192
ds_read_b64_tr_b16 a[250:251], v210 offset:9216
v_mfma_f32_16x16x32_bf16 v[52:55], a[212:215], a[164:167], v[52:55]
buffer_load_dwordx4 a[136:139], v198, s[76:79], s44 offen offset:0 sc1
v_mfma_f32_16x16x32_bf16 v[48:51], a[208:211], a[164:167], v[48:51]
s_add_u32 s14, s10, 32768
ds_read_b64_tr_b16 a[252:253], v211 offset:8192
ds_read_b64_tr_b16 a[254:255], v211 offset:9216
v_mfma_f32_16x16x32_bf16 v[80:83], a[208:211], a[168:171], v[80:83]
buffer_store_dwordx4 v[212:215], v216, s[28:31], s60 offen offset:1024 sc1
v_mfma_f32_16x16x32_bf16 v[84:87], a[212:215], a[168:171], v[84:87]
s_mov_b32 s15, 0x20000
v_accvgpr_write_b32 a40, 0
v_accvgpr_write_b32 a41, 0
v_mfma_f32_16x16x32_bf16 v[116:119], a[212:215], a[172:175], v[116:119]
s_lshl_b32 s68, s3, 12
v_accvgpr_write_b32 a42, 0
v_accvgpr_write_b32 a43, 0
v_mfma_f32_16x16x32_bf16 v[112:115], a[208:211], a[172:175], v[112:115]
s_mov_b32 s69, 0xffff
v_accvgpr_write_b32 a44, 0
v_accvgpr_write_b32 a45, 0
v_mfma_f32_16x16x32_bf16 v[120:123], a[216:219], a[172:175], v[120:123]
s_cmp_eq_u32 s5, 0
s_cselect_b32 s70, 1.0, 0
v_mfma_f32_16x16x32_bf16 v[124:127], a[220:223], a[172:175], v[124:127]
v_mfma_f32_16x16x32_bf16 v[92:95], a[220:223], a[168:171], v[92:95]
buffer_load_dwordx4 a[140:143], v198, s[76:79], s45 offen offset:0 sc1
v_mfma_f32_16x16x32_bf16 v[88:91], a[216:219], a[168:171], v[88:91]
v_accvgpr_write_b32 a46, 0
v_mov_b32 v217, v216
v_mfma_f32_16x16x32_bf16 v[56:59], a[216:219], a[164:167], v[56:59]
v_accvgpr_write_b32 a47, 0
v_add_u32 v218, 114688, v216
v_mfma_f32_16x16x32_bf16 v[60:63], a[220:223], a[164:167], v[60:63]
v_mfma_f32_16x16x32_bf16 v[28:31], a[220:223], a[160:163], v[28:31]
v_mfma_f32_16x16x32_bf16 v[24:27], a[216:219], a[160:163], v[24:27]
s_waitcnt vmcnt(21) lgkmcnt(0)
v_mfma_f32_16x16x32_bf16 v[0:3], a[224:227], a[176:179], v[0:3]
v_mfma_f32_16x16x32_bf16 v[4:7], a[228:231], a[176:179], v[4:7]
ds_read_b64_tr_b16 a[192:193], v204 offset:16384
v_accvgpr_read_b32 v192, a48
v_mfma_f32_16x16x32_bf16 v[36:39], a[228:231], a[180:183], v[36:39]
buffer_load_dwordx4 a[144:147], v198, s[76:79], s42 offen offset:256 sc1
v_mfma_f32_16x16x32_bf16 v[32:35], a[224:227], a[180:183], v[32:35]
ds_read_b64_tr_b16 a[194:195], v204 offset:17408
v_accvgpr_read_b32 v193, a49
v_mfma_f32_16x16x32_bf16 v[64:67], a[224:227], a[184:187], v[64:67]
ds_read_b64_tr_b16 a[196:197], v205 offset:16384
v_accvgpr_read_b32 v194, a50
v_mfma_f32_16x16x32_bf16 v[68:71], a[228:231], a[184:187], v[68:71]
buffer_load_dwordx4 a[148:151], v198, s[76:79], s43 offen offset:256 sc1
v_mfma_f32_16x16x32_bf16 v[100:103], a[228:231], a[188:191], v[100:103]
ds_read_b64_tr_b16 a[198:199], v205 offset:17408
v_accvgpr_read_b32 v195, a51
v_mfma_f32_16x16x32_bf16 v[96:99], a[224:227], a[188:191], v[96:99]
ds_read_b64_tr_b16 a[200:201], v206 offset:16384
v_cvt_pk_bf16_f32 v200, v192, v193
v_mfma_f32_16x16x32_bf16 v[104:107], a[232:235], a[188:191], v[104:107]
buffer_load_dwordx4 a[152:155], v198, s[76:79], s44 offen offset:256 sc1
v_mfma_f32_16x16x32_bf16 v[108:111], a[236:239], a[188:191], v[108:111]
ds_read_b64_tr_b16 a[202:203], v206 offset:17408
v_cvt_pk_bf16_f32 v201, v194, v195
v_mfma_f32_16x16x32_bf16 v[76:79], a[236:239], a[184:187], v[76:79]
ds_read_b64_tr_b16 a[204:205], v207 offset:16384
v_accvgpr_read_b32 v192, a52
v_mfma_f32_16x16x32_bf16 v[72:75], a[232:235], a[184:187], v[72:75]
ds_read_b64_tr_b16 a[206:207], v207 offset:17408
v_accvgpr_read_b32 v193, a53
v_mfma_f32_16x16x32_bf16 v[40:43], a[232:235], a[180:183], v[40:43]
buffer_load_dwordx4 a[156:159], v198, s[76:79], s45 offen offset:256 sc1
v_mfma_f32_16x16x32_bf16 v[44:47], a[236:239], a[180:183], v[44:47]
ds_read_b64_tr_b16 a[208:209], v208 offset:16384
v_accvgpr_read_b32 v194, a54
v_mfma_f32_16x16x32_bf16 v[12:15], a[236:239], a[176:179], v[12:15]
s_getpc_b64 s[48:49]
Lpc9:
s_add_u32 s48, s48, LphC-Lpc9
s_addc_u32 s49, s49, 0
v_mfma_f32_16x16x32_bf16 v[8:11], a[232:235], a[176:179], v[8:11]
s_lshr_b32 s6, s2, 3
ds_read_b64_tr_b16 a[210:211], v208 offset:17408
v_accvgpr_read_b32 v195, a55
v_mfma_f32_16x16x32_bf16 v[16:19], a[240:243], a[176:179], v[16:19]
s_lshl_b32 s6, s6, 2
ds_read_b64_tr_b16 a[212:213], v209 offset:16384
v_cvt_pk_bf16_f32 v202, v192, v193
v_mfma_f32_16x16x32_bf16 v[20:23], a[244:247], a[176:179], v[20:23]
s_add_u32 s6, s6, s3
ds_read_b64_tr_b16 a[214:215], v209 offset:17408
v_cvt_pk_bf16_f32 v203, v194, v195
v_mfma_f32_16x16x32_bf16 v[52:55], a[244:247], a[180:183], v[52:55]
s_lshl_b32 s6, s6, 7
ds_read_b64_tr_b16 a[216:217], v210 offset:16384
v_min_u32 v196, 1, v220
v_mfma_f32_16x16x32_bf16 v[48:51], a[240:243], a[180:183], v[48:51]
ds_read_b64_tr_b16 a[218:219], v210 offset:17408
v_lshlrev_b32 v196, 14, v196
v_mfma_f32_16x16x32_bf16 v[80:83], a[240:243], a[184:187], v[80:83]
ds_read_b64_tr_b16 a[220:221], v211 offset:16384
v_add_u32 v196, s6, v196
v_mfma_f32_16x16x32_bf16 v[84:87], a[244:247], a[184:187], v[84:87]
buffer_store_dwordx4 v[200:203], v216, s[28:31], s60 offen offset:2048 sc1
v_mfma_f32_16x16x32_bf16 v[116:119], a[244:247], a[188:191], v[116:119]
ds_read_b64_tr_b16 a[222:223], v211 offset:17408
v_accvgpr_write_b32 a48, 0
v_mfma_f32_16x16x32_bf16 v[112:115], a[240:243], a[188:191], v[112:115]
v_accvgpr_write_b32 a49, 0
v_min_u32 v196, Lend-LphC, v196
v_mfma_f32_16x16x32_bf16 v[120:123], a[248:251], a[188:191], v[120:123]
v_accvgpr_write_b32 a50, 0
v_mov_b32 v197, s49
v_mfma_f32_16x16x32_bf16 v[124:127], a[252:255], a[188:191], v[124:127]
v_accvgpr_write_b32 a51, 0
v_accvgpr_write_b32 a52, 0
v_mfma_f32_16x16x32_bf16 v[92:95], a[252:255], a[184:187], v[92:95]
v_add_co_u32 v196, vcc, s48, v196
s_nop 1
v_addc_co_u32 v197, vcc, 0, v197, vcc
v_mfma_f32_16x16x32_bf16 v[88:91], a[248:251], a[184:187], v[88:91]
v_accvgpr_write_b32 a53, 0
v_accvgpr_write_b32 a54, 0
v_mfma_f32_16x16x32_bf16 v[56:59], a[248:251], a[180:183], v[56:59]
global_load_dword v199, v[196:197], off
v_mfma_f32_16x16x32_bf16 v[60:63], a[252:255], a[180:183], v[60:63]
v_accvgpr_write_b32 a55, 0
v_mfma_f32_16x16x32_bf16 v[28:31], a[252:255], a[176:179], v[28:31]
v_mfma_f32_16x16x32_bf16 v[24:27], a[248:251], a[176:179], v[24:27]
s_waitcnt vmcnt(18) lgkmcnt(0)
v_mfma_f32_16x16x32_bf16 v[0:3], a[192:195], v[240:243], v[0:3]
s_barrier
s_cmp_lg_u32 s3, 0
s_cbranch_scc1 Ls3ad
s_lshl_b32 s6, s5, 2
v_add_u32 v219, s6, v221
s_mov_b64 exec, 1
s_cmp_eq_u32 s39, 1
s_cbranch_scc1 Ls3al
Ls3af:
global_store_dword v219, v223, s[66:67] offset:128 sc1
s_branch Ls3ae
Ls3al:
global_store_dword v219, v223, s[66:67] offset:128
Ls3ae:
s_mov_b64 exec, -1
s_cmp_ge_u32 s5, 4
s_cbranch_scc1 Ls3ad
v_and_b32 v219, 0xfffffcff, v221
s_mov_b64 exec, 1
global_atomic_add v219, v223, s[66:67] offset:12 sc1
s_mov_b64 exec, -1
Ls3ad:
v_mfma_f32_16x16x32_bf16 v[4:7], a[196:199], v[240:243], v[4:7]
s_mov_b32 s16, s46
ds_read_b64_tr_b16 a[224:225], v204 offset:24576
buffer_load_dwordx4 a[160:163], v198, s[76:79], s42 offen offset:512 sc1
v_mfma_f32_16x16x32_bf16 v[36:39], a[196:199], v[244:247], v[36:39]
s_and_b32 s17, s47, 0xffff
v_accvgpr_read_b32 v192, a56
v_accvgpr_read_b32 v193, a57
v_mfma_f32_16x16x32_bf16 v[32:35], a[192:195], v[244:247], v[32:35]
s_mov_b32 s18, s98
ds_read_b64_tr_b16 a[226:227], v204 offset:25600
v_accvgpr_read_b32 v194, a58
v_accvgpr_read_b32 v195, a59
v_mfma_f32_16x16x32_bf16 v[64:67], a[192:195], v[248:251], v[64:67]
s_nop 0
ds_read_b64_tr_b16 a[228:229], v205 offset:24576
v_cvt_pk_bf16_f32 v212, v192, v193
v_mfma_f32_16x16x32_bf16 v[68:71], a[196:199], v[248:251], v[68:71]
s_mov_b32 s24, s50
ds_read_b64_tr_b16 a[230:231], v205 offset:25600
v_cvt_pk_bf16_f32 v213, v194, v195
v_accvgpr_read_b32 v192, a60
v_mfma_f32_16x16x32_bf16 v[100:103], a[196:199], v[252:255], v[100:103]
s_and_b32 s25, s51, 0xffff
ds_read_b64_tr_b16 a[232:233], v206 offset:24576
v_accvgpr_read_b32 v193, a61
v_mfma_f32_16x16x32_bf16 v[96:99], a[192:195], v[252:255], v[96:99]
s_mov_b32 s26, 0
ds_read_b64_tr_b16 a[234:235], v206 offset:25600
v_accvgpr_read_b32 v194, a62
v_accvgpr_read_b32 v195, a63
v_mfma_f32_16x16x32_bf16 v[104:107], a[200:203], v[252:255], v[104:107]
s_mov_b32 s27, 0x20000
ds_read_b64_tr_b16 a[236:237], v207 offset:24576
v_cvt_pk_bf16_f32 v214, v192, v193
v_mfma_f32_16x16x32_bf16 v[108:111], a[204:207], v[252:255], v[108:111]
s_mov_b32 s100, 0
ds_read_b64_tr_b16 a[238:239], v207 offset:25600
ds_read_b64_tr_b16 a[240:241], v208 offset:24576
v_cvt_pk_bf16_f32 v215, v194, v195
v_mfma_f32_16x16x32_bf16 v[76:79], a[204:207], v[248:251], v[76:79]
buffer_load_dwordx4 a[164:167], v198, s[76:79], s43 offen offset:512 sc1
v_mfma_f32_16x16x32_bf16 v[72:75], a[200:203], v[248:251], v[72:75]
s_mov_b32 s101, 0
ds_read_b64_tr_b16 a[242:243], v208 offset:25600
v_mfma_f32_16x16x32_bf16 v[40:43], a[200:203], v[244:247], v[40:43]
buffer_store_dwordx4 v[212:215], v216, s[28:31], s60 offen offset:3072 sc1
v_mfma_f32_16x16x32_bf16 v[44:47], a[204:207], v[244:247], v[44:47]
s_add_u32 s60, s60, 4096
v_accvgpr_write_b32 a56, 0
v_accvgpr_write_b32 a57, 0
v_accvgpr_write_b32 a58, 0
v_mfma_f32_16x16x32_bf16 v[12:15], a[204:207], v[240:243], v[12:15]
s_mov_b32 s38, 0
ds_read_b64_tr_b16 a[244:245], v209 offset:24576
v_accvgpr_write_b32 a59, 0
v_mfma_f32_16x16x32_bf16 v[8:11], a[200:203], v[240:243], v[8:11]
s_lshl_b32 s61, s3, 13
ds_read_b64_tr_b16 a[246:247], v209 offset:25600
v_accvgpr_write_b32 a60, 0
v_accvgpr_write_b32 a61, 0
v_mfma_f32_16x16x32_bf16 v[16:19], a[208:211], v[240:243], v[16:19]
s_add_u32 s61, s61, 131072
ds_read_b64_tr_b16 a[248:249], v210 offset:24576
v_accvgpr_write_b32 a62, 0
v_mfma_f32_16x16x32_bf16 v[20:23], a[212:215], v[240:243], v[20:23]
ds_read_b64_tr_b16 a[250:251], v210 offset:25600
v_accvgpr_write_b32 a63, 0
v_accvgpr_read_b32 v192, a64
v_mfma_f32_16x16x32_bf16 v[52:55], a[212:215], v[244:247], v[52:55]
buffer_load_dwordx4 a[168:171], v198, s[76:79], s44 offen offset:512 sc1
v_mfma_f32_16x16x32_bf16 v[48:51], a[208:211], v[244:247], v[48:51]
ds_read_b64_tr_b16 a[252:253], v211 offset:24576
v_accvgpr_read_b32 v193, a65
v_mfma_f32_16x16x32_bf16 v[80:83], a[208:211], v[248:251], v[80:83]
ds_read_b64_tr_b16 a[254:255], v211 offset:25600
v_accvgpr_read_b32 v194, a66
v_mfma_f32_16x16x32_bf16 v[84:87], a[212:215], v[248:251], v[84:87]
v_accvgpr_read_b32 v195, a67
v_cvt_pk_bf16_f32 v200, v192, v193
v_mfma_f32_16x16x32_bf16 v[116:119], a[212:215], v[252:255], v[116:119]
v_cvt_pk_bf16_f32 v201, v194, v195
v_accvgpr_read_b32 v192, a68
v_mfma_f32_16x16x32_bf16 v[112:115], a[208:211], v[252:255], v[112:115]
v_accvgpr_read_b32 v193, a69
v_accvgpr_read_b32 v194, a70
v_mfma_f32_16x16x32_bf16 v[120:123], a[216:219], v[252:255], v[120:123]
v_accvgpr_read_b32 v195, a71
v_cvt_pk_bf16_f32 v202, v192, v193
v_mfma_f32_16x16x32_bf16 v[124:127], a[220:223], v[252:255], v[124:127]
buffer_load_dwordx4 a[172:175], v198, s[76:79], s45 offen offset:512 sc1
v_mfma_f32_16x16x32_bf16 v[92:95], a[220:223], v[248:251], v[92:95]
v_cvt_pk_bf16_f32 v203, v194, v195
v_mfma_f32_16x16x32_bf16 v[88:91], a[216:219], v[248:251], v[88:91]
buffer_store_dwordx4 v[200:203], v216, s[28:31], s60 offen offset:0 sc1
v_accvgpr_write_b32 a64, 0
v_mfma_f32_16x16x32_bf16 v[56:59], a[216:219], v[244:247], v[56:59]
v_accvgpr_write_b32 a65, 0
v_accvgpr_write_b32 a66, 0
v_mfma_f32_16x16x32_bf16 v[60:63], a[220:223], v[244:247], v[60:63]
v_accvgpr_write_b32 a67, 0
v_accvgpr_write_b32 a68, 0
v_mfma_f32_16x16x32_bf16 v[28:31], a[220:223], v[240:243], v[28:31]
v_accvgpr_write_b32 a69, 0
v_accvgpr_write_b32 a70, 0
v_mfma_f32_16x16x32_bf16 v[24:27], a[216:219], v[240:243], v[24:27]
v_accvgpr_write_b32 a71, 0
s_waitcnt vmcnt(17) lgkmcnt(0)
v_mfma_f32_16x16x32_bf16 v[0:3], a[224:227], v[224:227], v[0:3]
v_mfma_f32_16x16x32_bf16 v[4:7], a[228:231], v[224:227], v[4:7]
ds_read_b64_tr_b16 a[192:193], v204 offset:32768
v_accvgpr_read_b32 v192, a72
v_mfma_f32_16x16x32_bf16 v[36:39], a[228:231], v[228:231], v[36:39]
buffer_load_dwordx4 a[176:179], v198, s[76:79], s42 offen offset:768 sc1
v_mfma_f32_16x16x32_bf16 v[32:35], a[224:227], v[228:231], v[32:35]
Lpad12:
s_cbranch_execz Lret0
ds_read_b64_tr_b16 a[194:195], v204 offset:33792
v_accvgpr_read_b32 v193, a73
v_mfma_f32_16x16x32_bf16 v[64:67], a[224:227], v[232:235], v[64:67]
ds_read_b64_tr_b16 a[196:197], v205 offset:32768
v_accvgpr_read_b32 v194, a74
v_mfma_f32_16x16x32_bf16 v[68:71], a[228:231], v[232:235], v[68:71]
ds_read_b64_tr_b16 a[198:199], v205 offset:33792
v_accvgpr_read_b32 v195, a75
v_mfma_f32_16x16x32_bf16 v[100:103], a[228:231], v[236:239], v[100:103]
ds_read_b64_tr_b16 a[200:201], v206 offset:32768
v_cvt_pk_bf16_f32 v212, v192, v193
v_mfma_f32_16x16x32_bf16 v[96:99], a[224:227], v[236:239], v[96:99]
ds_read_b64_tr_b16 a[202:203], v206 offset:33792
v_cvt_pk_bf16_f32 v213, v194, v195
v_mfma_f32_16x16x32_bf16 v[104:107], a[232:235], v[236:239], v[104:107]
ds_read_b64_tr_b16 a[204:205], v207 offset:32768
v_accvgpr_read_b32 v192, a76
v_mfma_f32_16x16x32_bf16 v[108:111], a[236:239], v[236:239], v[108:111]
ds_read_b64_tr_b16 a[206:207], v207 offset:33792
v_accvgpr_read_b32 v193, a77
v_mfma_f32_16x16x32_bf16 v[76:79], a[236:239], v[232:235], v[76:79]
buffer_load_dwordx4 a[180:183], v198, s[76:79], s43 offen offset:768 sc1
v_mfma_f32_16x16x32_bf16 v[72:75], a[232:235], v[232:235], v[72:75]
ds_read_b64_tr_b16 a[208:209], v208 offset:32768
v_accvgpr_read_b32 v194, a78
v_mfma_f32_16x16x32_bf16 v[40:43], a[232:235], v[228:231], v[40:43]
ds_read_b64_tr_b16 a[210:211], v208 offset:33792
v_accvgpr_read_b32 v195, a79
v_mfma_f32_16x16x32_bf16 v[44:47], a[236:239], v[228:231], v[44:47]
ds_read_b64_tr_b16 a[212:213], v209 offset:32768
v_cvt_pk_bf16_f32 v214, v192, v193
v_mfma_f32_16x16x32_bf16 v[12:15], a[236:239], v[224:227], v[12:15]
ds_read_b64_tr_b16 a[214:215], v209 offset:33792
v_cvt_pk_bf16_f32 v215, v194, v195
v_mfma_f32_16x16x32_bf16 v[8:11], a[232:235], v[224:227], v[8:11]
ds_read_b64_tr_b16 a[216:217], v210 offset:32768
ds_read_b64_tr_b16 a[218:219], v210 offset:33792
v_mfma_f32_16x16x32_bf16 v[16:19], a[240:243], v[224:227], v[16:19]
buffer_load_dwordx4 a[184:187], v198, s[76:79], s44 offen offset:768 sc1
v_mfma_f32_16x16x32_bf16 v[20:23], a[244:247], v[224:227], v[20:23]
ds_read_b64_tr_b16 a[220:221], v211 offset:32768
ds_read_b64_tr_b16 a[222:223], v211 offset:33792
v_mfma_f32_16x16x32_bf16 v[52:55], a[244:247], v[228:231], v[52:55]
buffer_store_dwordx4 v[212:215], v216, s[28:31], s60 offen offset:1024 sc1
v_mfma_f32_16x16x32_bf16 v[48:51], a[240:243], v[228:231], v[48:51]
v_accvgpr_write_b32 a72, 0
v_accvgpr_write_b32 a73, 0
v_mfma_f32_16x16x32_bf16 v[80:83], a[240:243], v[232:235], v[80:83]
v_mfma_f32_16x16x32_bf16 v[84:87], a[244:247], v[232:235], v[84:87]
v_accvgpr_write_b32 a74, 0
v_accvgpr_write_b32 a75, 0
v_mfma_f32_16x16x32_bf16 v[116:119], a[244:247], v[236:239], v[116:119]
v_mfma_f32_16x16x32_bf16 v[112:115], a[240:243], v[236:239], v[112:115]
v_accvgpr_write_b32 a76, 0
v_accvgpr_write_b32 a77, 0
v_mfma_f32_16x16x32_bf16 v[120:123], a[248:251], v[236:239], v[120:123]
buffer_load_dwordx4 a[188:191], v198, s[76:79], s45 offen offset:768 sc1
v_mfma_f32_16x16x32_bf16 v[124:127], a[252:255], v[236:239], v[124:127]
v_mfma_f32_16x16x32_bf16 v[92:95], a[252:255], v[232:235], v[92:95]
v_accvgpr_write_b32 a78, 0
v_accvgpr_write_b32 a79, 0
v_mfma_f32_16x16x32_bf16 v[88:91], a[248:251], v[232:235], v[88:91]
v_mfma_f32_16x16x32_bf16 v[56:59], a[248:251], v[228:231], v[56:59]
v_mfma_f32_16x16x32_bf16 v[60:63], a[252:255], v[228:231], v[60:63]
v_mfma_f32_16x16x32_bf16 v[28:31], a[252:255], v[224:227], v[28:31]
v_mfma_f32_16x16x32_bf16 v[24:27], a[248:251], v[224:227], v[24:27]
s_waitcnt vmcnt(17) lgkmcnt(0)
v_mfma_f32_16x16x32_bf16 v[0:3], a[192:195], a[128:131], v[0:3]
s_barrier
v_mfma_f32_16x16x32_bf16 v[4:7], a[196:199], a[128:131], v[4:7]
ds_read_b64_tr_b16 a[224:225], v204 offset:40960
v_accvgpr_read_b32 v192, a80
v_mfma_f32_16x16x32_bf16 v[36:39], a[196:199], a[132:135], v[36:39]
global_load_dword v219, v222, s[66:67] sc1
v_mfma_f32_16x16x32_bf16 v[32:35], a[192:195], a[132:135], v[32:35]
ds_read_b64_tr_b16 a[226:227], v204 offset:41984
v_accvgpr_read_b32 v193, a81
v_mfma_f32_16x16x32_bf16 v[64:67], a[192:195], a[136:139], v[64:67]
v_accvgpr_read_b32 v194, a82
v_accvgpr_read_b32 v195, a83
v_mfma_f32_16x16x32_bf16 v[68:71], a[196:199], a[136:139], v[68:71]
ds_read_b64_tr_b16 a[228:229], v205 offset:40960
v_cvt_pk_bf16_f32 v200, v192, v193
v_mfma_f32_16x16x32_bf16 v[100:103], a[196:199], a[140:143], v[100:103]
ds_read_b64_tr_b16 a[230:231], v205 offset:41984
v_cvt_pk_bf16_f32 v201, v194, v195
v_mfma_f32_16x16x32_bf16 v[96:99], a[192:195], a[140:143], v[96:99]
ds_read_b64_tr_b16 a[232:233], v206 offset:40960
v_accvgpr_read_b32 v192, a84
v_mfma_f32_16x16x32_bf16 v[104:107], a[200:203], a[140:143], v[104:107]
v_accvgpr_read_b32 v193, a85
v_accvgpr_read_b32 v194, a86
v_mfma_f32_16x16x32_bf16 v[108:111], a[204:207], a[140:143], v[108:111]
ds_read_b64_tr_b16 a[234:235], v206 offset:41984
v_accvgpr_read_b32 v195, a87
v_mfma_f32_16x16x32_bf16 v[76:79], a[204:207], a[136:139], v[76:79]
ds_read_b64_tr_b16 a[236:237], v207 offset:40960
v_cvt_pk_bf16_f32 v202, v192, v193
v_mfma_f32_16x16x32_bf16 v[72:75], a[200:203], a[136:139], v[72:75]
ds_read_b64_tr_b16 a[238:239], v207 offset:41984
v_cvt_pk_bf16_f32 v203, v194, v195
v_mfma_f32_16x16x32_bf16 v[40:43], a[200:203], a[132:135], v[40:43]
buffer_store_dwordx4 v[200:203], v216, s[28:31], s60 offen offset:2048 sc1
v_mfma_f32_16x16x32_bf16 v[44:47], a[204:207], a[132:135], v[44:47]
ds_read_b64_tr_b16 a[240:241], v208 offset:40960
v_accvgpr_write_b32 a80, 0
v_mfma_f32_16x16x32_bf16 v[12:15], a[204:207], a[128:131], v[12:15]
v_accvgpr_write_b32 a81, 0
v_accvgpr_write_b32 a82, 0
v_mfma_f32_16x16x32_bf16 v[8:11], a[200:203], a[128:131], v[8:11]
ds_read_b64_tr_b16 a[242:243], v208 offset:41984
v_accvgpr_write_b32 a83, 0
v_mfma_f32_16x16x32_bf16 v[16:19], a[208:211], a[128:131], v[16:19]
ds_read_b64_tr_b16 a[244:245], v209 offset:40960
v_accvgpr_write_b32 a84, 0
v_mfma_f32_16x16x32_bf16 v[20:23], a[212:215], a[128:131], v[20:23]
ds_read_b64_tr_b16 a[246:247], v209 offset:41984
v_accvgpr_write_b32 a85, 0
v_mfma_f32_16x16x32_bf16 v[52:55], a[212:215], a[132:135], v[52:55]
ds_read_b64_tr_b16 a[248:249], v210 offset:40960
v_accvgpr_write_b32 a86, 0
v_mfma_f32_16x16x32_bf16 v[48:51], a[208:211], a[132:135], v[48:51]
v_accvgpr_write_b32 a87, 0
v_accvgpr_read_b32 v192, a88
v_mfma_f32_16x16x32_bf16 v[80:83], a[208:211], a[136:139], v[80:83]
ds_read_b64_tr_b16 a[250:251], v210 offset:41984
v_accvgpr_read_b32 v193, a89
v_mfma_f32_16x16x32_bf16 v[84:87], a[212:215], a[136:139], v[84:87]
ds_read_b64_tr_b16 a[252:253], v211 offset:40960
v_accvgpr_read_b32 v194, a90
v_mfma_f32_16x16x32_bf16 v[116:119], a[212:215], a[140:143], v[116:119]
ds_read_b64_tr_b16 a[254:255], v211 offset:41984
v_accvgpr_read_b32 v195, a91
v_mfma_f32_16x16x32_bf16 v[112:115], a[208:211], a[140:143], v[112:115]
v_cvt_pk_bf16_f32 v212, v192, v193
v_cvt_pk_bf16_f32 v213, v194, v195
v_mfma_f32_16x16x32_bf16 v[120:123], a[216:219], a[140:143], v[120:123]
v_accvgpr_read_b32 v192, a92
v_accvgpr_read_b32 v193, a93
v_mfma_f32_16x16x32_bf16 v[124:127], a[220:223], a[140:143], v[124:127]
v_accvgpr_read_b32 v194, a94
v_accvgpr_read_b32 v195, a95
v_mfma_f32_16x16x32_bf16 v[92:95], a[220:223], a[136:139], v[92:95]
v_cvt_pk_bf16_f32 v214, v192, v193
v_cvt_pk_bf16_f32 v215, v194, v195
v_mfma_f32_16x16x32_bf16 v[88:91], a[216:219], a[136:139], v[88:91]
buffer_store_dwordx4 v[212:215], v216, s[28:31], s60 offen offset:3072 sc1
v_mfma_f32_16x16x32_bf16 v[56:59], a[216:219], a[132:135], v[56:59]
s_add_u32 s60, s60, 4096
v_accvgpr_write_b32 a88, 0
v_accvgpr_write_b32 a89, 0
v_mfma_f32_16x16x32_bf16 v[60:63], a[220:223], a[132:135], v[60:63]
v_accvgpr_write_b32 a90, 0
v_accvgpr_write_b32 a91, 0
v_mfma_f32_16x16x32_bf16 v[28:31], a[220:223], a[128:131], v[28:31]
v_accvgpr_write_b32 a92, 0
v_accvgpr_write_b32 a93, 0
v_mfma_f32_16x16x32_bf16 v[24:27], a[216:219], a[128:131], v[24:27]
v_accvgpr_write_b32 a94, 0
v_accvgpr_write_b32 a95, 0
s_mov_b64 exec, 0
s_cmp_eq_u32 s3, 0
s_cbranch_scc1 Lch1_0
s_cmp_eq_u32 s3, 1
s_cbranch_scc1 Lch1_1
s_cmp_eq_u32 s3, 2
s_cbranch_scc1 Lch1_2
s_branch Lch1_3
Lret1:
s_mov_b64 exec, -1
s_waitcnt vmcnt(2) lgkmcnt(0)
v_mfma_f32_16x16x32_bf16 v[0:3], a[224:227], a[144:147], v[0:3]
v_cmp_gt_u32 vcc, 1, v219
s_mov_b32 s6, 0
s_cmp_eq_u64 vcc, 0
s_cbranch_scc1 Lok10
Lsp11:
s_sleep 2
global_load_dword v219, v222, s[66:67] sc1
s_waitcnt vmcnt(0)
v_cmp_gt_u32 vcc, 1, v219
s_add_u32 s6, s6, 1
s_cmp_gt_u32 s6, 200000
s_cbranch_scc1 Lok10
s_cmp_lg_u64 vcc, 0
s_cbranch_scc1 Lsp11
Lok10:
v_mfma_f32_16x16x32_bf16 v[4:7], a[228:231], a[144:147], v[4:7]
s_and_b32 m0, s68, 0xffff
ds_read_b64_tr_b16 a[192:193], v204 offset:49152
v_and_b32 v250, 15, v220
v_mfma_f32_16x16x32_bf16 v[36:39], a[228:231], a[148:151], v[36:39]
s_lshl_b32 s6, s3, 4
ds_read_b64_tr_b16 a[194:195], v204 offset:50176
v_add_u32 v250, s6, v250
v_mfma_f32_16x16x32_bf16 v[32:35], a[224:227], a[148:151], v[32:35]
buffer_load_dwordx4 v216, s[8:11], s68 offen offset:0 lds
v_mfma_f32_16x16x32_bf16 v[64:67], a[224:227], a[152:155], v[64:67]
ds_read_b64_tr_b16 a[196:197], v205 offset:49152
v_lshrrev_b32 v251, 4, v220
v_mfma_f32_16x16x32_bf16 v[68:71], a[228:231], a[152:155], v[68:71]
ds_read_b64_tr_b16 a[198:199], v205 offset:50176
v_lshlrev_b32 v251, 2, v251
v_mfma_f32_16x16x32_bf16 v[100:103], a[228:231], a[156:159], v[100:103]
ds_read_b64_tr_b16 a[200:201], v206 offset:49152
v_sub_u32 v250, v250, v251
v_mfma_f32_16x16x32_bf16 v[96:99], a[224:227], a[156:159], v[96:99]
buffer_load_dwordx4 v216, s[8:11], s68 offen offset:1024 lds
v_mfma_f32_16x16x32_bf16 v[104:107], a[232:235], a[156:159], v[104:107]
ds_read_b64_tr_b16 a[202:203], v206 offset:50176
v_mov_b32 v251, 0xf149f2ca
v_mfma_f32_16x16x32_bf16 v[108:111], a[236:239], a[156:159], v[108:111]
ds_read_b64_tr_b16 a[204:205], v207 offset:49152
v_accvgpr_read_b32 v192, a96
v_mfma_f32_16x16x32_bf16 v[76:79], a[236:239], a[152:155], v[76:79]
ds_read_b64_tr_b16 a[206:207], v207 offset:50176
v_accvgpr_read_b32 v193, a97
v_mfma_f32_16x16x32_bf16 v[72:75], a[232:235], a[152:155], v[72:75]
buffer_load_dwordx4 v216, s[8:11], s68 offen offset:2048 lds
v_mfma_f32_16x16x32_bf16 v[40:43], a[232:235], a[148:151], v[40:43]
ds_read_b64_tr_b16 a[208:209], v208 offset:49152
v_accvgpr_read_b32 v194, a98
v_mfma_f32_16x16x32_bf16 v[44:47], a[236:239], a[148:151], v[44:47]
ds_read_b64_tr_b16 a[210:211], v208 offset:50176
v_accvgpr_read_b32 v195, a99
v_mfma_f32_16x16x32_bf16 v[12:15], a[236:239], a[144:147], v[12:15]
ds_read_b64_tr_b16 a[212:213], v209 offset:49152
v_cvt_pk_bf16_f32 v200, v192, v193
v_mfma_f32_16x16x32_bf16 v[8:11], a[232:235], a[144:147], v[8:11]
buffer_load_dwordx4 v216, s[8:11], s68 offen offset:3072 lds
v_mfma_f32_16x16x32_bf16 v[16:19], a[240:243], a[144:147], v[16:19]
s_add_u32 s68, s68, 16384
ds_read_b64_tr_b16 a[214:215], v209 offset:50176
v_cvt_pk_bf16_f32 v201, v194, v195
v_mfma_f32_16x16x32_bf16 v[20:23], a[244:247], a[144:147], v[20:23]
ds_read_b64_tr_b16 a[216:217], v210 offset:49152
v_accvgpr_read_b32 v192, a100
v_mfma_f32_16x16x32_bf16 v[52:55], a[244:247], a[148:151], v[52:55]
ds_read_b64_tr_b16 a[218:219], v210 offset:50176
v_cmp_gt_i32 s[48:49], 0, v250
v_mfma_f32_16x16x32_bf16 v[48:51], a[240:243], a[148:151], v[48:51]
v_accvgpr_read_b32 v193, a101
v_cmp_gt_i32 s[42:43], 1, v250
v_mfma_f32_16x16x32_bf16 v[80:83], a[240:243], a[152:155], v[80:83]
ds_read_b64_tr_b16 a[220:221], v211 offset:49152
v_accvgpr_read_b32 v194, a102
v_mfma_f32_16x16x32_bf16 v[84:87], a[244:247], a[152:155], v[84:87]
ds_read_b64_tr_b16 a[222:223], v211 offset:50176
v_accvgpr_read_b32 v195, a103
v_mfma_f32_16x16x32_bf16 v[116:119], a[244:247], a[156:159], v[116:119]
v_cndmask_b32 v224, 0, v251, s[48:49]
v_cvt_pk_bf16_f32 v202, v192, v193
v_mfma_f32_16x16x32_bf16 v[112:115], a[240:243], a[156:159], v[112:115]
v_cvt_pk_bf16_f32 v203, v194, v195
v_cndmask_b32 v225, 0, v251, s[42:43]
v_mfma_f32_16x16x32_bf16 v[120:123], a[248:251], a[156:159], v[120:123]
buffer_store_dwordx4 v[200:203], v216, s[28:31], s60 offen offset:0 sc1
v_mfma_f32_16x16x32_bf16 v[124:127], a[252:255], a[156:159], v[124:127]
v_accvgpr_write_b32 a96, 0
v_cmp_gt_i32 s[48:49], 2, v250
v_mfma_f32_16x16x32_bf16 v[92:95], a[252:255], a[152:155], v[92:95]
v_accvgpr_write_b32 a97, 0
v_accvgpr_write_b32 a98, 0
v_mfma_f32_16x16x32_bf16 v[88:91], a[248:251], a[152:155], v[88:91]
v_cmp_gt_i32 s[42:43], 3, v250
v_accvgpr_write_b32 a99, 0
v_mfma_f32_16x16x32_bf16 v[56:59], a[248:251], a[148:151], v[56:59]
v_accvgpr_write_b32 a100, 0
v_cndmask_b32 v226, 0, v251, s[48:49]
v_mfma_f32_16x16x32_bf16 v[60:63], a[252:255], a[148:151], v[60:63]
v_accvgpr_write_b32 a101, 0
v_accvgpr_write_b32 a102, 0
v_mfma_f32_16x16x32_bf16 v[28:31], a[252:255], a[144:147], v[28:31]
v_cndmask_b32 v227, 0, v251, s[42:43]
v_accvgpr_write_b32 a103, 0
v_mfma_f32_16x16x32_bf16 v[24:27], a[248:251], a[144:147], v[24:27]
s_waitcnt lgkmcnt(0)
v_mfma_f32_16x16x32_bf16 v[0:3], a[192:195], a[160:163], v[0:3]
s_barrier
v_mfma_f32_16x16x32_bf16 v[4:7], a[196:199], a[160:163], v[4:7]
s_and_b32 m0, s68, 0xffff
ds_read_b64_tr_b16 a[224:225], v204 offset:57344
v_accvgpr_read_b32 v192, a104
v_accvgpr_read_b32 v193, a105
v_mfma_f32_16x16x32_bf16 v[36:39], a[196:199], a[164:167], v[36:39]
ds_read_b64_tr_b16 a[226:227], v204 offset:58368
v_cmp_gt_i32 s[48:49], 16, v250
v_accvgpr_read_b32 v194, a106
v_mfma_f32_16x16x32_bf16 v[32:35], a[192:195], a[164:167], v[32:35]
ds_read_b64_tr_b16 a[228:229], v205 offset:57344
v_accvgpr_read_b32 v195, a107
v_cmp_gt_i32 s[42:43], 17, v250
v_mfma_f32_16x16x32_bf16 v[64:67], a[192:195], a[168:171], v[64:67]
ds_read_b64_tr_b16 a[230:231], v205 offset:58368
v_cvt_pk_bf16_f32 v212, v192, v193
v_cndmask_b32 v228, 0, v251, s[48:49]
v_mfma_f32_16x16x32_bf16 v[68:71], a[196:199], a[168:171], v[68:71]
v_cvt_pk_bf16_f32 v213, v194, v195
v_accvgpr_read_b32 v192, a108
v_cndmask_b32 v229, 0, v251, s[42:43]
v_mfma_f32_16x16x32_bf16 v[100:103], a[196:199], a[172:175], v[100:103]
ds_read_b64_tr_b16 a[232:233], v206 offset:57344
v_accvgpr_read_b32 v193, a109
v_mfma_f32_16x16x32_bf16 v[96:99], a[192:195], a[172:175], v[96:99]
ds_read_b64_tr_b16 a[234:235], v206 offset:58368
v_cmp_gt_i32 s[48:49], 18, v250
v_accvgpr_read_b32 v194, a110
v_mfma_f32_16x16x32_bf16 v[104:107], a[200:203], a[172:175], v[104:107]
buffer_load_dwordx4 v216, s[8:11], s68 offen offset:0 lds
v_accvgpr_read_b32 v195, a111
v_mfma_f32_16x16x32_bf16 v[108:111], a[204:207], a[172:175], v[108:111]
ds_read_b64_tr_b16 a[236:237], v207 offset:57344
v_cmp_gt_i32 s[42:43], 19, v250
v_cvt_pk_bf16_f32 v214, v192, v193
v_mfma_f32_16x16x32_bf16 v[76:79], a[204:207], a[168:171], v[76:79]
ds_read_b64_tr_b16 a[238:239], v207 offset:58368
v_cvt_pk_bf16_f32 v215, v194, v195
v_cndmask_b32 v230, 0, v251, s[48:49]
v_mfma_f32_16x16x32_bf16 v[72:75], a[200:203], a[168:171], v[72:75]
buffer_store_dwordx4 v[212:215], v216, s[28:31], s60 offen offset:1024 sc1
v_cndmask_b32 v231, 0, v251, s[42:43]
v_mfma_f32_16x16x32_bf16 v[40:43], a[200:203], a[164:167], v[40:43]
ds_read_b64_tr_b16 a[240:241], v208 offset:57344
v_accvgpr_write_b32 a104, 0
v_mfma_f32_16x16x32_bf16 v[44:47], a[204:207], a[164:167], v[44:47]
ds_read_b64_tr_b16 a[242:243], v208 offset:58368
v_accvgpr_write_b32 a105, 0
v_cmp_gt_i32 s[48:49], 32, v250
v_mfma_f32_16x16x32_bf16 v[12:15], a[204:207], a[160:163], v[12:15]
v_accvgpr_write_b32 a106, 0
v_accvgpr_write_b32 a107, 0
v_cmp_gt_i32 s[42:43], 33, v250
v_mfma_f32_16x16x32_bf16 v[8:11], a[200:203], a[160:163], v[8:11]
ds_read_b64_tr_b16 a[244:245], v209 offset:57344
v_accvgpr_write_b32 a108, 0
v_cndmask_b32 v232, 0, v251, s[48:49]
v_mfma_f32_16x16x32_bf16 v[16:19], a[208:211], a[160:163], v[16:19]
ds_read_b64_tr_b16 a[246:247], v209 offset:58368
v_accvgpr_write_b32 a109, 0
v_accvgpr_write_b32 a110, 0
v_mfma_f32_16x16x32_bf16 v[20:23], a[212:215], a[160:163], v[20:23]
ds_read_b64_tr_b16 a[248:249], v210 offset:57344
v_cndmask_b32 v233, 0, v251, s[42:43]
v_accvgpr_write_b32 a111, 0
v_mfma_f32_16x16x32_bf16 v[52:55], a[212:215], a[164:167], v[52:55]
ds_read_b64_tr_b16 a[250:251], v210 offset:58368
v_accvgpr_read_b32 v192, a112
v_mfma_f32_16x16x32_bf16 v[48:51], a[208:211], a[164:167], v[48:51]
ds_read_b64_tr_b16 a[252:253], v211 offset:57344
v_accvgpr_read_b32 v193, a113
v_cmp_gt_i32 s[48:49], 34, v250
v_mfma_f32_16x16x32_bf16 v[80:83], a[208:211], a[168:171], v[80:83]
v_accvgpr_read_b32 v194, a114
v_accvgpr_read_b32 v195, a115
v_cmp_gt_i32 s[42:43], 35, v250
v_mfma_f32_16x16x32_bf16 v[84:87], a[212:215], a[168:171], v[84:87]
ds_read_b64_tr_b16 a[254:255], v211 offset:58368
buffer_load_dwordx4 v216, s[8:11], s68 offen offset:1024 lds
v_mfma_f32_16x16x32_bf16 v[116:119], a[212:215], a[172:175], v[116:119]
v_cvt_pk_bf16_f32 v200, v192, v193
v_cndmask_b32 v234, 0, v251, s[48:49]
v_cvt_pk_bf16_f32 v201, v194, v195
v_mfma_f32_16x16x32_bf16 v[112:115], a[208:211], a[172:175], v[112:115]
v_accvgpr_read_b32 v192, a116
v_cndmask_b32 v235, 0, v251, s[42:43]
v_accvgpr_read_b32 v193, a117
v_mfma_f32_16x16x32_bf16 v[120:123], a[216:219], a[172:175], v[120:123]
v_cmp_gt_i32 s[48:49], 48, v250
v_accvgpr_read_b32 v194, a118
v_mfma_f32_16x16x32_bf16 v[124:127], a[220:223], a[172:175], v[124:127]
v_accvgpr_read_b32 v195, a119
v_cmp_gt_i32 s[42:43], 49, v250
v_cvt_pk_bf16_f32 v202, v192, v193
v_mfma_f32_16x16x32_bf16 v[92:95], a[220:223], a[168:171], v[92:95]
v_cvt_pk_bf16_f32 v203, v194, v195
buffer_store_dwordx4 v[200:203], v216, s[28:31], s60 offen offset:2048 sc1
v_mfma_f32_16x16x32_bf16 v[88:91], a[216:219], a[168:171], v[88:91]
v_cndmask_b32 v236, 0, v251, s[48:49]
v_accvgpr_write_b32 a112, 0
v_cndmask_b32 v237, 0, v251, s[42:43]
v_mfma_f32_16x16x32_bf16 v[56:59], a[216:219], a[164:167], v[56:59]
v_accvgpr_write_b32 a113, 0
v_cmp_gt_i32 s[48:49], 50, v250
v_accvgpr_write_b32 a114, 0
v_mfma_f32_16x16x32_bf16 v[60:63], a[220:223], a[164:167], v[60:63]
v_accvgpr_write_b32 a115, 0
v_cmp_gt_i32 s[42:43], 51, v250
v_mfma_f32_16x16x32_bf16 v[28:31], a[220:223], a[160:163], v[28:31]
v_accvgpr_write_b32 a116, 0
v_cndmask_b32 v238, 0, v251, s[48:49]
v_accvgpr_write_b32 a117, 0
v_mfma_f32_16x16x32_bf16 v[24:27], a[216:219], a[160:163], v[24:27]
v_accvgpr_write_b32 a118, 0
v_cndmask_b32 v239, 0, v251, s[42:43]
v_accvgpr_write_b32 a119, 0
s_waitcnt vmcnt(5) lgkmcnt(0)
v_mfma_f32_16x16x32_bf16 v[0:3], a[224:227], a[176:179], v[0:3]
s_barrier
v_mfma_f32_16x16x32_bf16 v[4:7], a[228:231], a[176:179], v[4:7]
ds_read_b128 a[192:195], v217 offset:0
buffer_load_dwordx4 v216, s[8:11], s68 offen offset:2048 lds
v_mfma_f32_16x16x32_bf16 v[8:11], a[232:235], a[176:179], v[8:11]
ds_read_b128 a[196:199], v217 offset:1024
v_accvgpr_read_b32 v192, a120
v_accvgpr_read_b32 v193, a121
v_mfma_f32_16x16x32_bf16 v[12:15], a[236:239], a[176:179], v[12:15]
ds_read_b128 a[200:203], v217 offset:2048
v_accvgpr_read_b32 v194, a122
v_mfma_f32_16x16x32_bf16 v[16:19], a[240:243], a[176:179], v[16:19]
ds_read_b128 a[204:207], v217 offset:3072
v_accvgpr_read_b32 v195, a123
v_cvt_pk_bf16_f32 v212, v192, v193
v_mfma_f32_16x16x32_bf16 v[20:23], a[244:247], a[176:179], v[20:23]
ds_read_b128 a[208:211], v217 offset:4096
v_mfma_f32_16x16x32_bf16 v[24:27], a[248:251], a[176:179], v[24:27]
ds_read_b128 a[212:215], v217 offset:5120
v_cvt_pk_bf16_f32 v213, v194, v195
v_mfma_f32_16x16x32_bf16 v[28:31], a[252:255], a[176:179], v[28:31]
ds_read_b128 a[216:219], v217 offset:6144
v_mfma_f32_16x16x32_bf16 v[32:35], a[224:227], a[180:183], v[32:35]
v_accvgpr_read_b32 v192, a124
v_mfma_f32_16x16x32_bf16 v[36:39], a[228:231], a[180:183], v[36:39]
ds_read_b128 a[220:223], v217 offset:7168
v_accvgpr_read_b32 v193, a125
v_accvgpr_read_b32 v194, a126
v_mfma_f32_16x16x32_bf16 v[40:43], a[232:235], a[180:183], v[40:43]
v_accvgpr_read_b32 v195, a127
v_mfma_f32_16x16x32_bf16 v[44:47], a[236:239], a[180:183], v[44:47]
buffer_load_dwordx4 v216, s[8:11], s68 offen offset:3072 lds
v_cvt_pk_bf16_f32 v214, v192, v193
v_mfma_f32_16x16x32_bf16 v[48:51], a[240:243], a[180:183], v[48:51]
s_add_u32 s68, s68, 16384
v_cvt_pk_bf16_f32 v128, v0, v1
v_cvt_pk_bf16_f32 v129, v2, v3
v_cvt_pk_bf16_f32 v130, v4, v5
v_mfma_f32_16x16x32_bf16 v[52:55], a[244:247], a[180:183], v[52:55]
v_cvt_pk_bf16_f32 v131, v6, v7
v_cvt_pk_bf16_f32 v132, v8, v9
v_cvt_pk_bf16_f32 v133, v10, v11
v_mfma_f32_16x16x32_bf16 v[56:59], a[248:251], a[180:183], v[56:59]
v_cvt_pk_bf16_f32 v134, v12, v13
v_cvt_pk_bf16_f32 v135, v14, v15
v_cvt_pk_bf16_f32 v136, v16, v17
v_mfma_f32_16x16x32_bf16 v[60:63], a[252:255], a[180:183], v[60:63]
v_cvt_pk_bf16_f32 v137, v18, v19
v_cvt_pk_bf16_f32 v138, v20, v21
v_mfma_f32_16x16x32_bf16 v[64:67], a[224:227], a[184:187], v[64:67]
v_cvt_pk_bf16_f32 v139, v22, v23
v_cvt_pk_bf16_f32 v140, v24, v25
v_cvt_pk_bf16_f32 v141, v26, v27
v_mfma_f32_16x16x32_bf16 v[68:71], a[228:231], a[184:187], v[68:71]
v_cvt_pk_bf16_f32 v142, v28, v29
v_cvt_pk_bf16_f32 v143, v30, v31
v_cvt_pk_bf16_f32 v215, v194, v195
v_mfma_f32_16x16x32_bf16 v[72:75], a[232:235], a[184:187], v[72:75]
buffer_store_dwordx4 v[212:215], v216, s[28:31], s60 offen offset:3072 sc1
s_add_u32 s60, s60, 4096
v_mfma_f32_16x16x32_bf16 v[76:79], a[236:239], a[184:187], v[76:79]
v_accvgpr_write_b32 a120, 0
v_accvgpr_write_b32 a121, 0
v_mfma_f32_16x16x32_bf16 v[80:83], a[240:243], a[184:187], v[80:83]
v_cvt_pk_bf16_f32 v144, v32, v33
v_cvt_pk_bf16_f32 v145, v34, v35
v_cvt_pk_bf16_f32 v146, v36, v37
v_mfma_f32_16x16x32_bf16 v[84:87], a[244:247], a[184:187], v[84:87]
v_cvt_pk_bf16_f32 v147, v38, v39
v_cvt_pk_bf16_f32 v148, v40, v41
v_cvt_pk_bf16_f32 v149, v42, v43
v_mfma_f32_16x16x32_bf16 v[88:91], a[248:251], a[184:187], v[88:91]
v_cvt_pk_bf16_f32 v150, v44, v45
v_cvt_pk_bf16_f32 v151, v46, v47
v_cvt_pk_bf16_f32 v152, v48, v49
v_mfma_f32_16x16x32_bf16 v[92:95], a[252:255], a[184:187], v[92:95]
v_cvt_pk_bf16_f32 v153, v50, v51
v_cvt_pk_bf16_f32 v154, v52, v53
v_cvt_pk_bf16_f32 v155, v54, v55
v_mfma_f32_16x16x32_bf16 v[96:99], a[224:227], a[188:191], v[96:99]
v_cvt_pk_bf16_f32 v156, v56, v57
v_cvt_pk_bf16_f32 v157, v58, v59
v_cvt_pk_bf16_f32 v158, v60, v61
v_cvt_pk_bf16_f32 v159, v62, v63
v_mfma_f32_16x16x32_bf16 v[100:103], a[228:231], a[188:191], v[100:103]
v_accvgpr_write_b32 a122, 0
v_accvgpr_write_b32 a123, 0
v_accvgpr_write_b32 a124, 0
v_mfma_f32_16x16x32_bf16 v[104:107], a[232:235], a[188:191], v[104:107]
v_accvgpr_write_b32 a125, 0
v_accvgpr_write_b32 a126, 0
v_accvgpr_write_b32 a127, 0
v_mfma_f32_16x16x32_bf16 v[108:111], a[236:239], a[188:191], v[108:111]
v_mfma_f32_16x16x32_bf16 v[112:115], a[240:243], a[188:191], v[112:115]
v_cvt_pk_bf16_f32 v160, v64, v65
v_cvt_pk_bf16_f32 v161, v66, v67
v_cvt_pk_bf16_f32 v162, v68, v69
v_cvt_pk_bf16_f32 v163, v70, v71
v_mfma_f32_16x16x32_bf16 v[116:119], a[244:247], a[188:191], v[116:119]
v_cvt_pk_bf16_f32 v164, v72, v73
v_cvt_pk_bf16_f32 v165, v74, v75
v_cvt_pk_bf16_f32 v166, v76, v77
v_cvt_pk_bf16_f32 v167, v78, v79
v_mfma_f32_16x16x32_bf16 v[120:123], a[248:251], a[188:191], v[120:123]
v_cvt_pk_bf16_f32 v168, v80, v81
v_cvt_pk_bf16_f32 v169, v82, v83
v_cvt_pk_bf16_f32 v170, v84, v85
v_cvt_pk_bf16_f32 v171, v86, v87
v_mfma_f32_16x16x32_bf16 v[124:127], a[252:255], a[188:191], v[124:127]
v_cvt_pk_bf16_f32 v172, v88, v89
v_cvt_pk_bf16_f32 v173, v90, v91
v_cvt_pk_bf16_f32 v174, v92, v93
v_cvt_pk_bf16_f32 v175, v94, v95
LphC:
s_nop 1
v_cvt_pk_bf16_f32 v176, v96, v97
v_cvt_pk_bf16_f32 v177, v98, v99
v_cvt_pk_bf16_f32 v178, v100, v101
v_cvt_pk_bf16_f32 v179, v102, v103
v_cvt_pk_bf16_f32 v180, v104, v105
v_cvt_pk_bf16_f32 v181, v106, v107
v_cvt_pk_bf16_f32 v182, v108, v109
v_cvt_pk_bf16_f32 v183, v110, v111
v_cvt_pk_bf16_f32 v184, v112, v113
v_cvt_pk_bf16_f32 v185, v114, v115
v_cvt_pk_bf16_f32 v186, v116, v117
v_cvt_pk_bf16_f32 v187, v118, v119
v_cvt_pk_bf16_f32 v188, v120, v121
v_cvt_pk_bf16_f32 v189, v122, v123
v_cvt_pk_bf16_f32 v190, v124, v125
v_cvt_pk_bf16_f32 v191, v126, v127
s_waitcnt lgkmcnt(4)
v_mfma_f32_16x16x32_bf16 v[4:7], a[192:195], v[144:147], 0
s_and_b32 m0, s68, 0xffff
ds_read_b128 a[224:227], v217 offset:8192
ds_read_b128 a[228:231], v217 offset:9216
ds_read_b128 a[232:235], v217 offset:10240
v_mfma_f32_16x16x32_bf16 v[4:7], a[196:199], v[148:151], v[4:7]
s_xor_b32 m0, m0, 0x18000
v_lshrrev_b32 v241, 2, v220
v_lshlrev_b32 v240, 7, v241
Lch1_0:
Lpad13:
s_cbranch_execz Lpad17
v_mfma_f32_16x16x32_bf16 v[4:7], a[200:203], v[152:155], v[4:7]
v_mul_f32 v112, s70, v224
v_mul_f32 v113, s70, v225
v_mfma_f32_16x16x32_bf16 v[4:7], a[204:207], v[156:159], v[4:7]
v_mul_f32 v114, s70, v226
v_mul_f32 v115, s70, v227
v_mfma_f32_16x16x32_bf16 v[8:11], a[204:207], v[172:175], 0
ds_read_b128 a[236:239], v217 offset:11264
v_bfe_u32 v241, v220, 3, 2
v_mfma_f32_16x16x32_bf16 v[8:11], a[200:203], v[168:171], v[8:11]
buffer_load_dwordx4 v216, s[12:15], s68 offen offset:0 lds
v_mfma_f32_16x16x32_bf16 v[8:11], a[196:199], v[164:167], v[8:11]
buffer_load_dwordx4 v216, s[12:15], s68 offen offset:1024 lds
v_mfma_f32_16x16x32_bf16 v[8:11], a[192:195], v[160:163], v[8:11]
v_lshl_add_u32 v240, v241, 5, v240
v_and_b32 v241, 3, v220
v_mfma_f32_16x16x32_bf16 v[12:15], a[192:195], v[176:179], 0
buffer_load_dwordx4 v216, s[12:15], s68 offen offset:2048 lds
v_mfma_f32_16x16x32_bf16 v[12:15], a[196:199], v[180:183], v[12:15]
v_lshl_add_u32 v240, v241, 3, v240
v_add_u32 v240, s61, v240
v_mfma_f32_16x16x32_bf16 v[12:15], a[200:203], v[184:187], v[12:15]
v_bfe_u32 v242, v220, 1, 2
v_lshrrev_b32 v241, 4, v220
v_mfma_f32_16x16x32_bf16 v[12:15], a[204:207], v[188:191], v[12:15]
v_xor_b32 v242, v242, v241
v_lshlrev_b32 v242, 5, v242
v_mfma_f32_16x16x32_bf16 v[0:3], a[204:207], v[140:143], v[112:115]
buffer_load_dwordx4 v216, s[12:15], s68 offen offset:3072 lds
v_mfma_f32_16x16x32_bf16 v[0:3], a[200:203], v[136:139], v[0:3]
s_xor_b32 m0, m0, 0x18000
v_and_b32 v241, 1, v220
v_lshl_add_u32 v242, v241, 4, v242
v_mfma_f32_16x16x32_bf16 v[0:3], a[196:199], v[132:135], v[0:3]
v_lshrrev_b32 v241, 3, v220
v_mad_u32_u24 v242, v241, s96, v242
v_mfma_f32_16x16x32_bf16 v[0:3], a[192:195], v[128:131], v[0:3]
s_waitcnt lgkmcnt(4)
ds_read_b128 a[240:243], v217 offset:12288
ds_read_b128 a[244:247], v217 offset:13312
v_mfma_f32_16x16x32_bf16 v[20:23], a[208:211], v[144:147], 0
buffer_load_dwordx4 v216, s[8:11], s68 offen offset:0 lds
v_mfma_f32_16x16x32_bf16 v[20:23], a[212:215], v[148:151], v[20:23]
s_lshl_b32 s96, s96, 3
ds_read_b128 a[248:251], v217 offset:14336
ds_read_b128 a[252:255], v217 offset:15360
v_mfma_f32_16x16x32_bf16 v[20:23], a[216:219], v[152:155], v[20:23]
s_sub_u32 s96, s96, 1024
v_mul_f32 v116, s70, v228
v_mul_f32 v117, s70, v229
v_mfma_f32_16x16x32_bf16 v[20:23], a[220:223], v[156:159], v[20:23]
v_mul_f32 v118, s70, v230
v_mul_f32 v119, s70, v231
v_mfma_f32_16x16x32_bf16 v[24:27], a[220:223], v[172:175], 0
buffer_load_dwordx4 v216, s[8:11], s68 offen offset:1024 lds
v_mfma_f32_16x16x32_bf16 v[24:27], a[216:219], v[168:171], v[24:27]
v_add_u32 v243, s96, v242
v_add_u32 v244, s96, v243
v_mfma_f32_16x16x32_bf16 v[24:27], a[212:215], v[164:167], v[24:27]
v_add_u32 v245, s96, v244
v_and_b32 v252, 3, v220
v_mfma_f32_16x16x32_bf16 v[24:27], a[208:211], v[160:163], v[24:27]
buffer_load_dwordx4 v216, s[8:11], s68 offen offset:2048 lds
v_mfma_f32_16x16x32_bf16 v[28:31], a[208:211], v[176:179], 0
v_subrev_u32 v252, 1, v252
v_ashrrev_i32 v252, 31, v252
v_mfma_f32_16x16x32_bf16 v[28:31], a[212:215], v[180:183], v[28:31]
v_mov_b32 v246, v216
v_add_u32 v247, s97, v246
v_mfma_f32_16x16x32_bf16 v[28:31], a[216:219], v[184:187], v[28:31]
v_add_u32 v248, s97, v247
v_add_u32 v249, s97, v248
v_mfma_f32_16x16x32_bf16 v[28:31], a[220:223], v[188:191], v[28:31]
buffer_load_dwordx4 v216, s[8:11], s68 offen offset:3072 lds
v_mfma_f32_16x16x32_bf16 v[16:19], a[220:223], v[140:143], v[116:119]
s_add_u32 s68, s68, 16384
v_accvgpr_write_b32 a128, 0
v_accvgpr_write_b32 a129, 0
v_mfma_f32_16x16x32_bf16 v[16:19], a[216:219], v[136:139], v[16:19]
v_accvgpr_write_b32 a130, 0
v_accvgpr_write_b32 a131, 0
v_mfma_f32_16x16x32_bf16 v[16:19], a[212:215], v[132:135], v[16:19]
v_accvgpr_write_b32 a132, 0
v_accvgpr_write_b32 a133, 0
v_mfma_f32_16x16x32_bf16 v[16:19], a[208:211], v[128:131], v[16:19]
s_waitcnt lgkmcnt(4)
v_accvgpr_write_b32 a134, 0
v_accvgpr_write_b32 a135, 0
v_accvgpr_write_b32 a136, 0
v_accvgpr_write_b32 a137, 0
v_accvgpr_write_b32 a138, 0
v_accvgpr_write_b32 a139, 0
v_accvgpr_write_b32 a140, 0
v_max3_f32 v209, v4, v5, v6
v_max3_f32 v209, v209, v7, v20
v_max3_f32 v209, v209, v21, v22
v_max_f32 v209, v209, v23
v_max3_f32 v210, v8, v9, v10
v_max3_f32 v210, v210, v11, v24
v_max3_f32 v210, v210, v25, v26
v_max_f32 v210, v210, v27
v_max3_f32 v211, v12, v13, v14
v_max3_f32 v211, v211, v15, v28
v_max3_f32 v211, v211, v29, v30
v_max_f32 v211, v211, v31
v_max3_f32 v208, v0, v1, v2
v_max3_f32 v208, v208, v3, v16
v_max3_f32 v208, v208, v17, v18
v_max_f32 v208, v208, v19
v_mov_b32 v212, v208
v_mov_b32 v213, v209
v_mov_b32 v214, v210
v_mov_b32 v215, v211
v_accvgpr_write_b32 a141, 0
v_accvgpr_write_b32 a142, 0
v_accvgpr_write_b32 a143, 0
v_and_b32 v252, 0x3f803f80, v252
v_permlane32_swap_b32 v208, v212
v_permlane32_swap_b32 v209, v213
v_permlane32_swap_b32 v210, v214
v_permlane32_swap_b32 v211, v215
v_max_f32 v208, v208, v212
v_max_f32 v209, v209, v213
v_max_f32 v210, v210, v214
v_max_f32 v211, v211, v215
v_mov_b32 v212, v208
v_mov_b32 v213, v209
v_mov_b32 v214, v210
v_mov_b32 v215, v211
v_accvgpr_write_b32 a144, v252
v_accvgpr_write_b32 a145, v252
v_accvgpr_write_b32 a146, v252
v_accvgpr_write_b32 a147, v252
v_permlane16_swap_b32 v208, v212
v_permlane16_swap_b32 v209, v213
v_permlane16_swap_b32 v210, v214
v_permlane16_swap_b32 v211, v215
v_max_f32 v208, v208, v212
v_max_f32 v209, v209, v213
v_max_f32 v210, v210, v214
v_max_f32 v211, v211, v215
v_pk_add_f32 v[96:97], 0, v[208:209] op_sel:[0,0] op_sel_hi:[1,0] neg_lo:[0,1] neg_hi:[0,1]
v_pk_add_f32 v[98:99], 0, v[208:209] op_sel:[0,0] op_sel_hi:[1,0] neg_lo:[0,1] neg_hi:[0,1]
v_pk_add_f32 v[0:1], v[0:1], v[208:209] op_sel:[0,0] op_sel_hi:[1,0] neg_lo:[0,1] neg_hi:[0,1]
v_pk_add_f32 v[2:3], v[2:3], v[208:209] op_sel:[0,0] op_sel_hi:[1,0] neg_lo:[0,1] neg_hi:[0,1]
v_pk_add_f32 v[16:17], v[16:17], v[208:209] op_sel:[0,0] op_sel_hi:[1,0] neg_lo:[0,1] neg_hi:[0,1]
v_pk_add_f32 v[18:19], v[18:19], v[208:209] op_sel:[0,0] op_sel_hi:[1,0] neg_lo:[0,1] neg_hi:[0,1]
v_pk_add_f32 v[100:101], 0, v[208:209] op_sel:[0,1] op_sel_hi:[1,1] neg_lo:[0,1] neg_hi:[0,1]
v_pk_add_f32 v[102:103], 0, v[208:209] op_sel:[0,1] op_sel_hi:[1,1] neg_lo:[0,1] neg_hi:[0,1]
v_pk_add_f32 v[4:5], v[4:5], v[208:209] op_sel:[0,1] op_sel_hi:[1,1] neg_lo:[0,1] neg_hi:[0,1]
v_pk_add_f32 v[6:7], v[6:7], v[208:209] op_sel:[0,1] op_sel_hi:[1,1] neg_lo:[0,1] neg_hi:[0,1]
v_pk_add_f32 v[20:21], v[20:21], v[208:209] op_sel:[0,1] op_sel_hi:[1,1] neg_lo:[0,1] neg_hi:[0,1]
v_pk_add_f32 v[22:23], v[22:23], v[208:209] op_sel:[0,1] op_sel_hi:[1,1] neg_lo:[0,1] neg_hi:[0,1]
v_pk_add_f32 v[104:105], 0, v[210:211] op_sel:[0,0] op_sel_hi:[1,0] neg_lo:[0,1] neg_hi:[0,1]
v_pk_add_f32 v[106:107], 0, v[210:211] op_sel:[0,0] op_sel_hi:[1,0] neg_lo:[0,1] neg_hi:[0,1]
v_pk_add_f32 v[8:9], v[8:9], v[210:211] op_sel:[0,0] op_sel_hi:[1,0] neg_lo:[0,1] neg_hi:[0,1]
v_pk_add_f32 v[10:11], v[10:11], v[210:211] op_sel:[0,0] op_sel_hi:[1,0] neg_lo:[0,1] neg_hi:[0,1]
v_pk_add_f32 v[24:25], v[24:25], v[210:211] op_sel:[0,0] op_sel_hi:[1,0] neg_lo:[0,1] neg_hi:[0,1]
v_pk_add_f32 v[26:27], v[26:27], v[210:211] op_sel:[0,0] op_sel_hi:[1,0] neg_lo:[0,1] neg_hi:[0,1]
v_pk_add_f32 v[108:109], 0, v[210:211] op_sel:[0,1] op_sel_hi:[1,1] neg_lo:[0,1] neg_hi:[0,1]
v_pk_add_f32 v[110:111], 0, v[210:211] op_sel:[0,1] op_sel_hi:[1,1] neg_lo:[0,1] neg_hi:[0,1]
v_pk_add_f32 v[12:13], v[12:13], v[210:211] op_sel:[0,1] op_sel_hi:[1,1] neg_lo:[0,1] neg_hi:[0,1]
v_pk_add_f32 v[14:15], v[14:15], v[210:211] op_sel:[0,1] op_sel_hi:[1,1] neg_lo:[0,1] neg_hi:[0,1]
v_pk_add_f32 v[28:29], v[28:29], v[210:211] op_sel:[0,1] op_sel_hi:[1,1] neg_lo:[0,1] neg_hi:[0,1]
v_pk_add_f32 v[30:31], v[30:31], v[210:211] op_sel:[0,1] op_sel_hi:[1,1] neg_lo:[0,1] neg_hi:[0,1]
s_waitcnt vmcnt(4) lgkmcnt(0)
s_barrier
v_mfma_f32_16x16x32_bf16 v[36:39], a[224:227], v[144:147], v[100:103]
s_and_b32 m0, s68, 0xffff
v_add_u32 v217, 16384, v217
v_and_b32 v217, 0xffff, v217
ds_read_b128 a[192:195], v217 offset:0
ds_read_b128 a[196:199], v217 offset:1024
ds_read_b128 a[200:203], v217 offset:2048
s_cmp_lg_u32 s3, 0
s_cbranch_scc1 Ls3bd
s_lshl_b32 s6, s5, 2
v_add_u32 v219, s6, v221
s_mov_b64 exec, 1
s_cmp_eq_u32 s39, 1
s_cbranch_scc1 Ls3bl
Ls3bf:
global_store_dword v219, v223, s[66:67] offset:160 sc1
s_branch Ls3be
Ls3bl:
global_store_dword v219, v223, s[66:67] offset:160
Ls3be:
s_mov_b64 exec, -1
Ls3bd:
v_mfma_f32_16x16x32_bf16 v[36:39], a[228:231], v[148:151], v[36:39]
buffer_load_dwordx4 v216, s[8:11], s68 offen offset:0 lds
v_exp_f32 v208, v0
v_mfma_f32_16x16x32_bf16 v[36:39], a[232:235], v[152:155], v[36:39]
v_fma_f32 v120, s70, v232, v96
v_fma_f32 v121, s70, v233, v97
v_fma_f32 v122, s70, v234, v98
v_fma_f32 v123, s70, v235, v99
v_mfma_f32_16x16x32_bf16 v[36:39], a[236:239], v[156:159], v[36:39]
ds_read_b128 a[204:207], v217 offset:3072
buffer_load_dwordx4 v216, s[8:11], s68 offen offset:1024 lds
v_exp_f32 v209, v1
v_mfma_f32_16x16x32_bf16 v[40:43], a[236:239], v[172:175], v[104:107]
buffer_load_dwordx4 v216, s[8:11], s68 offen offset:2048 lds
v_cvt_pk_bf16_f32 v64, v208, v209
v_add_u32 v222, 32, v222
v_mfma_f32_16x16x32_bf16 v[40:43], a[232:235], v[168:171], v[40:43]
v_exp_f32 v210, v2
v_exp_f32 v211, v3
v_mfma_f32_16x16x32_bf16 v[40:43], a[228:231], v[164:167], v[40:43]
buffer_load_dwordx4 v216, s[8:11], s68 offen offset:3072 lds
v_cvt_pk_bf16_f32 v65, v210, v211
s_xor_b32 m0, m0, 0x18000
v_mfma_f32_16x16x32_bf16 v[40:43], a[224:227], v[160:163], v[40:43]
v_exp_f32 v212, v16
v_exp_f32 v213, v17
v_mfma_f32_16x16x32_bf16 v[44:47], a[224:227], v[176:179], v[108:111]
buffer_load_dwordx4 v216, s[12:15], s68 offen offset:0 lds
v_exp_f32 v214, v18
v_mfma_f32_16x16x32_bf16 v[44:47], a[228:231], v[180:183], v[44:47]
v_exp_f32 v215, v19
v_exp_f32 v208, v4
v_mfma_f32_16x16x32_bf16 v[44:47], a[232:235], v[184:187], v[44:47]
buffer_load_dwordx4 v216, s[12:15], s68 offen offset:1024 lds
v_cvt_pk_bf16_f32 v66, v212, v213
v_exp_f32 v209, v5
v_mfma_f32_16x16x32_bf16 v[44:47], a[236:239], v[188:191], v[44:47]
v_cvt_pk_bf16_f32 v67, v214, v215
v_cvt_pk_bf16_f32 v68, v208, v209
v_exp_f32 v210, v6
v_mfma_f32_16x16x32_bf16 v[32:35], a[236:239], v[140:143], v[120:123]
buffer_load_dwordx4 v216, s[12:15], s68 offen offset:2048 lds
v_exp_f32 v211, v7
v_mfma_f32_16x16x32_bf16 v[32:35], a[232:235], v[136:139], v[32:35]
v_cvt_pk_bf16_f32 v69, v210, v211
v_exp_f32 v212, v20
v_exp_f32 v213, v21
v_mfma_f32_16x16x32_bf16 v[32:35], a[228:231], v[132:135], v[32:35]
buffer_load_dwordx4 v216, s[12:15], s68 offen offset:3072 lds
v_cvt_pk_bf16_f32 v70, v212, v213
s_add_u32 s68, s68, 16384
v_mfma_f32_16x16x32_bf16 v[32:35], a[224:227], v[128:131], v[32:35]
s_waitcnt lgkmcnt(4)
ds_read_b128 a[208:211], v217 offset:4096
ds_read_b128 a[212:215], v217 offset:5120
ds_read_b128 a[216:219], v217 offset:6144
ds_read_b128 a[220:223], v217 offset:7168
v_mfma_f32_16x16x32_bf16 v[52:55], a[240:243], v[144:147], v[100:103]
s_and_b32 m0, s68, 0xffff
v_exp_f32 v214, v22
v_exp_f32 v215, v23
v_mfma_f32_16x16x32_bf16 v[52:55], a[244:247], v[148:151], v[52:55]
buffer_load_dwordx4 v216, s[8:11], s68 offen offset:0 lds
buffer_load_dwordx4 v216, s[8:11], s68 offen offset:1024 lds
v_mfma_f32_16x16x32_bf16 v[52:55], a[248:251], v[152:155], v[52:55]
v_fma_f32 v124, s70, v236, v96
v_fma_f32 v125, s70, v237, v97
v_fma_f32 v126, s70, v238, v98
v_fma_f32 v127, s70, v239, v99
v_mfma_f32_16x16x32_bf16 v[52:55], a[252:255], v[156:159], v[52:55]
buffer_load_dwordx4 v216, s[8:11], s68 offen offset:2048 lds
v_cvt_pk_bf16_f32 v71, v214, v215
v_exp_f32 v208, v8
v_mfma_f32_16x16x32_bf16 v[56:59], a[252:255], v[172:175], v[104:107]
v_exp_f32 v209, v9
v_exp_f32 v210, v10
v_mfma_f32_16x16x32_bf16 v[56:59], a[248:251], v[168:171], v[56:59]
buffer_load_dwordx4 v216, s[8:11], s68 offen offset:3072 lds
v_cvt_pk_bf16_f32 v72, v208, v209
v_exp_f32 v211, v11
v_mfma_f32_16x16x32_bf16 v[56:59], a[244:247], v[164:167], v[56:59]
s_xor_b32 m0, m0, 0x18000
v_exp_f32 v212, v24
v_exp_f32 v213, v25
v_mfma_f32_16x16x32_bf16 v[56:59], a[240:243], v[160:163], v[56:59]
buffer_load_dwordx4 v216, s[12:15], s68 offen offset:0 lds
v_cvt_pk_bf16_f32 v73, v210, v211
v_cvt_pk_bf16_f32 v74, v212, v213
v_mfma_f32_16x16x32_bf16 v[60:63], a[240:243], v[176:179], v[108:111]
v_exp_f32 v214, v26
v_exp_f32 v215, v27
v_mfma_f32_16x16x32_bf16 v[60:63], a[244:247], v[180:183], v[60:63]
buffer_load_dwordx4 v216, s[12:15], s68 offen offset:1024 lds
v_exp_f32 v208, v12
v_mfma_f32_16x16x32_bf16 v[60:63], a[248:251], v[184:187], v[60:63]
v_cvt_pk_bf16_f32 v75, v214, v215
v_exp_f32 v209, v13
v_exp_f32 v210, v14
v_mfma_f32_16x16x32_bf16 v[60:63], a[252:255], v[188:191], v[60:63]
buffer_load_dwordx4 v216, s[12:15], s68 offen offset:2048 lds
v_exp_f32 v211, v15
v_mfma_f32_16x16x32_bf16 v[48:51], a[252:255], v[140:143], v[124:127]
v_cvt_pk_bf16_f32 v76, v208, v209
v_exp_f32 v212, v28
v_exp_f32 v213, v29
v_mfma_f32_16x16x32_bf16 v[48:51], a[248:251], v[136:139], v[48:51]
buffer_load_dwordx4 v216, s[12:15], s68 offen offset:3072 lds
v_cvt_pk_bf16_f32 v77, v210, v211
v_cvt_pk_bf16_f32 v78, v212, v213
v_mfma_f32_16x16x32_bf16 v[48:51], a[244:247], v[132:135], v[48:51]
s_add_u32 s68, s68, 16384
v_exp_f32 v214, v30
v_exp_f32 v215, v31
v_mfma_f32_16x16x32_bf16 v[48:51], a[240:243], v[128:131], v[48:51]
s_waitcnt lgkmcnt(4)
v_cvt_pk_bf16_f32 v79, v214, v215
s_cmp_ge_u32 s5, 4
s_cselect_b32 s99, 8, 100
s_cmp_eq_u32 s3, 0
s_cselect_b32 s99, s99, 100
s_lshl_b32 s71, s5, 1
s_sub_u32 s71, s71, 1
s_cmp_eq_u32 s5, 7
s_cselect_b32 s70, 1.0, 0
s_cmp_ge_u32 s5, 4
s_cbranch_scc1 LloopR0
Lntouch:
s_cmp_eq_u32 s5, 0
s_cbranch_scc1 LmaskB
s_branch Lloop1
LloopR0:
s_waitcnt vmcnt(8)
s_nop 0
s_nop 0
s_nop 0
LloopR:
v_mfma_f32_16x16x32_bf16 v[0:3], a[192:195], v[128:131], v[96:99]
s_mov_b32 m0, s61
v_add_u32 v219, 16384, v218
v_bfi_b32 v218, s69, v219, v218
v_mfma_f32_16x16x32_bf16 v[0:3], a[196:199], v[132:135], v[0:3]
ds_read_b128 a[224:227], v218 offset:0
ds_read_b128 a[228:231], v218 offset:1024
v_mfma_f32_16x16x32_bf16 v[0:3], a[200:203], v[136:139], v[0:3]
buffer_load_dwordx4 v242, s[16:19], s101 offen offset:0 lds
v_mfma_f32_16x16x32_bf16 v[0:3], a[204:207], v[140:143], v[0:3]
ds_read_b128 a[232:235], v218 offset:2048
ds_read_b128 a[236:239], v218 offset:3072
v_mfma_f32_16x16x32_bf16 v[4:7], a[204:207], v[156:159], v[100:103]
v_exp_f32 v208, v32
v_mfma_f32_16x16x32_bf16 v[4:7], a[200:203], v[152:155], v[4:7]
v_exp_f32 v209, v33
v_mfma_f32_16x16x32_bf16 v[4:7], a[196:199], v[148:151], v[4:7]
v_exp_f32 v210, v34
v_mfma_f32_16x16x32_bf16 v[4:7], a[192:195], v[144:147], v[4:7]
buffer_load_dwordx4 v243, s[16:19], s101 offen offset:1024 lds
v_mfma_f32_16x16x32_bf16 v[8:11], a[192:195], v[160:163], v[104:107]
v_exp_f32 v211, v35
v_mfma_f32_16x16x32_bf16 v[8:11], a[196:199], v[164:167], v[8:11]
v_cvt_pk_bf16_f32 v80, v208, v209
v_cvt_pk_bf16_f32 v81, v210, v211
v_mfma_f32_16x16x32_bf16 v[8:11], a[200:203], v[168:171], v[8:11]
v_exp_f32 v212, v48
v_mfma_f32_16x16x32_bf16 v[8:11], a[204:207], v[172:175], v[8:11]
v_exp_f32 v213, v49
v_mfma_f32_16x16x32_bf16 v[12:15], a[204:207], v[188:191], v[108:111]
buffer_load_dwordx4 v244, s[16:19], s101 offen offset:2048 lds
v_mfma_f32_16x16x32_bf16 v[12:15], a[200:203], v[184:187], v[12:15]
v_exp_f32 v214, v50
v_mfma_f32_16x16x32_bf16 v[12:15], a[196:199], v[180:183], v[12:15]
v_exp_f32 v215, v51
v_mfma_f32_16x16x32_bf16 v[12:15], a[192:195], v[176:179], v[12:15]
s_waitcnt lgkmcnt(4)
ds_read_b128 a[240:243], v218 offset:4096
v_cvt_pk_bf16_f32 v82, v212, v213
v_mfma_f32_16x16x32_bf16 v[28:31], a[208:211], v[176:179], v[108:111]
ds_read_b128 a[244:247], v218 offset:5120
v_cvt_pk_bf16_f32 v83, v214, v215
v_mfma_f32_16x16x32_bf16 v[28:31], a[212:215], v[180:183], v[28:31]
buffer_load_dwordx4 v245, s[16:19], s101 offen offset:3072 lds
v_mfma_f32_16x16x32_bf16 v[28:31], a[216:219], v[184:187], v[28:31]
s_add_u32 s101, s101, s54
ds_read_b128 a[248:251], v218 offset:6144
ds_read_b128 a[252:255], v218 offset:7168
v_mfma_f32_16x16x32_bf16 v[28:31], a[220:223], v[188:191], v[28:31]
s_xor_b32 s61, s61, 4096
s_sub_u32 s71, s71, 1
s_add_u32 s38, s38, 1
v_mfma_f32_16x16x32_bf16 v[24:27], a[220:223], v[172:175], v[104:107]
s_cmp_ge_u32 s38, 3
s_cselect_b32 s26, s98, 0
v_mfma_f32_16x16x32_bf16 v[24:27], a[216:219], v[168:171], v[24:27]
s_cmp_ge_u32 s38, 3
s_cselect_b32 s7, s55, 0
v_mfma_f32_16x16x32_bf16 v[24:27], a[212:215], v[164:167], v[24:27]
v_exp_f32 v208, v36
v_mfma_f32_16x16x32_bf16 v[24:27], a[208:211], v[160:163], v[24:27]
v_exp_f32 v209, v37
v_mfma_f32_16x16x32_bf16 v[20:23], a[208:211], v[144:147], v[100:103]
v_exp_f32 v210, v38
v_mfma_f32_16x16x32_bf16 v[20:23], a[212:215], v[148:151], v[20:23]
v_exp_f32 v211, v39
v_mfma_f32_16x16x32_bf16 v[20:23], a[216:219], v[152:155], v[20:23]
v_cvt_pk_bf16_f32 v84, v208, v209
v_cvt_pk_bf16_f32 v85, v210, v211
v_mfma_f32_16x16x32_bf16 v[20:23], a[220:223], v[156:159], v[20:23]
v_exp_f32 v212, v52
v_mfma_f32_16x16x32_bf16 v[16:19], a[220:223], v[140:143], v[96:99]
global_load_dword v253, v222, s[66:67] sc1
v_mfma_f32_16x16x32_bf16 v[16:19], a[216:219], v[136:139], v[16:19]
v_exp_f32 v213, v53
v_mfma_f32_16x16x32_bf16 v[16:19], a[212:215], v[132:135], v[16:19]
v_exp_f32 v214, v54
v_mfma_f32_16x16x32_bf16 v[16:19], a[208:211], v[128:131], v[16:19]
s_waitcnt lgkmcnt(4)
v_exp_f32 v215, v55
v_mfma_f32_16x16x32_bf16 a[0:3], a[224:227], v[64:67], a[0:3]
ds_read_b128 a[192:195], v217 offset:8192
v_cvt_pk_bf16_f32 v86, v212, v213
v_mfma_f32_16x16x32_bf16 a[4:7], a[228:231], v[64:67], a[4:7]
ds_read_b128 a[196:199], v217 offset:9216
v_cvt_pk_bf16_f32 v87, v214, v215
v_mfma_f32_16x16x32_bf16 a[36:39], a[228:231], v[68:71], a[36:39]
buffer_store_dwordx4 a[160:163], v246, s[24:27], s100 offen sc1
v_mfma_f32_16x16x32_bf16 a[32:35], a[224:227], v[68:71], a[32:35]
ds_read_b128 a[200:203], v217 offset:10240
ds_read_b128 a[204:207], v217 offset:11264
v_mfma_f32_16x16x32_bf16 a[64:67], a[224:227], v[72:75], a[64:67]
v_exp_f32 v208, v40
v_mfma_f32_16x16x32_bf16 a[68:71], a[228:231], v[72:75], a[68:71]
v_exp_f32 v209, v41
v_mfma_f32_16x16x32_bf16 a[100:103], a[228:231], v[76:79], a[100:103]
v_exp_f32 v210, v42
v_mfma_f32_16x16x32_bf16 a[96:99], a[224:227], v[76:79], a[96:99]
v_exp_f32 v211, v43
v_mfma_f32_16x16x32_bf16 a[104:107], a[232:235], v[76:79], a[104:107]
v_cvt_pk_bf16_f32 v88, v208, v209
v_cvt_pk_bf16_f32 v89, v210, v211
v_mfma_f32_16x16x32_bf16 a[108:111], a[236:239], v[76:79], a[108:111]
buffer_store_dwordx4 a[164:167], v247, s[24:27], s100 offen sc1
v_mfma_f32_16x16x32_bf16 a[76:79], a[236:239], v[72:75], a[76:79]
v_exp_f32 v212, v56
v_mfma_f32_16x16x32_bf16 a[72:75], a[232:235], v[72:75], a[72:75]
v_exp_f32 v213, v57
v_mfma_f32_16x16x32_bf16 a[40:43], a[232:235], v[68:71], a[40:43]
v_exp_f32 v214, v58
v_mfma_f32_16x16x32_bf16 a[44:47], a[236:239], v[68:71], a[44:47]
v_exp_f32 v215, v59
v_mfma_f32_16x16x32_bf16 a[12:15], a[236:239], v[64:67], a[12:15]
v_cvt_pk_bf16_f32 v90, v212, v213
v_cvt_pk_bf16_f32 v91, v214, v215
v_mfma_f32_16x16x32_bf16 a[8:11], a[232:235], v[64:67], a[8:11]
s_waitcnt lgkmcnt(4)
ds_read_b128 a[208:211], v217 offset:12288
ds_read_b128 a[212:215], v217 offset:13312
v_mfma_f32_16x16x32_bf16 a[16:19], a[240:243], v[64:67], a[16:19]
v_exp_f32 v208, v44
v_mfma_f32_16x16x32_bf16 a[20:23], a[244:247], v[64:67], a[20:23]
ds_read_b128 a[216:219], v217 offset:14336
ds_read_b128 a[220:223], v217 offset:15360
v_mfma_f32_16x16x32_bf16 a[52:55], a[244:247], v[68:71], a[52:55]
buffer_store_dwordx4 a[168:171], v248, s[24:27], s100 offen sc1
v_mfma_f32_16x16x32_bf16 a[48:51], a[240:243], v[68:71], a[48:51]
v_exp_f32 v209, v45
v_mfma_f32_16x16x32_bf16 a[80:83], a[240:243], v[72:75], a[80:83]
v_exp_f32 v210, v46
v_mfma_f32_16x16x32_bf16 a[84:87], a[244:247], v[72:75], a[84:87]
v_exp_f32 v211, v47
v_mfma_f32_16x16x32_bf16 a[116:119], a[244:247], v[76:79], a[116:119]
v_cvt_pk_bf16_f32 v92, v208, v209
v_cvt_pk_bf16_f32 v93, v210, v211
v_mfma_f32_16x16x32_bf16 a[112:115], a[240:243], v[76:79], a[112:115]
v_exp_f32 v212, v60
v_mfma_f32_16x16x32_bf16 a[120:123], a[248:251], v[76:79], a[120:123]
v_exp_f32 v213, v61
v_mfma_f32_16x16x32_bf16 a[124:127], a[252:255], v[76:79], a[124:127]
buffer_store_dwordx4 a[172:175], v249, s[24:27], s100 offen sc1
v_mfma_f32_16x16x32_bf16 a[92:95], a[252:255], v[72:75], a[92:95]
s_add_u32 s100, s100, s7
v_exp_f32 v214, v62
v_mfma_f32_16x16x32_bf16 a[88:91], a[248:251], v[72:75], a[88:91]
s_cmp_lt_u32 s38, 5
s_cselect_b32 s18, s18, 0
v_cvt_pk_bf16_f32 v94, v212, v213
v_mfma_f32_16x16x32_bf16 a[56:59], a[248:251], v[68:71], a[56:59]
v_exp_f32 v215, v63
v_mfma_f32_16x16x32_bf16 a[60:63], a[252:255], v[68:71], a[60:63]
v_cvt_pk_bf16_f32 v95, v214, v215
v_mfma_f32_16x16x32_bf16 a[28:31], a[252:255], v[64:67], a[28:31]
v_mfma_f32_16x16x32_bf16 a[24:27], a[248:251], v[64:67], a[24:27]
v_mfma_f32_16x16x32_bf16 a[128:131], a[144:147], v[64:67], a[128:131]
v_mfma_f32_16x16x32_bf16 a[132:135], a[144:147], v[68:71], a[132:135]
v_mfma_f32_16x16x32_bf16 a[136:139], a[144:147], v[72:75], a[136:139]
v_mfma_f32_16x16x32_bf16 a[140:143], a[144:147], v[76:79], a[140:143]
s_waitcnt lgkmcnt(4)
v_mfma_f32_16x16x32_bf16 v[32:35], a[192:195], v[128:131], v[96:99]
ds_read_b128 a[224:227], v218 offset:8192
ds_read_b128 a[228:231], v218 offset:9216
v_mfma_f32_16x16x32_bf16 v[32:35], a[196:199], v[132:135], v[32:35]
v_exp_f32 v208, v0
v_mfma_f32_16x16x32_bf16 v[32:35], a[200:203], v[136:139], v[32:35]
ds_read_b128 a[232:235], v218 offset:10240
ds_read_b128 a[236:239], v218 offset:11264
v_mfma_f32_16x16x32_bf16 v[32:35], a[204:207], v[140:143], v[32:35]
v_exp_f32 v209, v1
v_mfma_f32_16x16x32_bf16 v[36:39], a[204:207], v[156:159], v[100:103]
v_exp_f32 v210, v2
v_mfma_f32_16x16x32_bf16 v[36:39], a[200:203], v[152:155], v[36:39]
v_exp_f32 v211, v3
v_mfma_f32_16x16x32_bf16 v[36:39], a[196:199], v[148:151], v[36:39]
v_cvt_pk_bf16_f32 v64, v208, v209
v_cvt_pk_bf16_f32 v65, v210, v211
v_mfma_f32_16x16x32_bf16 v[36:39], a[192:195], v[144:147], v[36:39]
v_exp_f32 v212, v16
v_mfma_f32_16x16x32_bf16 v[40:43], a[192:195], v[160:163], v[104:107]
v_exp_f32 v213, v17
v_mfma_f32_16x16x32_bf16 v[40:43], a[196:199], v[164:167], v[40:43]
v_exp_f32 v214, v18
v_mfma_f32_16x16x32_bf16 v[40:43], a[200:203], v[168:171], v[40:43]
v_exp_f32 v215, v19
v_mfma_f32_16x16x32_bf16 v[40:43], a[204:207], v[172:175], v[40:43]
v_cvt_pk_bf16_f32 v66, v212, v213
v_cvt_pk_bf16_f32 v67, v214, v215
v_mfma_f32_16x16x32_bf16 v[44:47], a[204:207], v[188:191], v[108:111]
v_exp_f32 v208, v4
v_mfma_f32_16x16x32_bf16 v[44:47], a[200:203], v[184:187], v[44:47]
v_exp_f32 v209, v5
v_mfma_f32_16x16x32_bf16 v[44:47], a[196:199], v[180:183], v[44:47]
v_exp_f32 v210, v6
v_mfma_f32_16x16x32_bf16 v[44:47], a[192:195], v[176:179], v[44:47]
s_waitcnt lgkmcnt(4)
ds_read_b128 a[240:243], v218 offset:12288
v_cvt_pk_bf16_f32 v68, v208, v209
v_mfma_f32_16x16x32_bf16 v[60:63], a[208:211], v[176:179], v[108:111]
v_exp_f32 v211, v7
v_mfma_f32_16x16x32_bf16 v[60:63], a[212:215], v[180:183], v[60:63]
ds_read_b128 a[244:247], v218 offset:13312
v_cvt_pk_bf16_f32 v69, v210, v211
v_mfma_f32_16x16x32_bf16 v[60:63], a[216:219], v[184:187], v[60:63]
v_exp_f32 v212, v20
v_mfma_f32_16x16x32_bf16 v[60:63], a[220:223], v[188:191], v[60:63]
ds_read_b128 a[248:251], v218 offset:14336
ds_read_b128 a[252:255], v218 offset:15360
v_mfma_f32_16x16x32_bf16 v[56:59], a[220:223], v[172:175], v[104:107]
v_exp_f32 v213, v21
v_mfma_f32_16x16x32_bf16 v[56:59], a[216:219], v[168:171], v[56:59]
v_exp_f32 v214, v22
v_mfma_f32_16x16x32_bf16 v[56:59], a[212:215], v[164:167], v[56:59]
v_exp_f32 v215, v23
v_mfma_f32_16x16x32_bf16 v[56:59], a[208:211], v[160:163], v[56:59]
v_cvt_pk_bf16_f32 v70, v212, v213
v_cvt_pk_bf16_f32 v71, v214, v215
v_mfma_f32_16x16x32_bf16 v[52:55], a[208:211], v[144:147], v[100:103]
v_add_u32 v217, 16384, v217
v_and_b32 v217, 0xffff, v217
v_mfma_f32_16x16x32_bf16 v[52:55], a[212:215], v[148:151], v[52:55]
v_exp_f32 v208, v8
v_mfma_f32_16x16x32_bf16 v[52:55], a[216:219], v[152:155], v[52:55]
v_exp_f32 v209, v9
v_mfma_f32_16x16x32_bf16 v[52:55], a[220:223], v[156:159], v[52:55]
v_exp_f32 v210, v10
v_mfma_f32_16x16x32_bf16 v[48:51], a[220:223], v[140:143], v[96:99]
v_exp_f32 v211, v11
v_mfma_f32_16x16x32_bf16 v[48:51], a[216:219], v[136:139], v[48:51]
v_cvt_pk_bf16_f32 v72, v208, v209
v_cvt_pk_bf16_f32 v73, v210, v211
v_mfma_f32_16x16x32_bf16 v[48:51], a[212:215], v[132:135], v[48:51]
v_exp_f32 v212, v24
v_mfma_f32_16x16x32_bf16 v[48:51], a[208:211], v[128:131], v[48:51]
s_waitcnt vmcnt(22) lgkmcnt(4)
s_barrier
v_mfma_f32_16x16x32_bf16 a[0:3], a[224:227], v[80:83], a[0:3]
s_and_b32 m0, s68, 0xffff
ds_read_b128 a[192:195], v217 offset:0
ds_read_b128 a[196:199], v217 offset:1024
v_mfma_f32_16x16x32_bf16 a[4:7], a[228:231], v[80:83], a[4:7]
buffer_load_dwordx4 v216, s[8:11], s68 offen offset:0 lds
v_mfma_f32_16x16x32_bf16 a[36:39], a[228:231], v[84:87], a[36:39]
ds_read_b128 a[200:203], v217 offset:2048
ds_read_b128 a[204:207], v217 offset:3072
v_mfma_f32_16x16x32_bf16 a[32:35], a[224:227], v[84:87], a[32:35]
v_exp_f32 v213, v25
v_mfma_f32_16x16x32_bf16 a[64:67], a[224:227], v[88:91], a[64:67]
v_exp_f32 v214, v26
v_mfma_f32_16x16x32_bf16 a[68:71], a[228:231], v[88:91], a[68:71]
buffer_load_dwordx4 v216, s[8:11], s68 offen offset:1024 lds
v_mfma_f32_16x16x32_bf16 a[100:103], a[228:231], v[92:95], a[100:103]
v_xor_b32 v240, 4096, v240
v_xor_b32 v241, 0, v240
v_mfma_f32_16x16x32_bf16 a[96:99], a[224:227], v[92:95], a[96:99]
ds_read_b64_tr_b16 a[160:161], v241
v_cvt_pk_bf16_f32 v74, v212, v213
v_mfma_f32_16x16x32_bf16 a[104:107], a[232:235], v[92:95], a[104:107]
ds_read_b64_tr_b16 a[162:163], v241 offset:2048
v_xor_b32 v241, 32, v240
v_mfma_f32_16x16x32_bf16 a[108:111], a[236:239], v[92:95], a[108:111]
buffer_load_dwordx4 v216, s[8:11], s68 offen offset:2048 lds
v_mfma_f32_16x16x32_bf16 a[76:79], a[236:239], v[88:91], a[76:79]
ds_read_b64_tr_b16 a[164:165], v241
ds_read_b64_tr_b16 a[166:167], v241 offset:2048
v_mfma_f32_16x16x32_bf16 a[72:75], a[232:235], v[88:91], a[72:75]
v_xor_b32 v241, 64, v240
ds_read_b64_tr_b16 a[168:169], v241
v_mfma_f32_16x16x32_bf16 a[40:43], a[232:235], v[84:87], a[40:43]
ds_read_b64_tr_b16 a[170:171], v241 offset:2048
v_xor_b32 v241, 96, v240
v_mfma_f32_16x16x32_bf16 a[44:47], a[236:239], v[84:87], a[44:47]
buffer_load_dwordx4 v216, s[8:11], s68 offen offset:3072 lds
v_mfma_f32_16x16x32_bf16 a[12:15], a[236:239], v[80:83], a[12:15]
s_xor_b32 m0, m0, 0x18000
ds_read_b64_tr_b16 a[172:173], v241
ds_read_b64_tr_b16 a[174:175], v241 offset:2048
v_mfma_f32_16x16x32_bf16 a[8:11], a[232:235], v[80:83], a[8:11]
s_waitcnt lgkmcnt(4)
v_exp_f32 v215, v27
v_mfma_f32_16x16x32_bf16 a[16:19], a[240:243], v[80:83], a[16:19]
ds_read_b128 a[208:211], v217 offset:4096
v_cvt_pk_bf16_f32 v75, v214, v215
v_mfma_f32_16x16x32_bf16 a[20:23], a[244:247], v[80:83], a[20:23]
v_exp_f32 v208, v12
v_mfma_f32_16x16x32_bf16 a[52:55], a[244:247], v[84:87], a[52:55]
ds_read_b128 a[212:215], v217 offset:5120
ds_read_b128 a[216:219], v217 offset:6144
v_mfma_f32_16x16x32_bf16 a[48:51], a[240:243], v[84:87], a[48:51]
buffer_load_dwordx4 v216, s[12:15], s68 offen offset:0 lds
v_mfma_f32_16x16x32_bf16 a[80:83], a[240:243], v[88:91], a[80:83]
Lch1_1:
Lpad14:
s_cbranch_execz Lpad18
v_exp_f32 v209, v13
v_mfma_f32_16x16x32_bf16 a[84:87], a[244:247], v[88:91], a[84:87]
ds_read_b128 a[220:223], v217 offset:7168
v_cvt_pk_bf16_f32 v76, v208, v209
v_mfma_f32_16x16x32_bf16 a[116:119], a[244:247], v[92:95], a[116:119]
buffer_load_dwordx4 v216, s[12:15], s68 offen offset:1024 lds
v_mfma_f32_16x16x32_bf16 a[112:115], a[240:243], v[92:95], a[112:115]
v_exp_f32 v210, v14
v_mfma_f32_16x16x32_bf16 a[120:123], a[248:251], v[92:95], a[120:123]
v_exp_f32 v211, v15
v_mfma_f32_16x16x32_bf16 a[124:127], a[252:255], v[92:95], a[124:127]
v_exp_f32 v212, v28
v_mfma_f32_16x16x32_bf16 a[92:95], a[252:255], v[88:91], a[92:95]
buffer_load_dwordx4 v216, s[12:15], s68 offen offset:2048 lds
v_mfma_f32_16x16x32_bf16 a[88:91], a[248:251], v[88:91], a[88:91]
v_exp_f32 v213, v29
v_mfma_f32_16x16x32_bf16 a[56:59], a[248:251], v[84:87], a[56:59]
v_cvt_pk_bf16_f32 v77, v210, v211
v_cvt_pk_bf16_f32 v78, v212, v213
v_mfma_f32_16x16x32_bf16 a[60:63], a[252:255], v[84:87], a[60:63]
v_exp_f32 v214, v30
v_mfma_f32_16x16x32_bf16 a[28:31], a[252:255], v[80:83], a[28:31]
buffer_load_dwordx4 v216, s[12:15], s68 offen offset:3072 lds
v_mfma_f32_16x16x32_bf16 a[24:27], a[248:251], v[80:83], a[24:27]
s_add_u32 s68, s68, 16384
v_exp_f32 v215, v31
v_mfma_f32_16x16x32_bf16 a[128:131], a[144:147], v[80:83], a[128:131]
v_cvt_pk_bf16_f32 v79, v214, v215
v_mfma_f32_16x16x32_bf16 a[132:135], a[144:147], v[84:87], a[132:135]
v_mfma_f32_16x16x32_bf16 a[136:139], a[144:147], v[88:91], a[136:139]
v_mfma_f32_16x16x32_bf16 a[140:143], a[144:147], v[92:95], a[140:143]
s_waitcnt lgkmcnt(4)
s_cmp_lt_u32 s38, 7
s_cbranch_scc1 LloopR
LloopRx:
s_waitcnt vmcnt(12)
v_cmp_gt_u32 vcc, 1, v253
s_mov_b32 s6, 0
s_cmp_eq_u64 vcc, 0
s_cbranch_scc1 Lok12
Lsp13:
s_sleep 2
global_load_dword v253, v222, s[66:67] sc1
s_waitcnt vmcnt(0)
v_cmp_gt_u32 vcc, 1, v253
s_add_u32 s6, s6, 1
s_cmp_gt_u32 s6, 200000
s_cbranch_scc1 Lok12
s_cmp_lg_u64 vcc, 0
s_cbranch_scc1 Lsp13
Lok12:
s_cmp_eq_u32 s71, 0
s_cbranch_scc1 LmaskA
s_nop 0
s_nop 0
Lloop1:
Lch1_2:
Lpad15:
s_cbranch_execz Lpad19
v_mfma_f32_16x16x32_bf16 v[0:3], a[192:195], v[128:131], v[96:99]
s_sub_u32 s71, s71, 1
v_add_u32 v219, 16384, v218
v_bfi_b32 v218, s69, v219, v218
v_mfma_f32_16x16x32_bf16 v[0:3], a[196:199], v[132:135], v[0:3]
s_add_u32 s38, s38, 1
ds_read_b128 a[224:227], v218 offset:0
ds_read_b128 a[228:231], v218 offset:1024
v_mfma_f32_16x16x32_bf16 v[0:3], a[200:203], v[136:139], v[0:3]
v_exp_f32 v208, v32
v_mfma_f32_16x16x32_bf16 v[0:3], a[204:207], v[140:143], v[0:3]
ds_read_b128 a[232:235], v218 offset:2048
ds_read_b128 a[236:239], v218 offset:3072
v_mfma_f32_16x16x32_bf16 v[4:7], a[204:207], v[156:159], v[100:103]
v_exp_f32 v209, v33
v_mfma_f32_16x16x32_bf16 v[4:7], a[200:203], v[152:155], v[4:7]
v_exp_f32 v210, v34
v_mfma_f32_16x16x32_bf16 v[4:7], a[196:199], v[148:151], v[4:7]
v_exp_f32 v211, v35
v_mfma_f32_16x16x32_bf16 v[4:7], a[192:195], v[144:147], v[4:7]
v_cvt_pk_bf16_f32 v80, v208, v209
v_cvt_pk_bf16_f32 v81, v210, v211
v_mfma_f32_16x16x32_bf16 v[8:11], a[192:195], v[160:163], v[104:107]
v_exp_f32 v212, v48
v_mfma_f32_16x16x32_bf16 v[8:11], a[196:199], v[164:167], v[8:11]
v_exp_f32 v213, v49
v_mfma_f32_16x16x32_bf16 v[8:11], a[200:203], v[168:171], v[8:11]
v_exp_f32 v214, v50
v_mfma_f32_16x16x32_bf16 v[8:11], a[204:207], v[172:175], v[8:11]
v_exp_f32 v215, v51
v_mfma_f32_16x16x32_bf16 v[12:15], a[204:207], v[188:191], v[108:111]
v_cvt_pk_bf16_f32 v82, v212, v213
v_cvt_pk_bf16_f32 v83, v214, v215
v_mfma_f32_16x16x32_bf16 v[12:15], a[200:203], v[184:187], v[12:15]
v_exp_f32 v208, v36
v_mfma_f32_16x16x32_bf16 v[12:15], a[196:199], v[180:183], v[12:15]
v_exp_f32 v209, v37
v_mfma_f32_16x16x32_bf16 v[12:15], a[192:195], v[176:179], v[12:15]
s_waitcnt lgkmcnt(4)
ds_read_b128 a[240:243], v218 offset:4096
v_cvt_pk_bf16_f32 v84, v208, v209
v_mfma_f32_16x16x32_bf16 v[28:31], a[208:211], v[176:179], v[108:111]
v_exp_f32 v210, v38
v_mfma_f32_16x16x32_bf16 v[28:31], a[212:215], v[180:183], v[28:31]
ds_read_b128 a[244:247], v218 offset:5120
ds_read_b128 a[248:251], v218 offset:6144
v_mfma_f32_16x16x32_bf16 v[28:31], a[216:219], v[184:187], v[28:31]
v_exp_f32 v211, v39
v_mfma_f32_16x16x32_bf16 v[28:31], a[220:223], v[188:191], v[28:31]
ds_read_b128 a[252:255], v218 offset:7168
v_cvt_pk_bf16_f32 v85, v210, v211
v_mfma_f32_16x16x32_bf16 v[24:27], a[220:223], v[172:175], v[104:107]
v_exp_f32 v212, v52
v_mfma_f32_16x16x32_bf16 v[24:27], a[216:219], v[168:171], v[24:27]
v_exp_f32 v213, v53
v_mfma_f32_16x16x32_bf16 v[24:27], a[212:215], v[164:167], v[24:27]
v_exp_f32 v214, v54
v_mfma_f32_16x16x32_bf16 v[24:27], a[208:211], v[160:163], v[24:27]
v_exp_f32 v215, v55
v_mfma_f32_16x16x32_bf16 v[20:23], a[208:211], v[144:147], v[100:103]
v_cvt_pk_bf16_f32 v86, v212, v213
v_cvt_pk_bf16_f32 v87, v214, v215
v_mfma_f32_16x16x32_bf16 v[20:23], a[212:215], v[148:151], v[20:23]
v_exp_f32 v208, v40
v_mfma_f32_16x16x32_bf16 v[20:23], a[216:219], v[152:155], v[20:23]
v_exp_f32 v209, v41
v_mfma_f32_16x16x32_bf16 v[20:23], a[220:223], v[156:159], v[20:23]
v_exp_f32 v210, v42
v_mfma_f32_16x16x32_bf16 v[16:19], a[220:223], v[140:143], v[96:99]
v_exp_f32 v211, v43
v_mfma_f32_16x16x32_bf16 v[16:19], a[216:219], v[136:139], v[16:19]
v_cvt_pk_bf16_f32 v88, v208, v209
v_cvt_pk_bf16_f32 v89, v210, v211
v_mfma_f32_16x16x32_bf16 v[16:19], a[212:215], v[132:135], v[16:19]
v_exp_f32 v212, v56
v_mfma_f32_16x16x32_bf16 v[16:19], a[208:211], v[128:131], v[16:19]
s_waitcnt lgkmcnt(4)
v_exp_f32 v213, v57
v_mfma_f32_16x16x32_bf16 a[0:3], a[224:227], v[64:67], a[0:3]
ds_read_b128 a[192:195], v217 offset:8192
v_cvt_pk_bf16_f32 v90, v212, v213
v_mfma_f32_16x16x32_bf16 a[4:7], a[228:231], v[64:67], a[4:7]
v_exp_f32 v214, v58
v_mfma_f32_16x16x32_bf16 a[36:39], a[228:231], v[68:71], a[36:39]
ds_read_b128 a[196:199], v217 offset:9216
ds_read_b128 a[200:203], v217 offset:10240
v_mfma_f32_16x16x32_bf16 a[32:35], a[224:227], v[68:71], a[32:35]
v_exp_f32 v215, v59
v_mfma_f32_16x16x32_bf16 a[64:67], a[224:227], v[72:75], a[64:67]
ds_read_b128 a[204:207], v217 offset:11264
v_cvt_pk_bf16_f32 v91, v214, v215
v_mfma_f32_16x16x32_bf16 a[68:71], a[228:231], v[72:75], a[68:71]
v_exp_f32 v208, v44
v_mfma_f32_16x16x32_bf16 a[100:103], a[228:231], v[76:79], a[100:103]
v_exp_f32 v209, v45
v_mfma_f32_16x16x32_bf16 a[96:99], a[224:227], v[76:79], a[96:99]
v_exp_f32 v210, v46
v_mfma_f32_16x16x32_bf16 a[104:107], a[232:235], v[76:79], a[104:107]
v_exp_f32 v211, v47
v_mfma_f32_16x16x32_bf16 a[108:111], a[236:239], v[76:79], a[108:111]
v_cvt_pk_bf16_f32 v92, v208, v209
v_cvt_pk_bf16_f32 v93, v210, v211
v_mfma_f32_16x16x32_bf16 a[76:79], a[236:239], v[72:75], a[76:79]
v_exp_f32 v212, v60
v_mfma_f32_16x16x32_bf16 a[72:75], a[232:235], v[72:75], a[72:75]
v_exp_f32 v213, v61
v_mfma_f32_16x16x32_bf16 a[40:43], a[232:235], v[68:71], a[40:43]
v_exp_f32 v214, v62
v_mfma_f32_16x16x32_bf16 a[44:47], a[236:239], v[68:71], a[44:47]
v_exp_f32 v215, v63
v_mfma_f32_16x16x32_bf16 a[12:15], a[236:239], v[64:67], a[12:15]
v_cvt_pk_bf16_f32 v94, v212, v213
v_cvt_pk_bf16_f32 v95, v214, v215
v_mfma_f32_16x16x32_bf16 a[8:11], a[232:235], v[64:67], a[8:11]
s_waitcnt lgkmcnt(4)
ds_read_b128 a[208:211], v217 offset:12288
ds_read_b128 a[212:215], v217 offset:13312
v_mfma_f32_16x16x32_bf16 a[16:19], a[240:243], v[64:67], a[16:19]
v_mfma_f32_16x16x32_bf16 a[20:23], a[244:247], v[64:67], a[20:23]
ds_read_b128 a[216:219], v217 offset:14336
ds_read_b128 a[220:223], v217 offset:15360
v_mfma_f32_16x16x32_bf16 a[52:55], a[244:247], v[68:71], a[52:55]
v_mfma_f32_16x16x32_bf16 a[48:51], a[240:243], v[68:71], a[48:51]
v_mfma_f32_16x16x32_bf16 a[80:83], a[240:243], v[72:75], a[80:83]
v_mfma_f32_16x16x32_bf16 a[84:87], a[244:247], v[72:75], a[84:87]
v_mfma_f32_16x16x32_bf16 a[116:119], a[244:247], v[76:79], a[116:119]
v_mfma_f32_16x16x32_bf16 a[112:115], a[240:243], v[76:79], a[112:115]
v_mfma_f32_16x16x32_bf16 a[120:123], a[248:251], v[76:79], a[120:123]
v_mfma_f32_16x16x32_bf16 a[124:127], a[252:255], v[76:79], a[124:127]
v_mfma_f32_16x16x32_bf16 a[92:95], a[252:255], v[72:75], a[92:95]
v_mfma_f32_16x16x32_bf16 a[88:91], a[248:251], v[72:75], a[88:91]
v_mfma_f32_16x16x32_bf16 a[56:59], a[248:251], v[68:71], a[56:59]
v_mfma_f32_16x16x32_bf16 a[60:63], a[252:255], v[68:71], a[60:63]
v_mfma_f32_16x16x32_bf16 a[28:31], a[252:255], v[64:67], a[28:31]
v_mfma_f32_16x16x32_bf16 a[24:27], a[248:251], v[64:67], a[24:27]
v_mfma_f32_16x16x32_bf16 a[128:131], a[144:147], v[64:67], a[128:131]
v_mfma_f32_16x16x32_bf16 a[132:135], a[144:147], v[68:71], a[132:135]
v_mfma_f32_16x16x32_bf16 a[136:139], a[144:147], v[72:75], a[136:139]
v_mfma_f32_16x16x32_bf16 a[140:143], a[144:147], v[76:79], a[140:143]
s_waitcnt lgkmcnt(4)
v_mfma_f32_16x16x32_bf16 v[32:35], a[192:195], v[128:131], v[96:99]
ds_read_b128 a[224:227], v218 offset:8192
ds_read_b128 a[228:231], v218 offset:9216
v_mfma_f32_16x16x32_bf16 v[32:35], a[196:199], v[132:135], v[32:35]
v_exp_f32 v208, v0
v_mfma_f32_16x16x32_bf16 v[32:35], a[200:203], v[136:139], v[32:35]
ds_read_b128 a[232:235], v218 offset:10240
ds_read_b128 a[236:239], v218 offset:11264
v_mfma_f32_16x16x32_bf16 v[32:35], a[204:207], v[140:143], v[32:35]
v_exp_f32 v209, v1
v_mfma_f32_16x16x32_bf16 v[36:39], a[204:207], v[156:159], v[100:103]
v_exp_f32 v210, v2
v_mfma_f32_16x16x32_bf16 v[36:39], a[200:203], v[152:155], v[36:39]
v_exp_f32 v211, v3
v_mfma_f32_16x16x32_bf16 v[36:39], a[196:199], v[148:151], v[36:39]
v_cvt_pk_bf16_f32 v64, v208, v209
v_cvt_pk_bf16_f32 v65, v210, v211
v_mfma_f32_16x16x32_bf16 v[36:39], a[192:195], v[144:147], v[36:39]
v_exp_f32 v212, v16
v_mfma_f32_16x16x32_bf16 v[40:43], a[192:195], v[160:163], v[104:107]
v_exp_f32 v213, v17
v_mfma_f32_16x16x32_bf16 v[40:43], a[196:199], v[164:167], v[40:43]
v_exp_f32 v214, v18
v_mfma_f32_16x16x32_bf16 v[40:43], a[200:203], v[168:171], v[40:43]
v_exp_f32 v215, v19
v_mfma_f32_16x16x32_bf16 v[40:43], a[204:207], v[172:175], v[40:43]
v_cvt_pk_bf16_f32 v66, v212, v213
v_cvt_pk_bf16_f32 v67, v214, v215
v_mfma_f32_16x16x32_bf16 v[44:47], a[204:207], v[188:191], v[108:111]
v_exp_f32 v208, v4
v_mfma_f32_16x16x32_bf16 v[44:47], a[200:203], v[184:187], v[44:47]
v_exp_f32 v209, v5
v_mfma_f32_16x16x32_bf16 v[44:47], a[196:199], v[180:183], v[44:47]
v_exp_f32 v210, v6
v_mfma_f32_16x16x32_bf16 v[44:47], a[192:195], v[176:179], v[44:47]
s_waitcnt lgkmcnt(4)
ds_read_b128 a[240:243], v218 offset:12288
v_cvt_pk_bf16_f32 v68, v208, v209
v_mfma_f32_16x16x32_bf16 v[60:63], a[208:211], v[176:179], v[108:111]
v_exp_f32 v211, v7
v_mfma_f32_16x16x32_bf16 v[60:63], a[212:215], v[180:183], v[60:63]
ds_read_b128 a[244:247], v218 offset:13312
v_cvt_pk_bf16_f32 v69, v210, v211
v_mfma_f32_16x16x32_bf16 v[60:63], a[216:219], v[184:187], v[60:63]
v_exp_f32 v212, v20
v_mfma_f32_16x16x32_bf16 v[60:63], a[220:223], v[188:191], v[60:63]
ds_read_b128 a[248:251], v218 offset:14336
ds_read_b128 a[252:255], v218 offset:15360
v_mfma_f32_16x16x32_bf16 v[56:59], a[220:223], v[172:175], v[104:107]
v_exp_f32 v213, v21
v_mfma_f32_16x16x32_bf16 v[56:59], a[216:219], v[168:171], v[56:59]
v_exp_f32 v214, v22
v_mfma_f32_16x16x32_bf16 v[56:59], a[212:215], v[164:167], v[56:59]
v_exp_f32 v215, v23
v_mfma_f32_16x16x32_bf16 v[56:59], a[208:211], v[160:163], v[56:59]
v_cvt_pk_bf16_f32 v70, v212, v213
v_cvt_pk_bf16_f32 v71, v214, v215
v_mfma_f32_16x16x32_bf16 v[52:55], a[208:211], v[144:147], v[100:103]
v_add_u32 v217, 16384, v217
v_and_b32 v217, 0xffff, v217
v_mfma_f32_16x16x32_bf16 v[52:55], a[212:215], v[148:151], v[52:55]
v_exp_f32 v208, v8
v_mfma_f32_16x16x32_bf16 v[52:55], a[216:219], v[152:155], v[52:55]
v_exp_f32 v209, v9
v_mfma_f32_16x16x32_bf16 v[52:55], a[220:223], v[156:159], v[52:55]
v_exp_f32 v210, v10
v_mfma_f32_16x16x32_bf16 v[48:51], a[220:223], v[140:143], v[96:99]
v_exp_f32 v211, v11
v_mfma_f32_16x16x32_bf16 v[48:51], a[216:219], v[136:139], v[48:51]
v_cvt_pk_bf16_f32 v72, v208, v209
v_cvt_pk_bf16_f32 v73, v210, v211
v_mfma_f32_16x16x32_bf16 v[48:51], a[212:215], v[132:135], v[48:51]
v_exp_f32 v212, v24
v_mfma_f32_16x16x32_bf16 v[48:51], a[208:211], v[128:131], v[48:51]
s_waitcnt vmcnt(8) lgkmcnt(4)
s_barrier
v_mfma_f32_16x16x32_bf16 a[0:3], a[224:227], v[80:83], a[0:3]
s_and_b32 m0, s68, 0xffff
ds_read_b128 a[192:195], v217 offset:0
ds_read_b128 a[196:199], v217 offset:1024
v_mfma_f32_16x16x32_bf16 a[4:7], a[228:231], v[80:83], a[4:7]
buffer_load_dwordx4 v216, s[8:11], s68 offen offset:0 lds
v_mfma_f32_16x16x32_bf16 a[36:39], a[228:231], v[84:87], a[36:39]
ds_read_b128 a[200:203], v217 offset:2048
ds_read_b128 a[204:207], v217 offset:3072
v_mfma_f32_16x16x32_bf16 a[32:35], a[224:227], v[84:87], a[32:35]
v_exp_f32 v213, v25
v_mfma_f32_16x16x32_bf16 a[64:67], a[224:227], v[88:91], a[64:67]
v_exp_f32 v214, v26
v_mfma_f32_16x16x32_bf16 a[68:71], a[228:231], v[88:91], a[68:71]
buffer_load_dwordx4 v216, s[8:11], s68 offen offset:1024 lds
v_mfma_f32_16x16x32_bf16 a[100:103], a[228:231], v[92:95], a[100:103]
v_exp_f32 v215, v27
v_mfma_f32_16x16x32_bf16 a[96:99], a[224:227], v[92:95], a[96:99]
v_cvt_pk_bf16_f32 v74, v212, v213
v_cvt_pk_bf16_f32 v75, v214, v215
v_mfma_f32_16x16x32_bf16 a[104:107], a[232:235], v[92:95], a[104:107]
v_exp_f32 v208, v12
v_mfma_f32_16x16x32_bf16 a[108:111], a[236:239], v[92:95], a[108:111]
buffer_load_dwordx4 v216, s[8:11], s68 offen offset:2048 lds
v_mfma_f32_16x16x32_bf16 a[76:79], a[236:239], v[88:91], a[76:79]
v_exp_f32 v209, v13
v_mfma_f32_16x16x32_bf16 a[72:75], a[232:235], v[88:91], a[72:75]
v_exp_f32 v210, v14
v_mfma_f32_16x16x32_bf16 a[40:43], a[232:235], v[84:87], a[40:43]
v_exp_f32 v211, v15
v_mfma_f32_16x16x32_bf16 a[44:47], a[236:239], v[84:87], a[44:47]
buffer_load_dwordx4 v216, s[8:11], s68 offen offset:3072 lds
v_mfma_f32_16x16x32_bf16 a[12:15], a[236:239], v[80:83], a[12:15]
s_xor_b32 m0, m0, 0x18000
v_cvt_pk_bf16_f32 v76, v208, v209
v_cvt_pk_bf16_f32 v77, v210, v211
v_mfma_f32_16x16x32_bf16 a[8:11], a[232:235], v[80:83], a[8:11]
s_waitcnt lgkmcnt(4)
ds_read_b128 a[208:211], v217 offset:4096
ds_read_b128 a[212:215], v217 offset:5120
v_mfma_f32_16x16x32_bf16 a[16:19], a[240:243], v[80:83], a[16:19]
v_exp_f32 v212, v28
v_mfma_f32_16x16x32_bf16 a[20:23], a[244:247], v[80:83], a[20:23]
ds_read_b128 a[216:219], v217 offset:6144
ds_read_b128 a[220:223], v217 offset:7168
v_mfma_f32_16x16x32_bf16 a[52:55], a[244:247], v[84:87], a[52:55]
buffer_load_dwordx4 v216, s[12:15], s68 offen offset:0 lds
v_mfma_f32_16x16x32_bf16 a[48:51], a[240:243], v[84:87], a[48:51]
v_exp_f32 v213, v29
v_mfma_f32_16x16x32_bf16 a[80:83], a[240:243], v[88:91], a[80:83]
v_exp_f32 v214, v30
v_mfma_f32_16x16x32_bf16 a[84:87], a[244:247], v[88:91], a[84:87]
v_exp_f32 v215, v31
v_mfma_f32_16x16x32_bf16 a[116:119], a[244:247], v[92:95], a[116:119]
buffer_load_dwordx4 v216, s[12:15], s68 offen offset:1024 lds
v_mfma_f32_16x16x32_bf16 a[112:115], a[240:243], v[92:95], a[112:115]
v_cvt_pk_bf16_f32 v78, v212, v213
v_cvt_pk_bf16_f32 v79, v214, v215
v_mfma_f32_16x16x32_bf16 a[120:123], a[248:251], v[92:95], a[120:123]
v_mfma_f32_16x16x32_bf16 a[124:127], a[252:255], v[92:95], a[124:127]
v_mfma_f32_16x16x32_bf16 a[92:95], a[252:255], v[88:91], a[92:95]
buffer_load_dwordx4 v216, s[12:15], s68 offen offset:2048 lds
v_mfma_f32_16x16x32_bf16 a[88:91], a[248:251], v[88:91], a[88:91]
v_mfma_f32_16x16x32_bf16 a[56:59], a[248:251], v[84:87], a[56:59]
v_mfma_f32_16x16x32_bf16 a[60:63], a[252:255], v[84:87], a[60:63]
v_mfma_f32_16x16x32_bf16 a[28:31], a[252:255], v[80:83], a[28:31]
buffer_load_dwordx4 v216, s[12:15], s68 offen offset:3072 lds
v_mfma_f32_16x16x32_bf16 a[24:27], a[248:251], v[80:83], a[24:27]
s_add_u32 s68, s68, 16384
v_mfma_f32_16x16x32_bf16 a[128:131], a[144:147], v[80:83], a[128:131]
v_mfma_f32_16x16x32_bf16 a[132:135], a[144:147], v[84:87], a[132:135]
v_mfma_f32_16x16x32_bf16 a[136:139], a[144:147], v[88:91], a[136:139]
v_mfma_f32_16x16x32_bf16 a[140:143], a[144:147], v[92:95], a[140:143]
s_waitcnt lgkmcnt(4)
s_cmp_eq_u32 s38, s99
s_cbranch_scc1 Lrpdone
Lloop1e:
s_cmp_lg_u32 s71, 0
s_cbranch_scc1 Lloop1
LmaskA:
Lch1_3:
Lpad16:
s_cbranch_execz Lpad20
v_mfma_f32_16x16x32_bf16 v[4:7], a[192:195], v[144:147], v[100:103]
v_add_u32 v219, 16384, v218
v_bfi_b32 v218, s69, v219, v218
v_mfma_f32_16x16x32_bf16 v[4:7], a[196:199], v[148:151], v[4:7]
ds_read_b128 a[224:227], v218 offset:0
ds_read_b128 a[228:231], v218 offset:1024
v_mfma_f32_16x16x32_bf16 v[4:7], a[200:203], v[152:155], v[4:7]
v_add_f32 v112, v224, v96
v_add_f32 v113, v225, v97
v_mfma_f32_16x16x32_bf16 v[4:7], a[204:207], v[156:159], v[4:7]
v_add_f32 v114, v226, v98
v_add_f32 v115, v227, v99
v_mfma_f32_16x16x32_bf16 v[8:11], a[204:207], v[172:175], v[104:107]
ds_read_b128 a[232:235], v218 offset:2048
ds_read_b128 a[236:239], v218 offset:3072
v_mfma_f32_16x16x32_bf16 v[8:11], a[200:203], v[168:171], v[8:11]
v_exp_f32 v208, v32
v_mfma_f32_16x16x32_bf16 v[8:11], a[196:199], v[164:167], v[8:11]
v_exp_f32 v209, v33
v_mfma_f32_16x16x32_bf16 v[8:11], a[192:195], v[160:163], v[8:11]
v_exp_f32 v210, v34
v_mfma_f32_16x16x32_bf16 v[12:15], a[192:195], v[176:179], v[108:111]
v_exp_f32 v211, v35
v_mfma_f32_16x16x32_bf16 v[12:15], a[196:199], v[180:183], v[12:15]
v_cvt_pk_bf16_f32 v80, v208, v209
v_cvt_pk_bf16_f32 v81, v210, v211
v_mfma_f32_16x16x32_bf16 v[12:15], a[200:203], v[184:187], v[12:15]
v_exp_f32 v212, v48
v_mfma_f32_16x16x32_bf16 v[12:15], a[204:207], v[188:191], v[12:15]
v_exp_f32 v213, v49
v_mfma_f32_16x16x32_bf16 v[0:3], a[204:207], v[140:143], v[112:115]
v_exp_f32 v214, v50
v_mfma_f32_16x16x32_bf16 v[0:3], a[200:203], v[136:139], v[0:3]
v_exp_f32 v215, v51
v_mfma_f32_16x16x32_bf16 v[0:3], a[196:199], v[132:135], v[0:3]
v_cvt_pk_bf16_f32 v82, v212, v213
v_cvt_pk_bf16_f32 v83, v214, v215
v_mfma_f32_16x16x32_bf16 v[0:3], a[192:195], v[128:131], v[0:3]
s_waitcnt lgkmcnt(4)
ds_read_b128 a[240:243], v218 offset:4096
ds_read_b128 a[244:247], v218 offset:5120
v_mfma_f32_16x16x32_bf16 v[20:23], a[208:211], v[144:147], v[100:103]
v_exp_f32 v208, v36
v_mfma_f32_16x16x32_bf16 v[20:23], a[212:215], v[148:151], v[20:23]
ds_read_b128 a[248:251], v218 offset:6144
ds_read_b128 a[252:255], v218 offset:7168
v_mfma_f32_16x16x32_bf16 v[20:23], a[216:219], v[152:155], v[20:23]
v_add_f32 v116, v228, v96
v_add_f32 v117, v229, v97
v_mfma_f32_16x16x32_bf16 v[20:23], a[220:223], v[156:159], v[20:23]
v_add_f32 v118, v230, v98
v_add_f32 v119, v231, v99
v_mfma_f32_16x16x32_bf16 v[24:27], a[220:223], v[172:175], v[104:107]
v_exp_f32 v209, v37
v_mfma_f32_16x16x32_bf16 v[24:27], a[216:219], v[168:171], v[24:27]
v_exp_f32 v210, v38
v_mfma_f32_16x16x32_bf16 v[24:27], a[212:215], v[164:167], v[24:27]
v_exp_f32 v211, v39
v_mfma_f32_16x16x32_bf16 v[24:27], a[208:211], v[160:163], v[24:27]
v_cvt_pk_bf16_f32 v84, v208, v209
v_cvt_pk_bf16_f32 v85, v210, v211
v_mfma_f32_16x16x32_bf16 v[28:31], a[208:211], v[176:179], v[108:111]
v_exp_f32 v212, v52
v_mfma_f32_16x16x32_bf16 v[28:31], a[212:215], v[180:183], v[28:31]
v_exp_f32 v213, v53
v_mfma_f32_16x16x32_bf16 v[28:31], a[216:219], v[184:187], v[28:31]
v_exp_f32 v214, v54
v_mfma_f32_16x16x32_bf16 v[28:31], a[220:223], v[188:191], v[28:31]
v_exp_f32 v215, v55
v_mfma_f32_16x16x32_bf16 v[16:19], a[220:223], v[140:143], v[116:119]
v_cvt_pk_bf16_f32 v86, v212, v213
v_cvt_pk_bf16_f32 v87, v214, v215
v_mfma_f32_16x16x32_bf16 v[16:19], a[216:219], v[136:139], v[16:19]
v_exp_f32 v208, v40
v_mfma_f32_16x16x32_bf16 v[16:19], a[212:215], v[132:135], v[16:19]
v_exp_f32 v209, v41
v_mfma_f32_16x16x32_bf16 v[16:19], a[208:211], v[128:131], v[16:19]
s_waitcnt lgkmcnt(4)
v_exp_f32 v210, v42
v_mfma_f32_16x16x32_bf16 a[0:3], a[224:227], v[64:67], a[0:3]
ds_read_b128 a[192:195], v217 offset:8192
v_cvt_pk_bf16_f32 v88, v208, v209
v_mfma_f32_16x16x32_bf16 a[4:7], a[228:231], v[64:67], a[4:7]
v_exp_f32 v211, v43
v_mfma_f32_16x16x32_bf16 a[36:39], a[228:231], v[68:71], a[36:39]
ds_read_b128 a[196:199], v217 offset:9216
v_cvt_pk_bf16_f32 v89, v210, v211
v_mfma_f32_16x16x32_bf16 a[32:35], a[224:227], v[68:71], a[32:35]
v_exp_f32 v212, v56
v_mfma_f32_16x16x32_bf16 a[64:67], a[224:227], v[72:75], a[64:67]
ds_read_b128 a[200:203], v217 offset:10240
ds_read_b128 a[204:207], v217 offset:11264
v_mfma_f32_16x16x32_bf16 a[68:71], a[228:231], v[72:75], a[68:71]
v_exp_f32 v213, v57
v_mfma_f32_16x16x32_bf16 a[100:103], a[228:231], v[76:79], a[100:103]
v_exp_f32 v214, v58
v_mfma_f32_16x16x32_bf16 a[96:99], a[224:227], v[76:79], a[96:99]
v_exp_f32 v215, v59
v_mfma_f32_16x16x32_bf16 a[104:107], a[232:235], v[76:79], a[104:107]
v_cvt_pk_bf16_f32 v90, v212, v213
v_cvt_pk_bf16_f32 v91, v214, v215
v_mfma_f32_16x16x32_bf16 a[108:111], a[236:239], v[76:79], a[108:111]
v_exp_f32 v208, v44
v_mfma_f32_16x16x32_bf16 a[76:79], a[236:239], v[72:75], a[76:79]
v_exp_f32 v209, v45
v_mfma_f32_16x16x32_bf16 a[72:75], a[232:235], v[72:75], a[72:75]
v_exp_f32 v210, v46
v_mfma_f32_16x16x32_bf16 a[40:43], a[232:235], v[68:71], a[40:43]
v_exp_f32 v211, v47
v_mfma_f32_16x16x32_bf16 a[44:47], a[236:239], v[68:71], a[44:47]
v_cvt_pk_bf16_f32 v92, v208, v209
v_cvt_pk_bf16_f32 v93, v210, v211
v_mfma_f32_16x16x32_bf16 a[12:15], a[236:239], v[64:67], a[12:15]
v_exp_f32 v212, v60
v_mfma_f32_16x16x32_bf16 a[8:11], a[232:235], v[64:67], a[8:11]
s_waitcnt lgkmcnt(4)
ds_read_b128 a[208:211], v217 offset:12288
ds_read_b128 a[212:215], v217 offset:13312
v_mfma_f32_16x16x32_bf16 a[16:19], a[240:243], v[64:67], a[16:19]
v_exp_f32 v213, v61
v_mfma_f32_16x16x32_bf16 a[20:23], a[244:247], v[64:67], a[20:23]
ds_read_b128 a[216:219], v217 offset:14336
v_cvt_pk_bf16_f32 v94, v212, v213
v_mfma_f32_16x16x32_bf16 a[52:55], a[244:247], v[68:71], a[52:55]
v_exp_f32 v214, v62
v_mfma_f32_16x16x32_bf16 a[48:51], a[240:243], v[68:71], a[48:51]
v_exp_f32 v215, v63
v_mfma_f32_16x16x32_bf16 a[80:83], a[240:243], v[72:75], a[80:83]
ds_read_b128 a[220:223], v217 offset:15360
v_cvt_pk_bf16_f32 v95, v214, v215
v_mfma_f32_16x16x32_bf16 a[84:87], a[244:247], v[72:75], a[84:87]
v_mfma_f32_16x16x32_bf16 a[116:119], a[244:247], v[76:79], a[116:119]
v_mfma_f32_16x16x32_bf16 a[112:115], a[240:243], v[76:79], a[112:115]
v_mfma_f32_16x16x32_bf16 a[120:123], a[248:251], v[76:79], a[120:123]
v_mfma_f32_16x16x32_bf16 a[124:127], a[252:255], v[76:79], a[124:127]
v_mfma_f32_16x16x32_bf16 a[92:95], a[252:255], v[72:75], a[92:95]
v_mfma_f32_16x16x32_bf16 a[88:91], a[248:251], v[72:75], a[88:91]
v_mfma_f32_16x16x32_bf16 a[56:59], a[248:251], v[68:71], a[56:59]
v_mfma_f32_16x16x32_bf16 a[60:63], a[252:255], v[68:71], a[60:63]
v_mfma_f32_16x16x32_bf16 a[28:31], a[252:255], v[64:67], a[28:31]
v_mfma_f32_16x16x32_bf16 a[24:27], a[248:251], v[64:67], a[24:27]
v_mfma_f32_16x16x32_bf16 a[128:131], a[144:147], v[64:67], a[128:131]
v_mfma_f32_16x16x32_bf16 a[132:135], a[144:147], v[68:71], a[132:135]
v_mfma_f32_16x16x32_bf16 a[136:139], a[144:147], v[72:75], a[136:139]
v_mfma_f32_16x16x32_bf16 a[140:143], a[144:147], v[76:79], a[140:143]
s_waitcnt lgkmcnt(4)
v_mfma_f32_16x16x32_bf16 v[36:39], a[192:195], v[144:147], v[100:103]
ds_read_b128 a[224:227], v218 offset:8192
ds_read_b128 a[228:231], v218 offset:9216
v_mfma_f32_16x16x32_bf16 v[36:39], a[196:199], v[148:151], v[36:39]
v_exp_f32 v208, v0
v_mfma_f32_16x16x32_bf16 v[36:39], a[200:203], v[152:155], v[36:39]
v_add_f32 v120, v232, v96
v_add_f32 v121, v233, v97
v_mfma_f32_16x16x32_bf16 v[36:39], a[204:207], v[156:159], v[36:39]
v_add_f32 v122, v234, v98
v_add_f32 v123, v235, v99
v_mfma_f32_16x16x32_bf16 v[40:43], a[204:207], v[172:175], v[104:107]
ds_read_b128 a[232:235], v218 offset:10240
ds_read_b128 a[236:239], v218 offset:11264
v_mfma_f32_16x16x32_bf16 v[40:43], a[200:203], v[168:171], v[40:43]
v_exp_f32 v209, v1
v_mfma_f32_16x16x32_bf16 v[40:43], a[196:199], v[164:167], v[40:43]
v_exp_f32 v210, v2
v_mfma_f32_16x16x32_bf16 v[40:43], a[192:195], v[160:163], v[40:43]
v_exp_f32 v211, v3
v_mfma_f32_16x16x32_bf16 v[44:47], a[192:195], v[176:179], v[108:111]
v_cvt_pk_bf16_f32 v64, v208, v209
v_cvt_pk_bf16_f32 v65, v210, v211
v_mfma_f32_16x16x32_bf16 v[44:47], a[196:199], v[180:183], v[44:47]
v_exp_f32 v212, v16
v_mfma_f32_16x16x32_bf16 v[44:47], a[200:203], v[184:187], v[44:47]
v_exp_f32 v213, v17
v_mfma_f32_16x16x32_bf16 v[44:47], a[204:207], v[188:191], v[44:47]
v_exp_f32 v214, v18
v_mfma_f32_16x16x32_bf16 v[32:35], a[204:207], v[140:143], v[120:123]
v_exp_f32 v215, v19
v_mfma_f32_16x16x32_bf16 v[32:35], a[200:203], v[136:139], v[32:35]
v_cvt_pk_bf16_f32 v66, v212, v213
v_cvt_pk_bf16_f32 v67, v214, v215
v_mfma_f32_16x16x32_bf16 v[32:35], a[196:199], v[132:135], v[32:35]
v_exp_f32 v208, v4
v_mfma_f32_16x16x32_bf16 v[32:35], a[192:195], v[128:131], v[32:35]
s_waitcnt lgkmcnt(4)
ds_read_b128 a[240:243], v218 offset:12288
ds_read_b128 a[244:247], v218 offset:13312
v_mfma_f32_16x16x32_bf16 v[52:55], a[208:211], v[144:147], v[100:103]
v_exp_f32 v209, v5
v_mfma_f32_16x16x32_bf16 v[52:55], a[212:215], v[148:151], v[52:55]
ds_read_b128 a[248:251], v218 offset:14336
v_cvt_pk_bf16_f32 v68, v208, v209
v_mfma_f32_16x16x32_bf16 v[52:55], a[216:219], v[152:155], v[52:55]
v_add_f32 v124, v236, v96
v_add_f32 v125, v237, v97
v_mfma_f32_16x16x32_bf16 v[52:55], a[220:223], v[156:159], v[52:55]
v_add_f32 v126, v238, v98
v_add_f32 v127, v239, v99
v_mfma_f32_16x16x32_bf16 v[56:59], a[220:223], v[172:175], v[104:107]
v_exp_f32 v210, v6
v_mfma_f32_16x16x32_bf16 v[56:59], a[216:219], v[168:171], v[56:59]
v_exp_f32 v211, v7
v_mfma_f32_16x16x32_bf16 v[56:59], a[212:215], v[164:167], v[56:59]
ds_read_b128 a[252:255], v218 offset:15360
v_cvt_pk_bf16_f32 v69, v210, v211
v_mfma_f32_16x16x32_bf16 v[56:59], a[208:211], v[160:163], v[56:59]
v_exp_f32 v212, v20
v_mfma_f32_16x16x32_bf16 v[60:63], a[208:211], v[176:179], v[108:111]
v_add_u32 v217, 16384, v217
v_and_b32 v217, 0xffff, v217
v_mfma_f32_16x16x32_bf16 v[60:63], a[212:215], v[180:183], v[60:63]
v_exp_f32 v213, v21
v_mfma_f32_16x16x32_bf16 v[60:63], a[216:219], v[184:187], v[60:63]
v_exp_f32 v214, v22
v_mfma_f32_16x16x32_bf16 v[60:63], a[220:223], v[188:191], v[60:63]
v_exp_f32 v215, v23
v_mfma_f32_16x16x32_bf16 v[48:51], a[220:223], v[140:143], v[124:127]
v_cvt_pk_bf16_f32 v70, v212, v213
v_cvt_pk_bf16_f32 v71, v214, v215
v_mfma_f32_16x16x32_bf16 v[48:51], a[216:219], v[136:139], v[48:51]
v_exp_f32 v208, v8
v_mfma_f32_16x16x32_bf16 v[48:51], a[212:215], v[132:135], v[48:51]
v_exp_f32 v209, v9
v_mfma_f32_16x16x32_bf16 v[48:51], a[208:211], v[128:131], v[48:51]
s_waitcnt vmcnt(8) lgkmcnt(4)
s_barrier
v_mfma_f32_16x16x32_bf16 a[0:3], a[224:227], v[80:83], a[0:3]
s_and_b32 m0, s68, 0xffff
ds_read_b128 a[192:195], v217 offset:0
v_cvt_pk_bf16_f32 v72, v208, v209
v_mfma_f32_16x16x32_bf16 a[4:7], a[228:231], v[80:83], a[4:7]
buffer_load_dwordx4 v216, s[8:11], s68 offen offset:0 lds
v_mfma_f32_16x16x32_bf16 a[36:39], a[228:231], v[84:87], a[36:39]
ds_read_b128 a[196:199], v217 offset:1024
ds_read_b128 a[200:203], v217 offset:2048
v_mfma_f32_16x16x32_bf16 a[32:35], a[224:227], v[84:87], a[32:35]
v_exp_f32 v210, v10
v_mfma_f32_16x16x32_bf16 a[64:67], a[224:227], v[88:91], a[64:67]
v_exp_f32 v211, v11
v_mfma_f32_16x16x32_bf16 a[68:71], a[228:231], v[88:91], a[68:71]
ds_read_b128 a[204:207], v217 offset:3072
v_cvt_pk_bf16_f32 v73, v210, v211
v_mfma_f32_16x16x32_bf16 a[100:103], a[228:231], v[92:95], a[100:103]
buffer_load_dwordx4 v216, s[8:11], s68 offen offset:1024 lds
v_mfma_f32_16x16x32_bf16 a[96:99], a[224:227], v[92:95], a[96:99]
v_exp_f32 v212, v24
v_mfma_f32_16x16x32_bf16 a[104:107], a[232:235], v[92:95], a[104:107]
v_exp_f32 v213, v25
v_mfma_f32_16x16x32_bf16 a[108:111], a[236:239], v[92:95], a[108:111]
buffer_load_dwordx4 v216, s[8:11], s68 offen offset:2048 lds
v_mfma_f32_16x16x32_bf16 a[76:79], a[236:239], v[88:91], a[76:79]
v_exp_f32 v214, v26
v_mfma_f32_16x16x32_bf16 a[72:75], a[232:235], v[88:91], a[72:75]
Lpad17:
s_cbranch_execz Lpad21
v_exp_f32 v215, v27
v_mfma_f32_16x16x32_bf16 a[40:43], a[232:235], v[84:87], a[40:43]
v_cvt_pk_bf16_f32 v74, v212, v213
v_cvt_pk_bf16_f32 v75, v214, v215
v_mfma_f32_16x16x32_bf16 a[44:47], a[236:239], v[84:87], a[44:47]
buffer_load_dwordx4 v216, s[8:11], s68 offen offset:3072 lds
v_mfma_f32_16x16x32_bf16 a[12:15], a[236:239], v[80:83], a[12:15]
s_xor_b32 m0, m0, 0x18000
v_exp_f32 v208, v12
v_mfma_f32_16x16x32_bf16 a[8:11], a[232:235], v[80:83], a[8:11]
s_waitcnt lgkmcnt(4)
ds_read_b128 a[208:211], v217 offset:4096
ds_read_b128 a[212:215], v217 offset:5120
v_mfma_f32_16x16x32_bf16 a[16:19], a[240:243], v[80:83], a[16:19]
v_exp_f32 v209, v13
v_mfma_f32_16x16x32_bf16 a[20:23], a[244:247], v[80:83], a[20:23]
ds_read_b128 a[216:219], v217 offset:6144
v_cvt_pk_bf16_f32 v76, v208, v209
v_mfma_f32_16x16x32_bf16 a[52:55], a[244:247], v[84:87], a[52:55]
buffer_load_dwordx4 v216, s[12:15], s68 offen offset:0 lds
v_mfma_f32_16x16x32_bf16 a[48:51], a[240:243], v[84:87], a[48:51]
v_exp_f32 v210, v14
v_mfma_f32_16x16x32_bf16 a[80:83], a[240:243], v[88:91], a[80:83]
v_exp_f32 v211, v15
v_mfma_f32_16x16x32_bf16 a[84:87], a[244:247], v[88:91], a[84:87]
ds_read_b128 a[220:223], v217 offset:7168
v_cvt_pk_bf16_f32 v77, v210, v211
v_mfma_f32_16x16x32_bf16 a[116:119], a[244:247], v[92:95], a[116:119]
buffer_load_dwordx4 v216, s[12:15], s68 offen offset:1024 lds
v_mfma_f32_16x16x32_bf16 a[112:115], a[240:243], v[92:95], a[112:115]
v_exp_f32 v212, v28
v_mfma_f32_16x16x32_bf16 a[120:123], a[248:251], v[92:95], a[120:123]
v_exp_f32 v213, v29
v_mfma_f32_16x16x32_bf16 a[124:127], a[252:255], v[92:95], a[124:127]
v_exp_f32 v214, v30
v_mfma_f32_16x16x32_bf16 a[92:95], a[252:255], v[88:91], a[92:95]
buffer_load_dwordx4 v216, s[12:15], s68 offen offset:2048 lds
v_mfma_f32_16x16x32_bf16 a[88:91], a[248:251], v[88:91], a[88:91]
v_exp_f32 v215, v31
v_mfma_f32_16x16x32_bf16 a[56:59], a[248:251], v[84:87], a[56:59]
v_cvt_pk_bf16_f32 v78, v212, v213
v_cvt_pk_bf16_f32 v79, v214, v215
v_mfma_f32_16x16x32_bf16 a[60:63], a[252:255], v[84:87], a[60:63]
v_mfma_f32_16x16x32_bf16 a[28:31], a[252:255], v[80:83], a[28:31]
buffer_load_dwordx4 v216, s[12:15], s68 offen offset:3072 lds
v_mfma_f32_16x16x32_bf16 a[24:27], a[248:251], v[80:83], a[24:27]
s_add_u32 s68, s68, 16384
v_mfma_f32_16x16x32_bf16 a[128:131], a[144:147], v[80:83], a[128:131]
v_mfma_f32_16x16x32_bf16 a[132:135], a[144:147], v[84:87], a[132:135]
v_mfma_f32_16x16x32_bf16 a[136:139], a[144:147], v[88:91], a[136:139]
v_mfma_f32_16x16x32_bf16 a[140:143], a[144:147], v[92:95], a[140:143]
s_waitcnt lgkmcnt(4)
s_add_u32 s38, s38, 1
s_cmp_lg_u32 s38, s99
s_cbranch_scc1 LmaskB
v_and_b32 v219, 0xfffffcff, v221
s_mov_b64 exec, 1
global_atomic_add v219, v223, s[66:67] offset:12 sc1
s_mov_b64 exec, -1
LmaskB:
Lpad18:
s_cbranch_execz Lpad22
v_mfma_f32_16x16x32_bf16 v[8:11], a[192:195], v[160:163], v[104:107]
v_add_f32 v112, v224, v100
v_add_f32 v113, v225, v101
v_mfma_f32_16x16x32_bf16 v[8:11], a[196:199], v[164:167], v[8:11]
v_add_f32 v114, v226, v102
v_add_f32 v115, v227, v103
v_mfma_f32_16x16x32_bf16 v[8:11], a[200:203], v[168:171], v[8:11]
v_add_u32 v219, 16384, v218
v_bfi_b32 v218, s69, v219, v218
v_mfma_f32_16x16x32_bf16 v[8:11], a[204:207], v[172:175], v[8:11]
ds_read_b128 a[224:227], v218 offset:0
v_and_b32 v197, 7, v220
v_mfma_f32_16x16x32_bf16 v[12:15], a[204:207], v[188:191], v[108:111]
ds_read_b128 a[228:231], v218 offset:1024
v_lshlrev_b32 v197, 10, v197
v_mfma_f32_16x16x32_bf16 v[12:15], a[200:203], v[184:187], v[12:15]
ds_read_b128 a[232:235], v218 offset:2048
v_add_u32 v197, 264204, v197
v_mfma_f32_16x16x32_bf16 v[12:15], a[196:199], v[180:183], v[12:15]
s_lshr_b32 s59, s2, 4
ds_read_b128 a[236:239], v218 offset:3072
s_lshr_b32 s61, s59, 1
v_mfma_f32_16x16x32_bf16 v[12:15], a[192:195], v[176:179], v[12:15]
s_mul_i32 s6, s61, 655360
v_add_u32 v192, s6, v216
s_add_u32 s6, s6, 131072
v_mfma_f32_16x16x32_bf16 v[4:7], a[192:195], v[144:147], v[112:115]
v_add_u32 v193, s6, v216
s_add_u32 s6, s6, 131072
v_mfma_f32_16x16x32_bf16 v[4:7], a[196:199], v[148:151], v[4:7]
v_add_u32 v194, s6, v216
s_add_u32 s6, s6, 131072
v_mfma_f32_16x16x32_bf16 v[4:7], a[200:203], v[152:155], v[4:7]
v_add_f32 v116, v228, v100
v_add_f32 v117, v229, v101
v_mfma_f32_16x16x32_bf16 v[4:7], a[204:207], v[156:159], v[4:7]
s_waitcnt lgkmcnt(4)
v_add_f32 v118, v230, v102
v_add_f32 v119, v231, v103
v_mfma_f32_16x16x32_bf16 v[24:27], a[220:223], v[172:175], v[104:107]
ds_read_b128 a[240:243], v218 offset:4096
v_add_u32 v195, s6, v216
v_mfma_f32_16x16x32_bf16 v[24:27], a[216:219], v[168:171], v[24:27]
s_add_u32 s6, s6, 131072
ds_read_b128 a[244:247], v218 offset:5120
v_add_u32 v196, s6, v216
v_mfma_f32_16x16x32_bf16 v[24:27], a[212:215], v[164:167], v[24:27]
s_add_u32 s28, s66, 71303168
s_addc_u32 s29, s67, 0
v_mfma_f32_16x16x32_bf16 v[24:27], a[208:211], v[160:163], v[24:27]
s_and_b32 s29, s29, 0xffff
ds_read_b128 a[248:251], v218 offset:6144
ds_read_b128 a[252:255], v218 offset:7168
v_mfma_f32_16x16x32_bf16 v[28:31], a[208:211], v[176:179], v[108:111]
s_mov_b32 s30, 17825792
v_exp_f32 v208, v32
v_mfma_f32_16x16x32_bf16 v[28:31], a[212:215], v[180:183], v[28:31]
v_exp_f32 v209, v33
v_mfma_f32_16x16x32_bf16 v[28:31], a[216:219], v[184:187], v[28:31]
v_exp_f32 v210, v34
v_mfma_f32_16x16x32_bf16 v[28:31], a[220:223], v[188:191], v[28:31]
v_exp_f32 v211, v35
v_mfma_f32_16x16x32_bf16 v[20:23], a[220:223], v[156:159], v[116:119]
v_cvt_pk_bf16_f32 v80, v208, v209
v_cvt_pk_bf16_f32 v81, v210, v211
v_mfma_f32_16x16x32_bf16 v[20:23], a[216:219], v[152:155], v[20:23]
v_exp_f32 v212, v48
v_mfma_f32_16x16x32_bf16 v[20:23], a[212:215], v[148:151], v[20:23]
v_exp_f32 v213, v49
v_mfma_f32_16x16x32_bf16 v[20:23], a[208:211], v[144:147], v[20:23]
s_waitcnt lgkmcnt(4)
v_exp_f32 v214, v50
v_mfma_f32_16x16x32_bf16 a[0:3], a[224:227], v[64:67], a[0:3]
ds_read_b128 a[192:195], v217 offset:8192
v_cvt_pk_bf16_f32 v82, v212, v213
v_mfma_f32_16x16x32_bf16 a[4:7], a[228:231], v[64:67], a[4:7]
v_exp_f32 v215, v51
v_mfma_f32_16x16x32_bf16 a[36:39], a[228:231], v[68:71], a[36:39]
ds_read_b128 a[196:199], v217 offset:9216
v_cvt_pk_bf16_f32 v83, v214, v215
v_mfma_f32_16x16x32_bf16 a[32:35], a[224:227], v[68:71], a[32:35]
v_exp_f32 v208, v36
v_mfma_f32_16x16x32_bf16 a[64:67], a[224:227], v[72:75], a[64:67]
ds_read_b128 a[200:203], v217 offset:10240
ds_read_b128 a[204:207], v217 offset:11264
v_mfma_f32_16x16x32_bf16 a[68:71], a[228:231], v[72:75], a[68:71]
v_exp_f32 v209, v37
v_mfma_f32_16x16x32_bf16 a[100:103], a[228:231], v[76:79], a[100:103]
v_exp_f32 v210, v38
v_mfma_f32_16x16x32_bf16 a[96:99], a[224:227], v[76:79], a[96:99]
v_exp_f32 v211, v39
v_mfma_f32_16x16x32_bf16 a[104:107], a[232:235], v[76:79], a[104:107]
v_cvt_pk_bf16_f32 v84, v208, v209
v_cvt_pk_bf16_f32 v85, v210, v211
v_mfma_f32_16x16x32_bf16 a[108:111], a[236:239], v[76:79], a[108:111]
v_exp_f32 v212, v52
v_mfma_f32_16x16x32_bf16 a[76:79], a[236:239], v[72:75], a[76:79]
v_exp_f32 v213, v53
v_mfma_f32_16x16x32_bf16 a[72:75], a[232:235], v[72:75], a[72:75]
v_exp_f32 v214, v54
v_mfma_f32_16x16x32_bf16 a[40:43], a[232:235], v[68:71], a[40:43]
v_exp_f32 v215, v55
v_mfma_f32_16x16x32_bf16 a[44:47], a[236:239], v[68:71], a[44:47]
v_cvt_pk_bf16_f32 v86, v212, v213
v_cvt_pk_bf16_f32 v87, v214, v215
v_mfma_f32_16x16x32_bf16 a[12:15], a[236:239], v[64:67], a[12:15]
v_exp_f32 v208, v40
v_mfma_f32_16x16x32_bf16 a[8:11], a[232:235], v[64:67], a[8:11]
s_waitcnt lgkmcnt(4)
ds_read_b128 a[208:211], v217 offset:12288
ds_read_b128 a[212:215], v217 offset:13312
v_mfma_f32_16x16x32_bf16 a[16:19], a[240:243], v[64:67], a[16:19]
v_exp_f32 v209, v41
v_mfma_f32_16x16x32_bf16 a[20:23], a[244:247], v[64:67], a[20:23]
ds_read_b128 a[216:219], v217 offset:14336
v_cvt_pk_bf16_f32 v88, v208, v209
v_mfma_f32_16x16x32_bf16 a[52:55], a[244:247], v[68:71], a[52:55]
v_exp_f32 v210, v42
v_mfma_f32_16x16x32_bf16 a[48:51], a[240:243], v[68:71], a[48:51]
v_exp_f32 v211, v43
v_mfma_f32_16x16x32_bf16 a[80:83], a[240:243], v[72:75], a[80:83]
ds_read_b128 a[220:223], v217 offset:15360
v_cvt_pk_bf16_f32 v89, v210, v211
v_mfma_f32_16x16x32_bf16 a[84:87], a[244:247], v[72:75], a[84:87]
v_exp_f32 v212, v56
v_mfma_f32_16x16x32_bf16 a[116:119], a[244:247], v[76:79], a[116:119]
v_exp_f32 v213, v57
v_mfma_f32_16x16x32_bf16 a[112:115], a[240:243], v[76:79], a[112:115]
v_exp_f32 v214, v58
v_mfma_f32_16x16x32_bf16 a[120:123], a[248:251], v[76:79], a[120:123]
global_load_dword v253, v222, s[66:67] sc1
v_mfma_f32_16x16x32_bf16 a[124:127], a[252:255], v[76:79], a[124:127]
v_exp_f32 v215, v59
v_mfma_f32_16x16x32_bf16 a[92:95], a[252:255], v[72:75], a[92:95]
v_cvt_pk_bf16_f32 v90, v212, v213
v_cvt_pk_bf16_f32 v91, v214, v215
v_mfma_f32_16x16x32_bf16 a[88:91], a[248:251], v[72:75], a[88:91]
v_exp_f32 v208, v44
v_mfma_f32_16x16x32_bf16 a[56:59], a[248:251], v[68:71], a[56:59]
global_load_dword v221, v197, s[66:67] sc1
v_mfma_f32_16x16x32_bf16 a[60:63], a[252:255], v[68:71], a[60:63]
v_exp_f32 v209, v45
v_mfma_f32_16x16x32_bf16 a[28:31], a[252:255], v[64:67], a[28:31]
v_exp_f32 v210, v46
v_mfma_f32_16x16x32_bf16 a[24:27], a[248:251], v[64:67], a[24:27]
v_exp_f32 v211, v47
v_mfma_f32_16x16x32_bf16 a[128:131], a[144:147], v[64:67], a[128:131]
v_cvt_pk_bf16_f32 v92, v208, v209
v_cvt_pk_bf16_f32 v93, v210, v211
v_mfma_f32_16x16x32_bf16 a[132:135], a[144:147], v[68:71], a[132:135]
v_exp_f32 v212, v60
v_mfma_f32_16x16x32_bf16 a[136:139], a[144:147], v[72:75], a[136:139]
v_exp_f32 v213, v61
v_mfma_f32_16x16x32_bf16 a[140:143], a[144:147], v[76:79], a[140:143]
s_waitcnt lgkmcnt(4)
v_exp_f32 v214, v62
v_cvt_pk_bf16_f32 v94, v212, v213
v_exp_f32 v215, v63
s_nop 0
v_cvt_pk_bf16_f32 v95, v214, v215
v_mfma_f32_16x16x32_bf16 v[40:43], a[192:195], v[160:163], v[104:107]
s_mov_b32 s31, 0x20000
v_add_f32 v120, v232, v100
v_add_f32 v121, v233, v101
v_mfma_f32_16x16x32_bf16 v[40:43], a[196:199], v[164:167], v[40:43]
v_add_f32 v122, v234, v102
v_add_f32 v123, v235, v103
v_mfma_f32_16x16x32_bf16 v[40:43], a[200:203], v[168:171], v[40:43]
ds_read_b128 a[224:227], v218 offset:8192
ds_read_b128 a[228:231], v218 offset:9216
v_mfma_f32_16x16x32_bf16 v[40:43], a[204:207], v[172:175], v[40:43]
s_add_u32 s24, s66, 10485760
s_addc_u32 s25, s67, 0
v_mfma_f32_16x16x32_bf16 v[44:47], a[204:207], v[188:191], v[108:111]
s_and_b32 s25, s25, 0xffff
ds_read_b128 a[232:235], v218 offset:10240
ds_read_b128 a[236:239], v218 offset:11264
v_mfma_f32_16x16x32_bf16 v[44:47], a[200:203], v[184:187], v[44:47]
s_mov_b32 s26, 5242880
s_mov_b32 s27, 0x20000
s_and_b32 s6, s2, 1
v_mfma_f32_16x16x32_bf16 v[44:47], a[196:199], v[180:183], v[44:47]
s_lshl_b32 s6, s6, 2
s_add_u32 s6, s6, s3
s_lshl_b32 s32, s6, 14
v_mfma_f32_16x16x32_bf16 v[44:47], a[192:195], v[176:179], v[44:47]
s_add_u32 s33, s32, 6144
s_add_u32 s35, s32, 4096
s_mul_i32 s34, s3, 20480
v_mfma_f32_16x16x32_bf16 v[36:39], a[192:195], v[144:147], v[120:123]
s_cmp_eq_u32 s3, 3
s_cselect_b32 s34, 143360, s34
v_mfma_f32_16x16x32_bf16 v[36:39], a[196:199], v[148:151], v[36:39]
s_lshl_b32 s6, s4, 12
s_mul_i32 s42, s72, 131072
s_add_u32 s42, s42, s6
v_mfma_f32_16x16x32_bf16 v[36:39], a[200:203], v[152:155], v[36:39]
s_mul_i32 s43, s73, 131072
v_add_f32 v124, v236, v100
v_add_f32 v125, v237, v101
v_mfma_f32_16x16x32_bf16 v[36:39], a[204:207], v[156:159], v[36:39]
s_waitcnt lgkmcnt(4)
v_add_f32 v126, v238, v102
v_add_f32 v127, v239, v103
v_mfma_f32_16x16x32_bf16 v[56:59], a[220:223], v[172:175], v[104:107]
s_add_u32 s43, s43, s6
ds_read_b128 a[240:243], v218 offset:12288
ds_read_b128 a[244:247], v218 offset:13312
v_mfma_f32_16x16x32_bf16 v[56:59], a[216:219], v[168:171], v[56:59]
s_mul_i32 s44, s74, 131072
v_exp_f32 v208, v4
v_mfma_f32_16x16x32_bf16 v[56:59], a[212:215], v[164:167], v[56:59]
s_add_u32 s44, s44, s6
ds_read_b128 a[248:251], v218 offset:14336
ds_read_b128 a[252:255], v218 offset:15360
v_mfma_f32_16x16x32_bf16 v[56:59], a[208:211], v[160:163], v[56:59]
s_mul_i32 s45, s75, 131072
v_exp_f32 v209, v5
v_mfma_f32_16x16x32_bf16 v[60:63], a[208:211], v[176:179], v[108:111]
s_add_u32 s45, s45, s6
v_add_u32 v217, 16384, v217
v_and_b32 v217, 0xffff, v217
v_mfma_f32_16x16x32_bf16 v[60:63], a[212:215], v[180:183], v[60:63]
s_cmp_eq_u32 s5, 7
s_cselect_b32 s99, 1, 2
v_mfma_f32_16x16x32_bf16 v[60:63], a[216:219], v[184:187], v[60:63]
v_exp_f32 v210, v6
v_mfma_f32_16x16x32_bf16 v[60:63], a[220:223], v[188:191], v[60:63]
v_exp_f32 v211, v7
v_mfma_f32_16x16x32_bf16 v[52:55], a[220:223], v[156:159], v[124:127]
v_cvt_pk_bf16_f32 v68, v208, v209
v_cvt_pk_bf16_f32 v69, v210, v211
v_mfma_f32_16x16x32_bf16 v[52:55], a[216:219], v[152:155], v[52:55]
v_exp_f32 v212, v20
v_mfma_f32_16x16x32_bf16 v[52:55], a[212:215], v[148:151], v[52:55]
v_exp_f32 v213, v21
v_mfma_f32_16x16x32_bf16 v[52:55], a[208:211], v[144:147], v[52:55]
s_waitcnt vmcnt(10) lgkmcnt(4)
s_barrier
v_mfma_f32_16x16x32_bf16 a[0:3], a[224:227], v[80:83], a[0:3]
s_and_b32 m0, s68, 0xffff
ds_read_b128 a[192:195], v217 offset:0
v_cvt_pk_bf16_f32 v70, v212, v213
v_mfma_f32_16x16x32_bf16 a[4:7], a[228:231], v[80:83], a[4:7]
buffer_load_dwordx4 v216, s[8:11], s68 offen offset:0 lds
v_mfma_f32_16x16x32_bf16 a[36:39], a[228:231], v[84:87], a[36:39]
ds_read_b128 a[196:199], v217 offset:1024
ds_read_b128 a[200:203], v217 offset:2048
v_mfma_f32_16x16x32_bf16 a[32:35], a[224:227], v[84:87], a[32:35]
v_exp_f32 v214, v22
v_mfma_f32_16x16x32_bf16 a[64:67], a[224:227], v[88:91], a[64:67]
v_exp_f32 v215, v23
v_mfma_f32_16x16x32_bf16 a[68:71], a[228:231], v[88:91], a[68:71]
ds_read_b128 a[204:207], v217 offset:3072
v_cvt_pk_bf16_f32 v71, v214, v215
v_mfma_f32_16x16x32_bf16 a[100:103], a[228:231], v[92:95], a[100:103]
buffer_load_dwordx4 v216, s[8:11], s68 offen offset:1024 lds
v_mfma_f32_16x16x32_bf16 a[96:99], a[224:227], v[92:95], a[96:99]
v_exp_f32 v208, v8
v_mfma_f32_16x16x32_bf16 a[104:107], a[232:235], v[92:95], a[104:107]
v_exp_f32 v209, v9
v_mfma_f32_16x16x32_bf16 a[108:111], a[236:239], v[92:95], a[108:111]
buffer_load_dwordx4 v216, s[8:11], s68 offen offset:2048 lds
v_mfma_f32_16x16x32_bf16 a[76:79], a[236:239], v[88:91], a[76:79]
v_exp_f32 v210, v10
v_mfma_f32_16x16x32_bf16 a[72:75], a[232:235], v[88:91], a[72:75]
v_exp_f32 v211, v11
v_mfma_f32_16x16x32_bf16 a[40:43], a[232:235], v[84:87], a[40:43]
v_cvt_pk_bf16_f32 v72, v208, v209
v_cvt_pk_bf16_f32 v73, v210, v211
v_mfma_f32_16x16x32_bf16 a[44:47], a[236:239], v[84:87], a[44:47]
buffer_load_dwordx4 v216, s[8:11], s68 offen offset:3072 lds
v_mfma_f32_16x16x32_bf16 a[12:15], a[236:239], v[80:83], a[12:15]
s_xor_b32 m0, m0, 0x18000
v_exp_f32 v212, v24
v_mfma_f32_16x16x32_bf16 a[8:11], a[232:235], v[80:83], a[8:11]
s_waitcnt lgkmcnt(4)
ds_read_b128 a[208:211], v217 offset:4096
ds_read_b128 a[212:215], v217 offset:5120
v_mfma_f32_16x16x32_bf16 a[16:19], a[240:243], v[80:83], a[16:19]
v_exp_f32 v213, v25
v_mfma_f32_16x16x32_bf16 a[20:23], a[244:247], v[80:83], a[20:23]
ds_read_b128 a[216:219], v217 offset:6144
v_cvt_pk_bf16_f32 v74, v212, v213
v_mfma_f32_16x16x32_bf16 a[52:55], a[244:247], v[84:87], a[52:55]
buffer_load_dwordx4 v216, s[12:15], s68 offen offset:0 lds
v_mfma_f32_16x16x32_bf16 a[48:51], a[240:243], v[84:87], a[48:51]
v_exp_f32 v214, v26
v_mfma_f32_16x16x32_bf16 a[80:83], a[240:243], v[88:91], a[80:83]
v_exp_f32 v215, v27
v_mfma_f32_16x16x32_bf16 a[84:87], a[244:247], v[88:91], a[84:87]
ds_read_b128 a[220:223], v217 offset:7168
v_cvt_pk_bf16_f32 v75, v214, v215
v_mfma_f32_16x16x32_bf16 a[116:119], a[244:247], v[92:95], a[116:119]
buffer_load_dwordx4 v216, s[12:15], s68 offen offset:1024 lds
v_mfma_f32_16x16x32_bf16 a[112:115], a[240:243], v[92:95], a[112:115]
v_exp_f32 v208, v12
v_mfma_f32_16x16x32_bf16 a[120:123], a[248:251], v[92:95], a[120:123]
v_exp_f32 v209, v13
v_mfma_f32_16x16x32_bf16 a[124:127], a[252:255], v[92:95], a[124:127]
v_exp_f32 v210, v14
v_mfma_f32_16x16x32_bf16 a[92:95], a[252:255], v[88:91], a[92:95]
buffer_load_dwordx4 v216, s[12:15], s68 offen offset:2048 lds
v_mfma_f32_16x16x32_bf16 a[88:91], a[248:251], v[88:91], a[88:91]
v_exp_f32 v211, v15
v_mfma_f32_16x16x32_bf16 a[56:59], a[248:251], v[84:87], a[56:59]
v_cvt_pk_bf16_f32 v76, v208, v209
v_cvt_pk_bf16_f32 v77, v210, v211
v_mfma_f32_16x16x32_bf16 a[60:63], a[252:255], v[84:87], a[60:63]
v_exp_f32 v212, v28
v_mfma_f32_16x16x32_bf16 a[28:31], a[252:255], v[80:83], a[28:31]
buffer_load_dwordx4 v216, s[12:15], s68 offen offset:3072 lds
v_mfma_f32_16x16x32_bf16 a[24:27], a[248:251], v[80:83], a[24:27]
s_add_u32 s68, s68, 16384
v_exp_f32 v213, v29
v_mfma_f32_16x16x32_bf16 a[128:131], a[144:147], v[80:83], a[128:131]
v_exp_f32 v214, v30
v_mfma_f32_16x16x32_bf16 a[132:135], a[144:147], v[84:87], a[132:135]
v_exp_f32 v215, v31
v_mfma_f32_16x16x32_bf16 a[136:139], a[144:147], v[88:91], a[136:139]
v_cvt_pk_bf16_f32 v78, v212, v213
v_cvt_pk_bf16_f32 v79, v214, v215
v_mfma_f32_16x16x32_bf16 a[140:143], a[144:147], v[92:95], a[140:143]
s_waitcnt lgkmcnt(4)
v_mfma_f32_16x16x32_bf16 v[4:7], a[192:195], v[176:179], v[108:111]
s_lshl_b32 s71, s5, 1
v_fma_f32 v112, s70, v224, v104
v_fma_f32 v113, s70, v225, v105
v_fma_f32 v114, s70, v226, v106
v_fma_f32 v115, s70, v227, v107
v_mfma_f32_16x16x32_bf16 v[4:7], a[196:199], v[180:183], v[4:7]
s_sub_u32 s71, 13, s71
ds_read_b128 a[224:227], v217 offset:8192
ds_read_b128 a[228:231], v217 offset:9216
ds_read_b128 a[232:235], v217 offset:10240
v_mfma_f32_16x16x32_bf16 v[4:7], a[200:203], v[184:187], v[4:7]
ds_read_b128 a[236:239], v217 offset:11264
v_fma_f32 v116, s70, v228, v104
v_fma_f32 v117, s70, v229, v105
v_mfma_f32_16x16x32_bf16 v[4:7], a[204:207], v[188:191], v[4:7]
v_fma_f32 v118, s70, v230, v106
v_exp_f32 v208, v36
v_mfma_f32_16x16x32_bf16 v[0:3], a[204:207], v[172:175], v[112:115]
v_exp_f32 v209, v37
v_exp_f32 v210, v38
v_mfma_f32_16x16x32_bf16 v[0:3], a[200:203], v[168:171], v[0:3]
v_fma_f32 v119, s70, v231, v107
v_exp_f32 v211, v39
v_mfma_f32_16x16x32_bf16 v[0:3], a[196:199], v[164:167], v[0:3]
v_accvgpr_read_b32 v199, a128
v_rcp_f32 v199, v199
v_mfma_f32_16x16x32_bf16 v[0:3], a[192:195], v[160:163], v[0:3]
s_waitcnt lgkmcnt(4)
ds_read_b128 a[240:243], v217 offset:12288
ds_read_b128 a[244:247], v217 offset:13312
v_accvgpr_read_b32 v200, a0
v_mfma_f32_16x16x32_bf16 v[12:15], a[208:211], v[176:179], v[108:111]
ds_read_b128 a[248:251], v217 offset:14336
ds_read_b128 a[252:255], v217 offset:15360
v_accvgpr_read_b32 v201, a1
v_accvgpr_read_b32 v202, a2
v_mfma_f32_16x16x32_bf16 v[12:15], a[212:215], v[180:183], v[12:15]
v_accvgpr_read_b32 v203, a3
v_accvgpr_read_b32 v204, a4
v_accvgpr_read_b32 v205, a5
v_mfma_f32_16x16x32_bf16 v[12:15], a[216:219], v[184:187], v[12:15]
v_fma_f32 v120, s70, v232, v104
v_fma_f32 v121, s70, v233, v105
v_fma_f32 v122, s70, v234, v106
v_mfma_f32_16x16x32_bf16 v[12:15], a[220:223], v[188:191], v[12:15]
v_fma_f32 v123, s70, v235, v107
v_accvgpr_read_b32 v206, a6
v_accvgpr_read_b32 v207, a7
v_mfma_f32_16x16x32_bf16 v[8:11], a[220:223], v[172:175], v[116:119]
v_mul_f32 v200, v199, v200
v_mul_f32 v201, v199, v201
v_mul_f32 v202, v199, v202
v_mfma_f32_16x16x32_bf16 v[8:11], a[216:219], v[168:171], v[8:11]
v_mul_f32 v203, v199, v203
v_mul_f32 v204, v199, v204
v_mul_f32 v205, v199, v205
v_mul_f32 v206, v199, v206
v_mfma_f32_16x16x32_bf16 v[8:11], a[212:215], v[164:167], v[8:11]
v_mul_f32 v207, v199, v207
v_cvt_pk_bf16_f32 v240, v200, v201
v_cvt_pk_bf16_f32 v241, v202, v203
v_mfma_f32_16x16x32_bf16 v[8:11], a[208:211], v[160:163], v[8:11]
s_waitcnt lgkmcnt(4)
ds_read_b128 a[192:195], v218 offset:16384
ds_read_b128 a[196:199], v218 offset:17408
v_cvt_pk_bf16_f32 v242, v204, v205
v_mfma_f32_16x16x32_bf16 v[20:23], a[224:227], v[176:179], v[108:111]
ds_read_b128 a[200:203], v218 offset:18432
ds_read_b128 a[204:207], v218 offset:19456
v_cvt_pk_bf16_f32 v243, v206, v207
v_mfma_f32_16x16x32_bf16 v[20:23], a[228:231], v[180:183], v[20:23]
buffer_store_dwordx4 v[240:243], v216, s[28:31], s42 offen offset:0 sc1
v_accvgpr_read_b32 v200, a8
v_accvgpr_read_b32 v201, a9
v_mfma_f32_16x16x32_bf16 v[20:23], a[232:235], v[184:187], v[20:23]
v_fma_f32 v124, s70, v236, v104
v_fma_f32 v125, s70, v237, v105
v_fma_f32 v126, s70, v238, v106
v_mfma_f32_16x16x32_bf16 v[20:23], a[236:239], v[188:191], v[20:23]
v_fma_f32 v127, s70, v239, v107
v_accvgpr_read_b32 v202, a10
v_accvgpr_read_b32 v203, a11
v_mfma_f32_16x16x32_bf16 v[16:19], a[236:239], v[172:175], v[120:123]
v_accvgpr_read_b32 v204, a12
v_accvgpr_read_b32 v205, a13
v_accvgpr_read_b32 v206, a14
v_mfma_f32_16x16x32_bf16 v[16:19], a[232:235], v[168:171], v[16:19]
v_accvgpr_read_b32 v207, a15
v_mul_f32 v200, v199, v200
v_mul_f32 v201, v199, v201
v_mul_f32 v202, v199, v202
v_mfma_f32_16x16x32_bf16 v[16:19], a[228:231], v[164:167], v[16:19]
v_mul_f32 v203, v199, v203
v_mul_f32 v204, v199, v204
v_mul_f32 v205, v199, v205
v_mfma_f32_16x16x32_bf16 v[16:19], a[224:227], v[160:163], v[16:19]
s_waitcnt lgkmcnt(4)
ds_read_b128 a[208:211], v218 offset:20480
ds_read_b128 a[212:215], v218 offset:21504
v_mul_f32 v206, v199, v206
v_mfma_f32_16x16x32_bf16 v[28:31], a[240:243], v[176:179], v[108:111]
ds_read_b128 a[216:219], v218 offset:22528
ds_read_b128 a[220:223], v218 offset:23552
v_mul_f32 v207, v199, v207
v_mfma_f32_16x16x32_bf16 v[28:31], a[244:247], v[180:183], v[28:31]
v_cvt_pk_bf16_f32 v244, v200, v201
v_cvt_pk_bf16_f32 v245, v202, v203
v_cvt_pk_bf16_f32 v246, v204, v205
v_mfma_f32_16x16x32_bf16 v[28:31], a[248:251], v[184:187], v[28:31]
v_cvt_pk_bf16_f32 v247, v206, v207
v_cvt_pk_bf16_f32 v84, v208, v209
buffer_store_dwordx4 v[244:247], v216, s[28:31], s42 offen offset:1024 sc1
v_mfma_f32_16x16x32_bf16 v[28:31], a[252:255], v[188:191], v[28:31]
v_accvgpr_read_b32 v200, a16
v_exp_f32 v212, v52
v_mfma_f32_16x16x32_bf16 v[24:27], a[252:255], v[172:175], v[124:127]
v_accvgpr_read_b32 v201, a17
v_accvgpr_read_b32 v202, a18
v_cvt_pk_bf16_f32 v85, v210, v211
v_mfma_f32_16x16x32_bf16 v[24:27], a[248:251], v[168:171], v[24:27]
v_accvgpr_read_b32 v203, a19
v_exp_f32 v213, v53
v_mfma_f32_16x16x32_bf16 v[24:27], a[244:247], v[164:167], v[24:27]
v_accvgpr_read_b32 v204, a20
v_accvgpr_read_b32 v205, a21
v_exp_f32 v214, v54
v_mfma_f32_16x16x32_bf16 v[24:27], a[240:243], v[160:163], v[24:27]
s_waitcnt lgkmcnt(4)
v_accvgpr_read_b32 v206, a22
v_accvgpr_read_b32 v207, a23
v_cvt_pk_bf16_f32 v86, v212, v213
v_mfma_f32_16x16x32_bf16 a[32:35], a[192:195], v[68:71], a[32:35]
ds_read_b128 a[224:227], v217 offset:16384
ds_read_b128 a[228:231], v217 offset:17408
v_mul_f32 v200, v199, v200
v_mfma_f32_16x16x32_bf16 a[36:39], a[196:199], v[68:71], a[36:39]
ds_read_b128 a[232:235], v217 offset:18432
ds_read_b128 a[236:239], v217 offset:19456
v_mul_f32 v201, v199, v201
v_mfma_f32_16x16x32_bf16 a[68:71], a[196:199], v[72:75], a[68:71]
v_mul_f32 v202, v199, v202
v_mul_f32 v203, v199, v203
v_mul_f32 v204, v199, v204
v_mul_f32 v205, v199, v205
v_mfma_f32_16x16x32_bf16 a[64:67], a[192:195], v[72:75], a[64:67]
v_mul_f32 v206, v199, v206
v_exp_f32 v215, v55
v_mfma_f32_16x16x32_bf16 a[96:99], a[192:195], v[76:79], a[96:99]
v_mul_f32 v207, v199, v207
v_cvt_pk_bf16_f32 v240, v200, v201
v_cvt_pk_bf16_f32 v87, v214, v215
v_mfma_f32_16x16x32_bf16 a[100:103], a[196:199], v[76:79], a[100:103]
v_cvt_pk_bf16_f32 v241, v202, v203
v_exp_f32 v208, v40
v_mfma_f32_16x16x32_bf16 a[104:107], a[200:203], v[76:79], a[104:107]
v_cvt_pk_bf16_f32 v242, v204, v205
v_exp_f32 v209, v41
v_mfma_f32_16x16x32_bf16 a[108:111], a[204:207], v[76:79], a[108:111]
v_cvt_pk_bf16_f32 v243, v206, v207
v_cvt_pk_bf16_f32 v88, v208, v209
buffer_store_dwordx4 v[240:243], v216, s[28:31], s42 offen offset:2048 sc1
v_mfma_f32_16x16x32_bf16 a[76:79], a[204:207], v[72:75], a[76:79]
v_accvgpr_read_b32 v200, a24
v_exp_f32 v210, v42
v_mfma_f32_16x16x32_bf16 a[72:75], a[200:203], v[72:75], a[72:75]
v_accvgpr_read_b32 v201, a25
v_accvgpr_read_b32 v202, a26
v_accvgpr_read_b32 v203, a27
v_mfma_f32_16x16x32_bf16 a[40:43], a[200:203], v[68:71], a[40:43]
v_accvgpr_read_b32 v204, a28
v_exp_f32 v211, v43
v_mfma_f32_16x16x32_bf16 a[44:47], a[204:207], v[68:71], a[44:47]
s_waitcnt lgkmcnt(4)
ds_read_b128 a[240:243], v217 offset:20480
ds_read_b128 a[244:247], v217 offset:21504
v_accvgpr_read_b32 v205, a29
v_accvgpr_read_b32 v206, a30
v_mfma_f32_16x16x32_bf16 a[48:51], a[208:211], v[68:71], a[48:51]
ds_read_b128 a[248:251], v217 offset:22528
ds_read_b128 a[252:255], v217 offset:23552
v_accvgpr_read_b32 v207, a31
v_mfma_f32_16x16x32_bf16 a[52:55], a[212:215], v[68:71], a[52:55]
v_mul_f32 v200, v199, v200
v_mul_f32 v201, v199, v201
v_mul_f32 v202, v199, v202
v_mfma_f32_16x16x32_bf16 a[84:87], a[212:215], v[72:75], a[84:87]
v_mul_f32 v203, v199, v203
v_cvt_pk_bf16_f32 v89, v210, v211
v_mul_f32 v204, v199, v204
v_mfma_f32_16x16x32_bf16 a[80:83], a[208:211], v[72:75], a[80:83]
v_mul_f32 v205, v199, v205
v_exp_f32 v212, v56
v_mfma_f32_16x16x32_bf16 a[112:115], a[208:211], v[76:79], a[112:115]
v_mul_f32 v206, v199, v206
v_mul_f32 v207, v199, v207
v_exp_f32 v213, v57
v_mfma_f32_16x16x32_bf16 a[116:119], a[212:215], v[76:79], a[116:119]
v_cvt_pk_bf16_f32 v90, v212, v213
v_cvt_pk_bf16_f32 v244, v200, v201
v_cvt_pk_bf16_f32 v245, v202, v203
v_mfma_f32_16x16x32_bf16 a[120:123], a[216:219], v[76:79], a[120:123]
v_cvt_pk_bf16_f32 v246, v204, v205
v_exp_f32 v214, v58
v_mfma_f32_16x16x32_bf16 a[124:127], a[220:223], v[76:79], a[124:127]
v_cvt_pk_bf16_f32 v247, v206, v207
buffer_store_dwordx4 v[244:247], v216, s[28:31], s42 offen offset:3072 sc1
v_mfma_f32_16x16x32_bf16 a[92:95], a[220:223], v[72:75], a[92:95]
v_exp_f32 v215, v59
v_exp_f32 v208, v44
v_mfma_f32_16x16x32_bf16 a[88:91], a[216:219], v[72:75], a[88:91]
v_cvt_pk_bf16_f32 v91, v214, v215
v_exp_f32 v209, v45
v_mfma_f32_16x16x32_bf16 a[56:59], a[216:219], v[68:71], a[56:59]
v_cvt_pk_bf16_f32 v92, v208, v209
v_exp_f32 v210, v46
v_mfma_f32_16x16x32_bf16 a[60:63], a[220:223], v[68:71], a[60:63]
v_exp_f32 v211, v47
v_mfma_f32_16x16x32_bf16 a[132:135], a[144:147], v[68:71], a[132:135]
Lpad19:
s_cbranch_execz Lpad23
v_exp_f32 v212, v60
v_exp_f32 v213, v61
v_mfma_f32_16x16x32_bf16 a[136:139], a[144:147], v[72:75], a[136:139]
v_cvt_pk_bf16_f32 v93, v210, v211
v_exp_f32 v214, v62
v_mfma_f32_16x16x32_bf16 a[140:143], a[144:147], v[76:79], a[140:143]
s_waitcnt lgkmcnt(4)
v_exp_f32 v215, v63
v_cvt_pk_bf16_f32 v94, v212, v213
s_nop 0
v_cvt_pk_bf16_f32 v95, v214, v215
s_getpc_b64 s[48:49]
Lpc14:
s_add_u32 s48, s48, LtailA-Lpc14
s_addc_u32 s49, s49, 0
s_bfe_u32 s6, s2, 0x20003
s_lshl_b32 s6, s6, 2
s_add_u32 s6, s6, s3
s_lshl_b32 s6, s6, 7
v_min_u32 v250, 15, v220
v_lshlrev_b32 v250, 11, v250
v_add_u32 v250, s6, v250
v_min_u32 v250, Lend-LtailA, v250
v_mov_b32 v251, s49
v_add_co_u32 v250, vcc, s48, v250
s_nop 1
v_addc_co_u32 v251, vcc, 0, v251, vcc
global_load_dword v96, v[250:251], off
s_cmp_eq_u32 s5, 7
s_cbranch_scc1 LX2
LX1:
v_mfma_f32_16x16x32_bf16 v[32:35], a[224:227], v[160:163], v[104:107]
ds_read_b128 a[192:195], v217 offset:24576
ds_read_b128 a[196:199], v217 offset:25600
ds_read_b128 a[200:203], v217 offset:26624
v_mfma_f32_16x16x32_bf16 v[32:35], a[228:231], v[164:167], v[32:35]
v_exp_f32 v208, v0
v_mfma_f32_16x16x32_bf16 v[32:35], a[232:235], v[168:171], v[32:35]
ds_read_b128 a[204:207], v217 offset:27648
v_exp_f32 v209, v1
v_mfma_f32_16x16x32_bf16 v[32:35], a[236:239], v[172:175], v[32:35]
v_exp_f32 v210, v2
v_mfma_f32_16x16x32_bf16 v[36:39], a[236:239], v[188:191], v[108:111]
v_cvt_pk_bf16_f32 v64, v208, v209
v_exp_f32 v211, v3
v_mfma_f32_16x16x32_bf16 v[36:39], a[232:235], v[184:187], v[36:39]
v_exp_f32 v212, v8
v_mfma_f32_16x16x32_bf16 v[36:39], a[228:231], v[180:183], v[36:39]
v_cvt_pk_bf16_f32 v65, v210, v211
v_exp_f32 v213, v9
v_mfma_f32_16x16x32_bf16 v[36:39], a[224:227], v[176:179], v[36:39]
s_waitcnt lgkmcnt(4)
ds_read_b128 a[208:211], v217 offset:28672
v_cvt_pk_bf16_f32 v66, v212, v213
v_mfma_f32_16x16x32_bf16 v[44:47], a[240:243], v[176:179], v[108:111]
ds_read_b128 a[212:215], v217 offset:29696
ds_read_b128 a[216:219], v217 offset:30720
ds_read_b128 a[220:223], v217 offset:31744
v_mfma_f32_16x16x32_bf16 v[44:47], a[244:247], v[180:183], v[44:47]
v_exp_f32 v214, v10
v_mfma_f32_16x16x32_bf16 v[44:47], a[248:251], v[184:187], v[44:47]
v_exp_f32 v215, v11
v_mfma_f32_16x16x32_bf16 v[44:47], a[252:255], v[188:191], v[44:47]
v_exp_f32 v208, v16
v_mfma_f32_16x16x32_bf16 v[40:43], a[252:255], v[172:175], v[104:107]
v_exp_f32 v209, v17
v_mfma_f32_16x16x32_bf16 v[40:43], a[248:251], v[168:171], v[40:43]
v_cvt_pk_bf16_f32 v67, v214, v215
v_cvt_pk_bf16_f32 v68, v208, v209
v_mfma_f32_16x16x32_bf16 v[40:43], a[244:247], v[164:167], v[40:43]
v_exp_f32 v210, v18
v_mfma_f32_16x16x32_bf16 v[40:43], a[240:243], v[160:163], v[40:43]
s_waitcnt lgkmcnt(4)
ds_read_b128 a[224:227], v218 offset:24576
ds_read_b128 a[228:231], v218 offset:25600
v_mfma_f32_16x16x32_bf16 v[48:51], a[192:195], v[160:163], v[104:107]
v_exp_f32 v211, v19
v_mfma_f32_16x16x32_bf16 v[48:51], a[196:199], v[164:167], v[48:51]
ds_read_b128 a[232:235], v218 offset:26624
v_cvt_pk_bf16_f32 v69, v210, v211
v_mfma_f32_16x16x32_bf16 v[48:51], a[200:203], v[168:171], v[48:51]
v_exp_f32 v212, v24
v_mfma_f32_16x16x32_bf16 v[48:51], a[204:207], v[172:175], v[48:51]
v_exp_f32 v213, v25
v_mfma_f32_16x16x32_bf16 v[52:55], a[204:207], v[188:191], v[108:111]
ds_read_b128 a[236:239], v218 offset:27648
v_cvt_pk_bf16_f32 v70, v212, v213
v_mfma_f32_16x16x32_bf16 v[52:55], a[200:203], v[184:187], v[52:55]
v_exp_f32 v214, v26
v_mfma_f32_16x16x32_bf16 v[52:55], a[196:199], v[180:183], v[52:55]
v_exp_f32 v215, v27
v_mfma_f32_16x16x32_bf16 v[52:55], a[192:195], v[176:179], v[52:55]
s_waitcnt lgkmcnt(4)
ds_read_b128 a[240:243], v218 offset:28672
v_cvt_pk_bf16_f32 v71, v214, v215
v_mfma_f32_16x16x32_bf16 v[60:63], a[208:211], v[176:179], v[108:111]
v_exp_f32 v208, v4
v_mfma_f32_16x16x32_bf16 v[60:63], a[212:215], v[180:183], v[60:63]
ds_read_b128 a[244:247], v218 offset:29696
ds_read_b128 a[248:251], v218 offset:30720
v_mfma_f32_16x16x32_bf16 v[60:63], a[216:219], v[184:187], v[60:63]
v_exp_f32 v209, v5
v_mfma_f32_16x16x32_bf16 v[60:63], a[220:223], v[188:191], v[60:63]
ds_read_b128 a[252:255], v218 offset:31744
v_xor_b32 v217, 0x8000, v217
v_mfma_f32_16x16x32_bf16 v[56:59], a[220:223], v[172:175], v[104:107]
v_exp_f32 v210, v6
v_mfma_f32_16x16x32_bf16 v[56:59], a[216:219], v[168:171], v[56:59]
v_exp_f32 v211, v7
v_mfma_f32_16x16x32_bf16 v[56:59], a[212:215], v[164:167], v[56:59]
v_cvt_pk_bf16_f32 v72, v208, v209
v_cvt_pk_bf16_f32 v73, v210, v211
v_mfma_f32_16x16x32_bf16 v[56:59], a[208:211], v[160:163], v[56:59]
s_waitcnt vmcnt(12) lgkmcnt(4)
s_barrier
v_mfma_f32_16x16x32_bf16 a[32:35], a[224:227], v[84:87], a[32:35]
s_and_b32 m0, s68, 0xffff
ds_read_b128 a[192:195], v217 offset:0
ds_read_b128 a[196:199], v217 offset:1024
v_mfma_f32_16x16x32_bf16 a[36:39], a[228:231], v[84:87], a[36:39]
buffer_load_dwordx4 v216, s[8:11], s68 offen offset:0 lds
v_mfma_f32_16x16x32_bf16 a[68:71], a[228:231], v[88:91], a[68:71]
ds_read_b128 a[200:203], v217 offset:2048
ds_read_b128 a[204:207], v217 offset:3072
v_mfma_f32_16x16x32_bf16 a[64:67], a[224:227], v[88:91], a[64:67]
v_exp_f32 v212, v12
v_mfma_f32_16x16x32_bf16 a[96:99], a[224:227], v[92:95], a[96:99]
buffer_load_dwordx4 v216, s[8:11], s68 offen offset:1024 lds
v_mfma_f32_16x16x32_bf16 a[100:103], a[228:231], v[92:95], a[100:103]
v_exp_f32 v213, v13
v_mfma_f32_16x16x32_bf16 a[104:107], a[232:235], v[92:95], a[104:107]
v_exp_f32 v214, v14
v_mfma_f32_16x16x32_bf16 a[108:111], a[236:239], v[92:95], a[108:111]
buffer_load_dwordx4 v216, s[8:11], s68 offen offset:2048 lds
v_mfma_f32_16x16x32_bf16 a[76:79], a[236:239], v[88:91], a[76:79]
v_exp_f32 v215, v15
v_mfma_f32_16x16x32_bf16 a[72:75], a[232:235], v[88:91], a[72:75]
v_cvt_pk_bf16_f32 v74, v212, v213
v_cvt_pk_bf16_f32 v75, v214, v215
v_mfma_f32_16x16x32_bf16 a[40:43], a[232:235], v[84:87], a[40:43]
buffer_load_dwordx4 v216, s[8:11], s68 offen offset:3072 lds
v_mfma_f32_16x16x32_bf16 a[44:47], a[236:239], v[84:87], a[44:47]
s_waitcnt lgkmcnt(4)
ds_read_b128 a[208:211], v217 offset:4096
ds_read_b128 a[212:215], v217 offset:5120
v_mfma_f32_16x16x32_bf16 a[48:51], a[240:243], v[84:87], a[48:51]
s_xor_b32 m0, m0, 0x18000
v_exp_f32 v208, v20
v_mfma_f32_16x16x32_bf16 a[52:55], a[244:247], v[84:87], a[52:55]
ds_read_b128 a[216:219], v217 offset:6144
ds_read_b128 a[220:223], v217 offset:7168
v_mfma_f32_16x16x32_bf16 a[84:87], a[244:247], v[88:91], a[84:87]
buffer_load_dwordx4 v216, s[12:15], s68 offen offset:0 lds
v_mfma_f32_16x16x32_bf16 a[80:83], a[240:243], v[88:91], a[80:83]
v_exp_f32 v209, v21
v_mfma_f32_16x16x32_bf16 a[112:115], a[240:243], v[92:95], a[112:115]
buffer_load_dwordx4 v216, s[12:15], s68 offen offset:1024 lds
v_mfma_f32_16x16x32_bf16 a[116:119], a[244:247], v[92:95], a[116:119]
v_exp_f32 v210, v22
v_mfma_f32_16x16x32_bf16 a[120:123], a[248:251], v[92:95], a[120:123]
v_exp_f32 v211, v23
v_mfma_f32_16x16x32_bf16 a[124:127], a[252:255], v[92:95], a[124:127]
buffer_load_dwordx4 v216, s[12:15], s68 offen offset:2048 lds
v_mfma_f32_16x16x32_bf16 a[92:95], a[252:255], v[88:91], a[92:95]
v_cvt_pk_bf16_f32 v76, v208, v209
v_cvt_pk_bf16_f32 v77, v210, v211
v_mfma_f32_16x16x32_bf16 a[88:91], a[248:251], v[88:91], a[88:91]
v_exp_f32 v212, v28
v_mfma_f32_16x16x32_bf16 a[56:59], a[248:251], v[84:87], a[56:59]
buffer_load_dwordx4 v216, s[12:15], s68 offen offset:3072 lds
v_mfma_f32_16x16x32_bf16 a[60:63], a[252:255], v[84:87], a[60:63]
s_add_u32 s68, s68, 16384
v_exp_f32 v213, v29
v_mfma_f32_16x16x32_bf16 a[132:135], a[144:147], v[84:87], a[132:135]
v_exp_f32 v214, v30
v_mfma_f32_16x16x32_bf16 a[136:139], a[144:147], v[88:91], a[136:139]
v_exp_f32 v215, v31
v_mfma_f32_16x16x32_bf16 a[140:143], a[144:147], v[92:95], a[140:143]
s_waitcnt lgkmcnt(4)
v_cvt_pk_bf16_f32 v78, v212, v213
v_cvt_pk_bf16_f32 v79, v214, v215
v_cmp_gt_u32 vcc, 1, v253
s_mov_b32 s6, 0
s_cmp_eq_u64 vcc, 0
s_cbranch_scc1 Lok15
Lsp16:
s_sleep 2
global_load_dword v253, v222, s[66:67] sc1
s_waitcnt vmcnt(0)
v_cmp_gt_u32 vcc, 1, v253
s_add_u32 s6, s6, 1
s_cmp_gt_u32 s6, 200000
s_cbranch_scc1 Lok15
s_cmp_lg_u64 vcc, 0
s_cbranch_scc1 Lsp16
Lok15:
v_accvgpr_read_b32 v200, a32
v_accvgpr_read_b32 v201, a33
v_accvgpr_read_b32 v202, a34
v_accvgpr_read_b32 v203, a35
v_accvgpr_read_b32 v204, a36
v_accvgpr_read_b32 v205, a37
v_accvgpr_read_b32 v206, a38
v_accvgpr_read_b32 v207, a39
v_accvgpr_read_b32 v198, a132
v_rcp_f32 v198, v198
s_nop 0
v_pk_mul_f32 v[200:201], v[200:201], v[198:199] op_sel_hi:[1,0]
v_pk_mul_f32 v[202:203], v[202:203], v[198:199] op_sel_hi:[1,0]
v_pk_mul_f32 v[204:205], v[204:205], v[198:199] op_sel_hi:[1,0]
v_pk_mul_f32 v[206:207], v[206:207], v[198:199] op_sel_hi:[1,0]
v_cvt_pk_bf16_f32 v240, v200, v201
v_cvt_pk_bf16_f32 v241, v202, v203
v_cvt_pk_bf16_f32 v242, v204, v205
v_cvt_pk_bf16_f32 v243, v206, v207
v_accvgpr_read_b32 v200, a40
v_accvgpr_read_b32 v201, a41
v_accvgpr_read_b32 v202, a42
v_accvgpr_read_b32 v203, a43
v_accvgpr_read_b32 v204, a44
v_accvgpr_read_b32 v205, a45
v_accvgpr_read_b32 v206, a46
v_accvgpr_read_b32 v207, a47
v_pk_mul_f32 v[200:201], v[200:201], v[198:199] op_sel_hi:[1,0]
v_pk_mul_f32 v[202:203], v[202:203], v[198:199] op_sel_hi:[1,0]
v_pk_mul_f32 v[204:205], v[204:205], v[198:199] op_sel_hi:[1,0]
v_pk_mul_f32 v[206:207], v[206:207], v[198:199] op_sel_hi:[1,0]
v_cvt_pk_bf16_f32 v244, v200, v201
v_cvt_pk_bf16_f32 v245, v202, v203
v_cvt_pk_bf16_f32 v246, v204, v205
v_cvt_pk_bf16_f32 v247, v206, v207
v_accvgpr_read_b32 v200, a48
v_accvgpr_read_b32 v201, a49
v_accvgpr_read_b32 v202, a50
v_accvgpr_read_b32 v203, a51
v_accvgpr_read_b32 v204, a52
v_accvgpr_read_b32 v205, a53
v_accvgpr_read_b32 v206, a54
v_accvgpr_read_b32 v207, a55
v_pk_mul_f32 v[200:201], v[200:201], v[198:199] op_sel_hi:[1,0]
v_pk_mul_f32 v[202:203], v[202:203], v[198:199] op_sel_hi:[1,0]
v_pk_mul_f32 v[204:205], v[204:205], v[198:199] op_sel_hi:[1,0]
v_pk_mul_f32 v[206:207], v[206:207], v[198:199] op_sel_hi:[1,0]
v_cvt_pk_bf16_f32 v248, v200, v201
v_cvt_pk_bf16_f32 v249, v202, v203
v_cvt_pk_bf16_f32 v250, v204, v205
v_cvt_pk_bf16_f32 v251, v206, v207
v_accvgpr_read_b32 v200, a56
v_accvgpr_read_b32 v201, a57
v_accvgpr_read_b32 v202, a58
v_accvgpr_read_b32 v203, a59
v_accvgpr_read_b32 v204, a60
v_accvgpr_read_b32 v205, a61
v_accvgpr_read_b32 v206, a62
v_accvgpr_read_b32 v207, a63
v_pk_mul_f32 v[200:201], v[200:201], v[198:199] op_sel_hi:[1,0]
v_pk_mul_f32 v[202:203], v[202:203], v[198:199] op_sel_hi:[1,0]
v_pk_mul_f32 v[204:205], v[204:205], v[198:199] op_sel_hi:[1,0]
v_pk_mul_f32 v[206:207], v[206:207], v[198:199] op_sel_hi:[1,0]
v_cvt_pk_bf16_f32 v252, v200, v201
v_cvt_pk_bf16_f32 v253, v202, v203
v_cvt_pk_bf16_f32 v254, v204, v205
v_cvt_pk_bf16_f32 v255, v206, v207
v_mfma_f32_16x16x32_bf16 v[0:3], a[192:195], v[160:163], v[104:107]
s_sub_u32 s71, s71, 1
ds_read_b128 a[224:227], v217 offset:8192
ds_read_b128 a[228:231], v217 offset:9216
v_mfma_f32_16x16x32_bf16 v[0:3], a[196:199], v[164:167], v[0:3]
buffer_store_dwordx4 v[240:243], v216, s[28:31], s43 offen offset:0 sc1
v_mfma_f32_16x16x32_bf16 v[0:3], a[200:203], v[168:171], v[0:3]
ds_read_b128 a[232:235], v217 offset:10240
ds_read_b128 a[236:239], v217 offset:11264
v_mfma_f32_16x16x32_bf16 v[0:3], a[204:207], v[172:175], v[0:3]
v_exp_f32 v208, v32
v_mfma_f32_16x16x32_bf16 v[4:7], a[204:207], v[188:191], v[108:111]
v_exp_f32 v209, v33
v_mfma_f32_16x16x32_bf16 v[4:7], a[200:203], v[184:187], v[4:7]
v_exp_f32 v210, v34
v_mfma_f32_16x16x32_bf16 v[4:7], a[196:199], v[180:183], v[4:7]
v_exp_f32 v211, v35
v_mfma_f32_16x16x32_bf16 v[4:7], a[192:195], v[176:179], v[4:7]
s_waitcnt lgkmcnt(4)
ds_read_b128 a[240:243], v217 offset:12288
v_cvt_pk_bf16_f32 v80, v208, v209
v_mfma_f32_16x16x32_bf16 v[12:15], a[208:211], v[176:179], v[108:111]
ds_read_b128 a[244:247], v217 offset:13312
v_cvt_pk_bf16_f32 v81, v210, v211
v_mfma_f32_16x16x32_bf16 v[12:15], a[212:215], v[180:183], v[12:15]
v_exp_f32 v212, v40
v_mfma_f32_16x16x32_bf16 v[12:15], a[216:219], v[184:187], v[12:15]
ds_read_b128 a[248:251], v217 offset:14336
ds_read_b128 a[252:255], v217 offset:15360
v_mfma_f32_16x16x32_bf16 v[12:15], a[220:223], v[188:191], v[12:15]
v_exp_f32 v213, v41
v_mfma_f32_16x16x32_bf16 v[8:11], a[220:223], v[172:175], v[104:107]
v_xor_b32 v218, 0x8000, v218
v_cvt_pk_bf16_f32 v82, v212, v213
v_mfma_f32_16x16x32_bf16 v[8:11], a[216:219], v[168:171], v[8:11]
v_exp_f32 v214, v42
v_mfma_f32_16x16x32_bf16 v[8:11], a[212:215], v[164:167], v[8:11]
v_exp_f32 v215, v43
v_mfma_f32_16x16x32_bf16 v[8:11], a[208:211], v[160:163], v[8:11]
s_waitcnt lgkmcnt(4)
ds_read_b128 a[192:195], v218 offset:0
v_cvt_pk_bf16_f32 v83, v214, v215
v_mfma_f32_16x16x32_bf16 v[16:19], a[224:227], v[160:163], v[104:107]
buffer_store_dwordx4 v[244:247], v216, s[28:31], s43 offen offset:1024 sc1
v_mfma_f32_16x16x32_bf16 v[16:19], a[228:231], v[164:167], v[16:19]
ds_read_b128 a[196:199], v218 offset:8192
ds_read_b128 a[200:203], v218 offset:1024
v_mfma_f32_16x16x32_bf16 v[16:19], a[232:235], v[168:171], v[16:19]
v_exp_f32 v208, v48
v_mfma_f32_16x16x32_bf16 v[16:19], a[236:239], v[172:175], v[16:19]
v_exp_f32 v209, v49
v_mfma_f32_16x16x32_bf16 v[20:23], a[236:239], v[188:191], v[108:111]
ds_read_b128 a[204:207], v218 offset:9216
v_cvt_pk_bf16_f32 v84, v208, v209
v_mfma_f32_16x16x32_bf16 v[20:23], a[232:235], v[184:187], v[20:23]
v_exp_f32 v210, v50
v_mfma_f32_16x16x32_bf16 v[20:23], a[228:231], v[180:183], v[20:23]
v_exp_f32 v211, v51
v_mfma_f32_16x16x32_bf16 v[20:23], a[224:227], v[176:179], v[20:23]
s_waitcnt lgkmcnt(4)
ds_read_b128 a[208:211], v218 offset:2048
v_cvt_pk_bf16_f32 v85, v210, v211
v_mfma_f32_16x16x32_bf16 v[28:31], a[240:243], v[176:179], v[108:111]
v_exp_f32 v212, v56
v_mfma_f32_16x16x32_bf16 v[28:31], a[244:247], v[180:183], v[28:31]
ds_read_b128 a[212:215], v218 offset:10240
ds_read_b128 a[216:219], v218 offset:3072
v_mfma_f32_16x16x32_bf16 v[28:31], a[248:251], v[184:187], v[28:31]
v_exp_f32 v213, v57
v_mfma_f32_16x16x32_bf16 v[28:31], a[252:255], v[188:191], v[28:31]
ds_read_b128 a[220:223], v218 offset:11264
v_cvt_pk_bf16_f32 v86, v212, v213
v_mfma_f32_16x16x32_bf16 v[24:27], a[252:255], v[172:175], v[104:107]
v_exp_f32 v214, v58
v_mfma_f32_16x16x32_bf16 v[24:27], a[248:251], v[168:171], v[24:27]
v_exp_f32 v215, v59
v_mfma_f32_16x16x32_bf16 v[24:27], a[244:247], v[164:167], v[24:27]
v_exp_f32 v208, v36
v_mfma_f32_16x16x32_bf16 v[24:27], a[240:243], v[160:163], v[24:27]
s_waitcnt vmcnt(10) lgkmcnt(4)
s_barrier
v_mfma_f32_16x16x32_bf16 a[64:67], a[192:195], v[64:67], a[64:67]
s_and_b32 m0, s68, 0xffff
ds_read_b128 a[224:227], v218 offset:4096
v_cvt_pk_bf16_f32 v87, v214, v215
v_mfma_f32_16x16x32_bf16 a[64:67], a[196:199], v[68:71], a[64:67]
buffer_load_dwordx4 v216, s[8:11], s68 offen offset:0 lds
v_mfma_f32_16x16x32_bf16 a[96:99], a[196:199], v[76:79], a[96:99]
ds_read_b128 a[228:231], v218 offset:12288
ds_read_b128 a[232:235], v218 offset:5120
v_mfma_f32_16x16x32_bf16 a[96:99], a[192:195], v[72:75], a[96:99]
v_exp_f32 v209, v37
v_mfma_f32_16x16x32_bf16 a[100:103], a[200:203], v[72:75], a[100:103]
ds_read_b128 a[236:239], v218 offset:13312
v_cvt_pk_bf16_f32 v88, v208, v209
v_mfma_f32_16x16x32_bf16 a[100:103], a[204:207], v[76:79], a[100:103]
buffer_load_dwordx4 v216, s[8:11], s68 offen offset:1024 lds
v_mfma_f32_16x16x32_bf16 a[68:71], a[204:207], v[68:71], a[68:71]
v_exp_f32 v210, v38
v_mfma_f32_16x16x32_bf16 a[68:71], a[200:203], v[64:67], a[68:71]
s_waitcnt lgkmcnt(4)
ds_read_b128 a[240:243], v218 offset:6144
ds_read_b128 a[244:247], v218 offset:14336
v_mfma_f32_16x16x32_bf16 a[72:75], a[208:211], v[64:67], a[72:75]
v_exp_f32 v211, v39
v_mfma_f32_16x16x32_bf16 a[72:75], a[212:215], v[68:71], a[72:75]
ds_read_b128 a[248:251], v218 offset:7168
v_cvt_pk_bf16_f32 v89, v210, v211
v_mfma_f32_16x16x32_bf16 a[104:107], a[212:215], v[76:79], a[104:107]
buffer_load_dwordx4 v216, s[8:11], s68 offen offset:2048 lds
v_mfma_f32_16x16x32_bf16 a[104:107], a[208:211], v[72:75], a[104:107]
v_exp_f32 v212, v44
v_mfma_f32_16x16x32_bf16 a[108:111], a[216:219], v[72:75], a[108:111]
v_exp_f32 v213, v45
v_mfma_f32_16x16x32_bf16 a[108:111], a[220:223], v[76:79], a[108:111]
ds_read_b128 a[252:255], v218 offset:15360
v_cvt_pk_bf16_f32 v90, v212, v213
v_mfma_f32_16x16x32_bf16 a[76:79], a[220:223], v[68:71], a[76:79]
buffer_load_dwordx4 v216, s[8:11], s68 offen offset:3072 lds
v_mfma_f32_16x16x32_bf16 a[76:79], a[216:219], v[64:67], a[76:79]
s_waitcnt lgkmcnt(4)
ds_read_b128 a[192:195], v217 offset:16384
ds_read_b128 a[196:199], v217 offset:17408
v_mfma_f32_16x16x32_bf16 a[80:83], a[224:227], v[64:67], a[80:83]
s_xor_b32 m0, m0, 0x18000
v_exp_f32 v214, v46
v_mfma_f32_16x16x32_bf16 a[80:83], a[228:231], v[68:71], a[80:83]
ds_read_b128 a[200:203], v217 offset:18432
ds_read_b128 a[204:207], v217 offset:19456
v_mfma_f32_16x16x32_bf16 a[112:115], a[228:231], v[76:79], a[112:115]
buffer_load_dwordx4 v216, s[12:15], s68 offen offset:0 lds
v_mfma_f32_16x16x32_bf16 a[112:115], a[224:227], v[72:75], a[112:115]
v_exp_f32 v215, v47
v_mfma_f32_16x16x32_bf16 a[116:119], a[232:235], v[72:75], a[116:119]
v_exp_f32 v208, v52
v_mfma_f32_16x16x32_bf16 a[116:119], a[236:239], v[76:79], a[116:119]
v_exp_f32 v209, v53
v_mfma_f32_16x16x32_bf16 a[84:87], a[236:239], v[68:71], a[84:87]
buffer_load_dwordx4 v216, s[12:15], s68 offen offset:1024 lds
v_mfma_f32_16x16x32_bf16 a[84:87], a[232:235], v[64:67], a[84:87]
s_waitcnt lgkmcnt(4)
ds_read_b128 a[208:211], v217 offset:20480
v_cvt_pk_bf16_f32 v91, v214, v215
v_mfma_f32_16x16x32_bf16 a[88:91], a[240:243], v[64:67], a[88:91]
ds_read_b128 a[212:215], v217 offset:21504
v_cvt_pk_bf16_f32 v92, v208, v209
v_mfma_f32_16x16x32_bf16 a[88:91], a[244:247], v[68:71], a[88:91]
v_exp_f32 v210, v54
v_mfma_f32_16x16x32_bf16 a[120:123], a[244:247], v[76:79], a[120:123]
ds_read_b128 a[216:219], v217 offset:22528
ds_read_b128 a[220:223], v217 offset:23552
v_mfma_f32_16x16x32_bf16 a[120:123], a[240:243], v[72:75], a[120:123]
buffer_load_dwordx4 v216, s[12:15], s68 offen offset:2048 lds
v_mfma_f32_16x16x32_bf16 a[124:127], a[248:251], v[72:75], a[124:127]
v_exp_f32 v211, v55
v_mfma_f32_16x16x32_bf16 a[124:127], a[252:255], v[76:79], a[124:127]
v_exp_f32 v212, v60
v_mfma_f32_16x16x32_bf16 a[92:95], a[252:255], v[68:71], a[92:95]
buffer_load_dwordx4 v216, s[12:15], s68 offen offset:3072 lds
v_mfma_f32_16x16x32_bf16 a[92:95], a[248:251], v[64:67], a[92:95]
s_add_u32 s68, s68, 16384
v_exp_f32 v213, v61
v_mfma_f32_16x16x32_bf16 a[136:139], a[144:147], v[64:67], a[136:139]
v_cvt_pk_bf16_f32 v93, v210, v211
v_cvt_pk_bf16_f32 v94, v212, v213
v_mfma_f32_16x16x32_bf16 a[136:139], a[144:147], v[68:71], a[136:139]
v_exp_f32 v214, v62
v_mfma_f32_16x16x32_bf16 a[140:143], a[144:147], v[72:75], a[140:143]
v_exp_f32 v215, v63
v_mfma_f32_16x16x32_bf16 a[140:143], a[144:147], v[76:79], a[140:143]
s_waitcnt lgkmcnt(4)
v_cvt_pk_bf16_f32 v95, v214, v215
v_mfma_f32_16x16x32_bf16 v[32:35], a[192:195], v[160:163], v[104:107]
ds_read_b128 a[224:227], v217 offset:24576
ds_read_b128 a[228:231], v217 offset:25600
v_mfma_f32_16x16x32_bf16 v[32:35], a[196:199], v[164:167], v[32:35]
buffer_store_dwordx4 v[248:251], v216, s[28:31], s43 offen offset:2048 sc1
v_mfma_f32_16x16x32_bf16 v[32:35], a[200:203], v[168:171], v[32:35]
ds_read_b128 a[232:235], v217 offset:26624
ds_read_b128 a[236:239], v217 offset:27648
v_mfma_f32_16x16x32_bf16 v[32:35], a[204:207], v[172:175], v[32:35]
v_exp_f32 v208, v0
v_mfma_f32_16x16x32_bf16 v[36:39], a[204:207], v[188:191], v[108:111]
v_exp_f32 v209, v1
v_mfma_f32_16x16x32_bf16 v[36:39], a[200:203], v[184:187], v[36:39]
v_exp_f32 v210, v2
v_mfma_f32_16x16x32_bf16 v[36:39], a[196:199], v[180:183], v[36:39]
v_exp_f32 v211, v3
v_mfma_f32_16x16x32_bf16 v[36:39], a[192:195], v[176:179], v[36:39]
s_waitcnt lgkmcnt(4)
ds_read_b128 a[240:243], v217 offset:28672
v_cvt_pk_bf16_f32 v64, v208, v209
v_mfma_f32_16x16x32_bf16 v[44:47], a[208:211], v[176:179], v[108:111]
ds_read_b128 a[244:247], v217 offset:29696
v_cvt_pk_bf16_f32 v65, v210, v211
v_mfma_f32_16x16x32_bf16 v[44:47], a[212:215], v[180:183], v[44:47]
v_exp_f32 v212, v8
v_mfma_f32_16x16x32_bf16 v[44:47], a[216:219], v[184:187], v[44:47]
ds_read_b128 a[248:251], v217 offset:30720
ds_read_b128 a[252:255], v217 offset:31744
v_mfma_f32_16x16x32_bf16 v[44:47], a[220:223], v[188:191], v[44:47]
v_exp_f32 v213, v9
v_mfma_f32_16x16x32_bf16 v[40:43], a[220:223], v[172:175], v[104:107]
v_exp_f32 v214, v10
v_mfma_f32_16x16x32_bf16 v[40:43], a[216:219], v[168:171], v[40:43]
v_exp_f32 v215, v11
v_mfma_f32_16x16x32_bf16 v[40:43], a[212:215], v[164:167], v[40:43]
v_cvt_pk_bf16_f32 v66, v212, v213
v_cvt_pk_bf16_f32 v67, v214, v215
v_mfma_f32_16x16x32_bf16 v[40:43], a[208:211], v[160:163], v[40:43]
s_waitcnt lgkmcnt(4)
ds_read_b128 a[192:195], v218 offset:16384
ds_read_b128 a[196:199], v218 offset:24576
v_mfma_f32_16x16x32_bf16 v[48:51], a[224:227], v[160:163], v[104:107]
buffer_store_dwordx4 v[252:255], v216, s[28:31], s43 offen offset:3072 sc1
v_mfma_f32_16x16x32_bf16 v[48:51], a[228:231], v[164:167], v[48:51]
ds_read_b128 a[200:203], v218 offset:17408
ds_read_b128 a[204:207], v218 offset:25600
v_mfma_f32_16x16x32_bf16 v[48:51], a[232:235], v[168:171], v[48:51]
v_exp_f32 v208, v16
v_mfma_f32_16x16x32_bf16 v[48:51], a[236:239], v[172:175], v[48:51]
v_exp_f32 v209, v17
v_mfma_f32_16x16x32_bf16 v[52:55], a[236:239], v[188:191], v[108:111]
v_exp_f32 v210, v18
v_mfma_f32_16x16x32_bf16 v[52:55], a[232:235], v[184:187], v[52:55]
v_exp_f32 v211, v19
v_mfma_f32_16x16x32_bf16 v[52:55], a[228:231], v[180:183], v[52:55]
v_cvt_pk_bf16_f32 v68, v208, v209
v_cvt_pk_bf16_f32 v69, v210, v211
v_mfma_f32_16x16x32_bf16 v[52:55], a[224:227], v[176:179], v[52:55]
s_waitcnt lgkmcnt(4)
ds_read_b128 a[208:211], v218 offset:18432
ds_read_b128 a[212:215], v218 offset:26624
v_mfma_f32_16x16x32_bf16 v[60:63], a[240:243], v[176:179], v[108:111]
v_exp_f32 v212, v24
v_mfma_f32_16x16x32_bf16 v[60:63], a[244:247], v[180:183], v[60:63]
ds_read_b128 a[216:219], v218 offset:19456
ds_read_b128 a[220:223], v218 offset:27648
v_mfma_f32_16x16x32_bf16 v[60:63], a[248:251], v[184:187], v[60:63]
v_exp_f32 v213, v25
v_mfma_f32_16x16x32_bf16 v[60:63], a[252:255], v[188:191], v[60:63]
v_exp_f32 v214, v26
v_mfma_f32_16x16x32_bf16 v[56:59], a[252:255], v[172:175], v[104:107]
v_exp_f32 v215, v27
v_mfma_f32_16x16x32_bf16 v[56:59], a[248:251], v[168:171], v[56:59]
v_cvt_pk_bf16_f32 v70, v212, v213
v_cvt_pk_bf16_f32 v71, v214, v215
v_mfma_f32_16x16x32_bf16 v[56:59], a[244:247], v[164:167], v[56:59]
v_exp_f32 v208, v4
v_mfma_f32_16x16x32_bf16 v[56:59], a[240:243], v[160:163], v[56:59]
s_waitcnt vmcnt(12) lgkmcnt(4)
s_barrier
v_mfma_f32_16x16x32_bf16 a[64:67], a[192:195], v[80:83], a[64:67]
s_and_b32 m0, s68, 0xffff
ds_read_b128 a[224:227], v218 offset:20480
ds_read_b128 a[228:231], v218 offset:28672
v_mfma_f32_16x16x32_bf16 a[64:67], a[196:199], v[84:87], a[64:67]
buffer_load_dwordx4 v216, s[8:11], s68 offen offset:0 lds
v_mfma_f32_16x16x32_bf16 a[96:99], a[196:199], v[92:95], a[96:99]
ds_read_b128 a[232:235], v218 offset:21504
ds_read_b128 a[236:239], v218 offset:29696
v_mfma_f32_16x16x32_bf16 a[96:99], a[192:195], v[88:91], a[96:99]
v_exp_f32 v209, v5
v_mfma_f32_16x16x32_bf16 a[100:103], a[200:203], v[88:91], a[100:103]
v_exp_f32 v210, v6
v_mfma_f32_16x16x32_bf16 a[100:103], a[204:207], v[92:95], a[100:103]
buffer_load_dwordx4 v216, s[8:11], s68 offen offset:1024 lds
v_mfma_f32_16x16x32_bf16 a[68:71], a[204:207], v[84:87], a[68:71]
v_exp_f32 v211, v7
v_mfma_f32_16x16x32_bf16 a[68:71], a[200:203], v[80:83], a[68:71]
s_waitcnt lgkmcnt(4)
ds_read_b128 a[240:243], v218 offset:22528
v_cvt_pk_bf16_f32 v72, v208, v209
v_mfma_f32_16x16x32_bf16 a[72:75], a[208:211], v[80:83], a[72:75]
ds_read_b128 a[244:247], v218 offset:30720
v_cvt_pk_bf16_f32 v73, v210, v211
v_mfma_f32_16x16x32_bf16 a[72:75], a[212:215], v[84:87], a[72:75]
buffer_load_dwordx4 v216, s[8:11], s68 offen offset:2048 lds
v_mfma_f32_16x16x32_bf16 a[104:107], a[212:215], v[92:95], a[104:107]
ds_read_b128 a[248:251], v218 offset:23552
ds_read_b128 a[252:255], v218 offset:31744
v_mfma_f32_16x16x32_bf16 a[104:107], a[208:211], v[88:91], a[104:107]
v_exp_f32 v212, v12
v_mfma_f32_16x16x32_bf16 a[108:111], a[216:219], v[88:91], a[108:111]
v_exp_f32 v213, v13
v_mfma_f32_16x16x32_bf16 a[108:111], a[220:223], v[92:95], a[108:111]
v_xor_b32 v217, 0x8000, v217
v_cvt_pk_bf16_f32 v74, v212, v213
v_mfma_f32_16x16x32_bf16 a[76:79], a[220:223], v[84:87], a[76:79]
buffer_load_dwordx4 v216, s[8:11], s68 offen offset:3072 lds
v_mfma_f32_16x16x32_bf16 a[76:79], a[216:219], v[80:83], a[76:79]
s_waitcnt lgkmcnt(4)
ds_read_b128 a[192:195], v217 offset:0
ds_read_b128 a[196:199], v217 offset:1024
v_mfma_f32_16x16x32_bf16 a[80:83], a[224:227], v[80:83], a[80:83]
s_xor_b32 m0, m0, 0x18000
v_exp_f32 v214, v14
v_mfma_f32_16x16x32_bf16 a[80:83], a[228:231], v[84:87], a[80:83]
ds_read_b128 a[200:203], v217 offset:2048
ds_read_b128 a[204:207], v217 offset:3072
v_mfma_f32_16x16x32_bf16 a[112:115], a[228:231], v[92:95], a[112:115]
buffer_load_dwordx4 v216, s[12:15], s68 offen offset:0 lds
v_mfma_f32_16x16x32_bf16 a[112:115], a[224:227], v[88:91], a[112:115]
v_exp_f32 v215, v15
v_mfma_f32_16x16x32_bf16 a[116:119], a[232:235], v[88:91], a[116:119]
v_exp_f32 v208, v20
v_mfma_f32_16x16x32_bf16 a[116:119], a[236:239], v[92:95], a[116:119]
v_exp_f32 v209, v21
v_mfma_f32_16x16x32_bf16 a[84:87], a[236:239], v[84:87], a[84:87]
buffer_load_dwordx4 v216, s[12:15], s68 offen offset:1024 lds
v_mfma_f32_16x16x32_bf16 a[84:87], a[232:235], v[80:83], a[84:87]
s_waitcnt lgkmcnt(4)
ds_read_b128 a[208:211], v217 offset:4096
v_cvt_pk_bf16_f32 v75, v214, v215
v_mfma_f32_16x16x32_bf16 a[88:91], a[240:243], v[80:83], a[88:91]
ds_read_b128 a[212:215], v217 offset:5120
v_cvt_pk_bf16_f32 v76, v208, v209
v_mfma_f32_16x16x32_bf16 a[88:91], a[244:247], v[84:87], a[88:91]
v_exp_f32 v210, v22
v_mfma_f32_16x16x32_bf16 a[120:123], a[244:247], v[92:95], a[120:123]
ds_read_b128 a[216:219], v217 offset:6144
ds_read_b128 a[220:223], v217 offset:7168
v_mfma_f32_16x16x32_bf16 a[120:123], a[240:243], v[88:91], a[120:123]
buffer_load_dwordx4 v216, s[12:15], s68 offen offset:2048 lds
v_mfma_f32_16x16x32_bf16 a[124:127], a[248:251], v[88:91], a[124:127]
v_exp_f32 v211, v23
v_mfma_f32_16x16x32_bf16 a[124:127], a[252:255], v[92:95], a[124:127]
Lpad20:
s_cbranch_execz Lpad30
v_exp_f32 v212, v28
v_mfma_f32_16x16x32_bf16 a[92:95], a[252:255], v[84:87], a[92:95]
buffer_load_dwordx4 v216, s[12:15], s68 offen offset:3072 lds
v_mfma_f32_16x16x32_bf16 a[92:95], a[248:251], v[80:83], a[92:95]
s_add_u32 s68, s68, 16384
v_exp_f32 v213, v29
v_mfma_f32_16x16x32_bf16 a[136:139], a[144:147], v[80:83], a[136:139]
v_cvt_pk_bf16_f32 v77, v210, v211
v_cvt_pk_bf16_f32 v78, v212, v213
v_mfma_f32_16x16x32_bf16 a[136:139], a[144:147], v[84:87], a[136:139]
v_exp_f32 v214, v30
v_mfma_f32_16x16x32_bf16 a[140:143], a[144:147], v[88:91], a[140:143]
v_exp_f32 v215, v31
v_mfma_f32_16x16x32_bf16 a[140:143], a[144:147], v[92:95], a[140:143]
s_waitcnt lgkmcnt(4)
v_cvt_pk_bf16_f32 v79, v214, v215
s_cmp_eq_u32 s71, 0
s_cbranch_scc1 LtailA
s_nop 0
Lloop2:
v_mfma_f32_16x16x32_bf16 v[0:3], a[192:195], v[160:163], v[104:107]
s_sub_u32 s71, s71, 1
ds_read_b128 a[224:227], v217 offset:8192
ds_read_b128 a[228:231], v217 offset:9216
v_mfma_f32_16x16x32_bf16 v[0:3], a[196:199], v[164:167], v[0:3]
v_exp_f32 v208, v32
v_mfma_f32_16x16x32_bf16 v[0:3], a[200:203], v[168:171], v[0:3]
ds_read_b128 a[232:235], v217 offset:10240
ds_read_b128 a[236:239], v217 offset:11264
v_mfma_f32_16x16x32_bf16 v[0:3], a[204:207], v[172:175], v[0:3]
v_exp_f32 v209, v33
v_mfma_f32_16x16x32_bf16 v[4:7], a[204:207], v[188:191], v[108:111]
v_exp_f32 v210, v34
v_mfma_f32_16x16x32_bf16 v[4:7], a[200:203], v[184:187], v[4:7]
v_exp_f32 v211, v35
v_mfma_f32_16x16x32_bf16 v[4:7], a[196:199], v[180:183], v[4:7]
v_cvt_pk_bf16_f32 v80, v208, v209
v_cvt_pk_bf16_f32 v81, v210, v211
v_mfma_f32_16x16x32_bf16 v[4:7], a[192:195], v[176:179], v[4:7]
s_waitcnt lgkmcnt(4)
ds_read_b128 a[240:243], v217 offset:12288
ds_read_b128 a[244:247], v217 offset:13312
v_mfma_f32_16x16x32_bf16 v[12:15], a[208:211], v[176:179], v[108:111]
v_exp_f32 v212, v40
v_mfma_f32_16x16x32_bf16 v[12:15], a[212:215], v[180:183], v[12:15]
ds_read_b128 a[248:251], v217 offset:14336
ds_read_b128 a[252:255], v217 offset:15360
v_mfma_f32_16x16x32_bf16 v[12:15], a[216:219], v[184:187], v[12:15]
v_exp_f32 v213, v41
v_mfma_f32_16x16x32_bf16 v[12:15], a[220:223], v[188:191], v[12:15]
v_exp_f32 v214, v42
v_mfma_f32_16x16x32_bf16 v[8:11], a[220:223], v[172:175], v[104:107]
v_xor_b32 v218, 0x8000, v218
v_cvt_pk_bf16_f32 v82, v212, v213
v_mfma_f32_16x16x32_bf16 v[8:11], a[216:219], v[168:171], v[8:11]
v_exp_f32 v215, v43
v_mfma_f32_16x16x32_bf16 v[8:11], a[212:215], v[164:167], v[8:11]
v_exp_f32 v208, v48
v_mfma_f32_16x16x32_bf16 v[8:11], a[208:211], v[160:163], v[8:11]
s_waitcnt lgkmcnt(4)
ds_read_b128 a[192:195], v218 offset:0
v_cvt_pk_bf16_f32 v83, v214, v215
v_mfma_f32_16x16x32_bf16 v[16:19], a[224:227], v[160:163], v[104:107]
v_exp_f32 v209, v49
v_mfma_f32_16x16x32_bf16 v[16:19], a[228:231], v[164:167], v[16:19]
ds_read_b128 a[196:199], v218 offset:8192
v_cvt_pk_bf16_f32 v84, v208, v209
v_mfma_f32_16x16x32_bf16 v[16:19], a[232:235], v[168:171], v[16:19]
v_exp_f32 v210, v50
v_mfma_f32_16x16x32_bf16 v[16:19], a[236:239], v[172:175], v[16:19]
ds_read_b128 a[200:203], v218 offset:1024
ds_read_b128 a[204:207], v218 offset:9216
v_mfma_f32_16x16x32_bf16 v[20:23], a[236:239], v[188:191], v[108:111]
v_exp_f32 v211, v51
v_mfma_f32_16x16x32_bf16 v[20:23], a[232:235], v[184:187], v[20:23]
v_exp_f32 v212, v56
v_mfma_f32_16x16x32_bf16 v[20:23], a[228:231], v[180:183], v[20:23]
v_exp_f32 v213, v57
v_mfma_f32_16x16x32_bf16 v[20:23], a[224:227], v[176:179], v[20:23]
s_waitcnt lgkmcnt(4)
ds_read_b128 a[208:211], v218 offset:2048
v_cvt_pk_bf16_f32 v85, v210, v211
v_mfma_f32_16x16x32_bf16 v[28:31], a[240:243], v[176:179], v[108:111]
ds_read_b128 a[212:215], v218 offset:10240
v_cvt_pk_bf16_f32 v86, v212, v213
v_mfma_f32_16x16x32_bf16 v[28:31], a[244:247], v[180:183], v[28:31]
v_exp_f32 v214, v58
v_mfma_f32_16x16x32_bf16 v[28:31], a[248:251], v[184:187], v[28:31]
ds_read_b128 a[216:219], v218 offset:3072
ds_read_b128 a[220:223], v218 offset:11264
v_mfma_f32_16x16x32_bf16 v[28:31], a[252:255], v[188:191], v[28:31]
v_exp_f32 v215, v59
v_mfma_f32_16x16x32_bf16 v[24:27], a[252:255], v[172:175], v[104:107]
v_exp_f32 v208, v36
v_mfma_f32_16x16x32_bf16 v[24:27], a[248:251], v[168:171], v[24:27]
v_exp_f32 v209, v37
v_mfma_f32_16x16x32_bf16 v[24:27], a[244:247], v[164:167], v[24:27]
v_cvt_pk_bf16_f32 v87, v214, v215
v_cvt_pk_bf16_f32 v88, v208, v209
v_mfma_f32_16x16x32_bf16 v[24:27], a[240:243], v[160:163], v[24:27]
s_waitcnt vmcnt(8) lgkmcnt(4)
s_barrier
v_mfma_f32_16x16x32_bf16 a[64:67], a[192:195], v[64:67], a[64:67]
s_and_b32 m0, s68, 0xffff
ds_read_b128 a[224:227], v218 offset:4096
ds_read_b128 a[228:231], v218 offset:12288
v_mfma_f32_16x16x32_bf16 a[64:67], a[196:199], v[68:71], a[64:67]
buffer_load_dwordx4 v216, s[8:11], s68 offen offset:0 lds
v_mfma_f32_16x16x32_bf16 a[96:99], a[196:199], v[76:79], a[96:99]
ds_read_b128 a[232:235], v218 offset:5120
ds_read_b128 a[236:239], v218 offset:13312
v_mfma_f32_16x16x32_bf16 a[96:99], a[192:195], v[72:75], a[96:99]
v_exp_f32 v210, v38
v_mfma_f32_16x16x32_bf16 a[100:103], a[200:203], v[72:75], a[100:103]
v_exp_f32 v211, v39
v_mfma_f32_16x16x32_bf16 a[100:103], a[204:207], v[76:79], a[100:103]
buffer_load_dwordx4 v216, s[8:11], s68 offen offset:1024 lds
v_mfma_f32_16x16x32_bf16 a[68:71], a[204:207], v[68:71], a[68:71]
v_exp_f32 v212, v44
v_mfma_f32_16x16x32_bf16 a[68:71], a[200:203], v[64:67], a[68:71]
s_waitcnt lgkmcnt(4)
ds_read_b128 a[240:243], v218 offset:6144
v_cvt_pk_bf16_f32 v89, v210, v211
v_mfma_f32_16x16x32_bf16 a[72:75], a[208:211], v[64:67], a[72:75]
v_exp_f32 v213, v45
v_mfma_f32_16x16x32_bf16 a[72:75], a[212:215], v[68:71], a[72:75]
ds_read_b128 a[244:247], v218 offset:14336
v_cvt_pk_bf16_f32 v90, v212, v213
v_mfma_f32_16x16x32_bf16 a[104:107], a[212:215], v[76:79], a[104:107]
buffer_load_dwordx4 v216, s[8:11], s68 offen offset:2048 lds
v_mfma_f32_16x16x32_bf16 a[104:107], a[208:211], v[72:75], a[104:107]
ds_read_b128 a[248:251], v218 offset:7168
ds_read_b128 a[252:255], v218 offset:15360
v_mfma_f32_16x16x32_bf16 a[108:111], a[216:219], v[72:75], a[108:111]
v_exp_f32 v214, v46
v_mfma_f32_16x16x32_bf16 a[108:111], a[220:223], v[76:79], a[108:111]
buffer_load_dwordx4 v216, s[8:11], s68 offen offset:3072 lds
v_mfma_f32_16x16x32_bf16 a[76:79], a[220:223], v[68:71], a[76:79]
s_xor_b32 m0, m0, 0x18000
v_exp_f32 v215, v47
v_mfma_f32_16x16x32_bf16 a[76:79], a[216:219], v[64:67], a[76:79]
s_waitcnt lgkmcnt(4)
ds_read_b128 a[192:195], v217 offset:16384
v_cvt_pk_bf16_f32 v91, v214, v215
v_mfma_f32_16x16x32_bf16 a[80:83], a[224:227], v[64:67], a[80:83]
v_exp_f32 v208, v52
v_mfma_f32_16x16x32_bf16 a[80:83], a[228:231], v[68:71], a[80:83]
ds_read_b128 a[196:199], v217 offset:17408
ds_read_b128 a[200:203], v217 offset:18432
v_mfma_f32_16x16x32_bf16 a[112:115], a[228:231], v[76:79], a[112:115]
buffer_load_dwordx4 v216, s[12:15], s68 offen offset:0 lds
v_mfma_f32_16x16x32_bf16 a[112:115], a[224:227], v[72:75], a[112:115]
v_exp_f32 v209, v53
v_mfma_f32_16x16x32_bf16 a[116:119], a[232:235], v[72:75], a[116:119]
ds_read_b128 a[204:207], v217 offset:19456
v_cvt_pk_bf16_f32 v92, v208, v209
v_mfma_f32_16x16x32_bf16 a[116:119], a[236:239], v[76:79], a[116:119]
v_exp_f32 v210, v54
v_mfma_f32_16x16x32_bf16 a[84:87], a[236:239], v[68:71], a[84:87]
buffer_load_dwordx4 v216, s[12:15], s68 offen offset:1024 lds
v_mfma_f32_16x16x32_bf16 a[84:87], a[232:235], v[64:67], a[84:87]
s_waitcnt lgkmcnt(4)
ds_read_b128 a[208:211], v217 offset:20480
ds_read_b128 a[212:215], v217 offset:21504
v_mfma_f32_16x16x32_bf16 a[88:91], a[240:243], v[64:67], a[88:91]
v_exp_f32 v211, v55
v_mfma_f32_16x16x32_bf16 a[88:91], a[244:247], v[68:71], a[88:91]
ds_read_b128 a[216:219], v217 offset:22528
v_cvt_pk_bf16_f32 v93, v210, v211
v_mfma_f32_16x16x32_bf16 a[120:123], a[244:247], v[76:79], a[120:123]
buffer_load_dwordx4 v216, s[12:15], s68 offen offset:2048 lds
v_mfma_f32_16x16x32_bf16 a[120:123], a[240:243], v[72:75], a[120:123]
v_exp_f32 v212, v60
v_mfma_f32_16x16x32_bf16 a[124:127], a[248:251], v[72:75], a[124:127]
v_exp_f32 v213, v61
v_mfma_f32_16x16x32_bf16 a[124:127], a[252:255], v[76:79], a[124:127]
ds_read_b128 a[220:223], v217 offset:23552
v_cvt_pk_bf16_f32 v94, v212, v213
v_mfma_f32_16x16x32_bf16 a[92:95], a[252:255], v[68:71], a[92:95]
buffer_load_dwordx4 v216, s[12:15], s68 offen offset:3072 lds
v_mfma_f32_16x16x32_bf16 a[92:95], a[248:251], v[64:67], a[92:95]
s_add_u32 s68, s68, 16384
v_exp_f32 v214, v62
v_mfma_f32_16x16x32_bf16 a[136:139], a[144:147], v[64:67], a[136:139]
v_exp_f32 v215, v63
v_mfma_f32_16x16x32_bf16 a[136:139], a[144:147], v[68:71], a[136:139]
v_cvt_pk_bf16_f32 v95, v214, v215
v_mfma_f32_16x16x32_bf16 a[140:143], a[144:147], v[72:75], a[140:143]
v_mfma_f32_16x16x32_bf16 a[140:143], a[144:147], v[76:79], a[140:143]
s_waitcnt lgkmcnt(4)
v_mfma_f32_16x16x32_bf16 v[32:35], a[192:195], v[160:163], v[104:107]
ds_read_b128 a[224:227], v217 offset:24576
ds_read_b128 a[228:231], v217 offset:25600
v_mfma_f32_16x16x32_bf16 v[32:35], a[196:199], v[164:167], v[32:35]
v_exp_f32 v208, v0
v_mfma_f32_16x16x32_bf16 v[32:35], a[200:203], v[168:171], v[32:35]
ds_read_b128 a[232:235], v217 offset:26624
ds_read_b128 a[236:239], v217 offset:27648
v_mfma_f32_16x16x32_bf16 v[32:35], a[204:207], v[172:175], v[32:35]
v_exp_f32 v209, v1
v_mfma_f32_16x16x32_bf16 v[36:39], a[204:207], v[188:191], v[108:111]
v_exp_f32 v210, v2
v_mfma_f32_16x16x32_bf16 v[36:39], a[200:203], v[184:187], v[36:39]
v_exp_f32 v211, v3
v_mfma_f32_16x16x32_bf16 v[36:39], a[196:199], v[180:183], v[36:39]
v_cvt_pk_bf16_f32 v64, v208, v209
v_cvt_pk_bf16_f32 v65, v210, v211
v_mfma_f32_16x16x32_bf16 v[36:39], a[192:195], v[176:179], v[36:39]
s_waitcnt lgkmcnt(4)
ds_read_b128 a[240:243], v217 offset:28672
ds_read_b128 a[244:247], v217 offset:29696
v_mfma_f32_16x16x32_bf16 v[44:47], a[208:211], v[176:179], v[108:111]
v_exp_f32 v212, v8
v_mfma_f32_16x16x32_bf16 v[44:47], a[212:215], v[180:183], v[44:47]
ds_read_b128 a[248:251], v217 offset:30720
ds_read_b128 a[252:255], v217 offset:31744
v_mfma_f32_16x16x32_bf16 v[44:47], a[216:219], v[184:187], v[44:47]
v_exp_f32 v213, v9
v_mfma_f32_16x16x32_bf16 v[44:47], a[220:223], v[188:191], v[44:47]
v_exp_f32 v214, v10
v_mfma_f32_16x16x32_bf16 v[40:43], a[220:223], v[172:175], v[104:107]
v_exp_f32 v215, v11
v_mfma_f32_16x16x32_bf16 v[40:43], a[216:219], v[168:171], v[40:43]
v_cvt_pk_bf16_f32 v66, v212, v213
v_cvt_pk_bf16_f32 v67, v214, v215
v_mfma_f32_16x16x32_bf16 v[40:43], a[212:215], v[164:167], v[40:43]
v_exp_f32 v208, v16
v_mfma_f32_16x16x32_bf16 v[40:43], a[208:211], v[160:163], v[40:43]
s_waitcnt lgkmcnt(4)
ds_read_b128 a[192:195], v218 offset:16384
ds_read_b128 a[196:199], v218 offset:24576
v_mfma_f32_16x16x32_bf16 v[48:51], a[224:227], v[160:163], v[104:107]
v_exp_f32 v209, v17
v_mfma_f32_16x16x32_bf16 v[48:51], a[228:231], v[164:167], v[48:51]
ds_read_b128 a[200:203], v218 offset:17408
v_cvt_pk_bf16_f32 v68, v208, v209
v_mfma_f32_16x16x32_bf16 v[48:51], a[232:235], v[168:171], v[48:51]
v_exp_f32 v210, v18
v_mfma_f32_16x16x32_bf16 v[48:51], a[236:239], v[172:175], v[48:51]
v_exp_f32 v211, v19
v_mfma_f32_16x16x32_bf16 v[52:55], a[236:239], v[188:191], v[108:111]
ds_read_b128 a[204:207], v218 offset:25600
v_cvt_pk_bf16_f32 v69, v210, v211
v_mfma_f32_16x16x32_bf16 v[52:55], a[232:235], v[184:187], v[52:55]
v_exp_f32 v212, v24
v_mfma_f32_16x16x32_bf16 v[52:55], a[228:231], v[180:183], v[52:55]
v_exp_f32 v213, v25
v_mfma_f32_16x16x32_bf16 v[52:55], a[224:227], v[176:179], v[52:55]
s_waitcnt lgkmcnt(4)
ds_read_b128 a[208:211], v218 offset:18432
v_cvt_pk_bf16_f32 v70, v212, v213
v_mfma_f32_16x16x32_bf16 v[60:63], a[240:243], v[176:179], v[108:111]
v_exp_f32 v214, v26
v_mfma_f32_16x16x32_bf16 v[60:63], a[244:247], v[180:183], v[60:63]
ds_read_b128 a[212:215], v218 offset:26624
ds_read_b128 a[216:219], v218 offset:19456
v_mfma_f32_16x16x32_bf16 v[60:63], a[248:251], v[184:187], v[60:63]
v_exp_f32 v215, v27
v_mfma_f32_16x16x32_bf16 v[60:63], a[252:255], v[188:191], v[60:63]
ds_read_b128 a[220:223], v218 offset:27648
v_cvt_pk_bf16_f32 v71, v214, v215
v_mfma_f32_16x16x32_bf16 v[56:59], a[252:255], v[172:175], v[104:107]
v_exp_f32 v208, v4
v_mfma_f32_16x16x32_bf16 v[56:59], a[248:251], v[168:171], v[56:59]
v_exp_f32 v209, v5
v_mfma_f32_16x16x32_bf16 v[56:59], a[244:247], v[164:167], v[56:59]
v_exp_f32 v210, v6
v_mfma_f32_16x16x32_bf16 v[56:59], a[240:243], v[160:163], v[56:59]
s_waitcnt vmcnt(8) lgkmcnt(4)
s_barrier
v_mfma_f32_16x16x32_bf16 a[64:67], a[192:195], v[80:83], a[64:67]
s_and_b32 m0, s68, 0xffff
ds_read_b128 a[224:227], v218 offset:20480
v_cvt_pk_bf16_f32 v72, v208, v209
v_mfma_f32_16x16x32_bf16 a[64:67], a[196:199], v[84:87], a[64:67]
buffer_load_dwordx4 v216, s[8:11], s68 offen offset:0 lds
v_mfma_f32_16x16x32_bf16 a[96:99], a[196:199], v[92:95], a[96:99]
ds_read_b128 a[228:231], v218 offset:28672
ds_read_b128 a[232:235], v218 offset:21504
v_mfma_f32_16x16x32_bf16 a[96:99], a[192:195], v[88:91], a[96:99]
v_exp_f32 v211, v7
v_mfma_f32_16x16x32_bf16 a[100:103], a[200:203], v[88:91], a[100:103]
ds_read_b128 a[236:239], v218 offset:29696
v_cvt_pk_bf16_f32 v73, v210, v211
v_mfma_f32_16x16x32_bf16 a[100:103], a[204:207], v[92:95], a[100:103]
buffer_load_dwordx4 v216, s[8:11], s68 offen offset:1024 lds
v_mfma_f32_16x16x32_bf16 a[68:71], a[204:207], v[84:87], a[68:71]
v_exp_f32 v212, v12
v_mfma_f32_16x16x32_bf16 a[68:71], a[200:203], v[80:83], a[68:71]
s_waitcnt lgkmcnt(4)
ds_read_b128 a[240:243], v218 offset:22528
ds_read_b128 a[244:247], v218 offset:30720
v_mfma_f32_16x16x32_bf16 a[72:75], a[208:211], v[80:83], a[72:75]
v_exp_f32 v213, v13
v_mfma_f32_16x16x32_bf16 a[72:75], a[212:215], v[84:87], a[72:75]
ds_read_b128 a[248:251], v218 offset:23552
v_cvt_pk_bf16_f32 v74, v212, v213
v_mfma_f32_16x16x32_bf16 a[104:107], a[212:215], v[92:95], a[104:107]
buffer_load_dwordx4 v216, s[8:11], s68 offen offset:2048 lds
v_mfma_f32_16x16x32_bf16 a[104:107], a[208:211], v[88:91], a[104:107]
v_exp_f32 v214, v14
v_mfma_f32_16x16x32_bf16 a[108:111], a[216:219], v[88:91], a[108:111]
ds_read_b128 a[252:255], v218 offset:31744
v_xor_b32 v217, 0x8000, v217
v_mfma_f32_16x16x32_bf16 a[108:111], a[220:223], v[92:95], a[108:111]
buffer_load_dwordx4 v216, s[8:11], s68 offen offset:3072 lds
v_mfma_f32_16x16x32_bf16 a[76:79], a[220:223], v[84:87], a[76:79]
s_xor_b32 m0, m0, 0x18000
v_exp_f32 v215, v15
v_mfma_f32_16x16x32_bf16 a[76:79], a[216:219], v[80:83], a[76:79]
s_waitcnt lgkmcnt(4)
ds_read_b128 a[192:195], v217 offset:0
v_cvt_pk_bf16_f32 v75, v214, v215
v_mfma_f32_16x16x32_bf16 a[80:83], a[224:227], v[80:83], a[80:83]
v_exp_f32 v208, v20
v_mfma_f32_16x16x32_bf16 a[80:83], a[228:231], v[84:87], a[80:83]
ds_read_b128 a[196:199], v217 offset:1024
ds_read_b128 a[200:203], v217 offset:2048
v_mfma_f32_16x16x32_bf16 a[112:115], a[228:231], v[92:95], a[112:115]
buffer_load_dwordx4 v216, s[12:15], s68 offen offset:0 lds
v_mfma_f32_16x16x32_bf16 a[112:115], a[224:227], v[88:91], a[112:115]
v_exp_f32 v209, v21
v_mfma_f32_16x16x32_bf16 a[116:119], a[232:235], v[88:91], a[116:119]
ds_read_b128 a[204:207], v217 offset:3072
v_cvt_pk_bf16_f32 v76, v208, v209
v_mfma_f32_16x16x32_bf16 a[116:119], a[236:239], v[92:95], a[116:119]
v_exp_f32 v210, v22
v_mfma_f32_16x16x32_bf16 a[84:87], a[236:239], v[84:87], a[84:87]
buffer_load_dwordx4 v216, s[12:15], s68 offen offset:1024 lds
v_mfma_f32_16x16x32_bf16 a[84:87], a[232:235], v[80:83], a[84:87]
s_waitcnt lgkmcnt(4)
ds_read_b128 a[208:211], v217 offset:4096
ds_read_b128 a[212:215], v217 offset:5120
v_mfma_f32_16x16x32_bf16 a[88:91], a[240:243], v[80:83], a[88:91]
v_exp_f32 v211, v23
v_mfma_f32_16x16x32_bf16 a[88:91], a[244:247], v[84:87], a[88:91]
ds_read_b128 a[216:219], v217 offset:6144
v_cvt_pk_bf16_f32 v77, v210, v211
v_mfma_f32_16x16x32_bf16 a[120:123], a[244:247], v[92:95], a[120:123]
buffer_load_dwordx4 v216, s[12:15], s68 offen offset:2048 lds
v_mfma_f32_16x16x32_bf16 a[120:123], a[240:243], v[88:91], a[120:123]
v_exp_f32 v212, v28
v_mfma_f32_16x16x32_bf16 a[124:127], a[248:251], v[88:91], a[124:127]
v_exp_f32 v213, v29
v_mfma_f32_16x16x32_bf16 a[124:127], a[252:255], v[92:95], a[124:127]
ds_read_b128 a[220:223], v217 offset:7168
v_cvt_pk_bf16_f32 v78, v212, v213
v_mfma_f32_16x16x32_bf16 a[92:95], a[252:255], v[84:87], a[92:95]
buffer_load_dwordx4 v216, s[12:15], s68 offen offset:3072 lds
v_mfma_f32_16x16x32_bf16 a[92:95], a[248:251], v[80:83], a[92:95]
s_add_u32 s68, s68, 16384
v_exp_f32 v214, v30
v_mfma_f32_16x16x32_bf16 a[136:139], a[144:147], v[80:83], a[136:139]
v_exp_f32 v215, v31
v_mfma_f32_16x16x32_bf16 a[136:139], a[144:147], v[84:87], a[136:139]
v_cvt_pk_bf16_f32 v79, v214, v215
v_mfma_f32_16x16x32_bf16 a[140:143], a[144:147], v[88:91], a[140:143]
v_mfma_f32_16x16x32_bf16 a[140:143], a[144:147], v[92:95], a[140:143]
s_waitcnt lgkmcnt(4)
s_cmp_lg_u32 s71, 0
s_cbranch_scc1 Lloop2
LtailA:
Lpad21:
s_cbranch_execz Lpad31
v_mfma_f32_16x16x32_bf16 v[4:7], a[192:195], v[176:179], v[108:111]
v_add_f32 v112, v224, v104
v_add_f32 v113, v225, v105
v_add_f32 v114, v226, v106
v_mfma_f32_16x16x32_bf16 v[4:7], a[196:199], v[180:183], v[4:7]
ds_read_b128 a[224:227], v217 offset:8192
v_add_f32 v115, v227, v107
v_mfma_f32_16x16x32_bf16 v[4:7], a[200:203], v[184:187], v[4:7]
ds_read_b128 a[228:231], v217 offset:9216
ds_read_b128 a[232:235], v217 offset:10240
v_add_f32 v116, v228, v104
v_mfma_f32_16x16x32_bf16 v[4:7], a[204:207], v[188:191], v[4:7]
v_add_f32 v117, v229, v105
v_add_f32 v118, v230, v106
v_mfma_f32_16x16x32_bf16 v[0:3], a[204:207], v[172:175], v[112:115]
ds_read_b128 a[236:239], v217 offset:11264
v_exp_f32 v208, v32
v_mfma_f32_16x16x32_bf16 v[0:3], a[200:203], v[168:171], v[0:3]
v_exp_f32 v209, v33
v_mfma_f32_16x16x32_bf16 v[0:3], a[196:199], v[164:167], v[0:3]
v_add_f32 v119, v231, v107
v_exp_f32 v210, v34
v_mfma_f32_16x16x32_bf16 v[0:3], a[192:195], v[160:163], v[0:3]
s_waitcnt lgkmcnt(4)
ds_read_b128 a[240:243], v217 offset:12288
v_cvt_pk_bf16_f32 v80, v208, v209
v_mfma_f32_16x16x32_bf16 v[12:15], a[208:211], v[176:179], v[108:111]
ds_read_b128 a[244:247], v217 offset:13312
ds_read_b128 a[248:251], v217 offset:14336
ds_read_b128 a[252:255], v217 offset:15360
v_mfma_f32_16x16x32_bf16 v[12:15], a[212:215], v[180:183], v[12:15]
global_load_dword v221, v197, s[66:67] sc1
v_mfma_f32_16x16x32_bf16 v[12:15], a[216:219], v[184:187], v[12:15]
v_add_f32 v120, v232, v104
v_add_f32 v121, v233, v105
v_mfma_f32_16x16x32_bf16 v[12:15], a[220:223], v[188:191], v[12:15]
v_add_f32 v122, v234, v106
v_add_f32 v123, v235, v107
v_mfma_f32_16x16x32_bf16 v[8:11], a[220:223], v[172:175], v[116:119]
v_exp_f32 v211, v35
v_mfma_f32_16x16x32_bf16 v[8:11], a[216:219], v[168:171], v[8:11]
v_xor_b32 v218, 0x8000, v218
v_cvt_pk_bf16_f32 v81, v210, v211
v_mfma_f32_16x16x32_bf16 v[8:11], a[212:215], v[164:167], v[8:11]
v_exp_f32 v212, v40
v_mfma_f32_16x16x32_bf16 v[8:11], a[208:211], v[160:163], v[8:11]
s_waitcnt lgkmcnt(4)
ds_read_b128 a[192:195], v218 offset:0
ds_read_b128 a[196:199], v218 offset:8192
v_mfma_f32_16x16x32_bf16 v[20:23], a[224:227], v[176:179], v[108:111]
v_exp_f32 v213, v41
v_mfma_f32_16x16x32_bf16 v[20:23], a[228:231], v[180:183], v[20:23]
ds_read_b128 a[200:203], v218 offset:1024
v_cvt_pk_bf16_f32 v82, v212, v213
v_mfma_f32_16x16x32_bf16 v[20:23], a[232:235], v[184:187], v[20:23]
ds_read_b128 a[204:207], v218 offset:9216
v_add_f32 v124, v236, v104
v_mfma_f32_16x16x32_bf16 v[20:23], a[236:239], v[188:191], v[20:23]
v_add_f32 v125, v237, v105
v_add_f32 v126, v238, v106
v_mfma_f32_16x16x32_bf16 v[16:19], a[236:239], v[172:175], v[120:123]
v_exp_f32 v214, v42
v_mfma_f32_16x16x32_bf16 v[16:19], a[232:235], v[168:171], v[16:19]
v_exp_f32 v215, v43
v_mfma_f32_16x16x32_bf16 v[16:19], a[228:231], v[164:167], v[16:19]
v_add_f32 v127, v239, v107
v_cvt_pk_bf16_f32 v83, v214, v215
v_mfma_f32_16x16x32_bf16 v[16:19], a[224:227], v[160:163], v[16:19]
s_waitcnt lgkmcnt(4)
ds_read_b128 a[208:211], v218 offset:2048
ds_read_b128 a[212:215], v218 offset:10240
v_mfma_f32_16x16x32_bf16 v[28:31], a[240:243], v[176:179], v[108:111]
v_exp_f32 v208, v48
v_mfma_f32_16x16x32_bf16 v[28:31], a[244:247], v[180:183], v[28:31]
ds_read_b128 a[216:219], v218 offset:3072
ds_read_b128 a[220:223], v218 offset:11264
v_mfma_f32_16x16x32_bf16 v[28:31], a[248:251], v[184:187], v[28:31]
v_exp_f32 v209, v49
v_mfma_f32_16x16x32_bf16 v[28:31], a[252:255], v[188:191], v[28:31]
v_exp_f32 v210, v50
v_mfma_f32_16x16x32_bf16 v[24:27], a[252:255], v[172:175], v[124:127]
v_exp_f32 v211, v51
v_mfma_f32_16x16x32_bf16 v[24:27], a[248:251], v[168:171], v[24:27]
v_cvt_pk_bf16_f32 v84, v208, v209
v_cvt_pk_bf16_f32 v85, v210, v211
v_mfma_f32_16x16x32_bf16 v[24:27], a[244:247], v[164:167], v[24:27]
v_exp_f32 v212, v56
v_mfma_f32_16x16x32_bf16 v[24:27], a[240:243], v[160:163], v[24:27]
s_waitcnt vmcnt(9) lgkmcnt(4)
s_barrier
v_mfma_f32_16x16x32_bf16 a[64:67], a[192:195], v[64:67], a[64:67]
s_and_b32 m0, s68, 0xffff
ds_read_b128 a[224:227], v218 offset:4096
ds_read_b128 a[228:231], v218 offset:12288
v_mfma_f32_16x16x32_bf16 a[64:67], a[196:199], v[68:71], a[64:67]
s_xor_b32 m0, m0, 0x18000
v_exp_f32 v213, v57
v_mfma_f32_16x16x32_bf16 a[96:99], a[196:199], v[76:79], a[96:99]
ds_read_b128 a[232:235], v218 offset:5120
v_cvt_pk_bf16_f32 v86, v212, v213
v_mfma_f32_16x16x32_bf16 a[96:99], a[192:195], v[72:75], a[96:99]
buffer_load_dwordx4 v216, s[12:15], s68 offen offset:0 lds
v_mfma_f32_16x16x32_bf16 a[100:103], a[200:203], v[72:75], a[100:103]
v_exp_f32 v214, v58
v_mfma_f32_16x16x32_bf16 a[100:103], a[204:207], v[76:79], a[100:103]
ds_read_b128 a[236:239], v218 offset:13312
v_mfma_f32_16x16x32_bf16 a[68:71], a[204:207], v[68:71], a[68:71]
v_exp_f32 v215, v59
v_mfma_f32_16x16x32_bf16 a[68:71], a[200:203], v[64:67], a[68:71]
s_waitcnt lgkmcnt(4)
ds_read_b128 a[240:243], v218 offset:6144
v_cvt_pk_bf16_f32 v87, v214, v215
v_mfma_f32_16x16x32_bf16 a[72:75], a[208:211], v[64:67], a[72:75]
ds_read_b128 a[244:247], v218 offset:14336
ds_read_b128 a[248:251], v218 offset:7168
ds_read_b128 a[252:255], v218 offset:15360
v_mfma_f32_16x16x32_bf16 a[72:75], a[212:215], v[68:71], a[72:75]
buffer_load_dwordx4 v216, s[12:15], s68 offen offset:1024 lds
v_mfma_f32_16x16x32_bf16 a[104:107], a[212:215], v[76:79], a[104:107]
v_exp_f32 v208, v36
v_mfma_f32_16x16x32_bf16 a[104:107], a[208:211], v[72:75], a[104:107]
v_exp_f32 v209, v37
v_mfma_f32_16x16x32_bf16 a[108:111], a[216:219], v[72:75], a[108:111]
v_exp_f32 v210, v38
v_mfma_f32_16x16x32_bf16 a[108:111], a[220:223], v[76:79], a[108:111]
buffer_load_dwordx4 v216, s[12:15], s68 offen offset:2048 lds
v_mfma_f32_16x16x32_bf16 a[76:79], a[220:223], v[68:71], a[76:79]
v_exp_f32 v211, v39
v_mfma_f32_16x16x32_bf16 a[76:79], a[216:219], v[64:67], a[76:79]
s_waitcnt lgkmcnt(4)
ds_read_b128 a[192:195], v217 offset:16384
v_cvt_pk_bf16_f32 v88, v208, v209
v_mfma_f32_16x16x32_bf16 a[80:83], a[224:227], v[64:67], a[80:83]
ds_read_b128 a[196:199], v217 offset:17408
v_cvt_pk_bf16_f32 v89, v210, v211
v_mfma_f32_16x16x32_bf16 a[80:83], a[228:231], v[68:71], a[80:83]
v_exp_f32 v212, v44
v_mfma_f32_16x16x32_bf16 a[112:115], a[228:231], v[76:79], a[112:115]
ds_read_b128 a[200:203], v217 offset:18432
ds_read_b128 a[204:207], v217 offset:19456
v_mfma_f32_16x16x32_bf16 a[112:115], a[224:227], v[72:75], a[112:115]
buffer_load_dwordx4 v216, s[12:15], s68 offen offset:3072 lds
v_mfma_f32_16x16x32_bf16 a[116:119], a[232:235], v[72:75], a[116:119]
s_add_u32 s68, s68, 16384
v_exp_f32 v213, v45
v_mfma_f32_16x16x32_bf16 a[116:119], a[236:239], v[76:79], a[116:119]
v_exp_f32 v214, v46
v_mfma_f32_16x16x32_bf16 a[84:87], a[236:239], v[68:71], a[84:87]
v_exp_f32 v215, v47
v_mfma_f32_16x16x32_bf16 a[84:87], a[232:235], v[64:67], a[84:87]
s_waitcnt lgkmcnt(4)
ds_read_b128 a[208:211], v217 offset:20480
v_cvt_pk_bf16_f32 v90, v212, v213
v_mfma_f32_16x16x32_bf16 a[88:91], a[240:243], v[64:67], a[88:91]
ds_read_b128 a[212:215], v217 offset:21504
v_cvt_pk_bf16_f32 v91, v214, v215
v_mfma_f32_16x16x32_bf16 a[88:91], a[244:247], v[68:71], a[88:91]
v_exp_f32 v208, v52
v_mfma_f32_16x16x32_bf16 a[120:123], a[244:247], v[76:79], a[120:123]
ds_read_b128 a[216:219], v217 offset:22528
ds_read_b128 a[220:223], v217 offset:23552
v_mfma_f32_16x16x32_bf16 a[120:123], a[240:243], v[72:75], a[120:123]
v_exp_f32 v209, v53
v_mfma_f32_16x16x32_bf16 a[124:127], a[248:251], v[72:75], a[124:127]
v_exp_f32 v210, v54
v_mfma_f32_16x16x32_bf16 a[124:127], a[252:255], v[76:79], a[124:127]
v_exp_f32 v211, v55
v_mfma_f32_16x16x32_bf16 a[92:95], a[252:255], v[68:71], a[92:95]
v_cvt_pk_bf16_f32 v92, v208, v209
v_cvt_pk_bf16_f32 v93, v210, v211
v_mfma_f32_16x16x32_bf16 a[92:95], a[248:251], v[64:67], a[92:95]
v_exp_f32 v212, v60
v_mfma_f32_16x16x32_bf16 a[136:139], a[144:147], v[64:67], a[136:139]
v_exp_f32 v213, v61
v_mfma_f32_16x16x32_bf16 a[136:139], a[144:147], v[68:71], a[136:139]
v_exp_f32 v214, v62
v_mfma_f32_16x16x32_bf16 a[140:143], a[144:147], v[72:75], a[140:143]
v_exp_f32 v215, v63
v_mfma_f32_16x16x32_bf16 a[140:143], a[144:147], v[76:79], a[140:143]
s_waitcnt lgkmcnt(4)
v_cvt_pk_bf16_f32 v94, v212, v213
v_cvt_pk_bf16_f32 v95, v214, v215
v_add_f32 v112, v224, v108
v_add_f32 v113, v225, v109
v_add_f32 v114, v226, v110
v_add_f32 v115, v227, v111
v_add_f32 v116, v228, v108
v_add_f32 v117, v229, v109
v_add_f32 v118, v230, v110
v_add_f32 v119, v231, v111
s_nop 1
v_mfma_f32_16x16x32_bf16 v[36:39], a[192:195], v[176:179], v[112:115]
ds_read_b128 a[224:227], v217 offset:24576
ds_read_b128 a[228:231], v217 offset:25600
v_add_f32 v120, v232, v108
v_mfma_f32_16x16x32_bf16 v[36:39], a[196:199], v[180:183], v[36:39]
ds_read_b128 a[232:235], v217 offset:26624
ds_read_b128 a[236:239], v217 offset:27648
v_add_f32 v121, v233, v109
v_mfma_f32_16x16x32_bf16 v[36:39], a[200:203], v[184:187], v[36:39]
v_add_f32 v122, v234, v110
v_add_f32 v123, v235, v111
v_mfma_f32_16x16x32_bf16 v[36:39], a[204:207], v[188:191], v[36:39]
s_waitcnt lgkmcnt(4)
ds_read_b128 a[240:243], v217 offset:28672
ds_read_b128 a[244:247], v217 offset:29696
v_add_f32 v124, v236, v108
v_mfma_f32_16x16x32_bf16 v[44:47], a[220:223], v[188:191], v[116:119]
ds_read_b128 a[248:251], v217 offset:30720
ds_read_b128 a[252:255], v217 offset:31744
v_add_f32 v125, v237, v109
v_mfma_f32_16x16x32_bf16 v[44:47], a[216:219], v[184:187], v[44:47]
v_add_f32 v126, v238, v110
v_add_f32 v127, v239, v111
v_mfma_f32_16x16x32_bf16 v[44:47], a[212:215], v[180:183], v[44:47]
v_exp_f32 v208, v0
v_mfma_f32_16x16x32_bf16 v[44:47], a[208:211], v[176:179], v[44:47]
s_waitcnt lgkmcnt(4)
ds_read_b128 a[192:195], v218 offset:16384
ds_read_b128 a[196:199], v218 offset:24576
ds_read_b128 a[200:203], v218 offset:17408
v_mfma_f32_16x16x32_bf16 v[52:55], a[224:227], v[176:179], v[120:123]
v_exp_f32 v209, v1
v_mfma_f32_16x16x32_bf16 v[52:55], a[228:231], v[180:183], v[52:55]
ds_read_b128 a[204:207], v218 offset:25600
v_exp_f32 v210, v2
v_mfma_f32_16x16x32_bf16 v[52:55], a[232:235], v[184:187], v[52:55]
v_cvt_pk_bf16_f32 v64, v208, v209
v_exp_f32 v211, v3
v_mfma_f32_16x16x32_bf16 v[52:55], a[236:239], v[188:191], v[52:55]
s_waitcnt lgkmcnt(4)
ds_read_b128 a[208:211], v218 offset:18432
v_cvt_pk_bf16_f32 v65, v210, v211
v_mfma_f32_16x16x32_bf16 v[60:63], a[252:255], v[188:191], v[124:127]
ds_read_b128 a[212:215], v218 offset:26624
ds_read_b128 a[216:219], v218 offset:19456
ds_read_b128 a[220:223], v218 offset:27648
v_mfma_f32_16x16x32_bf16 v[60:63], a[248:251], v[184:187], v[60:63]
Lpad22:
s_cbranch_execz Lpad32
v_exp_f32 v212, v8
v_mfma_f32_16x16x32_bf16 v[60:63], a[244:247], v[180:183], v[60:63]
v_exp_f32 v213, v9
v_mfma_f32_16x16x32_bf16 v[60:63], a[240:243], v[176:179], v[60:63]
v_cvt_pk_bf16_f32 v66, v212, v213
s_waitcnt vmcnt(4) lgkmcnt(4)
s_barrier
v_cmp_gt_u32 vcc, 32, v221
s_mov_b32 s6, 0
s_cmp_eq_u64 vcc, 0
s_cbranch_scc1 Lok17
Lsp18:
s_sleep 10
global_load_dword v221, v197, s[66:67] sc1
s_waitcnt vmcnt(0)
v_cmp_gt_u32 vcc, 32, v221
s_add_u32 s6, s6, 1
s_cmp_gt_u32 s6, 200000
s_cbranch_scc1 Lok17
s_cmp_lg_u64 vcc, 0
s_cbranch_scc1 Lsp18
Lok17:
v_mfma_f32_16x16x32_bf16 a[64:67], a[192:195], v[80:83], a[64:67]
ds_read_b128 a[224:227], v218 offset:20480
ds_read_b128 a[228:231], v218 offset:28672
ds_read_b128 a[232:235], v218 offset:21504
v_mfma_f32_16x16x32_bf16 a[64:67], a[196:199], v[84:87], a[64:67]
buffer_load_dwordx4 a[180:183], v192, s[24:27], s32 offen offset:2048
v_mfma_f32_16x16x32_bf16 a[96:99], a[196:199], v[92:95], a[96:99]
ds_read_b128 a[236:239], v218 offset:29696
v_exp_f32 v214, v10
v_mfma_f32_16x16x32_bf16 a[96:99], a[192:195], v[88:91], a[96:99]
v_exp_f32 v215, v11
v_mfma_f32_16x16x32_bf16 a[100:103], a[200:203], v[88:91], a[100:103]
buffer_load_dwordx4 a[184:187], v193, s[24:27], s32 offen offset:2048
v_cvt_pk_bf16_f32 v67, v214, v215
v_mfma_f32_16x16x32_bf16 a[100:103], a[204:207], v[92:95], a[100:103]
v_exp_f32 v208, v16
v_mfma_f32_16x16x32_bf16 a[68:71], a[204:207], v[84:87], a[68:71]
v_exp_f32 v209, v17
v_mfma_f32_16x16x32_bf16 a[68:71], a[200:203], v[80:83], a[68:71]
s_waitcnt lgkmcnt(4)
ds_read_b128 a[240:243], v218 offset:22528
ds_read_b128 a[244:247], v218 offset:30720
v_cvt_pk_bf16_f32 v68, v208, v209
v_mfma_f32_16x16x32_bf16 a[72:75], a[208:211], v[80:83], a[72:75]
ds_read_b128 a[248:251], v218 offset:23552
v_exp_f32 v210, v18
v_mfma_f32_16x16x32_bf16 a[72:75], a[212:215], v[84:87], a[72:75]
buffer_load_dwordx4 a[188:191], v194, s[24:27], s32 offen offset:2048
v_mfma_f32_16x16x32_bf16 a[104:107], a[212:215], v[92:95], a[104:107]
ds_read_b128 a[252:255], v218 offset:31744
v_exp_f32 v211, v19
v_mfma_f32_16x16x32_bf16 a[104:107], a[208:211], v[88:91], a[104:107]
v_cvt_pk_bf16_f32 v69, v210, v211
v_exp_f32 v212, v24
v_mfma_f32_16x16x32_bf16 a[108:111], a[216:219], v[88:91], a[108:111]
v_xor_b32 v218, 0x8000, v218
v_exp_f32 v213, v25
v_mfma_f32_16x16x32_bf16 a[108:111], a[220:223], v[92:95], a[108:111]
v_exp_f32 v214, v26
v_mfma_f32_16x16x32_bf16 a[76:79], a[220:223], v[84:87], a[76:79]
buffer_load_dwordx4 a[160:163], v192, s[24:27], s32 offen offset:3072
v_cvt_pk_bf16_f32 v70, v212, v213
v_mfma_f32_16x16x32_bf16 a[76:79], a[216:219], v[80:83], a[76:79]
s_waitcnt lgkmcnt(4)
ds_read_b128 a[192:195], v218 offset:0
ds_read_b128 a[196:199], v218 offset:8192
ds_read_b128 a[200:203], v218 offset:1024
v_mfma_f32_16x16x32_bf16 a[80:83], a[224:227], v[80:83], a[80:83]
ds_read_b128 a[204:207], v218 offset:9216
v_exp_f32 v215, v27
v_mfma_f32_16x16x32_bf16 a[80:83], a[228:231], v[84:87], a[80:83]
v_exp_f32 v208, v4
v_mfma_f32_16x16x32_bf16 a[112:115], a[228:231], v[92:95], a[112:115]
v_cvt_pk_bf16_f32 v71, v214, v215
v_exp_f32 v209, v5
v_mfma_f32_16x16x32_bf16 a[112:115], a[224:227], v[88:91], a[112:115]
buffer_load_dwordx4 a[164:167], v193, s[24:27], s32 offen offset:3072
v_cvt_pk_bf16_f32 v72, v208, v209
v_mfma_f32_16x16x32_bf16 a[116:119], a[232:235], v[88:91], a[116:119]
v_exp_f32 v210, v6
v_mfma_f32_16x16x32_bf16 a[116:119], a[236:239], v[92:95], a[116:119]
v_exp_f32 v211, v7
v_mfma_f32_16x16x32_bf16 a[84:87], a[236:239], v[84:87], a[84:87]
v_cvt_pk_bf16_f32 v73, v210, v211
v_exp_f32 v212, v12
v_mfma_f32_16x16x32_bf16 a[84:87], a[232:235], v[80:83], a[84:87]
s_waitcnt lgkmcnt(4)
ds_read_b128 a[208:211], v218 offset:2048
ds_read_b128 a[212:215], v218 offset:10240
ds_read_b128 a[216:219], v218 offset:3072
v_mfma_f32_16x16x32_bf16 a[88:91], a[240:243], v[80:83], a[88:91]
ds_read_b128 a[220:223], v218 offset:11264
buffer_load_dwordx4 a[168:171], v194, s[24:27], s32 offen offset:3072
v_mfma_f32_16x16x32_bf16 a[88:91], a[244:247], v[84:87], a[88:91]
v_exp_f32 v213, v13
v_mfma_f32_16x16x32_bf16 a[120:123], a[244:247], v[92:95], a[120:123]
v_exp_f32 v214, v14
v_mfma_f32_16x16x32_bf16 a[120:123], a[240:243], v[88:91], a[120:123]
v_cvt_pk_bf16_f32 v74, v212, v213
v_exp_f32 v215, v15
v_mfma_f32_16x16x32_bf16 a[124:127], a[248:251], v[88:91], a[124:127]
v_cvt_pk_bf16_f32 v75, v214, v215
v_exp_f32 v208, v20
v_mfma_f32_16x16x32_bf16 a[124:127], a[252:255], v[92:95], a[124:127]
buffer_load_dwordx4 a[172:175], v195, s[24:27], s32 offen offset:3072
v_mfma_f32_16x16x32_bf16 a[92:95], a[252:255], v[84:87], a[92:95]
v_exp_f32 v209, v21
v_mfma_f32_16x16x32_bf16 a[92:95], a[248:251], v[80:83], a[92:95]
v_cvt_pk_bf16_f32 v76, v208, v209
v_exp_f32 v210, v22
v_mfma_f32_16x16x32_bf16 a[136:139], a[144:147], v[80:83], a[136:139]
v_exp_f32 v211, v23
v_exp_f32 v212, v28
v_mfma_f32_16x16x32_bf16 a[136:139], a[144:147], v[84:87], a[136:139]
v_cvt_pk_bf16_f32 v77, v210, v211
v_exp_f32 v213, v29
v_mfma_f32_16x16x32_bf16 a[140:143], a[144:147], v[88:91], a[140:143]
v_cvt_pk_bf16_f32 v78, v212, v213
v_exp_f32 v214, v30
v_mfma_f32_16x16x32_bf16 a[140:143], a[144:147], v[92:95], a[140:143]
s_waitcnt lgkmcnt(4)
v_exp_f32 v215, v31
s_nop 0
v_cvt_pk_bf16_f32 v79, v214, v215
LtailB:
Lpad23:
s_cbranch_execz Lpad33
s_waitcnt vmcnt(7) lgkmcnt(0)
s_barrier
v_mfma_f32_16x16x32_bf16 a[64:67], a[192:195], v[64:67], a[64:67]
ds_read_b128 a[224:227], v218 offset:4096
ds_read_b128 a[228:231], v218 offset:12288
v_mfma_f32_16x16x32_bf16 a[64:67], a[196:199], v[68:71], a[64:67]
s_add_u32 m0, s34, 0
v_exp_f32 v208, v36
v_mfma_f32_16x16x32_bf16 a[96:99], a[196:199], v[76:79], a[96:99]
ds_read_b128 a[232:235], v218 offset:5120
ds_read_b128 a[236:239], v218 offset:13312
v_mfma_f32_16x16x32_bf16 a[96:99], a[192:195], v[72:75], a[96:99]
buffer_load_dwordx4 v192, s[24:27], s33 offen offset:0 lds
v_mfma_f32_16x16x32_bf16 a[100:103], a[200:203], v[72:75], a[100:103]
v_exp_f32 v209, v37
v_mfma_f32_16x16x32_bf16 a[100:103], a[204:207], v[76:79], a[100:103]
v_exp_f32 v210, v38
v_mfma_f32_16x16x32_bf16 a[68:71], a[204:207], v[68:71], a[68:71]
buffer_load_dwordx4 v192, s[24:27], s33 offen offset:1024 lds
v_mfma_f32_16x16x32_bf16 a[68:71], a[200:203], v[64:67], a[68:71]
s_waitcnt lgkmcnt(4)
ds_read_b128 a[240:243], v218 offset:6144
v_cvt_pk_bf16_f32 v88, v208, v209
v_mfma_f32_16x16x32_bf16 a[72:75], a[208:211], v[64:67], a[72:75]
v_exp_f32 v211, v39
v_mfma_f32_16x16x32_bf16 a[72:75], a[212:215], v[68:71], a[72:75]
ds_read_b128 a[244:247], v218 offset:14336
v_cvt_pk_bf16_f32 v89, v210, v211
v_mfma_f32_16x16x32_bf16 a[104:107], a[212:215], v[76:79], a[104:107]
buffer_load_dwordx4 v192, s[24:27], s33 offen offset:2048 lds
v_mfma_f32_16x16x32_bf16 a[104:107], a[208:211], v[72:75], a[104:107]
ds_read_b128 a[248:251], v218 offset:7168
ds_read_b128 a[252:255], v218 offset:15360
v_mfma_f32_16x16x32_bf16 a[108:111], a[216:219], v[72:75], a[108:111]
v_exp_f32 v212, v44
v_mfma_f32_16x16x32_bf16 a[108:111], a[220:223], v[76:79], a[108:111]
v_exp_f32 v213, v45
v_mfma_f32_16x16x32_bf16 a[76:79], a[220:223], v[68:71], a[76:79]
buffer_load_dwordx4 v192, s[24:27], s33 offen offset:3072 lds
v_mfma_f32_16x16x32_bf16 a[76:79], a[216:219], v[64:67], a[76:79]
s_waitcnt lgkmcnt(4)
ds_read_b128 a[192:195], v218 offset:16384
v_cvt_pk_bf16_f32 v90, v212, v213
v_mfma_f32_16x16x32_bf16 a[80:83], a[224:227], v[64:67], a[80:83]
s_add_u32 m0, s34, 4096
v_exp_f32 v214, v46
v_mfma_f32_16x16x32_bf16 a[80:83], a[228:231], v[68:71], a[80:83]
ds_read_b128 a[196:199], v218 offset:24576
ds_read_b128 a[200:203], v218 offset:17408
v_mfma_f32_16x16x32_bf16 a[112:115], a[228:231], v[76:79], a[112:115]
buffer_load_dwordx4 v193, s[24:27], s33 offen offset:0 lds
v_mfma_f32_16x16x32_bf16 a[112:115], a[224:227], v[72:75], a[112:115]
v_exp_f32 v215, v47
v_mfma_f32_16x16x32_bf16 a[116:119], a[232:235], v[72:75], a[116:119]
ds_read_b128 a[204:207], v218 offset:25600
v_cvt_pk_bf16_f32 v91, v214, v215
v_mfma_f32_16x16x32_bf16 a[116:119], a[236:239], v[76:79], a[116:119]
v_exp_f32 v208, v52
v_mfma_f32_16x16x32_bf16 a[84:87], a[236:239], v[68:71], a[84:87]
v_exp_f32 v209, v53
v_mfma_f32_16x16x32_bf16 a[84:87], a[232:235], v[64:67], a[84:87]
s_waitcnt lgkmcnt(4)
ds_read_b128 a[208:211], v218 offset:18432
v_cvt_pk_bf16_f32 v92, v208, v209
v_mfma_f32_16x16x32_bf16 a[88:91], a[240:243], v[64:67], a[88:91]
buffer_load_dwordx4 v193, s[24:27], s33 offen offset:1024 lds
v_mfma_f32_16x16x32_bf16 a[88:91], a[244:247], v[68:71], a[88:91]
ds_read_b128 a[212:215], v218 offset:26624
ds_read_b128 a[216:219], v218 offset:19456
v_mfma_f32_16x16x32_bf16 a[120:123], a[244:247], v[76:79], a[120:123]
v_exp_f32 v210, v54
v_mfma_f32_16x16x32_bf16 a[120:123], a[240:243], v[72:75], a[120:123]
buffer_load_dwordx4 v193, s[24:27], s33 offen offset:2048 lds
v_mfma_f32_16x16x32_bf16 a[124:127], a[248:251], v[72:75], a[124:127]
v_exp_f32 v211, v55
v_mfma_f32_16x16x32_bf16 a[124:127], a[252:255], v[76:79], a[124:127]
ds_read_b128 a[220:223], v218 offset:27648
v_cvt_pk_bf16_f32 v93, v210, v211
v_mfma_f32_16x16x32_bf16 a[92:95], a[252:255], v[68:71], a[92:95]
v_exp_f32 v212, v60
v_mfma_f32_16x16x32_bf16 a[92:95], a[248:251], v[64:67], a[92:95]
buffer_load_dwordx4 v193, s[24:27], s33 offen offset:3072 lds
v_mfma_f32_16x16x32_bf16 a[136:139], a[144:147], v[64:67], a[136:139]
v_exp_f32 v213, v61
v_mfma_f32_16x16x32_bf16 a[136:139], a[144:147], v[68:71], a[136:139]
v_exp_f32 v214, v62
v_mfma_f32_16x16x32_bf16 a[140:143], a[144:147], v[72:75], a[140:143]
v_exp_f32 v215, v63
v_mfma_f32_16x16x32_bf16 a[140:143], a[144:147], v[76:79], a[140:143]
s_waitcnt lgkmcnt(4)
v_cvt_pk_bf16_f32 v94, v212, v213
v_cvt_pk_bf16_f32 v95, v214, v215
s_nop 1
v_mfma_f32_16x16x32_bf16 a[96:99], a[192:195], v[88:91], a[96:99]
ds_read_b128 a[224:227], v218 offset:20480
ds_read_b128 a[228:231], v218 offset:28672
v_mfma_f32_16x16x32_bf16 a[96:99], a[196:199], v[92:95], a[96:99]
s_add_u32 m0, s34, 8192
v_mfma_f32_16x16x32_bf16 a[100:103], a[204:207], v[92:95], a[100:103]
ds_read_b128 a[232:235], v218 offset:21504
ds_read_b128 a[236:239], v218 offset:29696
v_mfma_f32_16x16x32_bf16 a[100:103], a[200:203], v[88:91], a[100:103]
s_waitcnt lgkmcnt(4)
v_mfma_f32_16x16x32_bf16 a[104:107], a[208:211], v[88:91], a[104:107]
ds_read_b128 a[240:243], v218 offset:22528
ds_read_b128 a[244:247], v218 offset:30720
v_mfma_f32_16x16x32_bf16 a[104:107], a[212:215], v[92:95], a[104:107]
buffer_load_dwordx4 v194, s[24:27], s33 offen offset:0 lds
v_mfma_f32_16x16x32_bf16 a[108:111], a[220:223], v[92:95], a[108:111]
ds_read_b128 a[248:251], v218 offset:23552
ds_read_b128 a[252:255], v218 offset:31744
v_mfma_f32_16x16x32_bf16 a[108:111], a[216:219], v[88:91], a[108:111]
s_waitcnt lgkmcnt(4)
v_mfma_f32_16x16x32_bf16 a[112:115], a[224:227], v[88:91], a[112:115]
buffer_load_dwordx4 v194, s[24:27], s33 offen offset:1024 lds
v_mfma_f32_16x16x32_bf16 a[112:115], a[228:231], v[92:95], a[112:115]
v_mfma_f32_16x16x32_bf16 a[116:119], a[236:239], v[92:95], a[116:119]
buffer_load_dwordx4 v194, s[24:27], s33 offen offset:2048 lds
v_mfma_f32_16x16x32_bf16 a[116:119], a[232:235], v[88:91], a[116:119]
s_waitcnt lgkmcnt(0)
v_mfma_f32_16x16x32_bf16 a[120:123], a[240:243], v[88:91], a[120:123]
v_mfma_f32_16x16x32_bf16 a[120:123], a[244:247], v[92:95], a[120:123]
v_mfma_f32_16x16x32_bf16 a[124:127], a[252:255], v[92:95], a[124:127]
buffer_load_dwordx4 v194, s[24:27], s33 offen offset:3072 lds
v_mfma_f32_16x16x32_bf16 a[124:127], a[248:251], v[88:91], a[124:127]
v_mfma_f32_16x16x32_bf16 a[140:143], a[144:147], v[88:91], a[140:143]
v_mfma_f32_16x16x32_bf16 a[140:143], a[144:147], v[92:95], a[140:143]
s_mov_b32 s7, 0x5f800000
s_nop 3
s_nop 2
v_accvgpr_read_b32 v208, a128
v_accvgpr_read_b32 v209, a132
v_accvgpr_read_b32 v210, a136
v_accvgpr_read_b32 v211, a140
v_cmp_ngt_f32 vcc, s7, v208
v_cmp_ngt_f32 s[48:49], s7, v209
s_nop 0
s_or_b64 vcc, vcc, s[48:49]
v_cmp_ngt_f32 s[48:49], s7, v210
s_nop 0
s_or_b64 vcc, vcc, s[48:49]
v_cmp_ngt_f32 s[48:49], s7, v211
s_nop 0
s_or_b64 vcc, vcc, s[48:49]
s_cmp_lg_u64 vcc, 0
s_cbranch_scc1 Lslow
Lepi:
s_add_u32 m0, s34, 12288
s_nop 0
buffer_load_dwordx4 v195, s[24:27], s33 offen offset:0 lds
buffer_load_dwordx4 v195, s[24:27], s33 offen offset:1024 lds
buffer_load_dwordx4 v195, s[24:27], s33 offen offset:2048 lds
buffer_load_dwordx4 v195, s[24:27], s33 offen offset:3072 lds
v_accvgpr_read_b32 v208, a128
v_accvgpr_read_b32 v210, a132
v_accvgpr_read_b32 v212, a136
v_accvgpr_read_b32 v214, a140
v_rcp_f32 v208, v208
v_rcp_f32 v210, v210
v_rcp_f32 v212, v212
v_rcp_f32 v214, v214
s_cmp_lg_u32 s99, 2
s_cbranch_scc1 Lepi01
Lepi2:
v_accvgpr_read_b32 v0, a64
v_accvgpr_read_b32 v1, a65
v_accvgpr_read_b32 v2, a66
v_accvgpr_read_b32 v3, a67
v_accvgpr_read_b32 v4, a68
v_accvgpr_read_b32 v5, a69
v_accvgpr_read_b32 v6, a70
v_accvgpr_read_b32 v7, a71
v_pk_mul_f32 v[0:1], v[0:1], v[212:213] op_sel_hi:[1,0]
v_pk_mul_f32 v[2:3], v[2:3], v[212:213] op_sel_hi:[1,0]
v_pk_mul_f32 v[4:5], v[4:5], v[212:213] op_sel_hi:[1,0]
v_pk_mul_f32 v[6:7], v[6:7], v[212:213] op_sel_hi:[1,0]
v_cvt_pk_bf16_f32 v32, v0, v1
v_cvt_pk_bf16_f32 v33, v2, v3
v_cvt_pk_bf16_f32 v34, v4, v5
v_cvt_pk_bf16_f32 v35, v6, v7
buffer_store_dwordx4 v[32:35], v216, s[28:31], s44 offen offset:0 sc1
v_accvgpr_read_b32 v8, a72
v_accvgpr_read_b32 v9, a73
v_accvgpr_read_b32 v10, a74
v_accvgpr_read_b32 v11, a75
v_accvgpr_read_b32 v12, a76
v_accvgpr_read_b32 v13, a77
v_accvgpr_read_b32 v14, a78
v_accvgpr_read_b32 v15, a79
v_pk_mul_f32 v[8:9], v[8:9], v[212:213] op_sel_hi:[1,0]
v_pk_mul_f32 v[10:11], v[10:11], v[212:213] op_sel_hi:[1,0]
v_pk_mul_f32 v[12:13], v[12:13], v[212:213] op_sel_hi:[1,0]
v_pk_mul_f32 v[14:15], v[14:15], v[212:213] op_sel_hi:[1,0]
v_cvt_pk_bf16_f32 v36, v8, v9
v_cvt_pk_bf16_f32 v37, v10, v11
v_cvt_pk_bf16_f32 v38, v12, v13
v_cvt_pk_bf16_f32 v39, v14, v15
buffer_store_dwordx4 v[36:39], v216, s[28:31], s44 offen offset:1024 sc1
v_accvgpr_read_b32 v16, a80
v_accvgpr_read_b32 v17, a81
v_accvgpr_read_b32 v18, a82
v_accvgpr_read_b32 v19, a83
v_accvgpr_read_b32 v20, a84
v_accvgpr_read_b32 v21, a85
v_accvgpr_read_b32 v22, a86
v_accvgpr_read_b32 v23, a87
v_pk_mul_f32 v[16:17], v[16:17], v[212:213] op_sel_hi:[1,0]
v_pk_mul_f32 v[18:19], v[18:19], v[212:213] op_sel_hi:[1,0]
v_pk_mul_f32 v[20:21], v[20:21], v[212:213] op_sel_hi:[1,0]
v_pk_mul_f32 v[22:23], v[22:23], v[212:213] op_sel_hi:[1,0]
v_cvt_pk_bf16_f32 v40, v16, v17
v_cvt_pk_bf16_f32 v41, v18, v19
v_cvt_pk_bf16_f32 v42, v20, v21
v_cvt_pk_bf16_f32 v43, v22, v23
buffer_store_dwordx4 v[40:43], v216, s[28:31], s44 offen offset:2048 sc1
v_accvgpr_read_b32 v24, a88
v_accvgpr_read_b32 v25, a89
v_accvgpr_read_b32 v26, a90
v_accvgpr_read_b32 v27, a91
v_accvgpr_read_b32 v28, a92
v_accvgpr_read_b32 v29, a93
v_accvgpr_read_b32 v30, a94
v_accvgpr_read_b32 v31, a95
v_pk_mul_f32 v[24:25], v[24:25], v[212:213] op_sel_hi:[1,0]
v_pk_mul_f32 v[26:27], v[26:27], v[212:213] op_sel_hi:[1,0]
v_pk_mul_f32 v[28:29], v[28:29], v[212:213] op_sel_hi:[1,0]
v_pk_mul_f32 v[30:31], v[30:31], v[212:213] op_sel_hi:[1,0]
v_cvt_pk_bf16_f32 v44, v24, v25
v_cvt_pk_bf16_f32 v45, v26, v27
v_cvt_pk_bf16_f32 v46, v28, v29
v_cvt_pk_bf16_f32 v47, v30, v31
buffer_store_dwordx4 v[44:47], v216, s[28:31], s44 offen offset:3072 sc1
v_accvgpr_read_b32 v0, a96
v_accvgpr_read_b32 v1, a97
v_accvgpr_read_b32 v2, a98
v_accvgpr_read_b32 v3, a99
v_accvgpr_read_b32 v4, a100
v_accvgpr_read_b32 v5, a101
v_accvgpr_read_b32 v6, a102
v_accvgpr_read_b32 v7, a103
v_pk_mul_f32 v[0:1], v[0:1], v[214:215] op_sel_hi:[1,0]
v_pk_mul_f32 v[2:3], v[2:3], v[214:215] op_sel_hi:[1,0]
v_pk_mul_f32 v[4:5], v[4:5], v[214:215] op_sel_hi:[1,0]
v_pk_mul_f32 v[6:7], v[6:7], v[214:215] op_sel_hi:[1,0]
v_cvt_pk_bf16_f32 v32, v0, v1
v_cvt_pk_bf16_f32 v33, v2, v3
v_cvt_pk_bf16_f32 v34, v4, v5
v_cvt_pk_bf16_f32 v35, v6, v7
buffer_store_dwordx4 v[32:35], v216, s[28:31], s45 offen offset:0 sc1
v_accvgpr_read_b32 v8, a104
v_accvgpr_read_b32 v9, a105
v_accvgpr_read_b32 v10, a106
v_accvgpr_read_b32 v11, a107
v_accvgpr_read_b32 v12, a108
v_accvgpr_read_b32 v13, a109
v_accvgpr_read_b32 v14, a110
v_accvgpr_read_b32 v15, a111
v_pk_mul_f32 v[8:9], v[8:9], v[214:215] op_sel_hi:[1,0]
v_pk_mul_f32 v[10:11], v[10:11], v[214:215] op_sel_hi:[1,0]
v_pk_mul_f32 v[12:13], v[12:13], v[214:215] op_sel_hi:[1,0]
v_pk_mul_f32 v[14:15], v[14:15], v[214:215] op_sel_hi:[1,0]
v_cvt_pk_bf16_f32 v36, v8, v9
v_cvt_pk_bf16_f32 v37, v10, v11
v_cvt_pk_bf16_f32 v38, v12, v13
v_cvt_pk_bf16_f32 v39, v14, v15
buffer_store_dwordx4 v[36:39], v216, s[28:31], s45 offen offset:1024 sc1
v_accvgpr_read_b32 v16, a112
v_accvgpr_read_b32 v17, a113
v_accvgpr_read_b32 v18, a114
v_accvgpr_read_b32 v19, a115
v_accvgpr_read_b32 v20, a116
v_accvgpr_read_b32 v21, a117
v_accvgpr_read_b32 v22, a118
v_accvgpr_read_b32 v23, a119
v_pk_mul_f32 v[16:17], v[16:17], v[214:215] op_sel_hi:[1,0]
v_pk_mul_f32 v[18:19], v[18:19], v[214:215] op_sel_hi:[1,0]
v_pk_mul_f32 v[20:21], v[20:21], v[214:215] op_sel_hi:[1,0]
v_pk_mul_f32 v[22:23], v[22:23], v[214:215] op_sel_hi:[1,0]
v_cvt_pk_bf16_f32 v40, v16, v17
v_cvt_pk_bf16_f32 v41, v18, v19
v_cvt_pk_bf16_f32 v42, v20, v21
v_cvt_pk_bf16_f32 v43, v22, v23
buffer_store_dwordx4 v[40:43], v216, s[28:31], s45 offen offset:2048 sc1
v_accvgpr_read_b32 v24, a120
v_accvgpr_read_b32 v25, a121
v_accvgpr_read_b32 v26, a122
v_accvgpr_read_b32 v27, a123
v_accvgpr_read_b32 v28, a124
v_accvgpr_read_b32 v29, a125
v_accvgpr_read_b32 v30, a126
v_accvgpr_read_b32 v31, a127
v_pk_mul_f32 v[24:25], v[24:25], v[214:215] op_sel_hi:[1,0]
v_pk_mul_f32 v[26:27], v[26:27], v[214:215] op_sel_hi:[1,0]
v_pk_mul_f32 v[28:29], v[28:29], v[214:215] op_sel_hi:[1,0]
v_pk_mul_f32 v[30:31], v[30:31], v[214:215] op_sel_hi:[1,0]
v_cvt_pk_bf16_f32 v44, v24, v25
v_cvt_pk_bf16_f32 v45, v26, v27
v_cvt_pk_bf16_f32 v46, v28, v29
v_cvt_pk_bf16_f32 v47, v30, v31
buffer_store_dwordx4 v[44:47], v216, s[28:31], s45 offen offset:3072 sc1
s_add_u32 m0, s34, 16384
s_nop 0
buffer_load_dwordx4 v196, s[24:27], s33 offen offset:0 lds
buffer_load_dwordx4 v196, s[24:27], s33 offen offset:1024 lds
buffer_load_dwordx4 v196, s[24:27], s33 offen offset:2048 lds
buffer_load_dwordx4 v196, s[24:27], s33 offen offset:3072 lds
s_add_u32 s33, s32, 0
buffer_load_dwordx4 a[220:223], v192, s[24:27], s33 offen offset:0
buffer_load_dwordx4 a[224:227], v193, s[24:27], s33 offen offset:0
buffer_load_dwordx4 a[228:231], v194, s[24:27], s33 offen offset:0
buffer_load_dwordx4 a[232:235], v195, s[24:27], s33 offen offset:0
buffer_load_dwordx4 a[236:239], v196, s[24:27], s33 offen offset:0
buffer_load_dwordx4 a[200:203], v192, s[24:27], s33 offen offset:1024
buffer_load_dwordx4 a[204:207], v193, s[24:27], s33 offen offset:1024
buffer_load_dwordx4 a[208:211], v194, s[24:27], s33 offen offset:1024
buffer_load_dwordx4 a[212:215], v195, s[24:27], s33 offen offset:1024
buffer_load_dwordx4 a[216:219], v196, s[24:27], s33 offen offset:1024
s_and_b32 s6, s2, 7
s_lshl_b32 s6, s6, 1
s_bfe_u32 s7, s2, 0x10003
s_add_u32 s58, s6, s7
s_and_b32 s6, s59, 1
s_lshl_b32 s6, s6, 2
s_lshl_b32 s60, s58, 3
s_add_u32 s60, s60, s6
s_add_u32 s60, s60, s3
s_andn2_b32 s7, s60, 19
s_add_u32 s6, s3, 0
s_and_b32 s6, s6, 3
s_add_u32 s6, s6, s7
s_mul_i32 s6, s6, 131072
v_add_u32 v224, s6, v216
s_add_u32 s6, s3, 1
s_and_b32 s6, s6, 3
s_add_u32 s6, s6, s7
s_mul_i32 s6, s6, 131072
v_add_u32 v225, s6, v216
s_add_u32 s6, s3, 2
s_and_b32 s6, s6, 3
s_add_u32 s6, s6, s7
s_mul_i32 s6, s6, 131072
v_add_u32 v226, s6, v216
s_add_u32 s6, s3, 3
s_and_b32 s6, s6, 3
s_add_u32 s6, s6, s7
s_mul_i32 s6, s6, 131072
v_add_u32 v227, s6, v216
v_lshrrev_b32 v233, 4, v220
v_and_b32 v234, 15, v220
v_lshlrev_b32 v236, 4, v233
s_add_u32 s6, s3, 0
s_and_b32 s6, s6, 3
s_mul_i32 s6, s6, 20480
s_add_u32 s6, s6, 61440
v_add_u32 v237, s6, v216
s_add_u32 s6, s3, 1
s_and_b32 s6, s6, 3
s_mul_i32 s6, s6, 20480
s_add_u32 s6, s6, 61440
v_add_u32 v238, s6, v216
s_add_u32 s6, s3, 2
s_and_b32 s6, s6, 3
s_mul_i32 s6, s6, 20480
s_add_u32 s6, s6, 61440
v_add_u32 v239, s6, v216
s_add_u32 s6, s3, 3
s_and_b32 s6, s6, 3
s_mul_i32 s6, s6, 20480
s_add_u32 s6, s6, 61440
v_add_u32 v240, s6, v216
v_add_u32 v243, s34, v216
s_mul_i32 s35, s60, 20480
s_mul_i32 s6, s61, 160
s_add_u32 s35, s35, s6
s_mul_i32 s38, s61, 320
s_mov_b32 s16, s36
s_and_b32 s17, s37, 0xffff
s_mov_b32 s18, 2621440
s_mov_b32 s19, 0x20000
s_add_u32 s20, s66, 65536
s_addc_u32 s21, s67, 0
s_and_b32 s21, s21, 0xffff
s_mov_b32 s22, 17920
s_mov_b32 s23, 0x20000
s_lshl_b32 s6, s5, 2
s_lshr_b32 s7, s4, 3
s_add_u32 s6, s6, s7
s_lshl_b32 s6, s6, 8
s_add_u32 s6, s6, 272384
v_mov_b32 v241, s6
s_mov_b64 exec, 0
s_cmp_eq_u32 s3, 0
s_cbranch_scc1 Lch2_0
s_cmp_eq_u32 s3, 1
s_cbranch_scc1 Lch2_1
s_cmp_eq_u32 s3, 2
s_cbranch_scc1 Lch2_2
s_branch Lch2_3
Lret2:
s_mov_b64 exec, -1
s_waitcnt vmcnt(14)
s_barrier
s_cmp_lg_u32 s3, 0
s_cbranch_scc1 Larr21
s_mov_b64 exec, 1
global_atomic_add v241, v223, s[66:67] offset:0 sc1
s_mov_b64 exec, -1
Larr21:
v_and_b32 v241, 1, v220
v_lshlrev_b32 v241, 1, v241
v_xor_b32 v241, s58, v241
v_sub_u32 v242, 15, v241
v_min_u32 v241, v241, v242
s_lshr_b32 s7, s32, 15
s_lshl_b32 s7, s7, 8
s_add_u32 s7, s7, 272384
v_lshl_add_u32 v241, v241, 10, s7
s_and_b32 s6, s2, 1
s_mul_i32 s7, s6, 2097152
s_add_u32 s69, s32, s7
s_xor_b32 s6, s6, 1
s_mul_i32 s7, s6, 2097152
s_add_u32 s70, s32, s7
v_mul_u32_u24 v0, 3277, v220
v_lshrrev_b32 v0, 16, v0
v_min_u32 v1, 1, v0
v_add_u32 v1, v0, v1
v_mul_u32_u24 v1, 2560, v1
v_mul_u32_u24 v0, 320, v0
v_sub_u32 v0, v216, v0
v_add_u32 v197, v0, v1
s_add_u32 s42, s38, 5120
s_mov_b32 s45, 15360
buffer_load_dwordx4 a[192:195], v195, s[24:27], s33 offen offset:2048
buffer_load_dwordx4 a[196:199], v196, s[24:27], s33 offen offset:2048
buffer_load_dwordx4 a[176:179], v196, s[24:27], s33 offen offset:3072
s_add_u32 s33, s32, 4096
buffer_load_dwordx4 a[140:143], v192, s[24:27], s33 offen offset:0
buffer_load_dwordx4 a[144:147], v193, s[24:27], s33 offen offset:0
buffer_load_dwordx4 a[148:151], v194, s[24:27], s33 offen offset:0
buffer_load_dwordx4 a[152:155], v195, s[24:27], s33 offen offset:0
buffer_load_dwordx4 a[156:159], v196, s[24:27], s33 offen offset:0
buffer_load_dwordx4 a[120:123], v192, s[24:27], s33 offen offset:1024
buffer_load_dwordx4 a[124:127], v193, s[24:27], s33 offen offset:1024
buffer_load_dwordx4 a[128:131], v194, s[24:27], s33 offen offset:1024
buffer_load_dwordx4 a[132:135], v195, s[24:27], s33 offen offset:1024
buffer_load_dwordx4 a[136:139], v196, s[24:27], s33 offen offset:1024
s_add_u32 s33, s32, 8192
buffer_load_dwordx4 a[100:103], v192, s[24:27], s33 offen offset:2048
buffer_load_dwordx4 a[104:107], v193, s[24:27], s33 offen offset:2048
buffer_load_dwordx4 a[108:111], v194, s[24:27], s33 offen offset:2048
buffer_load_dwordx4 a[112:115], v195, s[24:27], s33 offen offset:2048
buffer_load_dwordx4 a[116:119], v196, s[24:27], s33 offen offset:2048
buffer_load_dwordx4 a[80:83], v192, s[24:27], s33 offen offset:3072
buffer_load_dwordx4 a[84:87], v193, s[24:27], s33 offen offset:3072
buffer_load_dwordx4 a[88:91], v194, s[24:27], s33 offen offset:3072
buffer_load_dwordx4 a[92:95], v195, s[24:27], s33 offen offset:3072
buffer_load_dwordx4 a[96:99], v196, s[24:27], s33 offen offset:3072
s_add_u32 s33, s32, 12288
buffer_load_dwordx4 a[60:63], v192, s[24:27], s33 offen offset:0
buffer_load_dwordx4 a[64:67], v193, s[24:27], s33 offen offset:0
buffer_load_dwordx4 a[68:71], v194, s[24:27], s33 offen offset:0
buffer_load_dwordx4 a[72:75], v195, s[24:27], s33 offen offset:0
buffer_load_dwordx4 a[76:79], v196, s[24:27], s33 offen offset:0
buffer_load_dwordx4 a[40:43], v192, s[24:27], s33 offen offset:1024
buffer_load_dwordx4 a[44:47], v193, s[24:27], s33 offen offset:1024
buffer_load_dwordx4 a[48:51], v194, s[24:27], s33 offen offset:1024
global_load_dword v242, v241, s[66:67] sc1
buffer_load_dwordx4 a[52:55], v195, s[24:27], s33 offen offset:1024
buffer_load_dwordx4 a[56:59], v196, s[24:27], s33 offen offset:1024
buffer_load_dwordx4 a[20:23], v192, s[24:27], s33 offen offset:2048
buffer_load_dwordx4 a[24:27], v193, s[24:27], s33 offen offset:2048
buffer_load_dwordx4 a[28:31], v194, s[24:27], s33 offen offset:2048
buffer_load_dwordx4 a[32:35], v195, s[24:27], s33 offen offset:2048
buffer_load_dwordx4 a[36:39], v196, s[24:27], s33 offen offset:2048
buffer_load_dwordx4 a[0:3], v192, s[24:27], s33 offen offset:3072
s_waitcnt vmcnt(8)
v_cmp_gt_u32 vcc, 8, v242
s_mov_b32 s6, 0
s_cmp_eq_u64 vcc, 0
s_cbranch_scc1 Lok22
Lsp23:
s_sleep 5
global_load_dword v242, v241, s[66:67] sc1
s_waitcnt vmcnt(0)
v_cmp_gt_u32 vcc, 8, v242
s_add_u32 s6, s6, 1
s_cmp_gt_u32 s6, 200000
s_cbranch_scc1 Lok22
s_cmp_lg_u64 vcc, 0
Lch2_0:
Lpad24:
s_cbranch_execz Lpad28
s_cbranch_scc1 Lsp23
Lok22:
s_add_u32 s32, s70, 0
buffer_load_dwordx4 v[80:83], v225, s[28:31], s32 offen offset:0
buffer_load_dwordx4 v[84:87], v225, s[28:31], s32 offen offset:1024
buffer_load_dwordx4 v[88:91], v225, s[28:31], s32 offen offset:2048
buffer_load_dwordx4 v[92:95], v226, s[28:31], s32 offen offset:0
buffer_load_dwordx4 v[96:99], v226, s[28:31], s32 offen offset:1024
buffer_load_dwordx4 v[100:103], v226, s[28:31], s32 offen offset:2048
buffer_load_dwordx4 v[104:107], v227, s[28:31], s32 offen offset:0
buffer_load_dwordx4 v[108:111], v227, s[28:31], s32 offen offset:1024
buffer_load_dwordx4 v[112:115], v227, s[28:31], s32 offen offset:2048
buffer_load_dwordx4 v[116:119], v224, s[28:31], s32 offen offset:0
buffer_load_dwordx4 v[120:123], v224, s[28:31], s32 offen offset:1024
buffer_load_dwordx4 v[124:127], v224, s[28:31], s32 offen offset:2048
buffer_load_dwordx4 v[128:131], v224, s[28:31], s32 offen offset:3072
buffer_load_dwordx4 v[132:135], v225, s[28:31], s32 offen offset:3072
buffer_load_dwordx4 v[136:139], v226, s[28:31], s32 offen offset:3072
buffer_load_dwordx4 v[140:143], v227, s[28:31], s32 offen offset:3072
s_waitcnt vmcnt(13)
v_mfma_f32_16x16x32_bf16 v[20:23], a[220:223], v[80:83], 0
buffer_load_dwordx4 a[4:7], v193, s[24:27], s33 offen offset:3072
v_mfma_f32_16x16x32_bf16 v[20:23], a[200:203], v[84:87], v[20:23]
v_mfma_f32_16x16x32_bf16 v[20:23], a[180:183], v[88:91], v[20:23]
v_mfma_f32_16x16x32_bf16 v[24:27], a[184:187], v[88:91], 0
v_mfma_f32_16x16x32_bf16 v[24:27], a[204:207], v[84:87], v[24:27]
buffer_load_dwordx4 a[8:11], v194, s[24:27], s33 offen offset:3072
v_mfma_f32_16x16x32_bf16 v[24:27], a[224:227], v[80:83], v[24:27]
v_mfma_f32_16x16x32_bf16 v[28:31], a[228:231], v[80:83], 0
v_mfma_f32_16x16x32_bf16 v[28:31], a[208:211], v[84:87], v[28:31]
v_mfma_f32_16x16x32_bf16 v[28:31], a[188:191], v[88:91], v[28:31]
v_mfma_f32_16x16x32_bf16 v[32:35], a[192:195], v[88:91], 0
buffer_load_dwordx4 a[12:15], v195, s[24:27], s33 offen offset:3072
v_mfma_f32_16x16x32_bf16 v[32:35], a[212:215], v[84:87], v[32:35]
v_mfma_f32_16x16x32_bf16 v[32:35], a[232:235], v[80:83], v[32:35]
v_mfma_f32_16x16x32_bf16 v[36:39], a[236:239], v[80:83], 0
v_mfma_f32_16x16x32_bf16 v[36:39], a[216:219], v[84:87], v[36:39]
v_mfma_f32_16x16x32_bf16 v[36:39], a[196:199], v[88:91], v[36:39]
s_waitcnt vmcnt(13)
v_mfma_f32_16x16x32_bf16 v[40:43], a[220:223], v[92:95], 0
s_add_u32 s32, s70, 4096
s_add_u32 s8, s66, 16777216
s_addc_u32 s9, s67, 0
v_mfma_f32_16x16x32_bf16 v[40:43], a[200:203], v[96:99], v[40:43]
buffer_load_dwordx4 v[80:83], v224, s[28:31], s32 offen offset:0
v_mfma_f32_16x16x32_bf16 v[40:43], a[180:183], v[100:103], v[40:43]
s_and_b32 s9, s9, 0xffff
v_mfma_f32_16x16x32_bf16 v[44:47], a[184:187], v[100:103], 0
s_mov_b32 s10, 2211840
v_mfma_f32_16x16x32_bf16 v[44:47], a[204:207], v[96:99], v[44:47]
buffer_load_dwordx4 v[84:87], v225, s[28:31], s32 offen offset:0
v_mfma_f32_16x16x32_bf16 v[44:47], a[224:227], v[92:95], v[44:47]
s_mov_b32 s11, 0x20000
s_lshl_b32 s6, s59, 3
s_lshl_b32 s7, s3, 1
v_mfma_f32_16x16x32_bf16 v[48:51], a[228:231], v[92:95], 0
s_add_u32 s49, s6, s7
v_mfma_f32_16x16x32_bf16 v[48:51], a[208:211], v[96:99], v[48:51]
buffer_load_dwordx4 v[88:91], v226, s[28:31], s32 offen offset:0
v_mfma_f32_16x16x32_bf16 v[48:51], a[188:191], v[100:103], v[48:51]
s_mul_i32 s6, s49, 20480
v_mfma_f32_16x16x32_bf16 v[52:55], a[192:195], v[100:103], 0
v_add_u32 v228, s6, v216
v_add_u32 v229, 20480, v228
v_mfma_f32_16x16x32_bf16 v[52:55], a[212:215], v[96:99], v[52:55]
buffer_load_dwordx4 a[16:19], v196, s[24:27], s33 offen offset:3072
v_mfma_f32_16x16x32_bf16 v[52:55], a[232:235], v[92:95], v[52:55]
s_mov_b32 s39, 0
v_mfma_f32_16x16x32_bf16 v[56:59], a[236:239], v[92:95], 0
s_lshl_b32 s44, s3, 12
v_mfma_f32_16x16x32_bf16 v[56:59], a[216:219], v[96:99], v[56:59]
s_add_u32 s44, s44, 147456
v_mfma_f32_16x16x32_bf16 v[56:59], a[196:199], v[100:103], v[56:59]
s_waitcnt vmcnt(14)
v_mfma_f32_16x16x32_bf16 v[60:63], a[220:223], v[104:107], 0
buffer_load_dwordx4 v[92:95], v227, s[28:31], s32 offen offset:0
v_mfma_f32_16x16x32_bf16 v[60:63], a[200:203], v[108:111], v[60:63]
s_lshr_b32 s48, s2, 3
v_mfma_f32_16x16x32_bf16 v[60:63], a[180:183], v[112:115], v[60:63]
s_lshl_b32 s48, s48, 2
v_mfma_f32_16x16x32_bf16 v[64:67], a[184:187], v[112:115], 0
buffer_load_dwordx4 v[96:99], v224, s[28:31], s32 offen offset:1024
v_mfma_f32_16x16x32_bf16 v[64:67], a[204:207], v[108:111], v[64:67]
s_add_u32 s48, s48, s3
v_mfma_f32_16x16x32_bf16 v[64:67], a[224:227], v[104:107], v[64:67]
s_mul_i32 s48, s48, 20480
v_mfma_f32_16x16x32_bf16 v[68:71], a[228:231], v[104:107], 0
s_add_u32 s48, s48, 8192
v_mfma_f32_16x16x32_bf16 v[68:71], a[208:211], v[108:111], v[68:71]
buffer_load_dwordx4 v[100:103], v225, s[28:31], s32 offen offset:1024
v_mfma_f32_16x16x32_bf16 v[68:71], a[188:191], v[112:115], v[68:71]
v_mfma_f32_16x16x32_bf16 v[72:75], a[192:195], v[112:115], 0
v_mfma_f32_16x16x32_bf16 v[72:75], a[212:215], v[108:111], v[72:75]
buffer_load_dwordx4 a[252:255], v197, s[20:23], s42 offen sc1
v_mfma_f32_16x16x32_bf16 v[72:75], a[232:235], v[104:107], v[72:75]
v_mfma_f32_16x16x32_bf16 v[76:79], a[236:239], v[104:107], 0
v_mfma_f32_16x16x32_bf16 v[76:79], a[216:219], v[108:111], v[76:79]
v_mfma_f32_16x16x32_bf16 v[76:79], a[196:199], v[112:115], v[76:79]
s_waitcnt vmcnt(15)
v_mfma_f32_16x16x32_bf16 v[0:3], a[220:223], v[116:119], 0
buffer_load_dwordx4 v[104:107], v226, s[28:31], s32 offen offset:1024
v_mfma_f32_16x16x32_bf16 v[0:3], a[200:203], v[120:123], v[0:3]
v_mfma_f32_16x16x32_bf16 v[0:3], a[180:183], v[124:127], v[0:3]
v_mfma_f32_16x16x32_bf16 v[4:7], a[184:187], v[124:127], 0
buffer_load_dwordx4 v[108:111], v227, s[28:31], s32 offen offset:1024
v_mfma_f32_16x16x32_bf16 v[4:7], a[204:207], v[120:123], v[4:7]
v_mfma_f32_16x16x32_bf16 v[4:7], a[224:227], v[116:119], v[4:7]
v_mfma_f32_16x16x32_bf16 v[8:11], a[228:231], v[116:119], 0
v_mfma_f32_16x16x32_bf16 v[8:11], a[208:211], v[120:123], v[8:11]
buffer_load_dwordx4 v[112:115], v224, s[28:31], s32 offen offset:2048
v_mfma_f32_16x16x32_bf16 v[8:11], a[188:191], v[124:127], v[8:11]
v_mfma_f32_16x16x32_bf16 v[12:15], a[192:195], v[124:127], 0
v_mfma_f32_16x16x32_bf16 v[12:15], a[212:215], v[120:123], v[12:15]
buffer_load_dwordx4 a[240:243], v216, s[20:23], s45 offen offset:0 sc1
v_mfma_f32_16x16x32_bf16 v[12:15], a[232:235], v[116:119], v[12:15]
v_mfma_f32_16x16x32_bf16 v[16:19], a[236:239], v[116:119], 0
v_mfma_f32_16x16x32_bf16 v[16:19], a[216:219], v[120:123], v[16:19]
v_mfma_f32_16x16x32_bf16 v[16:19], a[196:199], v[124:127], v[16:19]
s_waitcnt vmcnt(15)
v_mfma_f32_16x16x32_bf16 v[0:3], a[160:163], v[128:131], v[0:3]
buffer_load_dwordx4 v[116:119], v225, s[28:31], s32 offen offset:2048
v_mfma_f32_16x16x32_bf16 v[20:23], a[160:163], v[132:135], v[20:23]
s_lshl_b32 s6, s58, 8
s_add_u32 s6, s6, 280704
v_lshl_add_u32 v241, v234, 2, s6
v_mfma_f32_16x16x32_bf16 v[40:43], a[160:163], v[136:139], v[40:43]
s_lshl_b32 s7, s59, 2
v_mfma_f32_16x16x32_bf16 v[60:63], a[160:163], v[140:143], v[60:63]
s_add_u32 s7, s7, s6
v_mfma_f32_16x16x32_bf16 v[64:67], a[164:167], v[140:143], v[64:67]
buffer_load_dwordx4 v[120:123], v226, s[28:31], s32 offen offset:2048
v_mfma_f32_16x16x32_bf16 v[44:47], a[164:167], v[136:139], v[44:47]
v_mfma_f32_16x16x32_bf16 v[24:27], a[164:167], v[132:135], v[24:27]
v_mov_b32 v255, s7
v_mov_b32 v184, s6
v_mfma_f32_16x16x32_bf16 v[4:7], a[164:167], v[128:131], v[4:7]
s_lshl_b32 s6, s2, 7
v_mfma_f32_16x16x32_bf16 v[8:11], a[168:171], v[128:131], v[8:11]
s_lshl_b32 s7, s3, 2
v_mfma_f32_16x16x32_bf16 v[28:31], a[168:171], v[132:135], v[28:31]
buffer_load_dwordx4 v[124:127], v227, s[28:31], s32 offen offset:2048
v_mfma_f32_16x16x32_bf16 v[48:51], a[168:171], v[136:139], v[48:51]
s_add_u32 s6, s6, s7
v_mfma_f32_16x16x32_bf16 v[68:71], a[168:171], v[140:143], v[68:71]
s_add_u32 s6, s6, 288768
v_mfma_f32_16x16x32_bf16 v[72:75], a[172:175], v[140:143], v[72:75]
v_mfma_f32_16x16x32_bf16 v[52:55], a[172:175], v[136:139], v[52:55]
v_mov_b32 v231, s6
v_xor_b32 v230, 128, v231
v_mfma_f32_16x16x32_bf16 v[32:35], a[172:175], v[132:135], v[32:35]
buffer_load_dwordx4 a[244:247], v216, s[20:23], s45 offen offset:1024 sc1
v_mfma_f32_16x16x32_bf16 v[12:15], a[172:175], v[128:131], v[12:15]
v_mfma_f32_16x16x32_bf16 v[16:19], a[176:179], v[128:131], v[16:19]
global_load_dwordx2 v[186:187], v184, s[66:67] offset:-120 sc1
v_mfma_f32_16x16x32_bf16 v[36:39], a[176:179], v[132:135], v[36:39]
v_mfma_f32_16x16x32_bf16 v[56:59], a[176:179], v[136:139], v[56:59]
v_mfma_f32_16x16x32_bf16 v[76:79], a[176:179], v[140:143], v[76:79]
s_waitcnt vmcnt(12)
v_mfma_f32_16x16x32_bf16 v[0:3], a[140:143], v[80:83], v[0:3]
buffer_load_dwordx4 v[128:131], v224, s[28:31], s32 offen offset:3072
v_mfma_f32_16x16x32_bf16 v[20:23], a[140:143], v[84:87], v[20:23]
s_add_u32 s12, s66, 90177536
s_addc_u32 s13, s67, 0
v_mfma_f32_16x16x32_bf16 v[40:43], a[140:143], v[88:91], v[40:43]
s_and_b32 s13, s13, 0xffff
v_mfma_f32_16x16x32_bf16 v[60:63], a[140:143], v[92:95], v[60:63]
buffer_load_dwordx4 v[132:135], v225, s[28:31], s32 offen offset:3072
v_mfma_f32_16x16x32_bf16 v[64:67], a[144:147], v[92:95], v[64:67]
s_mov_b32 s14, 5242880
v_mfma_f32_16x16x32_bf16 v[44:47], a[144:147], v[88:91], v[44:47]
s_mov_b32 s15, 0x20000
v_mfma_f32_16x16x32_bf16 v[24:27], a[144:147], v[84:87], v[24:27]
s_lshl_b32 s71, s2, 2
v_mfma_f32_16x16x32_bf16 v[4:7], a[144:147], v[80:83], v[4:7]
buffer_load_dwordx4 v[136:139], v226, s[28:31], s32 offen offset:3072
v_mfma_f32_16x16x32_bf16 v[8:11], a[148:151], v[80:83], v[8:11]
s_add_u32 s71, s71, s3
v_mfma_f32_16x16x32_bf16 v[28:31], a[148:151], v[84:87], v[28:31]
s_xor_b32 s74, s71, 4
v_mfma_f32_16x16x32_bf16 v[48:51], a[148:151], v[88:91], v[48:51]
s_mul_i32 s71, s71, 5120
v_mfma_f32_16x16x32_bf16 v[68:71], a[148:151], v[92:95], v[68:71]
buffer_load_dwordx4 v[140:143], v227, s[28:31], s32 offen offset:3072
v_mfma_f32_16x16x32_bf16 v[72:75], a[152:155], v[92:95], v[72:75]
s_mul_i32 s74, s74, 5120
v_mfma_f32_16x16x32_bf16 v[52:55], a[152:155], v[88:91], v[52:55]
s_add_u32 s75, s71, 4096
v_mfma_f32_16x16x32_bf16 v[32:35], a[152:155], v[84:87], v[32:35]
s_add_u32 s76, s74, 4096
v_mfma_f32_16x16x32_bf16 v[12:15], a[152:155], v[80:83], v[12:15]
buffer_load_dwordx4 a[248:251], v216, s[20:23], s45 offen offset:2048 sc1
v_mfma_f32_16x16x32_bf16 v[16:19], a[156:159], v[80:83], v[16:19]
v_mfma_f32_16x16x32_bf16 v[36:39], a[156:159], v[84:87], v[36:39]
v_mfma_f32_16x16x32_bf16 v[56:59], a[156:159], v[88:91], v[56:59]
v_mfma_f32_16x16x32_bf16 v[76:79], a[156:159], v[92:95], v[76:79]
s_waitcnt vmcnt(12)
v_mfma_f32_16x16x32_bf16 v[0:3], a[120:123], v[96:99], v[0:3]
s_add_u32 s32, s70, 8192
ds_read_b128 v[144:147], v243 offset:0
ds_read_b128 v[148:151], v243 offset:4096
v_mfma_f32_16x16x32_bf16 v[20:23], a[120:123], v[100:103], v[20:23]
v_mfma_f32_16x16x32_bf16 v[40:43], a[120:123], v[104:107], v[40:43]
buffer_load_dwordx4 v[80:83], v224, s[28:31], s32 offen offset:0
v_mfma_f32_16x16x32_bf16 v[60:63], a[120:123], v[108:111], v[60:63]
ds_read_b128 v[152:155], v243 offset:8192
ds_read_b128 v[156:159], v243 offset:12288
v_mfma_f32_16x16x32_bf16 v[64:67], a[124:127], v[108:111], v[64:67]
v_mfma_f32_16x16x32_bf16 v[44:47], a[124:127], v[104:107], v[44:47]
v_mfma_f32_16x16x32_bf16 v[24:27], a[124:127], v[100:103], v[24:27]
buffer_load_dwordx4 v[84:87], v225, s[28:31], s32 offen offset:0
v_mfma_f32_16x16x32_bf16 v[4:7], a[124:127], v[96:99], v[4:7]
ds_read_b128 v[160:163], v243 offset:16384
v_mfma_f32_16x16x32_bf16 v[8:11], a[128:131], v[96:99], v[8:11]
v_mfma_f32_16x16x32_bf16 v[28:31], a[128:131], v[100:103], v[28:31]
v_mfma_f32_16x16x32_bf16 v[48:51], a[128:131], v[104:107], v[48:51]
buffer_load_dwordx4 v[88:91], v226, s[28:31], s32 offen offset:0
v_mfma_f32_16x16x32_bf16 v[68:71], a[128:131], v[108:111], v[68:71]
v_mfma_f32_16x16x32_bf16 v[72:75], a[132:135], v[108:111], v[72:75]
v_mfma_f32_16x16x32_bf16 v[52:55], a[132:135], v[104:107], v[52:55]
v_mfma_f32_16x16x32_bf16 v[32:35], a[132:135], v[100:103], v[32:35]
buffer_load_dwordx4 v[92:95], v227, s[28:31], s32 offen offset:0
v_mfma_f32_16x16x32_bf16 v[12:15], a[132:135], v[96:99], v[12:15]
v_mfma_f32_16x16x32_bf16 v[16:19], a[136:139], v[96:99], v[16:19]
v_mfma_f32_16x16x32_bf16 v[36:39], a[136:139], v[100:103], v[36:39]
v_mfma_f32_16x16x32_bf16 v[56:59], a[136:139], v[104:107], v[56:59]
v_mfma_f32_16x16x32_bf16 v[76:79], a[136:139], v[108:111], v[76:79]
s_waitcnt vmcnt(11) lgkmcnt(0)
v_mfma_f32_16x16x32_bf16 v[0:3], v[144:147], v[112:115], v[0:3]
ds_read_b128 v[164:167], v243 offset:1024
ds_read_b128 v[168:171], v243 offset:5120
v_mfma_f32_16x16x32_bf16 v[20:23], v[144:147], v[116:119], v[20:23]
buffer_load_dwordx4 v[96:99], v224, s[28:31], s32 offen offset:1024
v_mfma_f32_16x16x32_bf16 v[40:43], v[144:147], v[120:123], v[40:43]
v_mfma_f32_16x16x32_bf16 v[60:63], v[144:147], v[124:127], v[60:63]
ds_read_b128 v[172:175], v243 offset:9216
ds_read_b128 v[176:179], v243 offset:13312
v_mfma_f32_16x16x32_bf16 v[64:67], v[148:151], v[124:127], v[64:67]
buffer_load_dwordx4 v[100:103], v225, s[28:31], s32 offen offset:1024
v_mfma_f32_16x16x32_bf16 v[44:47], v[148:151], v[120:123], v[44:47]
v_mfma_f32_16x16x32_bf16 v[24:27], v[148:151], v[116:119], v[24:27]
ds_read_b128 v[180:183], v243 offset:17408
v_mfma_f32_16x16x32_bf16 v[4:7], v[148:151], v[112:115], v[4:7]
v_mfma_f32_16x16x32_bf16 v[8:11], v[152:155], v[112:115], v[8:11]
v_mfma_f32_16x16x32_bf16 v[28:31], v[152:155], v[116:119], v[28:31]
buffer_load_dwordx4 v[104:107], v226, s[28:31], s32 offen offset:1024
v_mfma_f32_16x16x32_bf16 v[48:51], v[152:155], v[120:123], v[48:51]
v_mfma_f32_16x16x32_bf16 v[68:71], v[152:155], v[124:127], v[68:71]
v_mfma_f32_16x16x32_bf16 v[72:75], v[156:159], v[124:127], v[72:75]
v_mfma_f32_16x16x32_bf16 v[52:55], v[156:159], v[120:123], v[52:55]
v_mfma_f32_16x16x32_bf16 v[32:35], v[156:159], v[116:119], v[32:35]
buffer_load_dwordx4 v[108:111], v227, s[28:31], s32 offen offset:1024
v_mfma_f32_16x16x32_bf16 v[12:15], v[156:159], v[112:115], v[12:15]
v_mfma_f32_16x16x32_bf16 v[16:19], v[160:163], v[112:115], v[16:19]
v_mfma_f32_16x16x32_bf16 v[36:39], v[160:163], v[116:119], v[36:39]
v_mfma_f32_16x16x32_bf16 v[56:59], v[160:163], v[120:123], v[56:59]
v_mfma_f32_16x16x32_bf16 v[76:79], v[160:163], v[124:127], v[76:79]
s_waitcnt vmcnt(9) lgkmcnt(0)
v_mfma_f32_16x16x32_bf16 v[0:3], v[164:167], v[128:131], v[0:3]
ds_read_b128 v[144:147], v243 offset:2048
ds_read_b128 v[148:151], v243 offset:6144
v_mfma_f32_16x16x32_bf16 v[20:23], v[164:167], v[132:135], v[20:23]
buffer_load_dwordx4 v[112:115], v224, s[28:31], s32 offen offset:2048
v_mfma_f32_16x16x32_bf16 v[40:43], v[164:167], v[136:139], v[40:43]
v_mfma_f32_16x16x32_bf16 v[60:63], v[164:167], v[140:143], v[60:63]
ds_read_b128 v[152:155], v243 offset:10240
ds_read_b128 v[156:159], v243 offset:14336
v_mfma_f32_16x16x32_bf16 v[64:67], v[168:171], v[140:143], v[64:67]
buffer_load_dwordx4 v[116:119], v225, s[28:31], s32 offen offset:2048
v_mfma_f32_16x16x32_bf16 v[44:47], v[168:171], v[136:139], v[44:47]
v_mfma_f32_16x16x32_bf16 v[24:27], v[168:171], v[132:135], v[24:27]
ds_read_b128 v[160:163], v243 offset:18432
v_mfma_f32_16x16x32_bf16 v[4:7], v[168:171], v[128:131], v[4:7]
v_mfma_f32_16x16x32_bf16 v[8:11], v[172:175], v[128:131], v[8:11]
v_mfma_f32_16x16x32_bf16 v[28:31], v[172:175], v[132:135], v[28:31]
buffer_load_dwordx4 v[120:123], v226, s[28:31], s32 offen offset:2048
v_mfma_f32_16x16x32_bf16 v[48:51], v[172:175], v[136:139], v[48:51]
v_mfma_f32_16x16x32_bf16 v[68:71], v[172:175], v[140:143], v[68:71]
v_mfma_f32_16x16x32_bf16 v[72:75], v[176:179], v[140:143], v[72:75]
v_mfma_f32_16x16x32_bf16 v[52:55], v[176:179], v[136:139], v[52:55]
v_mfma_f32_16x16x32_bf16 v[32:35], v[176:179], v[132:135], v[32:35]
buffer_load_dwordx4 v[124:127], v227, s[28:31], s32 offen offset:2048
v_mfma_f32_16x16x32_bf16 v[12:15], v[176:179], v[128:131], v[12:15]
v_mfma_f32_16x16x32_bf16 v[16:19], v[180:183], v[128:131], v[16:19]
v_mfma_f32_16x16x32_bf16 v[36:39], v[180:183], v[132:135], v[36:39]
v_mfma_f32_16x16x32_bf16 v[56:59], v[180:183], v[136:139], v[56:59]
v_mfma_f32_16x16x32_bf16 v[76:79], v[180:183], v[140:143], v[76:79]
s_waitcnt vmcnt(8) lgkmcnt(0)
v_mfma_f32_16x16x32_bf16 v[0:3], v[144:147], v[80:83], v[0:3]
s_getreg_b32 s6, hwreg(HW_REG_XCC_ID, 0, 4)
ds_read_b128 v[164:167], v243 offset:3072
v_readfirstlane_b32 s72, v186
v_mfma_f32_16x16x32_bf16 v[20:23], v[144:147], v[84:87], v[20:23]
buffer_load_dwordx4 v[128:131], v224, s[28:31], s32 offen offset:3072
v_mfma_f32_16x16x32_bf16 v[40:43], v[144:147], v[88:91], v[40:43]
ds_read_b128 v[168:171], v243 offset:7168
v_readfirstlane_b32 s73, v187
v_mfma_f32_16x16x32_bf16 v[60:63], v[144:147], v[92:95], v[60:63]
s_lshl_b32 s6, s6, 3
ds_read_b128 v[172:175], v243 offset:11264
s_lshl_b64 s[78:79], 16, s6
v_mfma_f32_16x16x32_bf16 v[64:67], v[148:151], v[92:95], v[64:67]
buffer_load_dwordx4 v[132:135], v225, s[28:31], s32 offen offset:3072
v_mfma_f32_16x16x32_bf16 v[44:47], v[148:151], v[88:91], v[44:47]
ds_read_b128 v[176:179], v243 offset:15360
ds_read_b128 v[180:183], v243 offset:19456
v_mfma_f32_16x16x32_bf16 v[24:27], v[148:151], v[84:87], v[24:27]
v_mfma_f32_16x16x32_bf16 v[4:7], v[148:151], v[80:83], v[4:7]
v_mfma_f32_16x16x32_bf16 v[8:11], v[152:155], v[80:83], v[8:11]
v_mfma_f32_16x16x32_bf16 v[28:31], v[152:155], v[84:87], v[28:31]
buffer_load_dwordx4 v[136:139], v226, s[28:31], s32 offen offset:3072
v_mfma_f32_16x16x32_bf16 v[48:51], v[152:155], v[88:91], v[48:51]
v_mfma_f32_16x16x32_bf16 v[68:71], v[152:155], v[92:95], v[68:71]
v_mfma_f32_16x16x32_bf16 v[72:75], v[156:159], v[92:95], v[72:75]
v_mfma_f32_16x16x32_bf16 v[52:55], v[156:159], v[88:91], v[52:55]
s_cmp_eq_u64 s[72:73], s[78:79]
s_cselect_b32 s68, 1, 0
v_mfma_f32_16x16x32_bf16 v[32:35], v[156:159], v[84:87], v[32:35]
buffer_load_dwordx4 v[140:143], v227, s[28:31], s32 offen offset:3072
v_mfma_f32_16x16x32_bf16 v[12:15], v[156:159], v[80:83], v[12:15]
v_mfma_f32_16x16x32_bf16 v[16:19], v[160:163], v[80:83], v[16:19]
v_mfma_f32_16x16x32_bf16 v[36:39], v[160:163], v[84:87], v[36:39]
v_mfma_f32_16x16x32_bf16 v[56:59], v[160:163], v[88:91], v[56:59]
v_mfma_f32_16x16x32_bf16 v[76:79], v[160:163], v[92:95], v[76:79]
s_waitcnt vmcnt(8) lgkmcnt(0)
v_mfma_f32_16x16x32_bf16 v[0:3], v[164:167], v[96:99], v[0:3]
s_add_u32 s32, s70, 12288
v_mfma_f32_16x16x32_bf16 v[20:23], v[164:167], v[100:103], v[20:23]
v_mfma_f32_16x16x32_bf16 v[40:43], v[164:167], v[104:107], v[40:43]
buffer_load_dwordx4 v[80:83], v224, s[28:31], s32 offen offset:0
v_mfma_f32_16x16x32_bf16 v[60:63], v[164:167], v[108:111], v[60:63]
v_mfma_f32_16x16x32_bf16 v[64:67], v[168:171], v[108:111], v[64:67]
v_mfma_f32_16x16x32_bf16 v[44:47], v[168:171], v[104:107], v[44:47]
v_mfma_f32_16x16x32_bf16 v[24:27], v[168:171], v[100:103], v[24:27]
buffer_load_dwordx4 v[84:87], v225, s[28:31], s32 offen offset:0
v_mfma_f32_16x16x32_bf16 v[4:7], v[168:171], v[96:99], v[4:7]
v_mfma_f32_16x16x32_bf16 v[8:11], v[172:175], v[96:99], v[8:11]
v_mfma_f32_16x16x32_bf16 v[28:31], v[172:175], v[100:103], v[28:31]
v_mfma_f32_16x16x32_bf16 v[48:51], v[172:175], v[104:107], v[48:51]
buffer_load_dwordx4 v[88:91], v226, s[28:31], s32 offen offset:0
v_mfma_f32_16x16x32_bf16 v[68:71], v[172:175], v[108:111], v[68:71]
v_mfma_f32_16x16x32_bf16 v[72:75], v[176:179], v[108:111], v[72:75]
v_mfma_f32_16x16x32_bf16 v[52:55], v[176:179], v[104:107], v[52:55]
v_mfma_f32_16x16x32_bf16 v[32:35], v[176:179], v[100:103], v[32:35]
buffer_load_dwordx4 v[92:95], v227, s[28:31], s32 offen offset:0
v_mfma_f32_16x16x32_bf16 v[12:15], v[176:179], v[96:99], v[12:15]
v_mfma_f32_16x16x32_bf16 v[16:19], v[180:183], v[96:99], v[16:19]
v_mfma_f32_16x16x32_bf16 v[36:39], v[180:183], v[100:103], v[36:39]
v_mfma_f32_16x16x32_bf16 v[56:59], v[180:183], v[104:107], v[56:59]
v_mfma_f32_16x16x32_bf16 v[76:79], v[180:183], v[108:111], v[76:79]
s_waitcnt vmcnt(8)
v_mfma_f32_16x16x32_bf16 v[0:3], a[100:103], v[112:115], v[0:3]
buffer_load_dwordx4 v[96:99], v225, s[28:31], s32 offen offset:1024
v_mfma_f32_16x16x32_bf16 v[20:23], a[100:103], v[116:119], v[20:23]
v_mfma_f32_16x16x32_bf16 v[40:43], a[100:103], v[120:123], v[40:43]
v_mfma_f32_16x16x32_bf16 v[60:63], a[100:103], v[124:127], v[60:63]
v_mfma_f32_16x16x32_bf16 v[64:67], a[104:107], v[124:127], v[64:67]
buffer_load_dwordx4 v[100:103], v225, s[28:31], s32 offen offset:2048
v_mfma_f32_16x16x32_bf16 v[44:47], a[104:107], v[120:123], v[44:47]
v_mfma_f32_16x16x32_bf16 v[24:27], a[104:107], v[116:119], v[24:27]
v_mfma_f32_16x16x32_bf16 v[4:7], a[104:107], v[112:115], v[4:7]
v_mfma_f32_16x16x32_bf16 v[8:11], a[108:111], v[112:115], v[8:11]
v_mfma_f32_16x16x32_bf16 v[28:31], a[108:111], v[116:119], v[28:31]
buffer_load_dwordx4 v[104:107], v225, s[28:31], s32 offen offset:3072
v_mfma_f32_16x16x32_bf16 v[48:51], a[108:111], v[120:123], v[48:51]
v_mfma_f32_16x16x32_bf16 v[68:71], a[108:111], v[124:127], v[68:71]
v_mfma_f32_16x16x32_bf16 v[72:75], a[112:115], v[124:127], v[72:75]
v_mfma_f32_16x16x32_bf16 v[52:55], a[112:115], v[120:123], v[52:55]
v_mfma_f32_16x16x32_bf16 v[32:35], a[112:115], v[116:119], v[32:35]
buffer_load_dwordx4 v[108:111], v226, s[28:31], s32 offen offset:1024
v_mfma_f32_16x16x32_bf16 v[12:15], a[112:115], v[112:115], v[12:15]
v_mfma_f32_16x16x32_bf16 v[16:19], a[116:119], v[112:115], v[16:19]
v_mfma_f32_16x16x32_bf16 v[36:39], a[116:119], v[116:119], v[36:39]
v_mfma_f32_16x16x32_bf16 v[56:59], a[116:119], v[120:123], v[56:59]
v_mfma_f32_16x16x32_bf16 v[76:79], a[116:119], v[124:127], v[76:79]
s_waitcnt vmcnt(8)
v_mfma_f32_16x16x32_bf16 v[0:3], a[80:83], v[128:131], v[0:3]
buffer_load_dwordx4 v[112:115], v226, s[28:31], s32 offen offset:2048
v_mfma_f32_16x16x32_bf16 v[20:23], a[80:83], v[132:135], v[20:23]
s_mul_i32 s6, s61, 5
s_lshr_b32 s6, s6, 1
s_lshl_b32 s6, s6, 10
v_mfma_f32_16x16x32_bf16 v[40:43], a[80:83], v[136:139], v[40:43]
s_mul_i32 s7, s60, 20480
v_mfma_f32_16x16x32_bf16 v[60:63], a[80:83], v[140:143], v[60:63]
s_add_u32 s77, s6, s7
v_mfma_f32_16x16x32_bf16 v[64:67], a[84:87], v[140:143], v[64:67]
buffer_load_dwordx4 v[116:119], v226, s[28:31], s32 offen offset:3072
v_mfma_f32_16x16x32_bf16 v[44:47], a[84:87], v[136:139], v[44:47]
s_lshr_b32 s6, s60, 2
v_mfma_f32_16x16x32_bf16 v[24:27], a[84:87], v[132:135], v[24:27]
s_lshl_b32 s6, s6, 12
v_mfma_f32_16x16x32_bf16 v[4:7], a[84:87], v[128:131], v[4:7]
s_lshl_b32 s7, s3, 8
v_mfma_f32_16x16x32_bf16 v[8:11], a[88:91], v[128:131], v[8:11]
s_add_u32 s6, s6, s7
v_mfma_f32_16x16x32_bf16 v[28:31], a[88:91], v[132:135], v[28:31]
buffer_load_dwordx4 v[120:123], v227, s[28:31], s32 offen offset:1024
v_mfma_f32_16x16x32_bf16 v[48:51], a[88:91], v[136:139], v[48:51]
s_lshr_b32 s7, s61, 1
v_mfma_f32_16x16x32_bf16 v[68:71], a[88:91], v[140:143], v[68:71]
s_lshl_b32 s7, s7, 10
v_mfma_f32_16x16x32_bf16 v[72:75], a[92:95], v[140:143], v[72:75]
s_add_u32 s6, s6, s7
v_mfma_f32_16x16x32_bf16 v[52:55], a[92:95], v[136:139], v[52:55]
s_and_b32 s7, s61, 1
v_mfma_f32_16x16x32_bf16 v[32:35], a[92:95], v[132:135], v[32:35]
buffer_load_dwordx4 v[124:127], v227, s[28:31], s32 offen offset:2048
v_mfma_f32_16x16x32_bf16 v[12:15], a[92:95], v[128:131], v[12:15]
s_lshl_b32 s7, s7, 3
v_mfma_f32_16x16x32_bf16 v[16:19], a[96:99], v[128:131], v[16:19]
s_add_u32 s78, s6, s7
v_mfma_f32_16x16x32_bf16 v[36:39], a[96:99], v[132:135], v[36:39]
v_lshlrev_b32 v254, 3, v220
v_mfma_f32_16x16x32_bf16 v[56:59], a[96:99], v[136:139], v[56:59]
v_mfma_f32_16x16x32_bf16 v[76:79], a[96:99], v[140:143], v[76:79]
s_waitcnt vmcnt(8)
v_mfma_f32_16x16x32_bf16 v[0:3], a[60:63], v[80:83], v[0:3]
buffer_load_dwordx4 v[128:131], v227, s[28:31], s32 offen offset:3072
v_mfma_f32_16x16x32_bf16 v[20:23], a[60:63], v[84:87], v[20:23]
v_add_u32 v221, 0, v220
v_mul_u32_u24 v222, 6554, v221
v_mfma_f32_16x16x32_bf16 v[40:43], a[60:63], v[88:91], v[40:43]
v_lshrrev_b32 v222, 16, v222
v_mul_u32_u24 v222, 1120, v222
v_mfma_f32_16x16x32_bf16 v[60:63], a[60:63], v[92:95], v[60:63]
v_add_u32 v244, v222, v216
v_add_u32 v221, 64, v220
v_mfma_f32_16x16x32_bf16 v[64:67], a[64:67], v[92:95], v[64:67]
buffer_load_dwordx4 v[132:135], v224, s[28:31], s32 offen offset:1024
v_mfma_f32_16x16x32_bf16 v[44:47], a[64:67], v[88:91], v[44:47]
v_mul_u32_u24 v222, 6554, v221
v_lshrrev_b32 v222, 16, v222
v_mfma_f32_16x16x32_bf16 v[24:27], a[64:67], v[84:87], v[24:27]
v_mfma_f32_16x16x32_bf16 v[4:7], a[64:67], v[80:83], v[4:7]
v_mul_u32_u24 v222, 1120, v222
v_add_u32 v245, v222, v216
v_mfma_f32_16x16x32_bf16 v[8:11], a[68:71], v[80:83], v[8:11]
v_mfma_f32_16x16x32_bf16 v[28:31], a[68:71], v[84:87], v[28:31]
buffer_load_dwordx4 v[136:139], v224, s[28:31], s32 offen offset:2048
v_mfma_f32_16x16x32_bf16 v[48:51], a[68:71], v[88:91], v[48:51]
v_add_u32 v221, 128, v220
v_mul_u32_u24 v222, 6554, v221
v_mfma_f32_16x16x32_bf16 v[68:71], a[68:71], v[92:95], v[68:71]
v_lshrrev_b32 v222, 16, v222
v_mul_u32_u24 v222, 1120, v222
v_mfma_f32_16x16x32_bf16 v[72:75], a[72:75], v[92:95], v[72:75]
v_mfma_f32_16x16x32_bf16 v[52:55], a[72:75], v[88:91], v[52:55]
v_add_u32 v246, v222, v216
v_lshrrev_b32 v221, 5, v220
v_mfma_f32_16x16x32_bf16 v[32:35], a[72:75], v[84:87], v[32:35]
buffer_load_dwordx4 v[140:143], v224, s[28:31], s32 offen offset:3072
v_mfma_f32_16x16x32_bf16 v[12:15], a[72:75], v[80:83], v[12:15]
v_lshl_add_u32 v246, v221, 30, v246
v_mul_u32_u24 v235, 160, v234
v_mfma_f32_16x16x32_bf16 v[16:19], a[76:79], v[80:83], v[16:19]
v_mfma_f32_16x16x32_bf16 v[36:39], a[76:79], v[84:87], v[36:39]
v_lshl_add_u32 v235, v233, 3, v235
v_add_u32 v235, s34, v235
v_mfma_f32_16x16x32_bf16 v[56:59], a[76:79], v[88:91], v[56:59]
v_mfma_f32_16x16x32_bf16 v[76:79], a[76:79], v[92:95], v[76:79]
s_waitcnt vmcnt(9)
v_mfma_f32_16x16x32_bf16 v[20:23], a[40:43], v[96:99], v[20:23]
s_add_u32 s32, s69, 0
v_mfma_f32_16x16x32_bf16 v[20:23], a[20:23], v[100:103], v[20:23]
buffer_load_dwordx4 v[80:83], v225, s[28:31], s32 offen offset:0
v_mfma_f32_16x16x32_bf16 v[20:23], a[0:3], v[104:107], v[20:23]
v_mfma_f32_16x16x32_bf16 v[24:27], a[4:7], v[104:107], v[24:27]
v_mfma_f32_16x16x32_bf16 v[24:27], a[24:27], v[100:103], v[24:27]
buffer_load_dwordx4 v[84:87], v225, s[28:31], s32 offen offset:1024
v_mfma_f32_16x16x32_bf16 v[24:27], a[44:47], v[96:99], v[24:27]
v_mfma_f32_16x16x32_bf16 v[28:31], a[48:51], v[96:99], v[28:31]
v_mfma_f32_16x16x32_bf16 v[28:31], a[28:31], v[100:103], v[28:31]
buffer_load_dwordx4 v[88:91], v225, s[28:31], s32 offen offset:2048
v_mfma_f32_16x16x32_bf16 v[28:31], a[8:11], v[104:107], v[28:31]
v_mfma_f32_16x16x32_bf16 v[32:35], a[12:15], v[104:107], v[32:35]
v_mfma_f32_16x16x32_bf16 v[32:35], a[32:35], v[100:103], v[32:35]
buffer_load_dwordx4 v[92:95], v226, s[28:31], s32 offen offset:0
v_mfma_f32_16x16x32_bf16 v[32:35], a[52:55], v[96:99], v[32:35]
v_mfma_f32_16x16x32_bf16 v[36:39], a[56:59], v[96:99], v[36:39]
v_mfma_f32_16x16x32_bf16 v[36:39], a[36:39], v[100:103], v[36:39]
v_mfma_f32_16x16x32_bf16 v[36:39], a[16:19], v[104:107], v[36:39]
s_waitcnt vmcnt(10)
v_mfma_f32_16x16x32_bf16 v[40:43], a[40:43], v[108:111], v[40:43]
buffer_load_dwordx4 v[96:99], v226, s[28:31], s32 offen offset:1024
v_mfma_f32_16x16x32_bf16 v[40:43], a[20:23], v[112:115], v[40:43]
v_mfma_f32_16x16x32_bf16 v[40:43], a[0:3], v[116:119], v[40:43]
v_mfma_f32_16x16x32_bf16 v[44:47], a[4:7], v[116:119], v[44:47]
ds_write_b128 v238, v[20:23] offset:5120
v_mfma_f32_16x16x32_bf16 v[44:47], a[24:27], v[112:115], v[44:47]
buffer_load_dwordx4 v[100:103], v226, s[28:31], s32 offen offset:2048
v_mfma_f32_16x16x32_bf16 v[44:47], a[44:47], v[108:111], v[44:47]
ds_write_b128 v238, v[24:27] offset:6144
v_mfma_f32_16x16x32_bf16 v[48:51], a[48:51], v[108:111], v[48:51]
v_mfma_f32_16x16x32_bf16 v[48:51], a[28:31], v[112:115], v[48:51]
ds_write_b128 v238, v[28:31] offset:7168
v_mfma_f32_16x16x32_bf16 v[48:51], a[8:11], v[116:119], v[48:51]
v_mfma_f32_16x16x32_bf16 v[52:55], a[12:15], v[116:119], v[52:55]
buffer_load_dwordx4 v[104:107], v227, s[28:31], s32 offen offset:0
v_mfma_f32_16x16x32_bf16 v[52:55], a[32:35], v[112:115], v[52:55]
ds_write_b128 v238, v[32:35] offset:8192
v_mfma_f32_16x16x32_bf16 v[52:55], a[52:55], v[108:111], v[52:55]
v_mfma_f32_16x16x32_bf16 v[56:59], a[56:59], v[108:111], v[56:59]
ds_write_b128 v238, v[36:39] offset:9216
v_mfma_f32_16x16x32_bf16 v[56:59], a[36:39], v[112:115], v[56:59]
v_mfma_f32_16x16x32_bf16 v[56:59], a[16:19], v[116:119], v[56:59]
s_waitcnt vmcnt(10)
v_mfma_f32_16x16x32_bf16 v[60:63], a[40:43], v[120:123], v[60:63]
buffer_load_dwordx4 v[108:111], v227, s[28:31], s32 offen offset:1024
v_mfma_f32_16x16x32_bf16 v[60:63], a[20:23], v[124:127], v[60:63]
v_mfma_f32_16x16x32_bf16 v[60:63], a[0:3], v[128:131], v[60:63]
v_mfma_f32_16x16x32_bf16 v[64:67], a[4:7], v[128:131], v[64:67]
ds_write_b128 v239, v[40:43] offset:10240
v_mfma_f32_16x16x32_bf16 v[64:67], a[24:27], v[124:127], v[64:67]
buffer_load_dwordx4 v[112:115], v227, s[28:31], s32 offen offset:2048
v_mfma_f32_16x16x32_bf16 v[64:67], a[44:47], v[120:123], v[64:67]
ds_write_b128 v239, v[44:47] offset:11264
v_mfma_f32_16x16x32_bf16 v[68:71], a[48:51], v[120:123], v[68:71]
v_mfma_f32_16x16x32_bf16 v[68:71], a[28:31], v[124:127], v[68:71]
ds_write_b128 v239, v[48:51] offset:12288
v_mfma_f32_16x16x32_bf16 v[68:71], a[8:11], v[128:131], v[68:71]
v_mfma_f32_16x16x32_bf16 v[72:75], a[12:15], v[128:131], v[72:75]
buffer_load_dwordx4 v[116:119], v224, s[28:31], s32 offen offset:0
v_mfma_f32_16x16x32_bf16 v[72:75], a[32:35], v[124:127], v[72:75]
ds_write_b128 v239, v[52:55] offset:13312
v_mfma_f32_16x16x32_bf16 v[72:75], a[52:55], v[120:123], v[72:75]
v_mfma_f32_16x16x32_bf16 v[76:79], a[56:59], v[120:123], v[76:79]
ds_write_b128 v239, v[56:59] offset:14336
v_mfma_f32_16x16x32_bf16 v[76:79], a[36:39], v[124:127], v[76:79]
v_mfma_f32_16x16x32_bf16 v[76:79], a[16:19], v[128:131], v[76:79]
s_waitcnt vmcnt(10)
v_mfma_f32_16x16x32_bf16 v[0:3], a[40:43], v[132:135], v[0:3]
buffer_load_dwordx4 v[120:123], v224, s[28:31], s32 offen offset:1024
v_mfma_f32_16x16x32_bf16 v[0:3], a[20:23], v[136:139], v[0:3]
v_mfma_f32_16x16x32_bf16 v[0:3], a[0:3], v[140:143], v[0:3]
v_mfma_f32_16x16x32_bf16 v[4:7], a[4:7], v[140:143], v[4:7]
ds_write_b128 v240, v[60:63] offset:15360
v_mfma_f32_16x16x32_bf16 v[4:7], a[24:27], v[136:139], v[4:7]
buffer_load_dwordx4 v[124:127], v224, s[28:31], s32 offen offset:2048
v_mfma_f32_16x16x32_bf16 v[4:7], a[44:47], v[132:135], v[4:7]
ds_write_b128 v240, v[64:67] offset:16384
v_mfma_f32_16x16x32_bf16 v[8:11], a[48:51], v[132:135], v[8:11]
v_mfma_f32_16x16x32_bf16 v[8:11], a[28:31], v[136:139], v[8:11]
ds_write_b128 v240, v[68:71] offset:17408
v_mfma_f32_16x16x32_bf16 v[8:11], a[8:11], v[140:143], v[8:11]
Lch2_1:
Lpad25:
s_cbranch_execz Lpad29
v_mfma_f32_16x16x32_bf16 v[12:15], a[12:15], v[140:143], v[12:15]
buffer_load_dwordx4 v[128:131], v224, s[28:31], s32 offen offset:3072
v_mfma_f32_16x16x32_bf16 v[12:15], a[32:35], v[136:139], v[12:15]
ds_write_b128 v240, v[72:75] offset:18432
v_mfma_f32_16x16x32_bf16 v[12:15], a[52:55], v[132:135], v[12:15]
v_mfma_f32_16x16x32_bf16 v[16:19], a[56:59], v[132:135], v[16:19]
ds_write_b128 v240, v[76:79] offset:19456
v_mfma_f32_16x16x32_bf16 v[16:19], a[36:39], v[136:139], v[16:19]
v_mfma_f32_16x16x32_bf16 v[16:19], a[16:19], v[140:143], v[16:19]
s_waitcnt vmcnt(10)
v_mfma_f32_16x16x32_bf16 v[20:23], a[220:223], v[80:83], 0
buffer_load_dwordx4 v[132:135], v225, s[28:31], s32 offen offset:3072
v_mfma_f32_16x16x32_bf16 v[20:23], a[200:203], v[84:87], v[20:23]
v_mfma_f32_16x16x32_bf16 v[20:23], a[180:183], v[88:91], v[20:23]
v_mfma_f32_16x16x32_bf16 v[24:27], a[184:187], v[88:91], 0
ds_write_b128 v237, v[0:3] offset:0
v_mfma_f32_16x16x32_bf16 v[24:27], a[204:207], v[84:87], v[24:27]
buffer_load_dwordx4 v[136:139], v226, s[28:31], s32 offen offset:3072
v_mfma_f32_16x16x32_bf16 v[24:27], a[224:227], v[80:83], v[24:27]
ds_write_b128 v237, v[4:7] offset:1024
v_mfma_f32_16x16x32_bf16 v[28:31], a[228:231], v[80:83], 0
v_mfma_f32_16x16x32_bf16 v[28:31], a[208:211], v[84:87], v[28:31]
ds_write_b128 v237, v[8:11] offset:2048
v_mfma_f32_16x16x32_bf16 v[28:31], a[188:191], v[88:91], v[28:31]
v_mfma_f32_16x16x32_bf16 v[32:35], a[192:195], v[88:91], 0
buffer_load_dwordx4 v[140:143], v227, s[28:31], s32 offen offset:3072
v_mfma_f32_16x16x32_bf16 v[32:35], a[212:215], v[84:87], v[32:35]
ds_write_b128 v237, v[12:15] offset:3072
v_mfma_f32_16x16x32_bf16 v[32:35], a[232:235], v[80:83], v[32:35]
v_mfma_f32_16x16x32_bf16 v[36:39], a[236:239], v[80:83], 0
ds_write_b128 v237, v[16:19] offset:4096
v_mfma_f32_16x16x32_bf16 v[36:39], a[216:219], v[84:87], v[36:39]
v_mfma_f32_16x16x32_bf16 v[36:39], a[196:199], v[88:91], v[36:39]
s_waitcnt vmcnt(10)
v_mfma_f32_16x16x32_bf16 v[40:43], a[220:223], v[92:95], 0
s_add_u32 s32, s69, 4096
v_mfma_f32_16x16x32_bf16 v[40:43], a[200:203], v[96:99], v[40:43]
v_mfma_f32_16x16x32_bf16 v[40:43], a[180:183], v[100:103], v[40:43]
buffer_load_dwordx4 v[80:83], v224, s[28:31], s32 offen offset:0
v_mfma_f32_16x16x32_bf16 v[44:47], a[184:187], v[100:103], 0
v_mfma_f32_16x16x32_bf16 v[44:47], a[204:207], v[96:99], v[44:47]
v_mfma_f32_16x16x32_bf16 v[44:47], a[224:227], v[92:95], v[44:47]
v_mfma_f32_16x16x32_bf16 v[48:51], a[228:231], v[92:95], 0
buffer_load_dwordx4 v[84:87], v225, s[28:31], s32 offen offset:0
v_mfma_f32_16x16x32_bf16 v[48:51], a[208:211], v[96:99], v[48:51]
v_mfma_f32_16x16x32_bf16 v[48:51], a[188:191], v[100:103], v[48:51]
v_mfma_f32_16x16x32_bf16 v[52:55], a[192:195], v[100:103], 0
v_mfma_f32_16x16x32_bf16 v[52:55], a[212:215], v[96:99], v[52:55]
buffer_load_dwordx4 v[88:91], v226, s[28:31], s32 offen offset:0
v_mfma_f32_16x16x32_bf16 v[52:55], a[232:235], v[92:95], v[52:55]
v_mfma_f32_16x16x32_bf16 v[56:59], a[236:239], v[92:95], 0
v_mfma_f32_16x16x32_bf16 v[56:59], a[216:219], v[96:99], v[56:59]
v_mfma_f32_16x16x32_bf16 v[56:59], a[196:199], v[100:103], v[56:59]
s_waitcnt vmcnt(10) lgkmcnt(0)
v_mfma_f32_16x16x32_bf16 v[60:63], a[220:223], v[104:107], 0
s_barrier
v_mfma_f32_16x16x32_bf16 v[60:63], a[200:203], v[108:111], v[60:63]
buffer_load_dwordx4 v[92:95], v227, s[28:31], s32 offen offset:0
v_mfma_f32_16x16x32_bf16 v[60:63], a[180:183], v[112:115], v[60:63]
ds_read_b128 v[184:187], v237 offset:0
ds_read_b128 v[188:191], v237 offset:5120
v_mfma_f32_16x16x32_bf16 v[64:67], a[184:187], v[112:115], 0
v_mfma_f32_16x16x32_bf16 v[64:67], a[204:207], v[108:111], v[64:67]
ds_read_b128 v[192:195], v237 offset:10240
ds_read_b128 v[196:199], v237 offset:15360
v_mfma_f32_16x16x32_bf16 v[64:67], a[224:227], v[104:107], v[64:67]
buffer_load_dwordx4 v[96:99], v224, s[28:31], s32 offen offset:1024
v_mfma_f32_16x16x32_bf16 v[68:71], a[228:231], v[104:107], 0
v_mfma_f32_16x16x32_bf16 v[68:71], a[208:211], v[108:111], v[68:71]
ds_read_b128 v[200:203], v237 offset:1024
ds_read_b128 v[204:207], v237 offset:6144
v_mfma_f32_16x16x32_bf16 v[68:71], a[188:191], v[112:115], v[68:71]
v_mfma_f32_16x16x32_bf16 v[72:75], a[192:195], v[112:115], 0
buffer_load_dwordx4 v[100:103], v225, s[28:31], s32 offen offset:1024
v_mfma_f32_16x16x32_bf16 v[72:75], a[212:215], v[108:111], v[72:75]
ds_read_b128 v[208:211], v237 offset:11264
ds_read_b128 v[212:215], v237 offset:16384
v_mfma_f32_16x16x32_bf16 v[72:75], a[232:235], v[104:107], v[72:75]
v_mfma_f32_16x16x32_bf16 v[76:79], a[236:239], v[104:107], 0
v_mfma_f32_16x16x32_bf16 v[76:79], a[216:219], v[108:111], v[76:79]
v_mfma_f32_16x16x32_bf16 v[76:79], a[196:199], v[112:115], v[76:79]
s_waitcnt vmcnt(10) lgkmcnt(0)
v_mfma_f32_16x16x32_bf16 v[0:3], a[220:223], v[116:119], 0
buffer_load_dwordx4 v[104:107], v226, s[28:31], s32 offen offset:1024
v_mfma_f32_16x16x32_bf16 v[0:3], a[200:203], v[120:123], v[0:3]
v_add_f32 v184, v184, v188
v_add_f32 v192, v192, v196
v_mfma_f32_16x16x32_bf16 v[0:3], a[180:183], v[124:127], v[0:3]
v_add_f32 v185, v185, v189
v_add_f32 v193, v193, v197
v_mfma_f32_16x16x32_bf16 v[4:7], a[184:187], v[124:127], 0
v_add_f32 v186, v186, v190
v_add_f32 v194, v194, v198
v_mfma_f32_16x16x32_bf16 v[4:7], a[204:207], v[120:123], v[4:7]
buffer_load_dwordx4 v[108:111], v227, s[28:31], s32 offen offset:1024
v_mfma_f32_16x16x32_bf16 v[4:7], a[224:227], v[116:119], v[4:7]
v_add_f32 v187, v187, v191
v_add_f32 v195, v195, v199
v_mfma_f32_16x16x32_bf16 v[8:11], a[228:231], v[116:119], 0
v_add_f32 v184, v184, v192
v_add_f32 v185, v185, v193
v_mfma_f32_16x16x32_bf16 v[8:11], a[208:211], v[120:123], v[8:11]
v_add_f32 v186, v186, v194
v_add_f32 v187, v187, v195
v_mfma_f32_16x16x32_bf16 v[8:11], a[188:191], v[124:127], v[8:11]
v_mfma_f32_16x16x32_bf16 v[12:15], a[192:195], v[124:127], 0
buffer_load_dwordx4 v[112:115], v224, s[28:31], s32 offen offset:2048
v_mfma_f32_16x16x32_bf16 v[12:15], a[212:215], v[120:123], v[12:15]
buffer_store_dwordx4 v[184:187], v216, s[12:15], s71 offen offset:0 sc1
v_mfma_f32_16x16x32_bf16 v[12:15], a[232:235], v[116:119], v[12:15]
ds_read_b128 v[184:187], v237 offset:2048
ds_read_b128 v[188:191], v237 offset:7168
v_mfma_f32_16x16x32_bf16 v[16:19], a[236:239], v[116:119], 0
v_mfma_f32_16x16x32_bf16 v[16:19], a[216:219], v[120:123], v[16:19]
ds_read_b128 v[192:195], v237 offset:12288
ds_read_b128 v[196:199], v237 offset:17408
v_mfma_f32_16x16x32_bf16 v[16:19], a[196:199], v[124:127], v[16:19]
s_waitcnt vmcnt(10) lgkmcnt(0)
v_mfma_f32_16x16x32_bf16 v[0:3], a[160:163], v[128:131], v[0:3]
buffer_load_dwordx4 v[116:119], v225, s[28:31], s32 offen offset:2048
v_add_f32 v200, v200, v204
v_mfma_f32_16x16x32_bf16 v[20:23], a[160:163], v[132:135], v[20:23]
v_add_f32 v208, v208, v212
v_add_f32 v201, v201, v205
v_mfma_f32_16x16x32_bf16 v[40:43], a[160:163], v[136:139], v[40:43]
v_add_f32 v209, v209, v213
v_add_f32 v202, v202, v206
v_add_f32 v210, v210, v214
v_mfma_f32_16x16x32_bf16 v[60:63], a[160:163], v[140:143], v[60:63]
v_add_f32 v203, v203, v207
v_add_f32 v211, v211, v215
v_mfma_f32_16x16x32_bf16 v[64:67], a[164:167], v[140:143], v[64:67]
v_add_f32 v200, v200, v208
v_add_f32 v201, v201, v209
v_mfma_f32_16x16x32_bf16 v[44:47], a[164:167], v[136:139], v[44:47]
v_add_f32 v202, v202, v210
v_add_f32 v203, v203, v211
v_mfma_f32_16x16x32_bf16 v[24:27], a[164:167], v[132:135], v[24:27]
buffer_load_dwordx4 v[120:123], v226, s[28:31], s32 offen offset:2048
v_mfma_f32_16x16x32_bf16 v[4:7], a[164:167], v[128:131], v[4:7]
buffer_store_dwordx4 v[200:203], v216, s[12:15], s71 offen offset:1024 sc1
v_mfma_f32_16x16x32_bf16 v[8:11], a[168:171], v[128:131], v[8:11]
ds_read_b128 v[200:203], v237 offset:3072
ds_read_b128 v[204:207], v237 offset:8192
v_mfma_f32_16x16x32_bf16 v[28:31], a[168:171], v[132:135], v[28:31]
buffer_load_dwordx4 v[124:127], v227, s[28:31], s32 offen offset:2048
v_mfma_f32_16x16x32_bf16 v[48:51], a[168:171], v[136:139], v[48:51]
ds_read_b128 v[208:211], v237 offset:13312
ds_read_b128 v[212:215], v237 offset:18432
v_mfma_f32_16x16x32_bf16 v[68:71], a[168:171], v[140:143], v[68:71]
v_add_f32 v184, v184, v188
v_add_f32 v192, v192, v196
v_mfma_f32_16x16x32_bf16 v[72:75], a[172:175], v[140:143], v[72:75]
v_add_f32 v185, v185, v189
v_add_f32 v193, v193, v197
v_mfma_f32_16x16x32_bf16 v[52:55], a[172:175], v[136:139], v[52:55]
v_add_f32 v186, v186, v190
v_add_f32 v194, v194, v198
v_mfma_f32_16x16x32_bf16 v[32:35], a[172:175], v[132:135], v[32:35]
v_add_f32 v187, v187, v191
v_add_f32 v195, v195, v199
v_mfma_f32_16x16x32_bf16 v[12:15], a[172:175], v[128:131], v[12:15]
v_add_f32 v184, v184, v192
v_add_f32 v185, v185, v193
v_mfma_f32_16x16x32_bf16 v[16:19], a[176:179], v[128:131], v[16:19]
v_add_f32 v186, v186, v194
v_add_f32 v187, v187, v195
v_mfma_f32_16x16x32_bf16 v[36:39], a[176:179], v[132:135], v[36:39]
buffer_store_dwordx4 v[184:187], v216, s[12:15], s71 offen offset:2048 sc1
v_mfma_f32_16x16x32_bf16 v[56:59], a[176:179], v[136:139], v[56:59]
ds_read_b128 v[184:187], v237 offset:4096
ds_read_b128 v[188:191], v237 offset:9216
v_mfma_f32_16x16x32_bf16 v[76:79], a[176:179], v[140:143], v[76:79]
ds_read_b128 v[192:195], v237 offset:14336
ds_read_b128 v[196:199], v237 offset:19456
s_waitcnt vmcnt(11) lgkmcnt(0)
v_mfma_f32_16x16x32_bf16 v[0:3], a[140:143], v[80:83], v[0:3]
buffer_load_dwordx4 v[128:131], v224, s[28:31], s32 offen offset:3072
v_mfma_f32_16x16x32_bf16 v[20:23], a[140:143], v[84:87], v[20:23]
v_add_f32 v200, v200, v204
v_add_f32 v208, v208, v212
v_mfma_f32_16x16x32_bf16 v[40:43], a[140:143], v[88:91], v[40:43]
v_add_f32 v201, v201, v205
v_add_f32 v209, v209, v213
v_mfma_f32_16x16x32_bf16 v[60:63], a[140:143], v[92:95], v[60:63]
v_add_f32 v202, v202, v206
v_add_f32 v210, v210, v214
v_mfma_f32_16x16x32_bf16 v[64:67], a[144:147], v[92:95], v[64:67]
buffer_load_dwordx4 v[132:135], v225, s[28:31], s32 offen offset:3072
v_mfma_f32_16x16x32_bf16 v[44:47], a[144:147], v[88:91], v[44:47]
v_add_f32 v203, v203, v207
v_add_f32 v211, v211, v215
v_mfma_f32_16x16x32_bf16 v[24:27], a[144:147], v[84:87], v[24:27]
v_add_f32 v200, v200, v208
v_add_f32 v201, v201, v209
v_mfma_f32_16x16x32_bf16 v[4:7], a[144:147], v[80:83], v[4:7]
v_add_f32 v202, v202, v210
v_add_f32 v203, v203, v211
v_mfma_f32_16x16x32_bf16 v[8:11], a[148:151], v[80:83], v[8:11]
buffer_store_dwordx4 v[200:203], v216, s[12:15], s71 offen offset:3072 sc1
v_mfma_f32_16x16x32_bf16 v[28:31], a[148:151], v[84:87], v[28:31]
buffer_load_dwordx4 v[136:139], v226, s[28:31], s32 offen offset:3072
v_mfma_f32_16x16x32_bf16 v[48:51], a[148:151], v[88:91], v[48:51]
v_add_f32 v184, v184, v188
v_add_f32 v192, v192, v196
v_mfma_f32_16x16x32_bf16 v[68:71], a[148:151], v[92:95], v[68:71]
v_add_f32 v185, v185, v189
v_add_f32 v193, v193, v197
v_mfma_f32_16x16x32_bf16 v[72:75], a[152:155], v[92:95], v[72:75]
v_add_f32 v186, v186, v190
v_add_f32 v194, v194, v198
v_mfma_f32_16x16x32_bf16 v[52:55], a[152:155], v[88:91], v[52:55]
v_add_f32 v187, v187, v191
v_add_f32 v195, v195, v199
v_mfma_f32_16x16x32_bf16 v[32:35], a[152:155], v[84:87], v[32:35]
buffer_load_dwordx4 v[140:143], v227, s[28:31], s32 offen offset:3072
v_mfma_f32_16x16x32_bf16 v[12:15], a[152:155], v[80:83], v[12:15]
v_add_f32 v184, v184, v192
v_add_f32 v185, v185, v193
v_mfma_f32_16x16x32_bf16 v[16:19], a[156:159], v[80:83], v[16:19]
v_add_f32 v186, v186, v194
v_add_f32 v187, v187, v195
v_mfma_f32_16x16x32_bf16 v[36:39], a[156:159], v[84:87], v[36:39]
buffer_store_dwordx4 v[184:187], v216, s[12:15], s75 offen offset:0 sc1
v_mfma_f32_16x16x32_bf16 v[56:59], a[156:159], v[88:91], v[56:59]
v_mfma_f32_16x16x32_bf16 v[76:79], a[156:159], v[92:95], v[76:79]
s_waitcnt vmcnt(13)
v_mfma_f32_16x16x32_bf16 v[0:3], a[120:123], v[96:99], v[0:3]
s_add_u32 s32, s69, 8192
ds_read_b128 v[144:147], v243 offset:0
ds_read_b128 v[148:151], v243 offset:4096
v_mfma_f32_16x16x32_bf16 v[20:23], a[120:123], v[100:103], v[20:23]
v_mfma_f32_16x16x32_bf16 v[40:43], a[120:123], v[104:107], v[40:43]
buffer_load_dwordx4 v[80:83], v224, s[28:31], s32 offen offset:0
v_mfma_f32_16x16x32_bf16 v[60:63], a[120:123], v[108:111], v[60:63]
ds_read_b128 v[152:155], v243 offset:8192
ds_read_b128 v[156:159], v243 offset:12288
v_mfma_f32_16x16x32_bf16 v[64:67], a[124:127], v[108:111], v[64:67]
v_mfma_f32_16x16x32_bf16 v[44:47], a[124:127], v[104:107], v[44:47]
v_mfma_f32_16x16x32_bf16 v[24:27], a[124:127], v[100:103], v[24:27]
buffer_load_dwordx4 v[84:87], v225, s[28:31], s32 offen offset:0
v_mfma_f32_16x16x32_bf16 v[4:7], a[124:127], v[96:99], v[4:7]
ds_read_b128 v[160:163], v243 offset:16384
v_mfma_f32_16x16x32_bf16 v[8:11], a[128:131], v[96:99], v[8:11]
v_mfma_f32_16x16x32_bf16 v[28:31], a[128:131], v[100:103], v[28:31]
v_mfma_f32_16x16x32_bf16 v[48:51], a[128:131], v[104:107], v[48:51]
buffer_load_dwordx4 v[88:91], v226, s[28:31], s32 offen offset:0
v_mfma_f32_16x16x32_bf16 v[68:71], a[128:131], v[108:111], v[68:71]
v_mfma_f32_16x16x32_bf16 v[72:75], a[132:135], v[108:111], v[72:75]
v_mfma_f32_16x16x32_bf16 v[52:55], a[132:135], v[104:107], v[52:55]
v_mfma_f32_16x16x32_bf16 v[32:35], a[132:135], v[100:103], v[32:35]
buffer_load_dwordx4 v[92:95], v227, s[28:31], s32 offen offset:0
v_mfma_f32_16x16x32_bf16 v[12:15], a[132:135], v[96:99], v[12:15]
v_mfma_f32_16x16x32_bf16 v[16:19], a[136:139], v[96:99], v[16:19]
v_mfma_f32_16x16x32_bf16 v[36:39], a[136:139], v[100:103], v[36:39]
v_mfma_f32_16x16x32_bf16 v[56:59], a[136:139], v[104:107], v[56:59]
v_mfma_f32_16x16x32_bf16 v[76:79], a[136:139], v[108:111], v[76:79]
s_waitcnt vmcnt(4) lgkmcnt(0)
v_mfma_f32_16x16x32_bf16 v[0:3], v[144:147], v[112:115], v[0:3]
s_mov_b64 exec, 1
global_store_dword v231, v223, s[66:67] sc1
s_mov_b64 exec, -1
v_mfma_f32_16x16x32_bf16 v[20:23], v[144:147], v[116:119], v[20:23]
ds_read_b128 v[164:167], v243 offset:1024
ds_read_b128 v[168:171], v243 offset:5120
v_mfma_f32_16x16x32_bf16 v[40:43], v[144:147], v[120:123], v[40:43]
buffer_load_dwordx4 v[96:99], v224, s[28:31], s32 offen offset:1024
v_mfma_f32_16x16x32_bf16 v[60:63], v[144:147], v[124:127], v[60:63]
v_mfma_f32_16x16x32_bf16 v[64:67], v[148:151], v[124:127], v[64:67]
ds_read_b128 v[172:175], v243 offset:9216
ds_read_b128 v[176:179], v243 offset:13312
v_mfma_f32_16x16x32_bf16 v[44:47], v[148:151], v[120:123], v[44:47]
buffer_load_dwordx4 v[100:103], v225, s[28:31], s32 offen offset:1024
v_mfma_f32_16x16x32_bf16 v[24:27], v[148:151], v[116:119], v[24:27]
v_mfma_f32_16x16x32_bf16 v[4:7], v[148:151], v[112:115], v[4:7]
ds_read_b128 v[180:183], v243 offset:17408
v_mfma_f32_16x16x32_bf16 v[8:11], v[152:155], v[112:115], v[8:11]
v_mfma_f32_16x16x32_bf16 v[28:31], v[152:155], v[116:119], v[28:31]
v_mfma_f32_16x16x32_bf16 v[48:51], v[152:155], v[120:123], v[48:51]
buffer_load_dwordx4 v[104:107], v226, s[28:31], s32 offen offset:1024
v_mfma_f32_16x16x32_bf16 v[68:71], v[152:155], v[124:127], v[68:71]
v_mfma_f32_16x16x32_bf16 v[72:75], v[156:159], v[124:127], v[72:75]
v_mfma_f32_16x16x32_bf16 v[52:55], v[156:159], v[120:123], v[52:55]
v_mfma_f32_16x16x32_bf16 v[32:35], v[156:159], v[116:119], v[32:35]
buffer_load_dwordx4 v[108:111], v227, s[28:31], s32 offen offset:1024
v_mfma_f32_16x16x32_bf16 v[12:15], v[156:159], v[112:115], v[12:15]
v_mfma_f32_16x16x32_bf16 v[16:19], v[160:163], v[112:115], v[16:19]
v_mfma_f32_16x16x32_bf16 v[36:39], v[160:163], v[116:119], v[36:39]
v_mfma_f32_16x16x32_bf16 v[56:59], v[160:163], v[120:123], v[56:59]
v_mfma_f32_16x16x32_bf16 v[76:79], v[160:163], v[124:127], v[76:79]
s_waitcnt lgkmcnt(0)
v_mfma_f32_16x16x32_bf16 v[0:3], v[164:167], v[128:131], v[0:3]
ds_read_b128 v[144:147], v243 offset:2048
ds_read_b128 v[148:151], v243 offset:6144
v_mfma_f32_16x16x32_bf16 v[20:23], v[164:167], v[132:135], v[20:23]
buffer_load_dwordx4 v[112:115], v224, s[28:31], s32 offen offset:2048
v_mfma_f32_16x16x32_bf16 v[40:43], v[164:167], v[136:139], v[40:43]
buffer_load_dwordx4 v[116:119], v225, s[28:31], s32 offen offset:2048
v_mfma_f32_16x16x32_bf16 v[60:63], v[164:167], v[140:143], v[60:63]
ds_read_b128 v[152:155], v243 offset:10240
ds_read_b128 v[156:159], v243 offset:14336
v_mfma_f32_16x16x32_bf16 v[64:67], v[168:171], v[140:143], v[64:67]
buffer_load_dwordx4 v[120:123], v226, s[28:31], s32 offen offset:2048
v_mfma_f32_16x16x32_bf16 v[44:47], v[168:171], v[136:139], v[44:47]
buffer_load_dwordx4 v[124:127], v227, s[28:31], s32 offen offset:2048
v_mfma_f32_16x16x32_bf16 v[24:27], v[168:171], v[132:135], v[24:27]
s_getpc_b64 s[72:73]
Lpc24:
s_add_u32 s72, s72, Lxmodd-Lpc24
s_addc_u32 s73, s73, 0
v_mfma_f32_16x16x32_bf16 v[4:7], v[168:171], v[128:131], v[4:7]
s_lshr_b32 s6, s2, 3
ds_read_b128 v[160:163], v243 offset:18432
s_lshl_b32 s6, s6, 2
v_mfma_f32_16x16x32_bf16 v[8:11], v[172:175], v[128:131], v[8:11]
s_add_u32 s6, s6, s3
v_mfma_f32_16x16x32_bf16 v[28:31], v[172:175], v[132:135], v[28:31]
s_lshl_b32 s6, s6, 7
v_mfma_f32_16x16x32_bf16 v[48:51], v[172:175], v[136:139], v[48:51]
v_mfma_f32_16x16x32_bf16 v[68:71], v[172:175], v[140:143], v[68:71]
v_min_u32 v204, 0, v220
v_lshlrev_b32 v204, 14, v204
v_mfma_f32_16x16x32_bf16 v[72:75], v[176:179], v[140:143], v[72:75]
v_mfma_f32_16x16x32_bf16 v[52:55], v[176:179], v[136:139], v[52:55]
v_add_u32 v204, s6, v204
v_min_u32 v204, Lend-Lxmodd, v204
v_mfma_f32_16x16x32_bf16 v[32:35], v[176:179], v[132:135], v[32:35]
v_mov_b32 v205, s73
v_mfma_f32_16x16x32_bf16 v[12:15], v[176:179], v[128:131], v[12:15]
v_add_co_u32 v204, vcc, s72, v204
s_nop 1
v_addc_co_u32 v205, vcc, 0, v205, vcc
v_mfma_f32_16x16x32_bf16 v[16:19], v[180:183], v[128:131], v[16:19]
v_mfma_f32_16x16x32_bf16 v[36:39], v[180:183], v[132:135], v[36:39]
global_load_dword v206, v[204:205], off
v_mfma_f32_16x16x32_bf16 v[56:59], v[180:183], v[136:139], v[56:59]
v_mfma_f32_16x16x32_bf16 v[76:79], v[180:183], v[140:143], v[76:79]
s_waitcnt vmcnt(10) lgkmcnt(0)
v_mfma_f32_16x16x32_bf16 v[0:3], v[144:147], v[80:83], v[0:3]
ds_read_b128 v[164:167], v243 offset:3072
ds_read_b128 v[168:171], v243 offset:7168
v_mfma_f32_16x16x32_bf16 v[20:23], v[144:147], v[84:87], v[20:23]
buffer_load_dwordx4 v[128:131], v224, s[28:31], s32 offen offset:3072
v_mfma_f32_16x16x32_bf16 v[40:43], v[144:147], v[88:91], v[40:43]
v_mfma_f32_16x16x32_bf16 v[60:63], v[144:147], v[92:95], v[60:63]
ds_read_b128 v[172:175], v243 offset:11264
ds_read_b128 v[176:179], v243 offset:15360
v_mfma_f32_16x16x32_bf16 v[64:67], v[148:151], v[92:95], v[64:67]
buffer_load_dwordx4 v[132:135], v225, s[28:31], s32 offen offset:3072
v_mfma_f32_16x16x32_bf16 v[44:47], v[148:151], v[88:91], v[44:47]
v_mfma_f32_16x16x32_bf16 v[24:27], v[148:151], v[84:87], v[24:27]
ds_read_b128 v[180:183], v243 offset:19456
v_mfma_f32_16x16x32_bf16 v[4:7], v[148:151], v[80:83], v[4:7]
v_mfma_f32_16x16x32_bf16 v[8:11], v[152:155], v[80:83], v[8:11]
v_mfma_f32_16x16x32_bf16 v[28:31], v[152:155], v[84:87], v[28:31]
buffer_load_dwordx4 v[136:139], v226, s[28:31], s32 offen offset:3072
v_mfma_f32_16x16x32_bf16 v[48:51], v[152:155], v[88:91], v[48:51]
v_mfma_f32_16x16x32_bf16 v[68:71], v[152:155], v[92:95], v[68:71]
v_mfma_f32_16x16x32_bf16 v[72:75], v[156:159], v[92:95], v[72:75]
v_mfma_f32_16x16x32_bf16 v[52:55], v[156:159], v[88:91], v[52:55]
v_mfma_f32_16x16x32_bf16 v[32:35], v[156:159], v[84:87], v[32:35]
buffer_load_dwordx4 v[140:143], v227, s[28:31], s32 offen offset:3072
v_mfma_f32_16x16x32_bf16 v[12:15], v[156:159], v[80:83], v[12:15]
v_mfma_f32_16x16x32_bf16 v[16:19], v[160:163], v[80:83], v[16:19]
v_mfma_f32_16x16x32_bf16 v[36:39], v[160:163], v[84:87], v[36:39]
v_mfma_f32_16x16x32_bf16 v[56:59], v[160:163], v[88:91], v[56:59]
v_mfma_f32_16x16x32_bf16 v[76:79], v[160:163], v[92:95], v[76:79]
s_waitcnt vmcnt(9) lgkmcnt(0)
v_mfma_f32_16x16x32_bf16 v[0:3], v[164:167], v[96:99], v[0:3]
s_add_u32 s32, s69, 12288
v_mfma_f32_16x16x32_bf16 v[20:23], v[164:167], v[100:103], v[20:23]
buffer_load_dwordx4 v[80:83], v224, s[28:31], s32 offen offset:0
v_mfma_f32_16x16x32_bf16 v[40:43], v[164:167], v[104:107], v[40:43]
v_mfma_f32_16x16x32_bf16 v[60:63], v[164:167], v[108:111], v[60:63]
buffer_load_dwordx4 v[84:87], v225, s[28:31], s32 offen offset:0
v_mfma_f32_16x16x32_bf16 v[64:67], v[168:171], v[108:111], v[64:67]
v_mfma_f32_16x16x32_bf16 v[44:47], v[168:171], v[104:107], v[44:47]
buffer_load_dwordx4 v[88:91], v226, s[28:31], s32 offen offset:0
v_mfma_f32_16x16x32_bf16 v[24:27], v[168:171], v[100:103], v[24:27]
v_mfma_f32_16x16x32_bf16 v[4:7], v[168:171], v[96:99], v[4:7]
v_mfma_f32_16x16x32_bf16 v[8:11], v[172:175], v[96:99], v[8:11]
buffer_load_dwordx4 v[92:95], v227, s[28:31], s32 offen offset:0
v_mfma_f32_16x16x32_bf16 v[28:31], v[172:175], v[100:103], v[28:31]
s_mov_b32 m0, s34
v_mfma_f32_16x16x32_bf16 v[48:51], v[172:175], v[104:107], v[48:51]
v_mfma_f32_16x16x32_bf16 v[68:71], v[172:175], v[108:111], v[68:71]
buffer_load_dwordx4 v244, s[16:19], s35 offen offset:0 lds
v_mfma_f32_16x16x32_bf16 v[72:75], v[176:179], v[108:111], v[72:75]
v_mfma_f32_16x16x32_bf16 v[52:55], v[176:179], v[104:107], v[52:55]
v_mfma_f32_16x16x32_bf16 v[32:35], v[176:179], v[100:103], v[32:35]
buffer_load_dwordx4 v245, s[16:19], s35 offen offset:1024 lds
v_mfma_f32_16x16x32_bf16 v[12:15], v[176:179], v[96:99], v[12:15]
v_mfma_f32_16x16x32_bf16 v[16:19], v[180:183], v[96:99], v[16:19]
buffer_load_dwordx4 v246, s[16:19], s35 offen offset:2048 lds
v_mfma_f32_16x16x32_bf16 v[36:39], v[180:183], v[100:103], v[36:39]
v_mfma_f32_16x16x32_bf16 v[56:59], v[180:183], v[104:107], v[56:59]
v_mfma_f32_16x16x32_bf16 v[76:79], v[180:183], v[108:111], v[76:79]
s_waitcnt vmcnt(12)
v_mfma_f32_16x16x32_bf16 v[0:3], a[100:103], v[112:115], v[0:3]
s_barrier
v_mfma_f32_16x16x32_bf16 v[20:23], a[100:103], v[116:119], v[20:23]
buffer_load_dwordx4 v[96:99], v225, s[28:31], s32 offen offset:1024
v_mfma_f32_16x16x32_bf16 v[40:43], a[100:103], v[120:123], v[40:43]
v_mfma_f32_16x16x32_bf16 v[60:63], a[100:103], v[124:127], v[60:63]
v_mfma_f32_16x16x32_bf16 v[64:67], a[104:107], v[124:127], v[64:67]
v_mfma_f32_16x16x32_bf16 v[44:47], a[104:107], v[120:123], v[44:47]
buffer_load_dwordx4 v[100:103], v225, s[28:31], s32 offen offset:2048
v_mfma_f32_16x16x32_bf16 v[24:27], a[104:107], v[116:119], v[24:27]
v_mfma_f32_16x16x32_bf16 v[4:7], a[104:107], v[112:115], v[4:7]
v_mfma_f32_16x16x32_bf16 v[8:11], a[108:111], v[112:115], v[8:11]
v_mfma_f32_16x16x32_bf16 v[28:31], a[108:111], v[116:119], v[28:31]
v_mfma_f32_16x16x32_bf16 v[48:51], a[108:111], v[120:123], v[48:51]
buffer_load_dwordx4 v[104:107], v225, s[28:31], s32 offen offset:3072
v_mfma_f32_16x16x32_bf16 v[68:71], a[108:111], v[124:127], v[68:71]
v_mfma_f32_16x16x32_bf16 v[72:75], a[112:115], v[124:127], v[72:75]
v_mfma_f32_16x16x32_bf16 v[52:55], a[112:115], v[120:123], v[52:55]
v_mfma_f32_16x16x32_bf16 v[32:35], a[112:115], v[116:119], v[32:35]
buffer_load_dwordx4 v[108:111], v226, s[28:31], s32 offen offset:1024
v_mfma_f32_16x16x32_bf16 v[12:15], a[112:115], v[112:115], v[12:15]
v_mfma_f32_16x16x32_bf16 v[16:19], a[116:119], v[112:115], v[16:19]
v_mfma_f32_16x16x32_bf16 v[36:39], a[116:119], v[116:119], v[36:39]
v_mfma_f32_16x16x32_bf16 v[56:59], a[116:119], v[120:123], v[56:59]
v_mfma_f32_16x16x32_bf16 v[76:79], a[116:119], v[124:127], v[76:79]
s_waitcnt vmcnt(11)
v_mfma_f32_16x16x32_bf16 v[0:3], a[80:83], v[128:131], v[0:3]
buffer_load_dwordx4 v[112:115], v226, s[28:31], s32 offen offset:2048
v_mfma_f32_16x16x32_bf16 v[20:23], a[80:83], v[132:135], v[20:23]
v_add_u32 v208, s44, v216
v_add_u32 v209, s44, v236
v_mfma_f32_16x16x32_bf16 v[40:43], a[80:83], v[136:139], v[40:43]
v_mfma_f32_16x16x32_bf16 v[60:63], a[80:83], v[140:143], v[60:63]
v_mfma_f32_16x16x32_bf16 v[64:67], a[84:87], v[140:143], v[64:67]
buffer_load_dwordx4 v[116:119], v226, s[28:31], s32 offen offset:3072
v_mfma_f32_16x16x32_bf16 v[44:47], a[84:87], v[136:139], v[44:47]
v_mfma_f32_16x16x32_bf16 v[24:27], a[84:87], v[132:135], v[24:27]
ds_write_b128 v208, a[240:243] offset:0
ds_write_b128 v208, a[244:247] offset:1024
v_mfma_f32_16x16x32_bf16 v[4:7], a[84:87], v[128:131], v[4:7]
v_mfma_f32_16x16x32_bf16 v[8:11], a[88:91], v[128:131], v[8:11]
v_mfma_f32_16x16x32_bf16 v[28:31], a[88:91], v[132:135], v[28:31]
buffer_load_dwordx4 v[120:123], v227, s[28:31], s32 offen offset:1024
v_mfma_f32_16x16x32_bf16 v[48:51], a[88:91], v[136:139], v[48:51]
v_mfma_f32_16x16x32_bf16 v[68:71], a[88:91], v[140:143], v[68:71]
v_mfma_f32_16x16x32_bf16 v[72:75], a[92:95], v[140:143], v[72:75]
ds_write_b128 v208, a[248:251] offset:2048
ds_write_b128 v208, a[252:255] offset:3072
v_mfma_f32_16x16x32_bf16 v[52:55], a[92:95], v[136:139], v[52:55]
v_mfma_f32_16x16x32_bf16 v[32:35], a[92:95], v[132:135], v[32:35]
buffer_load_dwordx4 v[124:127], v227, s[28:31], s32 offen offset:2048
v_mfma_f32_16x16x32_bf16 v[12:15], a[92:95], v[128:131], v[12:15]
v_mfma_f32_16x16x32_bf16 v[16:19], a[96:99], v[128:131], v[16:19]
v_mfma_f32_16x16x32_bf16 v[36:39], a[96:99], v[132:135], v[36:39]
v_mfma_f32_16x16x32_bf16 v[56:59], a[96:99], v[136:139], v[56:59]
v_mfma_f32_16x16x32_bf16 v[76:79], a[96:99], v[140:143], v[76:79]
s_waitcnt vmcnt(11) lgkmcnt(0)
v_mfma_f32_16x16x32_bf16 v[0:3], a[60:63], v[80:83], v[0:3]
buffer_load_dwordx4 v[128:131], v227, s[28:31], s32 offen offset:3072
v_mfma_f32_16x16x32_bf16 v[20:23], a[60:63], v[84:87], v[20:23]
ds_read_b128 v[144:147], v209 offset:3072
ds_read_b128 v[148:151], v209 offset:3136
v_mfma_f32_16x16x32_bf16 v[40:43], a[60:63], v[88:91], v[40:43]
v_mfma_f32_16x16x32_bf16 v[60:63], a[60:63], v[92:95], v[60:63]
ds_read_b128 v[152:155], v209 offset:3200
ds_read_b128 v[156:159], v209 offset:3264
v_mfma_f32_16x16x32_bf16 v[64:67], a[64:67], v[92:95], v[64:67]
buffer_load_dwordx4 v[132:135], v224, s[28:31], s32 offen offset:1024
v_mfma_f32_16x16x32_bf16 v[44:47], a[64:67], v[88:91], v[44:47]
v_mfma_f32_16x16x32_bf16 v[24:27], a[64:67], v[84:87], v[24:27]
v_mfma_f32_16x16x32_bf16 v[4:7], a[64:67], v[80:83], v[4:7]
ds_read_b128 v[160:163], v209 offset:3328
ds_read_b128 v[164:167], v209 offset:3392
v_mfma_f32_16x16x32_bf16 v[8:11], a[68:71], v[80:83], v[8:11]
v_mfma_f32_16x16x32_bf16 v[28:31], a[68:71], v[84:87], v[28:31]
buffer_load_dwordx4 v[136:139], v224, s[28:31], s32 offen offset:2048
v_mfma_f32_16x16x32_bf16 v[48:51], a[68:71], v[88:91], v[48:51]
v_mfma_f32_16x16x32_bf16 v[68:71], a[68:71], v[92:95], v[68:71]
ds_read_b128 v[168:171], v209 offset:3456
ds_read_b128 v[172:175], v209 offset:3520
v_mfma_f32_16x16x32_bf16 v[72:75], a[72:75], v[92:95], v[72:75]
v_mfma_f32_16x16x32_bf16 v[52:55], a[72:75], v[88:91], v[52:55]
v_mfma_f32_16x16x32_bf16 v[32:35], a[72:75], v[84:87], v[32:35]
buffer_load_dwordx4 v[140:143], v224, s[28:31], s32 offen offset:3072
v_mfma_f32_16x16x32_bf16 v[12:15], a[72:75], v[80:83], v[12:15]
ds_read_b128 v[176:179], v209 offset:3584
ds_read_b128 v[180:183], v209 offset:3648
v_mfma_f32_16x16x32_bf16 v[16:19], a[76:79], v[80:83], v[16:19]
v_mfma_f32_16x16x32_bf16 v[36:39], a[76:79], v[84:87], v[36:39]
v_mfma_f32_16x16x32_bf16 v[56:59], a[76:79], v[88:91], v[56:59]
v_mfma_f32_16x16x32_bf16 v[76:79], a[76:79], v[92:95], v[76:79]
s_waitcnt vmcnt(9)
v_mfma_f32_16x16x32_bf16 v[20:23], a[40:43], v[96:99], v[20:23]
s_add_u32 s16, s66, 131072
s_addc_u32 s17, s67, 0
v_mfma_f32_16x16x32_bf16 v[20:23], a[20:23], v[100:103], v[20:23]
s_and_b32 s17, s17, 0xffff
v_mfma_f32_16x16x32_bf16 v[20:23], a[0:3], v[104:107], v[20:23]
s_mov_b32 s18, 131072
v_mfma_f32_16x16x32_bf16 v[24:27], a[4:7], v[104:107], v[24:27]
s_mov_b32 s19, 0x20000
v_mfma_f32_16x16x32_bf16 v[24:27], a[24:27], v[100:103], v[24:27]
v_mfma_f32_16x16x32_bf16 v[24:27], a[44:47], v[96:99], v[24:27]
v_mfma_f32_16x16x32_bf16 v[28:31], a[48:51], v[96:99], v[28:31]
v_mfma_f32_16x16x32_bf16 v[28:31], a[28:31], v[100:103], v[28:31]
v_mfma_f32_16x16x32_bf16 v[28:31], a[8:11], v[104:107], v[28:31]
global_load_dword v242, v230, s[66:67] sc1
v_mfma_f32_16x16x32_bf16 v[32:35], a[12:15], v[104:107], v[32:35]
buffer_load_dwordx4 a[64:67], v228, s[8:11], s39 offen offset:0
v_mfma_f32_16x16x32_bf16 v[32:35], a[32:35], v[100:103], v[32:35]
buffer_load_dwordx4 a[68:71], v229, s[8:11], s39 offen offset:0
v_mfma_f32_16x16x32_bf16 v[32:35], a[52:55], v[96:99], v[32:35]
v_mfma_f32_16x16x32_bf16 v[36:39], a[56:59], v[96:99], v[36:39]
v_mfma_f32_16x16x32_bf16 v[36:39], a[36:39], v[100:103], v[36:39]
v_mfma_f32_16x16x32_bf16 v[36:39], a[16:19], v[104:107], v[36:39]
s_waitcnt vmcnt(9)
v_mfma_f32_16x16x32_bf16 v[40:43], a[40:43], v[108:111], v[40:43]
buffer_load_dwordx4 a[72:75], v228, s[8:11], s39 offen offset:1024
v_mfma_f32_16x16x32_bf16 v[40:43], a[20:23], v[112:115], v[40:43]
ds_read_b64 v[244:245], v235 offset:0
ds_read_b64 v[246:247], v235 offset:32
v_mfma_f32_16x16x32_bf16 v[40:43], a[0:3], v[116:119], v[40:43]
ds_read_b64 v[248:249], v235 offset:64
ds_read_b64 v[250:251], v235 offset:96
v_mfma_f32_16x16x32_bf16 v[44:47], a[4:7], v[116:119], v[44:47]
ds_read_b64 v[252:253], v235 offset:128
ds_write_b128 v238, v[20:23] offset:5120
v_mfma_f32_16x16x32_bf16 v[44:47], a[24:27], v[112:115], v[44:47]
buffer_load_dwordx4 a[76:79], v229, s[8:11], s39 offen offset:1024
v_mfma_f32_16x16x32_bf16 v[44:47], a[44:47], v[108:111], v[44:47]
ds_write_b128 v238, v[24:27] offset:6144
v_mfma_f32_16x16x32_bf16 v[48:51], a[48:51], v[108:111], v[48:51]
v_mfma_f32_16x16x32_bf16 v[48:51], a[28:31], v[112:115], v[48:51]
s_add_u32 s28, s66, 4194304
s_addc_u32 s29, s67, 0
v_mfma_f32_16x16x32_bf16 v[48:51], a[8:11], v[116:119], v[48:51]
s_and_b32 s29, s29, 0xffff
ds_write_b128 v238, v[28:31] offset:7168
s_mov_b32 s30, 2621440
v_mfma_f32_16x16x32_bf16 v[52:55], a[12:15], v[116:119], v[52:55]
buffer_load_dwordx4 a[80:83], v228, s[8:11], s39 offen offset:2048
v_mfma_f32_16x16x32_bf16 v[52:55], a[32:35], v[112:115], v[52:55]
s_mov_b32 s31, 0x20000
ds_write_b128 v238, v[32:35] offset:8192
v_mfma_f32_16x16x32_bf16 v[52:55], a[52:55], v[108:111], v[52:55]
v_mfma_f32_16x16x32_bf16 v[56:59], a[56:59], v[108:111], v[56:59]
ds_write_b128 v238, v[36:39] offset:9216
v_mfma_f32_16x16x32_bf16 v[56:59], a[36:39], v[112:115], v[56:59]
v_mfma_f32_16x16x32_bf16 v[56:59], a[16:19], v[116:119], v[56:59]
s_waitcnt vmcnt(5)
v_mfma_f32_16x16x32_bf16 v[60:63], a[40:43], v[120:123], v[60:63]
v_readfirstlane_b32 s79, v242
v_mfma_f32_16x16x32_bf16 v[60:63], a[20:23], v[124:127], v[60:63]
s_cmp_eq_u32 s79, 0
s_cselect_b32 s14, 0, s14
v_mfma_f32_16x16x32_bf16 v[60:63], a[0:3], v[128:131], v[60:63]
buffer_load_dwordx4 v[184:187], v216, s[12:15], s74 offen offset:0
v_mfma_f32_16x16x32_bf16 v[64:67], a[4:7], v[128:131], v[64:67]
v_mfma_f32_16x16x32_bf16 v[64:67], a[24:27], v[124:127], v[64:67]
v_mfma_f32_16x16x32_bf16 v[64:67], a[44:47], v[120:123], v[64:67]
ds_write_b128 v239, v[40:43] offset:10240
v_mfma_f32_16x16x32_bf16 v[68:71], a[48:51], v[120:123], v[68:71]
buffer_load_dwordx4 v[188:191], v216, s[12:15], s74 offen offset:1024
v_mfma_f32_16x16x32_bf16 v[68:71], a[28:31], v[124:127], v[68:71]
ds_write_b128 v239, v[44:47] offset:11264
v_mfma_f32_16x16x32_bf16 v[68:71], a[8:11], v[128:131], v[68:71]
Lch2_2:
Lpad26:
s_cbranch_execz Lret2
v_mfma_f32_16x16x32_bf16 v[72:75], a[12:15], v[128:131], v[72:75]
ds_write_b128 v239, v[48:51] offset:12288
v_mfma_f32_16x16x32_bf16 v[72:75], a[32:35], v[124:127], v[72:75]
buffer_load_dwordx4 v[192:195], v216, s[12:15], s74 offen offset:2048
v_mfma_f32_16x16x32_bf16 v[72:75], a[52:55], v[120:123], v[72:75]
ds_write_b128 v239, v[52:55] offset:13312
v_mfma_f32_16x16x32_bf16 v[76:79], a[56:59], v[120:123], v[76:79]
v_mfma_f32_16x16x32_bf16 v[76:79], a[36:39], v[124:127], v[76:79]
ds_write_b128 v239, v[56:59] offset:14336
v_mfma_f32_16x16x32_bf16 v[76:79], a[16:19], v[128:131], v[76:79]
s_waitcnt lgkmcnt(5)
v_mfma_f32_16x16x32_bf16 v[0:3], a[40:43], v[132:135], v[0:3]
buffer_load_dwordx4 v[196:199], v216, s[12:15], s74 offen offset:3072
v_lshlrev_b32 v80, 16, v244
v_mfma_f32_16x16x32_bf16 v[0:3], a[20:23], v[136:139], v[0:3]
v_and_b32 v81, 0xffff0000, v244
v_lshlrev_b32 v82, 16, v245
v_mfma_f32_16x16x32_bf16 v[0:3], a[0:3], v[140:143], v[0:3]
v_and_b32 v83, 0xffff0000, v245
v_lshlrev_b32 v84, 16, v246
v_and_b32 v85, 0xffff0000, v246
v_mfma_f32_16x16x32_bf16 v[4:7], a[4:7], v[140:143], v[4:7]
buffer_load_dwordx4 v[200:203], v216, s[12:15], s76 offen offset:0
v_mfma_f32_16x16x32_bf16 v[4:7], a[24:27], v[136:139], v[4:7]
ds_write_b128 v240, v[60:63] offset:15360
v_lshlrev_b32 v86, 16, v247
v_and_b32 v87, 0xffff0000, v247
v_mfma_f32_16x16x32_bf16 v[4:7], a[44:47], v[132:135], v[4:7]
v_lshlrev_b32 v88, 16, v248
ds_write_b128 v240, v[64:67] offset:16384
v_mfma_f32_16x16x32_bf16 v[8:11], a[48:51], v[132:135], v[8:11]
v_and_b32 v89, 0xffff0000, v248
v_lshlrev_b32 v90, 16, v249
v_mfma_f32_16x16x32_bf16 v[8:11], a[28:31], v[136:139], v[8:11]
buffer_load_dwordx4 a[84:87], v229, s[8:11], s39 offen offset:2048
v_mfma_f32_16x16x32_bf16 v[8:11], a[8:11], v[140:143], v[8:11]
v_and_b32 v91, 0xffff0000, v249
ds_write_b128 v240, v[68:71] offset:17408
v_mfma_f32_16x16x32_bf16 v[12:15], a[12:15], v[140:143], v[12:15]
v_lshlrev_b32 v92, 16, v250
v_and_b32 v93, 0xffff0000, v250
v_mfma_f32_16x16x32_bf16 v[12:15], a[32:35], v[136:139], v[12:15]
v_lshlrev_b32 v94, 16, v251
v_and_b32 v95, 0xffff0000, v251
v_mfma_f32_16x16x32_bf16 v[12:15], a[52:55], v[132:135], v[12:15]
buffer_load_dwordx4 a[88:91], v228, s[8:11], s39 offen offset:3072
v_mfma_f32_16x16x32_bf16 v[16:19], a[56:59], v[132:135], v[16:19]
ds_write_b128 v240, v[72:75] offset:18432
v_lshlrev_b32 v96, 16, v252
v_mfma_f32_16x16x32_bf16 v[16:19], a[36:39], v[136:139], v[16:19]
v_and_b32 v97, 0xffff0000, v252
v_lshlrev_b32 v98, 16, v253
v_mfma_f32_16x16x32_bf16 v[16:19], a[16:19], v[140:143], v[16:19]
ds_write_b128 v240, v[76:79] offset:19456
v_and_b32 v99, 0xffff0000, v253
buffer_load_dwordx4 a[92:95], v229, s[8:11], s39 offen offset:3072
s_add_u32 s39, s39, 4096
buffer_load_dwordx4 a[96:99], v228, s[8:11], s39 offen offset:0
s_waitcnt lgkmcnt(0)
s_barrier
ds_read_b128 v[20:23], v237 offset:5120
ds_read_b128 v[24:27], v237 offset:6144
ds_read_b128 v[28:31], v237 offset:7168
ds_read_b128 v[32:35], v237 offset:8192
ds_read_b128 v[36:39], v237 offset:9216
ds_read_b128 v[40:43], v237 offset:10240
ds_read_b128 v[44:47], v237 offset:11264
ds_read_b128 v[48:51], v237 offset:12288
ds_read_b128 v[52:55], v237 offset:13312
ds_read_b128 v[56:59], v237 offset:14336
ds_read_b128 v[60:63], v237 offset:15360
ds_read_b128 v[64:67], v237 offset:16384
ds_read_b128 v[68:71], v237 offset:17408
ds_read_b128 v[72:75], v237 offset:18432
ds_read_b128 v[76:79], v237 offset:19456
s_waitcnt lgkmcnt(10)
v_pk_add_f32 v[0:1], v[0:1], v[20:21]
buffer_load_dwordx4 a[100:103], v229, s[8:11], s39 offen offset:0
v_pk_add_f32 v[2:3], v[2:3], v[22:23]
v_pk_add_f32 v[4:5], v[4:5], v[24:25]
v_pk_add_f32 v[6:7], v[6:7], v[26:27]
v_pk_add_f32 v[8:9], v[8:9], v[28:29]
v_pk_add_f32 v[10:11], v[10:11], v[30:31]
v_pk_add_f32 v[12:13], v[12:13], v[32:33]
v_pk_add_f32 v[14:15], v[14:15], v[34:35]
v_pk_add_f32 v[16:17], v[16:17], v[36:37]
v_pk_add_f32 v[18:19], v[18:19], v[38:39]
s_waitcnt lgkmcnt(5)
v_pk_add_f32 v[0:1], v[0:1], v[40:41]
v_pk_add_f32 v[2:3], v[2:3], v[42:43]
v_pk_add_f32 v[4:5], v[4:5], v[44:45]
v_pk_add_f32 v[6:7], v[6:7], v[46:47]
v_pk_add_f32 v[8:9], v[8:9], v[48:49]
buffer_load_dwordx4 a[104:107], v228, s[8:11], s39 offen offset:1024
v_pk_add_f32 v[10:11], v[10:11], v[50:51]
v_pk_add_f32 v[12:13], v[12:13], v[52:53]
v_pk_add_f32 v[14:15], v[14:15], v[54:55]
v_pk_add_f32 v[16:17], v[16:17], v[56:57]
v_pk_add_f32 v[18:19], v[18:19], v[58:59]
s_waitcnt lgkmcnt(0)
v_pk_add_f32 v[0:1], v[0:1], v[60:61]
v_pk_add_f32 v[2:3], v[2:3], v[62:63]
v_pk_add_f32 v[4:5], v[4:5], v[64:65]
v_pk_add_f32 v[6:7], v[6:7], v[66:67]
v_pk_add_f32 v[8:9], v[8:9], v[68:69]
v_pk_add_f32 v[10:11], v[10:11], v[70:71]
v_pk_add_f32 v[12:13], v[12:13], v[72:73]
v_pk_add_f32 v[14:15], v[14:15], v[74:75]
v_pk_add_f32 v[16:17], v[16:17], v[76:77]
buffer_load_dwordx4 a[108:111], v229, s[8:11], s39 offen offset:1024
v_pk_add_f32 v[18:19], v[18:19], v[78:79]
s_cmp_lg_u32 s79, 0
s_cbranch_scc1 Lepok
Leplate:
v_cmp_gt_u32 vcc, 1, v242
s_mov_b32 s6, 0
s_cmp_eq_u64 vcc, 0
s_cbranch_scc1 Lok25
Lsp26:
s_sleep 2
global_load_dword v242, v230, s[66:67] sc1
s_waitcnt vmcnt(0)
v_cmp_gt_u32 vcc, 1, v242
s_add_u32 s6, s6, 1
s_cmp_gt_u32 s6, 200000
s_cbranch_scc1 Lok25
s_cmp_lg_u64 vcc, 0
s_cbranch_scc1 Lsp26
Lok25:
s_mov_b32 s14, 5242880
buffer_load_dwordx4 v[184:187], v216, s[12:15], s74 offen offset:0
buffer_load_dwordx4 v[188:191], v216, s[12:15], s74 offen offset:1024
buffer_load_dwordx4 v[192:195], v216, s[12:15], s74 offen offset:2048
buffer_load_dwordx4 v[196:199], v216, s[12:15], s74 offen offset:3072
buffer_load_dwordx4 v[200:203], v216, s[12:15], s76 offen offset:0
s_waitcnt vmcnt(0)
Lepok:
s_waitcnt vmcnt(7)
v_pk_add_f32 v[0:1], v[0:1], v[184:185]
v_pk_add_f32 v[2:3], v[2:3], v[186:187]
v_pk_add_f32 v[4:5], v[4:5], v[188:189]
v_pk_add_f32 v[6:7], v[6:7], v[190:191]
v_pk_add_f32 v[8:9], v[8:9], v[192:193]
v_pk_add_f32 v[10:11], v[10:11], v[194:195]
v_pk_add_f32 v[12:13], v[12:13], v[196:197]
v_pk_add_f32 v[14:15], v[14:15], v[198:199]
v_pk_add_f32 v[16:17], v[16:17], v[200:201]
v_pk_add_f32 v[18:19], v[18:19], v[202:203]
v_pk_fma_f32 v[80:81], v[144:145], v[0:1], v[80:81]
v_pk_fma_f32 v[82:83], v[146:147], v[2:3], v[82:83]
v_pk_fma_f32 v[84:85], v[148:149], v[4:5], v[84:85]
v_pk_fma_f32 v[86:87], v[150:151], v[6:7], v[86:87]
buffer_load_dwordx4 a[112:115], v228, s[8:11], s39 offen offset:2048
v_pk_fma_f32 v[88:89], v[152:153], v[8:9], v[88:89]
v_pk_fma_f32 v[90:91], v[154:155], v[10:11], v[90:91]
v_pk_fma_f32 v[92:93], v[156:157], v[12:13], v[92:93]
v_pk_fma_f32 v[94:95], v[158:159], v[14:15], v[94:95]
v_pk_fma_f32 v[96:97], v[160:161], v[16:17], v[96:97]
v_pk_fma_f32 v[98:99], v[162:163], v[18:19], v[98:99]
v_cvt_pk_bf16_f32 v244, v80, v81
v_cvt_pk_bf16_f32 v245, v82, v83
v_cvt_pk_bf16_f32 v246, v84, v85
v_cvt_pk_bf16_f32 v247, v86, v87
v_cvt_pk_bf16_f32 v248, v88, v89
v_cvt_pk_bf16_f32 v249, v90, v91
v_cvt_pk_bf16_f32 v250, v92, v93
v_cvt_pk_bf16_f32 v251, v94, v95
v_cvt_pk_bf16_f32 v252, v96, v97
buffer_load_dwordx4 a[116:119], v229, s[8:11], s39 offen offset:2048
v_cvt_pk_bf16_f32 v253, v98, v99
v_lshlrev_b32 v80, 16, v244
v_and_b32 v81, 0xffff0000, v244
v_lshlrev_b32 v82, 16, v245
v_and_b32 v83, 0xffff0000, v245
v_lshlrev_b32 v84, 16, v246
v_and_b32 v85, 0xffff0000, v246
v_lshlrev_b32 v86, 16, v247
v_and_b32 v87, 0xffff0000, v247
v_lshlrev_b32 v88, 16, v248
v_and_b32 v89, 0xffff0000, v248
v_lshlrev_b32 v90, 16, v249
v_and_b32 v91, 0xffff0000, v249
v_lshlrev_b32 v92, 16, v250
v_and_b32 v93, 0xffff0000, v250
buffer_load_dwordx4 a[120:123], v228, s[8:11], s39 offen offset:3072
v_lshlrev_b32 v94, 16, v251
v_and_b32 v95, 0xffff0000, v251
v_lshlrev_b32 v96, 16, v252
v_and_b32 v97, 0xffff0000, v252
v_lshlrev_b32 v98, 16, v253
v_and_b32 v99, 0xffff0000, v253
v_pk_mul_f32 v[0:1], v[80:81], v[164:165]
v_pk_mul_f32 v[2:3], v[82:83], v[166:167]
v_pk_mul_f32 v[4:5], v[84:85], v[168:169]
v_pk_mul_f32 v[6:7], v[86:87], v[170:171]
v_pk_mul_f32 v[8:9], v[88:89], v[172:173]
v_pk_mul_f32 v[10:11], v[90:91], v[174:175]
v_pk_mul_f32 v[12:13], v[92:93], v[176:177]
v_pk_mul_f32 v[14:15], v[94:95], v[178:179]
v_pk_mul_f32 v[16:17], v[96:97], v[180:181]
buffer_load_dwordx4 a[124:127], v229, s[8:11], s39 offen offset:3072
s_add_u32 s39, s39, 4096
v_pk_mul_f32 v[18:19], v[98:99], v[182:183]
v_cvt_pk_bf16_f32 v52, v0, v1
v_cvt_pk_bf16_f32 v53, v2, v3
v_cvt_pk_bf16_f32 v54, v4, v5
v_cvt_pk_bf16_f32 v55, v6, v7
v_cvt_pk_bf16_f32 v56, v8, v9
v_cvt_pk_bf16_f32 v57, v10, v11
v_cvt_pk_bf16_f32 v58, v12, v13
v_cvt_pk_bf16_f32 v59, v14, v15
v_cvt_pk_bf16_f32 v60, v16, v17
v_cvt_pk_bf16_f32 v61, v18, v19
s_bitcmp1_b32 s61, 0
s_cbranch_scc1 Lxmodd
buffer_store_dwordx4 v[52:55], v216, s[28:31], s77 offen sc1
buffer_store_dwordx4 v[56:59], v216, s[28:31], s77 offen offset:1024 sc1
buffer_store_dwordx2 v[60:61], v254, s[28:31], s77 offen offset:2048 sc1
s_branch Lxmdone
Lxmodd:
buffer_store_dwordx2 v[52:53], v254, s[28:31], s77 offen offset:512 sc1
buffer_store_dwordx4 v[54:57], v216, s[28:31], s77 offen offset:1024 sc1
buffer_store_dwordx4 v[58:61], v216, s[28:31], s77 offen offset:2048 sc1
Lxmdone:
v_pk_add_f32 v[64:65], v[80:81], v[82:83]
v_pk_add_f32 v[64:65], v[64:65], v[84:85]
v_pk_add_f32 v[64:65], v[64:65], v[86:87]
v_pk_add_f32 v[64:65], v[64:65], v[88:89]
v_pk_add_f32 v[64:65], v[64:65], v[90:91]
v_pk_add_f32 v[64:65], v[64:65], v[92:93]
v_pk_add_f32 v[64:65], v[64:65], v[94:95]
v_pk_add_f32 v[64:65], v[64:65], v[96:97]
v_pk_add_f32 v[64:65], v[64:65], v[98:99]
v_add_f32 v64, v64, v65
v_mov_b32 v66, v64
s_nop 1
v_permlane32_swap_b32 v64, v66
v_add_f32 v64, v64, v66
v_mov_b32 v66, v64
s_nop 1
v_permlane16_swap_b32 v64, v66
v_add_f32 v64, v64, v66
v_mul_f32 v64, 0x3c4ccccd, v64
v_pk_add_f32 v[80:81], v[80:81], v[64:65] op_sel_hi:[1,0] neg_lo:[0,1] neg_hi:[0,1]
v_pk_add_f32 v[82:83], v[82:83], v[64:65] op_sel_hi:[1,0] neg_lo:[0,1] neg_hi:[0,1]
v_pk_add_f32 v[84:85], v[84:85], v[64:65] op_sel_hi:[1,0] neg_lo:[0,1] neg_hi:[0,1]
v_pk_add_f32 v[86:87], v[86:87], v[64:65] op_sel_hi:[1,0] neg_lo:[0,1] neg_hi:[0,1]
v_pk_add_f32 v[88:89], v[88:89], v[64:65] op_sel_hi:[1,0] neg_lo:[0,1] neg_hi:[0,1]
v_pk_add_f32 v[90:91], v[90:91], v[64:65] op_sel_hi:[1,0] neg_lo:[0,1] neg_hi:[0,1]
v_pk_add_f32 v[92:93], v[92:93], v[64:65] op_sel_hi:[1,0] neg_lo:[0,1] neg_hi:[0,1]
v_pk_add_f32 v[94:95], v[94:95], v[64:65] op_sel_hi:[1,0] neg_lo:[0,1] neg_hi:[0,1]
v_pk_add_f32 v[96:97], v[96:97], v[64:65] op_sel_hi:[1,0] neg_lo:[0,1] neg_hi:[0,1]
v_pk_add_f32 v[98:99], v[98:99], v[64:65] op_sel_hi:[1,0] neg_lo:[0,1] neg_hi:[0,1]
v_pk_mul_f32 v[66:67], v[80:81], v[80:81]
v_pk_fma_f32 v[66:67], v[82:83], v[82:83], v[66:67]
v_pk_fma_f32 v[66:67], v[84:85], v[84:85], v[66:67]
v_pk_fma_f32 v[66:67], v[86:87], v[86:87], v[66:67]
v_pk_fma_f32 v[66:67], v[88:89], v[88:89], v[66:67]
v_pk_fma_f32 v[66:67], v[90:91], v[90:91], v[66:67]
v_pk_fma_f32 v[66:67], v[92:93], v[92:93], v[66:67]
v_pk_fma_f32 v[66:67], v[94:95], v[94:95], v[66:67]
v_pk_fma_f32 v[66:67], v[96:97], v[96:97], v[66:67]
v_pk_fma_f32 v[66:67], v[98:99], v[98:99], v[66:67]
v_add_f32 v65, v66, v67
v_mov_b32 v66, v65
s_nop 1
v_permlane32_swap_b32 v65, v66
v_add_f32 v65, v65, v66
v_mov_b32 v66, v65
s_nop 1
v_permlane16_swap_b32 v65, v66
v_add_f32 v65, v65, v66
s_mov_b64 exec, 0xffff
buffer_store_dwordx2 v[64:65], v216, s[16:19], s78 offen sc1
s_mov_b64 exec, -1
v_lshrrev_b32 v68, 3, v234
v_mul_u32_u24 v68, 1280, v68
v_add3_u32 v68, v68, v236, s44
ds_read_b128 v[80:83], v68 offset:0
ds_read_b128 v[84:87], v68 offset:64
ds_read_b128 v[88:91], v68 offset:128
ds_read_b128 v[92:95], v68 offset:192
buffer_load_dwordx4 a[128:131], v228, s[8:11], s39 offen offset:0
ds_read_b128 v[96:99], v68 offset:256
ds_read_b128 v[100:103], v68 offset:320
ds_read_b128 v[104:107], v68 offset:384
ds_read_b128 v[108:111], v68 offset:448
buffer_load_dwordx4 a[132:135], v229, s[8:11], s39 offen offset:0
ds_read_b128 v[112:115], v68 offset:512
ds_read_b128 v[116:119], v68 offset:576
s_waitcnt lgkmcnt(4)
ds_read_b128 v[120:123], v68 offset:640
ds_read_b128 v[124:127], v68 offset:704
buffer_load_dwordx4 a[136:139], v228, s[8:11], s39 offen offset:1024
ds_read_b128 v[128:131], v68 offset:768
ds_read_b128 v[132:135], v68 offset:832
ds_read_b128 v[136:139], v68 offset:896
ds_read_b128 v[140:143], v68 offset:960
buffer_load_dwordx4 a[140:143], v229, s[8:11], s39 offen offset:1024
ds_read_b128 v[144:147], v68 offset:1024
ds_read_b128 v[148:151], v68 offset:1088
ds_read_b128 v[152:155], v68 offset:1152
ds_read_b128 v[156:159], v68 offset:1216
buffer_load_dwordx4 a[144:147], v228, s[8:11], s39 offen offset:2048
buffer_load_dwordx4 a[148:151], v229, s[8:11], s39 offen offset:2048
buffer_load_dwordx4 a[152:155], v228, s[8:11], s39 offen offset:3072
buffer_load_dwordx4 a[156:159], v229, s[8:11], s39 offen offset:3072
s_add_u32 s39, s39, 4096
buffer_load_dwordx4 a[160:163], v228, s[8:11], s39 offen offset:0
buffer_load_dwordx4 a[164:167], v229, s[8:11], s39 offen offset:0
buffer_load_dwordx4 a[168:171], v228, s[8:11], s39 offen offset:1024
s_lshl_b32 s6, s58, 3
s_lshl_b32 s7, s3, 1
s_add_u32 s6, s6, s7
s_mul_i32 s6, s6, 20480
v_add_u32 v224, s6, v216
v_add_u32 v225, 19456, v224
v_add_u32 v226, 65536, v216
s_lshl_b32 s34, s3, 11
s_mov_b32 s32, 0
s_lshl_b32 s42, s58, 13
s_add_u32 s43, s42, 4096
s_mov_b32 s12, s52
s_and_b32 s13, s53, 0xffff
s_mov_b32 s14, 3456
s_mov_b32 s15, 0x20000
v_lshlrev_b32 v69, 3, v233
s_lshl_b32 s49, s49, 5
s_add_u32 s24, s66, 19922944
s_addc_u32 s25, s67, 0
s_and_b32 s25, s25, 0xffff
s_mov_b32 s26, 2211840
s_mov_b32 s27, 0x20000
s_mul_i32 s33, s3, 14
s_cmp_eq_u32 s3, 3
s_cselect_b32 s33, 41, s33
s_lshl_b32 s33, s33, 10
s_mov_b32 s45, s33
s_waitcnt vmcnt(11) lgkmcnt(0)
s_barrier
s_cmp_lg_u32 s3, 0
s_cbranch_scc1 Lf5d
s_mov_b64 exec, 1
s_cmp_eq_u32 s68, 1
s_cbranch_scc1 Lf5l
Lf5f:
global_store_dword v255, v223, s[66:67] offset:0 sc1
s_branch Lf5e
Lf5l:
global_store_dword v255, v223, s[66:67] offset:0
Lf5e:
s_mov_b64 exec, -1
Lf5d:
s_cmp_ge_u32 s59, 14
s_cbranch_scc1 Lt4pre
Lt3:
buffer_load_dwordx4 a[172:175], v229, s[8:11], s39 offen offset:1024
buffer_load_dwordx4 a[176:179], v228, s[8:11], s39 offen offset:2048
buffer_load_dwordx4 a[180:183], v229, s[8:11], s39 offen offset:2048
buffer_load_dwordx4 a[184:187], v228, s[8:11], s39 offen offset:3072
buffer_load_dwordx4 a[188:191], v229, s[8:11], s39 offen offset:3072
s_add_u32 s39, s39, 4096
buffer_load_dwordx4 a[192:195], v228, s[8:11], s39 offen offset:0
buffer_load_dwordx4 a[196:199], v229, s[8:11], s39 offen offset:0
buffer_load_dwordx4 a[200:203], v228, s[8:11], s39 offen offset:1024
buffer_load_dwordx4 a[204:207], v229, s[8:11], s39 offen offset:1024
buffer_load_dwordx4 a[208:211], v228, s[8:11], s39 offen offset:2048
buffer_load_dwordx4 a[212:215], v229, s[8:11], s39 offen offset:2048
buffer_load_dwordx4 a[216:219], v228, s[8:11], s39 offen offset:3072
buffer_load_dwordx4 a[220:223], v229, s[8:11], s39 offen offset:3072
s_add_u32 s39, s39, 4096
buffer_load_dwordx2 v[70:71], v69, s[12:15], s49 offen offset:0
buffer_load_dwordx2 v[72:73], v69, s[12:15], s49 offen offset:32
s_mul_i32 s6, s61, 276480
v_add_u32 v228, s6, v216
s_add_u32 s6, s6, 55296
v_add_u32 v229, s6, v216
s_add_u32 s6, s6, 55296
v_add_u32 v230, s6, v216
s_add_u32 s6, s6, 55296
v_add_u32 v231, s6, v216
s_add_u32 s6, s6, 55296
v_add_u32 v232, s6, v216
s_mul_i32 s48, s3, 20480
s_add_u32 s48, s48, 81920
v_add_u32 v227, s48, v216
s_add_u32 s6, s45, 10240
global_load_dword v242, v241, s[66:67] sc1
s_waitcnt vmcnt(3) lgkmcnt(0)
v_mfma_f32_16x16x32_bf16 v[160:163], a[64:67], v[80:83], 0
v_mfma_f32_16x16x32_bf16 v[164:167], a[68:71], v[80:83], 0
v_mfma_f32_16x16x32_bf16 v[160:163], a[72:75], v[84:87], v[160:163]
v_mfma_f32_16x16x32_bf16 v[164:167], a[76:79], v[84:87], v[164:167]
v_mfma_f32_16x16x32_bf16 v[160:163], a[80:83], v[88:91], v[160:163]
v_mfma_f32_16x16x32_bf16 v[164:167], a[84:87], v[88:91], v[164:167]
v_mfma_f32_16x16x32_bf16 v[160:163], a[88:91], v[92:95], v[160:163]
v_mfma_f32_16x16x32_bf16 v[164:167], a[92:95], v[92:95], v[164:167]
v_mfma_f32_16x16x32_bf16 v[160:163], a[96:99], v[96:99], v[160:163]
v_mfma_f32_16x16x32_bf16 v[164:167], a[100:103], v[96:99], v[164:167]
v_mfma_f32_16x16x32_bf16 v[160:163], a[104:107], v[100:103], v[160:163]
v_mfma_f32_16x16x32_bf16 v[164:167], a[108:111], v[100:103], v[164:167]
v_mfma_f32_16x16x32_bf16 v[160:163], a[112:115], v[104:107], v[160:163]
v_mfma_f32_16x16x32_bf16 v[164:167], a[116:119], v[104:107], v[164:167]
v_mfma_f32_16x16x32_bf16 v[160:163], a[120:123], v[108:111], v[160:163]
v_mfma_f32_16x16x32_bf16 v[164:167], a[124:127], v[108:111], v[164:167]
v_mfma_f32_16x16x32_bf16 v[160:163], a[128:131], v[112:115], v[160:163]
v_mfma_f32_16x16x32_bf16 v[164:167], a[132:135], v[112:115], v[164:167]
v_mfma_f32_16x16x32_bf16 v[160:163], a[136:139], v[116:119], v[160:163]
v_mfma_f32_16x16x32_bf16 v[164:167], a[140:143], v[116:119], v[164:167]
s_waitcnt vmcnt(0)
v_cmp_gt_u32 vcc, 1, v242
s_mov_b32 s6, 0
s_cmp_eq_u64 vcc, 0
s_cbranch_scc1 Lok27
Lsp28:
s_sleep 2
global_load_dword v242, v241, s[66:67] sc1
s_waitcnt vmcnt(0)
v_cmp_gt_u32 vcc, 1, v242
s_add_u32 s6, s6, 1
s_cmp_gt_u32 s6, 200000
s_cbranch_scc1 Lok27
s_cmp_lg_u64 vcc, 0
s_cbranch_scc1 Lsp28
Lok27:
s_mov_b32 s32, 0
s_add_u32 m0, s34, 0
s_nop 0
buffer_load_dwordx4 v224, s[28:31], s32 offen offset:0 lds
buffer_load_dwordx4 v225, s[28:31], s32 offen offset:1024 lds
s_mov_b32 s32, 1024
s_add_u32 m0, s34, 8192
s_nop 0
buffer_load_dwordx4 v224, s[28:31], s32 offen offset:0 lds
buffer_load_dwordx4 v225, s[28:31], s32 offen offset:1024 lds
s_mov_b32 s32, 2048
s_add_u32 m0, s34, 16384
s_nop 0
buffer_load_dwordx4 v224, s[28:31], s32 offen offset:0 lds
buffer_load_dwordx4 v225, s[28:31], s32 offen offset:1024 lds
s_mov_b32 s32, 3072
s_add_u32 m0, s34, 24576
s_nop 0
buffer_load_dwordx4 v224, s[28:31], s32 offen offset:0 lds
buffer_load_dwordx4 v225, s[28:31], s32 offen offset:1024 lds
s_mov_b32 s32, 4096
s_add_u32 m0, s34, 32768
s_nop 0
buffer_load_dwordx4 v224, s[28:31], s32 offen offset:0 lds
buffer_load_dwordx4 v225, s[28:31], s32 offen offset:1024 lds
s_mov_b32 s32, 5120
s_add_u32 m0, s34, 40960
s_nop 0
buffer_load_dwordx4 v224, s[28:31], s32 offen offset:0 lds
buffer_load_dwordx4 v225, s[28:31], s32 offen offset:1024 lds
s_mov_b32 s32, 6144
s_add_u32 m0, s34, 49152
s_nop 0
buffer_load_dwordx4 v224, s[28:31], s32 offen offset:0 lds
buffer_load_dwordx4 v225, s[28:31], s32 offen offset:1024 lds
v_mfma_f32_16x16x32_bf16 v[160:163], a[144:147], v[120:123], v[160:163]
v_mfma_f32_16x16x32_bf16 v[164:167], a[148:151], v[120:123], v[164:167]
v_mfma_f32_16x16x32_bf16 v[160:163], a[152:155], v[124:127], v[160:163]
v_mfma_f32_16x16x32_bf16 v[164:167], a[156:159], v[124:127], v[164:167]
v_mfma_f32_16x16x32_bf16 v[160:163], a[160:163], v[128:131], v[160:163]
v_mfma_f32_16x16x32_bf16 v[164:167], a[164:167], v[128:131], v[164:167]
v_mfma_f32_16x16x32_bf16 v[160:163], a[168:171], v[132:135], v[160:163]
v_mfma_f32_16x16x32_bf16 v[164:167], a[172:175], v[132:135], v[164:167]
v_mfma_f32_16x16x32_bf16 v[160:163], a[176:179], v[136:139], v[160:163]
v_mfma_f32_16x16x32_bf16 v[164:167], a[180:183], v[136:139], v[164:167]
v_mfma_f32_16x16x32_bf16 v[160:163], a[184:187], v[140:143], v[160:163]
v_mfma_f32_16x16x32_bf16 v[164:167], a[188:191], v[140:143], v[164:167]
v_mfma_f32_16x16x32_bf16 v[160:163], a[192:195], v[144:147], v[160:163]
v_mfma_f32_16x16x32_bf16 v[164:167], a[196:199], v[144:147], v[164:167]
v_mfma_f32_16x16x32_bf16 v[160:163], a[200:203], v[148:151], v[160:163]
v_mfma_f32_16x16x32_bf16 v[164:167], a[204:207], v[148:151], v[164:167]
v_mfma_f32_16x16x32_bf16 v[160:163], a[208:211], v[152:155], v[160:163]
v_mfma_f32_16x16x32_bf16 v[164:167], a[212:215], v[152:155], v[164:167]
v_mfma_f32_16x16x32_bf16 v[160:163], a[216:219], v[156:159], v[160:163]
v_mfma_f32_16x16x32_bf16 v[164:167], a[220:223], v[156:159], v[164:167]
buffer_load_dwordx4 a[224:227], v228, s[24:27], s33 offen offset:0
buffer_load_dwordx4 a[228:231], v229, s[24:27], s33 offen offset:0
buffer_load_dwordx4 a[232:235], v230, s[24:27], s33 offen offset:0
buffer_load_dwordx4 a[236:239], v231, s[24:27], s33 offen offset:0
buffer_load_dwordx4 a[240:243], v232, s[24:27], s33 offen offset:0
buffer_load_dwordx4 a[244:247], v228, s[24:27], s33 offen offset:1024
s_waitcnt vmcnt(18)
s_barrier
ds_read_b128 a[0:3], v216 offset:0
ds_read_b128 a[4:7], v216 offset:1024
ds_read_b128 a[8:11], v216 offset:2048
ds_read_b128 a[12:15], v216 offset:3072
ds_read_b128 a[16:19], v216 offset:4096
ds_read_b128 a[20:23], v216 offset:5120
ds_read_b128 a[24:27], v216 offset:6144
ds_read_b128 a[28:31], v216 offset:7168
s_waitcnt vmcnt(14) lgkmcnt(0)
v_mfma_f32_16x16x32_bf16 v[0:3], a[64:67], a[0:3], 0
s_barrier
v_mfma_f32_16x16x32_bf16 v[4:7], a[68:71], a[0:3], 0
ds_read_b128 a[32:35], v216 offset:8192
ds_read_b128 a[36:39], v216 offset:9216
v_mfma_f32_16x16x32_bf16 v[12:15], a[68:71], a[4:7], 0
buffer_load_dwordx4 v[80:83], v216, s[16:19], s42 offen offset:0
v_mfma_f32_16x16x32_bf16 v[8:11], a[64:67], a[4:7], 0
ds_read_b128 a[40:43], v216 offset:10240
ds_read_b128 a[44:47], v216 offset:11264
v_mfma_f32_16x16x32_bf16 v[16:19], a[64:67], a[8:11], 0
buffer_load_dwordx4 v[84:87], v216, s[16:19], s42 offen offset:1024
v_mfma_f32_16x16x32_bf16 v[20:23], a[68:71], a[8:11], 0
ds_read_b128 a[48:51], v216 offset:12288
ds_read_b128 a[52:55], v216 offset:13312
v_mfma_f32_16x16x32_bf16 v[28:31], a[68:71], a[12:15], 0
buffer_load_dwordx4 v[88:91], v216, s[16:19], s42 offen offset:2048
v_mfma_f32_16x16x32_bf16 v[24:27], a[64:67], a[12:15], 0
s_mov_b32 s32, 7168
ds_read_b128 a[56:59], v216 offset:14336
ds_read_b128 a[60:63], v216 offset:15360
v_mfma_f32_16x16x32_bf16 v[32:35], a[64:67], a[16:19], 0
s_add_u32 m0, s34, 57344
v_mfma_f32_16x16x32_bf16 v[36:39], a[68:71], a[16:19], 0
v_mfma_f32_16x16x32_bf16 v[44:47], a[68:71], a[20:23], 0
buffer_load_dwordx4 v224, s[28:31], s32 offen offset:0 lds
v_mfma_f32_16x16x32_bf16 v[40:43], a[64:67], a[20:23], 0
v_mfma_f32_16x16x32_bf16 v[48:51], a[64:67], a[24:27], 0
buffer_load_dwordx4 v225, s[28:31], s32 offen offset:1024 lds
v_mfma_f32_16x16x32_bf16 v[52:55], a[68:71], a[24:27], 0
v_mfma_f32_16x16x32_bf16 v[60:63], a[68:71], a[28:31], 0
v_mfma_f32_16x16x32_bf16 v[56:59], a[64:67], a[28:31], 0
s_waitcnt lgkmcnt(0)
v_mfma_f32_16x16x32_bf16 v[0:3], a[72:75], a[32:35], v[0:3]
v_mfma_f32_16x16x32_bf16 v[4:7], a[76:79], a[32:35], v[4:7]
v_add_u32 v78, 16384, v254
ds_read2st64_b64 a[0:3], v78 offset0:0 offset1:1
v_mfma_f32_16x16x32_bf16 v[12:15], a[76:79], a[36:39], v[12:15]
buffer_load_dwordx4 v[92:95], v216, s[16:19], s42 offen offset:3072
v_mfma_f32_16x16x32_bf16 v[8:11], a[72:75], a[36:39], v[8:11]
ds_read2st64_b64 a[4:7], v78 offset0:2 offset1:3
ds_read2st64_b64 a[8:11], v78 offset0:4 offset1:5
v_mfma_f32_16x16x32_bf16 v[16:19], a[72:75], a[40:43], v[16:19]
buffer_load_dwordx4 v[96:99], v216, s[16:19], s43 offen offset:0
v_mfma_f32_16x16x32_bf16 v[20:23], a[76:79], a[40:43], v[20:23]
ds_read2st64_b64 a[12:15], v78 offset0:6 offset1:7
ds_read2st64_b64 a[16:19], v78 offset0:8 offset1:9
v_mfma_f32_16x16x32_bf16 v[28:31], a[76:79], a[44:47], v[28:31]
buffer_load_dwordx4 v[100:103], v216, s[16:19], s43 offen offset:1024
v_mfma_f32_16x16x32_bf16 v[24:27], a[72:75], a[44:47], v[24:27]
s_mov_b32 s32, 8192
ds_read2st64_b64 a[20:23], v78 offset0:10 offset1:11
ds_read2st64_b64 a[24:27], v78 offset0:12 offset1:13
v_mfma_f32_16x16x32_bf16 v[32:35], a[72:75], a[48:51], v[32:35]
s_add_u32 m0, s34, 65536
v_mfma_f32_16x16x32_bf16 v[36:39], a[76:79], a[48:51], v[36:39]
ds_read2st64_b64 a[28:31], v78 offset0:14 offset1:15
v_mfma_f32_16x16x32_bf16 v[44:47], a[76:79], a[52:55], v[44:47]
buffer_load_dwordx4 v224, s[28:31], s32 offen offset:0 lds
v_mfma_f32_16x16x32_bf16 v[40:43], a[72:75], a[52:55], v[40:43]
v_mfma_f32_16x16x32_bf16 v[48:51], a[72:75], a[56:59], v[48:51]
buffer_load_dwordx4 v225, s[28:31], s32 offen offset:1024 lds
v_mfma_f32_16x16x32_bf16 v[52:55], a[76:79], a[56:59], v[52:55]
v_mfma_f32_16x16x32_bf16 v[60:63], a[76:79], a[60:63], v[60:63]
v_mfma_f32_16x16x32_bf16 v[56:59], a[72:75], a[60:63], v[56:59]
s_waitcnt vmcnt(20) lgkmcnt(0)
v_mfma_f32_16x16x32_bf16 v[0:3], a[80:83], a[0:3], v[0:3]
s_barrier
v_mfma_f32_16x16x32_bf16 v[4:7], a[84:87], a[0:3], v[4:7]
ds_read_b128 a[32:35], v216 offset:24576
ds_read_b128 a[36:39], v216 offset:25600
v_mfma_f32_16x16x32_bf16 v[12:15], a[84:87], a[4:7], v[12:15]
buffer_load_dwordx4 v[104:107], v216, s[16:19], s43 offen offset:2048
v_mfma_f32_16x16x32_bf16 v[8:11], a[80:83], a[4:7], v[8:11]
ds_read_b128 a[40:43], v216 offset:26624
ds_read_b128 a[44:47], v216 offset:27648
v_mfma_f32_16x16x32_bf16 v[16:19], a[80:83], a[8:11], v[16:19]
s_add_u32 s8, s66, 23068672
s_addc_u32 s9, s67, 0
v_mfma_f32_16x16x32_bf16 v[20:23], a[84:87], a[8:11], v[20:23]
s_and_b32 s9, s9, 0xffff
ds_read_b128 a[48:51], v216 offset:28672
ds_read_b128 a[52:55], v216 offset:29696
v_mfma_f32_16x16x32_bf16 v[28:31], a[84:87], a[12:15], v[28:31]
buffer_load_dwordx4 v[108:111], v216, s[16:19], s43 offen offset:3072
v_mfma_f32_16x16x32_bf16 v[24:27], a[80:83], a[12:15], v[24:27]
s_mov_b32 s10, 7077888
ds_read_b128 a[56:59], v216 offset:30720
ds_read_b128 a[60:63], v216 offset:31744
v_mfma_f32_16x16x32_bf16 v[32:35], a[80:83], a[16:19], v[32:35]
s_mov_b32 s11, 0x20000
s_mov_b32 s32, 9216
s_lshl_b32 s6, s59, 2
v_mfma_f32_16x16x32_bf16 v[36:39], a[84:87], a[16:19], v[36:39]
s_add_u32 m0, s34, 73728
s_add_u32 s6, s6, s3
v_mfma_f32_16x16x32_bf16 v[44:47], a[84:87], a[20:23], v[44:47]
buffer_load_dwordx4 v224, s[28:31], s32 offen offset:0 lds
Lch2_3:
Lpad27:
s_cbranch_execz Lret2
v_mfma_f32_16x16x32_bf16 v[40:43], a[80:83], a[20:23], v[40:43]
s_cmp_lt_u32 s6, 54
s_cselect_b32 s10, s10, 0
v_mfma_f32_16x16x32_bf16 v[48:51], a[80:83], a[24:27], v[48:51]
s_lshl_b32 s6, s6, 10
s_mul_i32 s7, s58, 442368
s_add_u32 s77, s6, s7
v_mfma_f32_16x16x32_bf16 v[52:55], a[84:87], a[24:27], v[52:55]
buffer_load_dwordx4 v225, s[28:31], s32 offen offset:1024 lds
v_mfma_f32_16x16x32_bf16 v[60:63], a[84:87], a[28:31], v[60:63]
v_mfma_f32_16x16x32_bf16 v[56:59], a[80:83], a[28:31], v[56:59]
s_waitcnt lgkmcnt(0)
v_mfma_f32_16x16x32_bf16 v[0:3], a[88:91], a[32:35], v[0:3]
v_mfma_f32_16x16x32_bf16 v[4:7], a[92:95], a[32:35], v[4:7]
ds_read_b128 a[0:3], v216 offset:32768
ds_read_b128 a[4:7], v216 offset:33792
v_mfma_f32_16x16x32_bf16 v[12:15], a[92:95], a[36:39], v[12:15]
s_mov_b32 s32, 10240
v_cmp_gt_u32 vcc, 8, v234
s_nop 0
v_mfma_f32_16x16x32_bf16 v[8:11], a[88:91], a[36:39], v[8:11]
s_add_u32 m0, s34, 0
ds_read_b128 a[8:11], v216 offset:34816
v_mov_b32_dpp v76, v160 row_ror:8 row_mask:0xf bank_mask:0xf
v_mfma_f32_16x16x32_bf16 v[16:19], a[88:91], a[40:43], v[16:19]
ds_read_b128 a[12:15], v216 offset:35840
v_cndmask_b32 v168, v160, v76, vcc
v_mfma_f32_16x16x32_bf16 v[20:23], a[92:95], a[40:43], v[20:23]
ds_read_b128 a[16:19], v216 offset:36864
v_cndmask_b32 v160, v76, v160, vcc
v_mfma_f32_16x16x32_bf16 v[28:31], a[92:95], a[44:47], v[28:31]
ds_read_b128 a[20:23], v216 offset:37888
v_lshlrev_b32 v77, 16, v70
v_mfma_f32_16x16x32_bf16 v[24:27], a[88:91], a[44:47], v[24:27]
ds_read_b128 a[24:27], v216 offset:38912
v_add_f32 v168, v168, v77
v_mfma_f32_16x16x32_bf16 v[32:35], a[88:91], a[48:51], v[32:35]
ds_read_b128 a[28:31], v216 offset:39936
v_mov_b32_dpp v76, v161 row_ror:8 row_mask:0xf bank_mask:0xf
v_mfma_f32_16x16x32_bf16 v[36:39], a[92:95], a[48:51], v[36:39]
buffer_load_dwordx4 v224, s[28:31], s32 offen offset:0 lds
v_mfma_f32_16x16x32_bf16 v[44:47], a[92:95], a[52:55], v[44:47]
v_cndmask_b32 v169, v161, v76, vcc
v_cndmask_b32 v161, v76, v161, vcc
v_mfma_f32_16x16x32_bf16 v[40:43], a[88:91], a[52:55], v[40:43]
buffer_load_dwordx4 v224, s[28:31], s32 offen offset:1024 lds
v_mfma_f32_16x16x32_bf16 v[48:51], a[88:91], a[56:59], v[48:51]
v_and_b32 v77, 0xffff0000, v70
v_add_f32 v169, v169, v77
v_mfma_f32_16x16x32_bf16 v[52:55], a[92:95], a[56:59], v[52:55]
v_mov_b32_dpp v76, v162 row_ror:8 row_mask:0xf bank_mask:0xf
v_cndmask_b32 v170, v162, v76, vcc
v_mfma_f32_16x16x32_bf16 v[60:63], a[92:95], a[60:63], v[60:63]
v_cndmask_b32 v162, v76, v162, vcc
v_mfma_f32_16x16x32_bf16 v[56:59], a[88:91], a[60:63], v[56:59]
s_waitcnt vmcnt(22) lgkmcnt(0)
v_mfma_f32_16x16x32_bf16 v[0:3], a[96:99], a[0:3], v[0:3]
s_barrier
v_mfma_f32_16x16x32_bf16 v[4:7], a[100:103], a[0:3], v[4:7]
ds_read_b128 a[32:35], v216 offset:40960
ds_read_b128 a[36:39], v216 offset:41984
v_mfma_f32_16x16x32_bf16 v[12:15], a[100:103], a[4:7], v[12:15]
s_mov_b32 s32, 12288
v_lshlrev_b32 v77, 16, v71
v_add_f32 v170, v170, v77
v_mfma_f32_16x16x32_bf16 v[8:11], a[96:99], a[4:7], v[8:11]
s_add_u32 m0, s34, 8192
ds_read_b128 a[40:43], v216 offset:43008
v_mov_b32_dpp v76, v163 row_ror:8 row_mask:0xf bank_mask:0xf
v_mfma_f32_16x16x32_bf16 v[16:19], a[96:99], a[8:11], v[16:19]
ds_read_b128 a[44:47], v216 offset:44032
v_cndmask_b32 v171, v163, v76, vcc
v_mfma_f32_16x16x32_bf16 v[20:23], a[100:103], a[8:11], v[20:23]
ds_read_b128 a[48:51], v216 offset:45056
v_cndmask_b32 v163, v76, v163, vcc
v_mfma_f32_16x16x32_bf16 v[28:31], a[100:103], a[12:15], v[28:31]
ds_read_b128 a[52:55], v216 offset:46080
v_and_b32 v77, 0xffff0000, v71
v_mfma_f32_16x16x32_bf16 v[24:27], a[96:99], a[12:15], v[24:27]
ds_read_b128 a[56:59], v216 offset:47104
v_add_f32 v171, v171, v77
v_mfma_f32_16x16x32_bf16 v[32:35], a[96:99], a[16:19], v[32:35]
ds_read_b128 a[60:63], v216 offset:48128
v_mov_b32_dpp v76, v164 row_ror:8 row_mask:0xf bank_mask:0xf
v_mfma_f32_16x16x32_bf16 v[36:39], a[100:103], a[16:19], v[36:39]
buffer_load_dwordx4 v224, s[28:31], s32 offen offset:0 lds
v_mfma_f32_16x16x32_bf16 v[44:47], a[100:103], a[20:23], v[44:47]
v_cndmask_b32 v172, v164, v76, vcc
v_cndmask_b32 v164, v76, v164, vcc
v_mfma_f32_16x16x32_bf16 v[40:43], a[96:99], a[20:23], v[40:43]
buffer_load_dwordx4 v224, s[28:31], s32 offen offset:1024 lds
v_mfma_f32_16x16x32_bf16 v[48:51], a[96:99], a[24:27], v[48:51]
v_lshlrev_b32 v77, 16, v72
v_add_f32 v172, v172, v77
v_mfma_f32_16x16x32_bf16 v[52:55], a[100:103], a[24:27], v[52:55]
v_mov_b32_dpp v76, v165 row_ror:8 row_mask:0xf bank_mask:0xf
v_cndmask_b32 v173, v165, v76, vcc
v_mfma_f32_16x16x32_bf16 v[60:63], a[100:103], a[28:31], v[60:63]
v_mfma_f32_16x16x32_bf16 v[56:59], a[96:99], a[28:31], v[56:59]
s_waitcnt lgkmcnt(0)
v_mfma_f32_16x16x32_bf16 v[0:3], a[104:107], a[32:35], v[0:3]
v_mfma_f32_16x16x32_bf16 v[4:7], a[108:111], a[32:35], v[4:7]
ds_read_b128 a[0:3], v216 offset:49152
ds_read_b128 a[4:7], v216 offset:50176
v_mfma_f32_16x16x32_bf16 v[12:15], a[108:111], a[36:39], v[12:15]
s_mov_b32 s32, 14336
v_cndmask_b32 v165, v76, v165, vcc
v_and_b32 v77, 0xffff0000, v72
v_mfma_f32_16x16x32_bf16 v[8:11], a[104:107], a[36:39], v[8:11]
s_add_u32 m0, s34, 16384
ds_read_b128 a[8:11], v216 offset:51200
v_add_f32 v173, v173, v77
v_mfma_f32_16x16x32_bf16 v[16:19], a[104:107], a[40:43], v[16:19]
ds_read_b128 a[12:15], v216 offset:52224
v_mov_b32_dpp v76, v166 row_ror:8 row_mask:0xf bank_mask:0xf
v_mfma_f32_16x16x32_bf16 v[20:23], a[108:111], a[40:43], v[20:23]
ds_read_b128 a[16:19], v216 offset:53248
v_cndmask_b32 v174, v166, v76, vcc
v_mfma_f32_16x16x32_bf16 v[28:31], a[108:111], a[44:47], v[28:31]
ds_read_b128 a[20:23], v216 offset:54272
v_cndmask_b32 v166, v76, v166, vcc
v_mfma_f32_16x16x32_bf16 v[24:27], a[104:107], a[44:47], v[24:27]
ds_read_b128 a[24:27], v216 offset:55296
v_lshlrev_b32 v77, 16, v73
v_mfma_f32_16x16x32_bf16 v[32:35], a[104:107], a[48:51], v[32:35]
ds_read_b128 a[28:31], v216 offset:56320
v_add_f32 v174, v174, v77
v_mfma_f32_16x16x32_bf16 v[36:39], a[108:111], a[48:51], v[36:39]
buffer_load_dwordx4 v224, s[28:31], s32 offen offset:0 lds
v_mfma_f32_16x16x32_bf16 v[44:47], a[108:111], a[52:55], v[44:47]
buffer_load_dwordx4 v224, s[28:31], s32 offen offset:1024 lds
v_mfma_f32_16x16x32_bf16 v[40:43], a[104:107], a[52:55], v[40:43]
v_mov_b32_dpp v76, v167 row_ror:8 row_mask:0xf bank_mask:0xf
v_cndmask_b32 v175, v167, v76, vcc
v_mfma_f32_16x16x32_bf16 v[48:51], a[104:107], a[56:59], v[48:51]
buffer_load_dwordx4 a[248:251], v229, s[24:27], s33 offen offset:1024
v_mfma_f32_16x16x32_bf16 v[52:55], a[108:111], a[56:59], v[52:55]
v_cndmask_b32 v167, v76, v167, vcc
v_and_b32 v77, 0xffff0000, v73
v_mfma_f32_16x16x32_bf16 v[60:63], a[108:111], a[60:63], v[60:63]
v_add_f32 v175, v175, v77
v_mfma_f32_16x16x32_bf16 v[56:59], a[104:107], a[60:63], v[56:59]
s_waitcnt vmcnt(9) lgkmcnt(0)
v_mfma_f32_16x16x32_bf16 v[0:3], a[112:115], a[0:3], v[0:3]
s_barrier
v_mfma_f32_16x16x32_bf16 v[4:7], a[116:119], a[0:3], v[4:7]
v_add_u32 v78, 57344, v254
ds_read2st64_b64 a[32:35], v78 offset0:0 offset1:1
ds_read2st64_b64 a[36:39], v78 offset0:2 offset1:3
v_mfma_f32_16x16x32_bf16 v[12:15], a[116:119], a[4:7], v[12:15]
s_mov_b32 s32, 16384
v_add_f32 v112, v80, v82
v_add_f32 v112, v112, v84
v_mfma_f32_16x16x32_bf16 v[8:11], a[112:115], a[4:7], v[8:11]
s_add_u32 m0, s34, 24576
ds_read2st64_b64 a[40:43], v78 offset0:4 offset1:5
ds_read2st64_b64 a[44:47], v78 offset0:6 offset1:7
v_add_f32 v112, v112, v86
v_mfma_f32_16x16x32_bf16 v[16:19], a[112:115], a[8:11], v[16:19]
buffer_load_dwordx4 v224, s[28:31], s32 offen offset:0 lds
v_mfma_f32_16x16x32_bf16 v[20:23], a[116:119], a[8:11], v[20:23]
ds_read2st64_b64 a[48:51], v78 offset0:8 offset1:9
v_add_f32 v112, v112, v88
v_mfma_f32_16x16x32_bf16 v[28:31], a[116:119], a[12:15], v[28:31]
ds_read2st64_b64 a[52:55], v78 offset0:10 offset1:11
v_add_f32 v112, v112, v90
v_mfma_f32_16x16x32_bf16 v[24:27], a[112:115], a[12:15], v[24:27]
ds_read2st64_b64 a[56:59], v78 offset0:12 offset1:13
v_add_f32 v112, v112, v92
v_mfma_f32_16x16x32_bf16 v[32:35], a[112:115], a[16:19], v[32:35]
ds_read2st64_b64 a[60:63], v78 offset0:14 offset1:15
v_add_f32 v112, v112, v94
v_mfma_f32_16x16x32_bf16 v[36:39], a[116:119], a[16:19], v[36:39]
buffer_load_dwordx4 v224, s[28:31], s32 offen offset:1024 lds
v_mfma_f32_16x16x32_bf16 v[44:47], a[116:119], a[20:23], v[44:47]
v_mul_f32 v112, 0x3e000000, v112
v_sub_f32 v80, v80, v112
v_mfma_f32_16x16x32_bf16 v[40:43], a[112:115], a[20:23], v[40:43]
buffer_load_dwordx4 a[252:255], v230, s[24:27], s33 offen offset:1024
v_mfma_f32_16x16x32_bf16 v[48:51], a[112:115], a[24:27], v[48:51]
v_sub_f32 v82, v82, v112
v_sub_f32 v84, v84, v112
v_mfma_f32_16x16x32_bf16 v[52:55], a[116:119], a[24:27], v[52:55]
v_sub_f32 v86, v86, v112
v_sub_f32 v88, v88, v112
v_mfma_f32_16x16x32_bf16 v[60:63], a[116:119], a[28:31], v[60:63]
buffer_load_dwordx4 v[176:179], v231, s[24:27], s33 offen offset:1024
v_mfma_f32_16x16x32_bf16 v[56:59], a[112:115], a[28:31], v[56:59]
v_sub_f32 v90, v90, v112
v_sub_f32 v92, v92, v112
s_waitcnt lgkmcnt(0)
v_mfma_f32_16x16x32_bf16 v[0:3], a[120:123], a[32:35], v[0:3]
v_mfma_f32_16x16x32_bf16 v[4:7], a[124:127], a[32:35], v[4:7]
ds_read_b128 a[0:3], v226 offset:0
ds_read_b128 a[4:7], v226 offset:1024
v_mfma_f32_16x16x32_bf16 v[12:15], a[124:127], a[36:39], v[12:15]
s_mov_b32 s32, 18432
v_sub_f32 v94, v94, v112
v_mul_f32 v128, v80, v80
v_mfma_f32_16x16x32_bf16 v[8:11], a[120:123], a[36:39], v[8:11]
s_add_u32 m0, s34, 32768
ds_read_b128 a[8:11], v226 offset:2048
v_fmac_f32 v128, v82, v82
v_mfma_f32_16x16x32_bf16 v[16:19], a[120:123], a[40:43], v[16:19]
ds_read_b128 a[12:15], v226 offset:3072
v_fmac_f32 v128, v84, v84
v_mfma_f32_16x16x32_bf16 v[20:23], a[124:127], a[40:43], v[20:23]
ds_read_b128 a[16:19], v226 offset:4096
v_fmac_f32 v128, v86, v86
v_mfma_f32_16x16x32_bf16 v[28:31], a[124:127], a[44:47], v[28:31]
ds_read_b128 a[20:23], v226 offset:5120
v_fmac_f32 v128, v88, v88
v_mfma_f32_16x16x32_bf16 v[24:27], a[120:123], a[44:47], v[24:27]
ds_read_b128 a[24:27], v226 offset:6144
v_fmac_f32 v128, v90, v90
v_mfma_f32_16x16x32_bf16 v[32:35], a[120:123], a[48:51], v[32:35]
ds_read_b128 a[28:31], v226 offset:7168
v_fmac_f32 v128, v92, v92
v_mfma_f32_16x16x32_bf16 v[36:39], a[124:127], a[48:51], v[36:39]
buffer_load_dwordx4 v224, s[28:31], s32 offen offset:0 lds
v_mfma_f32_16x16x32_bf16 v[44:47], a[124:127], a[52:55], v[44:47]
buffer_load_dwordx4 v224, s[28:31], s32 offen offset:1024 lds
v_mfma_f32_16x16x32_bf16 v[40:43], a[120:123], a[52:55], v[40:43]
v_fmac_f32 v128, v94, v94
v_add_f32 v120, v81, v83
v_mfma_f32_16x16x32_bf16 v[48:51], a[120:123], a[56:59], v[48:51]
v_add_f32 v120, v120, v85
v_add_f32 v120, v120, v87
v_mfma_f32_16x16x32_bf16 v[52:55], a[124:127], a[56:59], v[52:55]
buffer_load_dwordx4 v[180:183], v232, s[24:27], s33 offen offset:1024
v_mfma_f32_16x16x32_bf16 v[60:63], a[124:127], a[60:63], v[60:63]
v_add_f32 v120, v120, v89
v_add_f32 v120, v120, v91
v_mfma_f32_16x16x32_bf16 v[56:59], a[120:123], a[60:63], v[56:59]
v_add_f32 v120, v120, v93
s_waitcnt vmcnt(12) lgkmcnt(0)
v_mfma_f32_16x16x32_bf16 v[0:3], a[128:131], a[0:3], v[0:3]
s_barrier
v_mfma_f32_16x16x32_bf16 v[4:7], a[132:135], a[0:3], v[4:7]
ds_read_b128 a[32:35], v226 offset:8192
ds_read_b128 a[36:39], v226 offset:9216
ds_read_b128 a[40:43], v226 offset:10240
v_mfma_f32_16x16x32_bf16 v[12:15], a[132:135], a[4:7], v[12:15]
s_mov_b32 s32, 11264
v_add_f32 v120, v120, v95
v_fmac_f32 v120, 0x42a00000, v128
v_mfma_f32_16x16x32_bf16 v[8:11], a[128:131], a[4:7], v[8:11]
s_add_u32 m0, s34, 40960
ds_read_b128 a[44:47], v226 offset:11264
ds_read_b128 a[48:51], v226 offset:12288
v_mov_b32 v128, 0x3727c5ac
v_mfma_f32_16x16x32_bf16 v[16:19], a[128:131], a[8:11], v[16:19]
buffer_load_dwordx4 v225, s[28:31], s32 offen offset:0 lds
v_mfma_f32_16x16x32_bf16 v[20:23], a[132:135], a[8:11], v[20:23]
ds_read_b128 a[52:55], v226 offset:13312
ds_read_b128 a[56:59], v226 offset:14336
v_fmac_f32 v128, 0x3acccccd, v120
v_mfma_f32_16x16x32_bf16 v[28:31], a[132:135], a[12:15], v[28:31]
v_rsq_f32 v120, v128
s_nop 0
v_mfma_f32_16x16x32_bf16 v[24:27], a[128:131], a[12:15], v[24:27]
ds_read_b128 a[60:63], v226 offset:15360
buffer_load_dwordx4 v225, s[28:31], s32 offen offset:1024 lds
v_mfma_f32_16x16x32_bf16 v[32:35], a[128:131], a[16:19], v[32:35]
buffer_load_dwordx4 v[184:187], v228, s[24:27], s33 offen offset:2048
v_mfma_f32_16x16x32_bf16 v[36:39], a[132:135], a[16:19], v[36:39]
buffer_load_dwordx4 v[188:191], v229, s[24:27], s33 offen offset:2048
v_mfma_f32_16x16x32_bf16 v[44:47], a[132:135], a[20:23], v[44:47]
v_mul_f32 v112, v112, v120
v_mfma_f32_16x16x32_bf16 v[40:43], a[128:131], a[20:23], v[40:43]
v_mov_b32 v114, v112
s_nop 1
v_permlane32_swap_b32 v112, v114
v_mfma_f32_16x16x32_bf16 v[48:51], a[128:131], a[24:27], v[48:51]
v_mov_b32 v113, v112
v_mfma_f32_16x16x32_bf16 v[52:55], a[132:135], a[24:27], v[52:55]
v_mov_b32 v115, v114
s_nop 1
v_permlane16_swap_b32 v112, v113
v_mfma_f32_16x16x32_bf16 v[60:63], a[132:135], a[28:31], v[60:63]
v_permlane16_swap_b32 v114, v115
v_mfma_f32_16x16x32_bf16 v[56:59], a[128:131], a[28:31], v[56:59]
v_mov_b32 v122, v120
s_nop 1
v_permlane32_swap_b32 v120, v122
s_waitcnt lgkmcnt(0)
v_mfma_f32_16x16x32_bf16 v[0:3], a[136:139], a[32:35], v[0:3]
v_mfma_f32_16x16x32_bf16 v[4:7], a[140:143], a[32:35], v[4:7]
ds_read_b128 a[0:3], v216 offset:0
ds_read_b128 a[4:7], v216 offset:1024
ds_read_b128 a[8:11], v216 offset:2048
v_mfma_f32_16x16x32_bf16 v[12:15], a[140:143], a[36:39], v[12:15]
s_mov_b32 s32, 13312
v_mov_b32 v121, v120
s_add_u32 m0, s34, 49152
v_mfma_f32_16x16x32_bf16 v[8:11], a[136:139], a[36:39], v[8:11]
ds_read_b128 a[12:15], v216 offset:3072
v_mov_b32 v123, v122
s_nop 1
v_mfma_f32_16x16x32_bf16 v[16:19], a[136:139], a[40:43], v[16:19]
ds_read_b128 a[16:19], v216 offset:4096
v_permlane16_swap_b32 v120, v121
v_mfma_f32_16x16x32_bf16 v[20:23], a[140:143], a[40:43], v[20:23]
ds_read_b128 a[20:23], v216 offset:5120
v_permlane16_swap_b32 v122, v123
v_mfma_f32_16x16x32_bf16 v[28:31], a[140:143], a[44:47], v[28:31]
ds_read_b128 a[24:27], v216 offset:6144
v_add_f32 v116, v96, v98
v_mfma_f32_16x16x32_bf16 v[24:27], a[136:139], a[44:47], v[24:27]
ds_read_b128 a[28:31], v216 offset:7168
v_add_f32 v116, v116, v100
v_mfma_f32_16x16x32_bf16 v[32:35], a[136:139], a[48:51], v[32:35]
buffer_load_dwordx4 v225, s[28:31], s32 offen offset:0 lds
v_mfma_f32_16x16x32_bf16 v[36:39], a[140:143], a[48:51], v[36:39]
buffer_load_dwordx4 v225, s[28:31], s32 offen offset:1024 lds
v_mfma_f32_16x16x32_bf16 v[44:47], a[140:143], a[52:55], v[44:47]
v_add_f32 v116, v116, v102
v_add_f32 v116, v116, v104
v_mfma_f32_16x16x32_bf16 v[40:43], a[136:139], a[52:55], v[40:43]
buffer_load_dwordx4 v[192:195], v230, s[24:27], s33 offen offset:2048
v_mfma_f32_16x16x32_bf16 v[48:51], a[136:139], a[56:59], v[48:51]
v_add_f32 v116, v116, v106
v_add_f32 v116, v116, v108
v_mfma_f32_16x16x32_bf16 v[52:55], a[140:143], a[56:59], v[52:55]
v_add_f32 v116, v116, v110
v_mul_f32 v116, 0x3e000000, v116
v_mfma_f32_16x16x32_bf16 v[60:63], a[140:143], a[60:63], v[60:63]
buffer_load_dwordx4 v[196:199], v231, s[24:27], s33 offen offset:2048
v_mfma_f32_16x16x32_bf16 v[56:59], a[136:139], a[60:63], v[56:59]
v_sub_f32 v96, v96, v116
v_sub_f32 v98, v98, v116
s_waitcnt vmcnt(16) lgkmcnt(0)
v_mfma_f32_16x16x32_bf16 v[0:3], a[144:147], a[0:3], v[0:3]
s_barrier
v_mfma_f32_16x16x32_bf16 v[0:3], a[152:155], a[4:7], v[0:3]
v_add_u32 v78, 8192, v254
ds_read2st64_b64 a[32:35], v78 offset0:0 offset1:1
v_mfma_f32_16x16x32_bf16 v[4:7], a[156:159], a[4:7], v[4:7]
s_mov_b32 s32, 15360
ds_read_b128 a[36:39], v216 offset:9216
v_sub_f32 v100, v100, v116
v_mfma_f32_16x16x32_bf16 v[4:7], a[148:151], a[0:3], v[4:7]
s_add_u32 m0, s34, 57344
ds_read2st64_b64 a[40:43], v78 offset0:4 offset1:5
v_sub_f32 v102, v102, v116
v_mfma_f32_16x16x32_bf16 v[20:23], a[148:151], a[8:11], v[20:23]
ds_read_b128 a[44:47], v216 offset:11264
v_sub_f32 v104, v104, v116
v_mfma_f32_16x16x32_bf16 v[20:23], a[156:159], a[12:15], v[20:23]
ds_read2st64_b64 a[48:51], v78 offset0:8 offset1:9
v_sub_f32 v106, v106, v116
v_mfma_f32_16x16x32_bf16 v[16:19], a[152:155], a[12:15], v[16:19]
ds_read_b128 a[52:55], v216 offset:13312
v_sub_f32 v108, v108, v116
v_mfma_f32_16x16x32_bf16 v[16:19], a[144:147], a[8:11], v[16:19]
ds_read2st64_b64 a[56:59], v78 offset0:12 offset1:13
v_sub_f32 v110, v110, v116
v_mfma_f32_16x16x32_bf16 v[32:35], a[144:147], a[16:19], v[32:35]
ds_read_b128 a[60:63], v216 offset:15360
v_mul_f32 v128, v96, v96
v_mfma_f32_16x16x32_bf16 v[32:35], a[152:155], a[20:23], v[32:35]
buffer_load_dwordx4 v225, s[28:31], s32 offen offset:0 lds
v_mfma_f32_16x16x32_bf16 v[36:39], a[156:159], a[20:23], v[36:39]
buffer_load_dwordx4 v225, s[28:31], s32 offen offset:1024 lds
v_mfma_f32_16x16x32_bf16 v[36:39], a[148:151], a[16:19], v[36:39]
v_fmac_f32 v128, v98, v98
v_fmac_f32 v128, v100, v100
v_mfma_f32_16x16x32_bf16 v[52:55], a[148:151], a[24:27], v[52:55]
v_fmac_f32 v128, v102, v102
v_fmac_f32 v128, v104, v104
v_mfma_f32_16x16x32_bf16 v[52:55], a[156:159], a[28:31], v[52:55]
buffer_load_dwordx4 a[64:67], v232, s[24:27], s33 offen offset:2048
v_mfma_f32_16x16x32_bf16 v[48:51], a[152:155], a[28:31], v[48:51]
v_fmac_f32 v128, v106, v106
v_fmac_f32 v128, v108, v108
v_mfma_f32_16x16x32_bf16 v[48:51], a[144:147], a[24:27], v[48:51]
v_fmac_f32 v128, v110, v110
s_waitcnt lgkmcnt(0)
v_mfma_f32_16x16x32_bf16 v[0:3], a[160:163], a[32:35], v[0:3]
v_mfma_f32_16x16x32_bf16 v[0:3], a[168:171], a[36:39], v[0:3]
ds_read_b128 a[0:3], v216 offset:16384
ds_read_b128 a[4:7], v216 offset:17408
ds_read_b128 a[8:11], v216 offset:18432
v_mfma_f32_16x16x32_bf16 v[4:7], a[172:175], a[36:39], v[4:7]
s_mov_b32 s32, 17408
v_add_f32 v124, v97, v99
v_add_f32 v124, v124, v101
v_mfma_f32_16x16x32_bf16 v[4:7], a[164:167], a[32:35], v[4:7]
s_add_u32 m0, s34, 65536
ds_read_b128 a[12:15], v216 offset:19456
ds_read_b128 a[16:19], v216 offset:20480
v_add_f32 v124, v124, v103
v_mfma_f32_16x16x32_bf16 v[20:23], a[164:167], a[40:43], v[20:23]
buffer_load_dwordx4 v225, s[28:31], s32 offen offset:0 lds
v_mfma_f32_16x16x32_bf16 v[20:23], a[172:175], a[44:47], v[20:23]
ds_read_b128 a[20:23], v216 offset:21504
v_add_f32 v124, v124, v105
v_mfma_f32_16x16x32_bf16 v[16:19], a[168:171], a[44:47], v[16:19]
ds_read_b128 a[24:27], v216 offset:22528
v_add_f32 v124, v124, v107
v_mfma_f32_16x16x32_bf16 v[16:19], a[160:163], a[40:43], v[16:19]
ds_read_b128 a[28:31], v216 offset:23552
v_add_f32 v124, v124, v109
v_mfma_f32_16x16x32_bf16 v[32:35], a[160:163], a[48:51], v[32:35]
v_add_f32 v124, v124, v111
v_fmac_f32 v124, 0x42a00000, v128
v_mfma_f32_16x16x32_bf16 v[32:35], a[168:171], a[52:55], v[32:35]
buffer_load_dwordx4 v225, s[28:31], s32 offen offset:1024 lds
v_mfma_f32_16x16x32_bf16 v[36:39], a[172:175], a[52:55], v[36:39]
v_mov_b32 v128, 0x3727c5ac
v_fmac_f32 v128, 0x3acccccd, v124
v_mfma_f32_16x16x32_bf16 v[36:39], a[164:167], a[48:51], v[36:39]
buffer_load_dwordx4 a[68:71], v228, s[24:27], s33 offen offset:3072
v_mfma_f32_16x16x32_bf16 v[52:55], a[164:167], a[56:59], v[52:55]
v_rsq_f32 v124, v128
s_nop 0
v_mfma_f32_16x16x32_bf16 v[52:55], a[172:175], a[60:63], v[52:55]
buffer_load_dwordx4 a[72:75], v229, s[24:27], s33 offen offset:3072
v_mfma_f32_16x16x32_bf16 v[48:51], a[168:171], a[60:63], v[48:51]
v_mul_f32 v116, v116, v124
v_mfma_f32_16x16x32_bf16 v[48:51], a[160:163], a[56:59], v[48:51]
v_mov_b32 v118, v116
s_nop 1
v_permlane32_swap_b32 v116, v118
s_waitcnt vmcnt(16) lgkmcnt(0)
v_mfma_f32_16x16x32_bf16 v[0:3], a[176:179], a[0:3], v[0:3]
s_barrier
v_mfma_f32_16x16x32_bf16 v[0:3], a[184:187], a[4:7], v[0:3]
v_add_u32 v78, 24576, v254
ds_read_b128 a[32:35], v216 offset:24576
ds_read2st64_b64 a[36:39], v78 offset0:2 offset1:3
v_mfma_f32_16x16x32_bf16 v[4:7], a[188:191], a[4:7], v[4:7]
s_mov_b32 s32, 19456
v_mov_b32 v117, v116
s_add_u32 m0, s34, 73728
v_mfma_f32_16x16x32_bf16 v[4:7], a[180:183], a[0:3], v[4:7]
ds_read_b128 a[40:43], v216 offset:26624
ds_read2st64_b64 a[44:47], v78 offset0:6 offset1:7
ds_read_b128 a[48:51], v216 offset:28672
v_mfma_f32_16x16x32_bf16 v[20:23], a[180:183], a[8:11], v[20:23]
v_mov_b32 v119, v118
s_nop 1
v_mfma_f32_16x16x32_bf16 v[20:23], a[188:191], a[12:15], v[20:23]
ds_read2st64_b64 a[52:55], v78 offset0:10 offset1:11
ds_read_b128 a[56:59], v216 offset:30720
v_permlane16_swap_b32 v116, v117
v_mfma_f32_16x16x32_bf16 v[16:19], a[184:187], a[12:15], v[16:19]
buffer_load_dwordx4 v225, s[28:31], s32 offen offset:0 lds
v_mfma_f32_16x16x32_bf16 v[16:19], a[176:179], a[8:11], v[16:19]
ds_read2st64_b64 a[60:63], v78 offset0:14 offset1:15
v_permlane16_swap_b32 v118, v119
v_mfma_f32_16x16x32_bf16 v[32:35], a[176:179], a[16:19], v[32:35]
v_mov_b32 v126, v124
s_nop 1
v_mfma_f32_16x16x32_bf16 v[32:35], a[184:187], a[20:23], v[32:35]
v_permlane32_swap_b32 v124, v126
v_mov_b32 v125, v124
v_mfma_f32_16x16x32_bf16 v[36:39], a[188:191], a[20:23], v[36:39]
buffer_load_dwordx4 v225, s[28:31], s32 offen offset:1024 lds
v_mfma_f32_16x16x32_bf16 v[36:39], a[180:183], a[16:19], v[36:39]
v_mov_b32 v127, v126
s_nop 1
v_mfma_f32_16x16x32_bf16 v[52:55], a[180:183], a[24:27], v[52:55]
v_permlane16_swap_b32 v124, v125
v_permlane16_swap_b32 v126, v127
v_mfma_f32_16x16x32_bf16 v[52:55], a[188:191], a[28:31], v[52:55]
buffer_load_dwordx4 a[76:79], v230, s[24:27], s33 offen offset:3072
v_mfma_f32_16x16x32_bf16 v[48:51], a[184:187], a[28:31], v[48:51]
v_fma_f32 v80, -v112, v160, v168
v_fma_f32 v81, -v112, v161, v169
v_mfma_f32_16x16x32_bf16 v[48:51], a[176:179], a[24:27], v[48:51]
v_fma_f32 v82, -v112, v162, v170
v_fma_f32 v83, -v112, v163, v171
s_waitcnt lgkmcnt(0)
v_mfma_f32_16x16x32_bf16 v[0:3], a[192:195], a[32:35], v[0:3]
v_mfma_f32_16x16x32_bf16 v[0:3], a[200:203], a[36:39], v[0:3]
ds_read_b128 a[0:3], v216 offset:32768
ds_read_b128 a[4:7], v216 offset:33792
v_mfma_f32_16x16x32_bf16 v[4:7], a[204:207], a[36:39], v[4:7]
buffer_load_dwordx4 a[80:83], v231, s[24:27], s33 offen offset:3072
v_mfma_f32_16x16x32_bf16 v[4:7], a[196:199], a[32:35], v[4:7]
ds_read_b128 a[8:11], v216 offset:34816
v_fma_f32 v84, -v112, v164, v172
v_mfma_f32_16x16x32_bf16 v[20:23], a[196:199], a[40:43], v[20:23]
ds_read_b128 a[12:15], v216 offset:35840
v_fma_f32 v85, -v112, v165, v173
v_mfma_f32_16x16x32_bf16 v[20:23], a[204:207], a[44:47], v[20:23]
ds_read_b128 a[16:19], v216 offset:36864
v_fma_f32 v86, -v112, v166, v174
v_mfma_f32_16x16x32_bf16 v[16:19], a[200:203], a[44:47], v[16:19]
ds_read_b128 a[20:23], v216 offset:37888
v_fma_f32 v87, -v112, v167, v175
v_mfma_f32_16x16x32_bf16 v[16:19], a[192:195], a[40:43], v[16:19]
ds_read_b128 a[24:27], v216 offset:38912
v_fma_f32 v88, -v114, v160, v168
v_mfma_f32_16x16x32_bf16 v[32:35], a[192:195], a[48:51], v[32:35]
ds_read_b128 a[28:31], v216 offset:39936
v_fma_f32 v89, -v114, v161, v169
v_mfma_f32_16x16x32_bf16 v[32:35], a[200:203], a[52:55], v[32:35]
buffer_load_dwordx4 a[84:87], v232, s[24:27], s33 offen offset:3072
v_mfma_f32_16x16x32_bf16 v[36:39], a[204:207], a[52:55], v[36:39]
s_add_u32 s33, s33, 4096
v_fma_f32 v90, -v114, v162, v170
v_fma_f32 v91, -v114, v163, v171
v_mfma_f32_16x16x32_bf16 v[36:39], a[196:199], a[48:51], v[36:39]
v_fma_f32 v92, -v114, v164, v172
v_fma_f32 v93, -v114, v165, v173
v_mfma_f32_16x16x32_bf16 v[52:55], a[196:199], a[56:59], v[52:55]
buffer_load_dwordx4 a[88:91], v228, s[24:27], s33 offen offset:0
v_mfma_f32_16x16x32_bf16 v[52:55], a[204:207], a[60:63], v[52:55]
v_fma_f32 v94, -v114, v166, v174
v_fma_f32 v95, -v114, v167, v175
v_mfma_f32_16x16x32_bf16 v[48:51], a[200:203], a[60:63], v[48:51]
buffer_load_dwordx4 a[92:95], v229, s[24:27], s33 offen offset:0
v_mfma_f32_16x16x32_bf16 v[48:51], a[192:195], a[56:59], v[48:51]
v_fma_f32 v96, -v116, v160, v168
v_fma_f32 v97, -v116, v161, v169
s_waitcnt vmcnt(16) lgkmcnt(0)
v_mfma_f32_16x16x32_bf16 v[0:3], a[208:211], a[0:3], v[0:3]
s_barrier
v_mfma_f32_16x16x32_bf16 v[0:3], a[216:219], a[4:7], v[0:3]
ds_read_b128 a[32:35], v216 offset:40960
ds_read_b128 a[36:39], v216 offset:41984
v_mfma_f32_16x16x32_bf16 v[4:7], a[220:223], a[4:7], v[4:7]
buffer_load_dwordx4 a[96:99], v230, s[24:27], s33 offen offset:0
v_mfma_f32_16x16x32_bf16 v[4:7], a[212:215], a[0:3], v[4:7]
ds_read_b128 a[40:43], v216 offset:43008
v_fma_f32 v98, -v116, v162, v170
v_mfma_f32_16x16x32_bf16 v[20:23], a[212:215], a[8:11], v[20:23]
ds_read_b128 a[44:47], v216 offset:44032
v_fma_f32 v99, -v116, v163, v171
v_mfma_f32_16x16x32_bf16 v[20:23], a[220:223], a[12:15], v[20:23]
ds_read_b128 a[48:51], v216 offset:45056
v_fma_f32 v100, -v116, v164, v172
v_mfma_f32_16x16x32_bf16 v[16:19], a[216:219], a[12:15], v[16:19]
ds_read_b128 a[52:55], v216 offset:46080
v_fma_f32 v101, -v116, v165, v173
v_mfma_f32_16x16x32_bf16 v[16:19], a[208:211], a[8:11], v[16:19]
ds_read_b128 a[56:59], v216 offset:47104
v_fma_f32 v102, -v116, v166, v174
v_mfma_f32_16x16x32_bf16 v[32:35], a[208:211], a[16:19], v[32:35]
ds_read_b128 a[60:63], v216 offset:48128
v_fma_f32 v103, -v116, v167, v175
v_mfma_f32_16x16x32_bf16 v[32:35], a[216:219], a[20:23], v[32:35]
buffer_load_dwordx4 a[100:103], v231, s[24:27], s33 offen offset:0
v_mfma_f32_16x16x32_bf16 v[36:39], a[220:223], a[20:23], v[36:39]
v_fma_f32 v104, -v118, v160, v168
v_fma_f32 v105, -v118, v161, v169
v_mfma_f32_16x16x32_bf16 v[36:39], a[212:215], a[16:19], v[36:39]
buffer_load_dwordx4 a[104:107], v232, s[24:27], s33 offen offset:0
v_mfma_f32_16x16x32_bf16 v[52:55], a[212:215], a[24:27], v[52:55]
v_fma_f32 v106, -v118, v162, v170
v_fma_f32 v107, -v118, v163, v171
v_mfma_f32_16x16x32_bf16 v[52:55], a[220:223], a[28:31], v[52:55]
v_fma_f32 v108, -v118, v164, v172
v_fma_f32 v109, -v118, v165, v173
v_mfma_f32_16x16x32_bf16 v[48:51], a[216:219], a[28:31], v[48:51]
buffer_load_dwordx4 a[108:111], v228, s[24:27], s33 offen offset:1024
v_mfma_f32_16x16x32_bf16 v[48:51], a[208:211], a[24:27], v[48:51]
v_fma_f32 v110, -v118, v166, v174
v_fma_f32 v111, -v118, v167, v175
s_waitcnt lgkmcnt(0)
v_mfma_f32_16x16x32_bf16 v[8:11], a[144:147], a[32:35], v[8:11]
v_mfma_f32_16x16x32_bf16 v[8:11], a[152:155], a[36:39], v[8:11]
v_add_u32 v78, 49152, v254
ds_read2st64_b64 a[0:3], v78 offset0:0 offset1:1
ds_read_b128 a[4:7], v216 offset:50176
v_mfma_f32_16x16x32_bf16 v[12:15], a[156:159], a[36:39], v[12:15]
buffer_load_dwordx4 a[112:115], v229, s[24:27], s33 offen offset:1024
v_mfma_f32_16x16x32_bf16 v[12:15], a[148:151], a[32:35], v[12:15]
ds_read2st64_b64 a[8:11], v78 offset0:4 offset1:5
ds_read_b128 a[12:15], v216 offset:52224
v_fmac_f32 v80, v120, v0
v_mfma_f32_16x16x32_bf16 v[28:31], a[148:151], a[40:43], v[28:31]
v_fmac_f32 v81, v120, v1
v_fmac_f32 v82, v120, v2
v_mfma_f32_16x16x32_bf16 v[28:31], a[156:159], a[44:47], v[28:31]
ds_read2st64_b64 a[16:19], v78 offset0:8 offset1:9
ds_read_b128 a[20:23], v216 offset:54272
v_fmac_f32 v83, v120, v3
v_mfma_f32_16x16x32_bf16 v[24:27], a[152:155], a[44:47], v[24:27]
v_fmac_f32 v84, v120, v4
v_fmac_f32 v85, v120, v5
v_mfma_f32_16x16x32_bf16 v[24:27], a[144:147], a[40:43], v[24:27]
ds_read2st64_b64 a[24:27], v78 offset0:12 offset1:13
v_fmac_f32 v86, v120, v6
v_mfma_f32_16x16x32_bf16 v[40:43], a[144:147], a[48:51], v[40:43]
Lpad28:
s_cbranch_execz Lret2
ds_read_b128 a[28:31], v216 offset:56320
v_fmac_f32 v87, v120, v7
v_mfma_f32_16x16x32_bf16 v[40:43], a[152:155], a[52:55], v[40:43]
v_max_f32 v80, 0, v80
v_max_f32 v81, 0, v81
v_mfma_f32_16x16x32_bf16 v[44:47], a[156:159], a[52:55], v[44:47]
v_max_f32 v82, 0, v82
v_max_f32 v83, 0, v83
v_mfma_f32_16x16x32_bf16 v[44:47], a[148:151], a[48:51], v[44:47]
v_max_f32 v84, 0, v84
v_max_f32 v85, 0, v85
v_mfma_f32_16x16x32_bf16 v[60:63], a[148:151], a[56:59], v[60:63]
v_max_f32 v86, 0, v86
v_max_f32 v87, 0, v87
v_mfma_f32_16x16x32_bf16 v[60:63], a[156:159], a[60:63], v[60:63]
v_mul_f32 v80, v80, v80
v_mul_f32 v81, v81, v81
v_mfma_f32_16x16x32_bf16 v[56:59], a[152:155], a[60:63], v[56:59]
v_mul_f32 v82, v82, v82
v_mul_f32 v83, v83, v83
v_mfma_f32_16x16x32_bf16 v[56:59], a[144:147], a[56:59], v[56:59]
v_mul_f32 v84, v84, v84
v_mul_f32 v85, v85, v85
s_waitcnt vmcnt(14) lgkmcnt(0)
v_mfma_f32_16x16x32_bf16 v[8:11], a[160:163], a[0:3], v[8:11]
s_barrier
v_mfma_f32_16x16x32_bf16 v[8:11], a[168:171], a[4:7], v[8:11]
ds_read_b128 a[32:35], v216 offset:57344
ds_read_b128 a[36:39], v216 offset:58368
ds_read_b128 a[40:43], v216 offset:59392
v_mfma_f32_16x16x32_bf16 v[12:15], a[172:175], a[4:7], v[12:15]
buffer_load_dwordx4 a[116:119], v230, s[24:27], s33 offen offset:1024
v_mfma_f32_16x16x32_bf16 v[12:15], a[164:167], a[0:3], v[12:15]
ds_read_b128 a[44:47], v216 offset:60416
v_mul_f32 v86, v86, v86
v_mul_f32 v87, v87, v87
v_mfma_f32_16x16x32_bf16 v[28:31], a[164:167], a[8:11], v[28:31]
ds_read_b128 a[48:51], v216 offset:61440
v_cvt_pk_bf16_f32 v128, v80, v81
v_mfma_f32_16x16x32_bf16 v[28:31], a[172:175], a[12:15], v[28:31]
ds_read_b128 a[52:55], v216 offset:62464
v_cvt_pk_bf16_f32 v129, v82, v83
v_mfma_f32_16x16x32_bf16 v[24:27], a[168:171], a[12:15], v[24:27]
ds_read_b128 a[56:59], v216 offset:63488
v_cvt_pk_bf16_f32 v130, v84, v85
v_mfma_f32_16x16x32_bf16 v[24:27], a[160:163], a[8:11], v[24:27]
ds_read_b128 a[60:63], v216 offset:64512
v_cvt_pk_bf16_f32 v131, v86, v87
v_mfma_f32_16x16x32_bf16 v[40:43], a[160:163], a[16:19], v[40:43]
buffer_store_dwordx4 v[128:131], v216, s[8:11], s77 offen sc1
v_mfma_f32_16x16x32_bf16 v[40:43], a[168:171], a[20:23], v[40:43]
s_add_u32 s77, s77, 110592
v_fmac_f32 v88, v122, v16
v_fmac_f32 v89, v122, v17
v_mfma_f32_16x16x32_bf16 v[44:47], a[172:175], a[20:23], v[44:47]
v_fmac_f32 v90, v122, v18
v_fmac_f32 v91, v122, v19
v_mfma_f32_16x16x32_bf16 v[44:47], a[164:167], a[16:19], v[44:47]
v_fmac_f32 v92, v122, v20
v_fmac_f32 v93, v122, v21
v_mfma_f32_16x16x32_bf16 v[60:63], a[164:167], a[24:27], v[60:63]
v_fmac_f32 v94, v122, v22
v_fmac_f32 v95, v122, v23
v_mfma_f32_16x16x32_bf16 v[60:63], a[172:175], a[28:31], v[60:63]
v_max_f32 v88, 0, v88
v_max_f32 v89, 0, v89
v_mfma_f32_16x16x32_bf16 v[56:59], a[168:171], a[28:31], v[56:59]
v_max_f32 v90, 0, v90
v_max_f32 v91, 0, v91
v_mfma_f32_16x16x32_bf16 v[56:59], a[160:163], a[24:27], v[56:59]
v_max_f32 v92, 0, v92
v_max_f32 v93, 0, v93
s_waitcnt lgkmcnt(0)
v_mfma_f32_16x16x32_bf16 v[8:11], a[176:179], a[32:35], v[8:11]
v_mfma_f32_16x16x32_bf16 v[8:11], a[184:187], a[36:39], v[8:11]
v_add_u32 v78, 65536, v254
ds_read_b128 a[0:3], v226 offset:0
ds_read2st64_b64 a[4:7], v78 offset0:2 offset1:3
v_mfma_f32_16x16x32_bf16 v[12:15], a[188:191], a[36:39], v[12:15]
buffer_load_dwordx4 a[120:123], v231, s[24:27], s33 offen offset:1024
v_mfma_f32_16x16x32_bf16 v[12:15], a[180:183], a[32:35], v[12:15]
ds_read_b128 a[8:11], v226 offset:2048
ds_read2st64_b64 a[12:15], v78 offset0:6 offset1:7
v_max_f32 v94, 0, v94
v_mfma_f32_16x16x32_bf16 v[28:31], a[180:183], a[40:43], v[28:31]
v_max_f32 v95, 0, v95
v_mul_f32 v88, v88, v88
v_mfma_f32_16x16x32_bf16 v[28:31], a[188:191], a[44:47], v[28:31]
ds_read_b128 a[16:19], v226 offset:4096
ds_read2st64_b64 a[20:23], v78 offset0:10 offset1:11
v_mul_f32 v89, v89, v89
v_mfma_f32_16x16x32_bf16 v[24:27], a[184:187], a[44:47], v[24:27]
v_mul_f32 v90, v90, v90
v_mul_f32 v91, v91, v91
v_mfma_f32_16x16x32_bf16 v[24:27], a[176:179], a[40:43], v[24:27]
ds_read_b128 a[24:27], v226 offset:6144
v_mul_f32 v92, v92, v92
v_mfma_f32_16x16x32_bf16 v[40:43], a[176:179], a[48:51], v[40:43]
ds_read2st64_b64 a[28:31], v78 offset0:14 offset1:15
v_mul_f32 v93, v93, v93
v_mfma_f32_16x16x32_bf16 v[40:43], a[184:187], a[52:55], v[40:43]
v_mul_f32 v94, v94, v94
v_mul_f32 v95, v95, v95
v_mfma_f32_16x16x32_bf16 v[44:47], a[188:191], a[52:55], v[44:47]
v_cvt_pk_bf16_f32 v132, v88, v89
v_cvt_pk_bf16_f32 v133, v90, v91
v_mfma_f32_16x16x32_bf16 v[44:47], a[180:183], a[48:51], v[44:47]
v_cvt_pk_bf16_f32 v134, v92, v93
v_cvt_pk_bf16_f32 v135, v94, v95
v_mfma_f32_16x16x32_bf16 v[60:63], a[180:183], a[56:59], v[60:63]
buffer_store_dwordx4 v[132:135], v216, s[8:11], s77 offen sc1
v_mfma_f32_16x16x32_bf16 v[60:63], a[188:191], a[60:63], v[60:63]
s_add_u32 s77, s77, 110592
v_fmac_f32 v96, v124, v32
v_fmac_f32 v97, v124, v33
v_mfma_f32_16x16x32_bf16 v[56:59], a[184:187], a[60:63], v[56:59]
v_fmac_f32 v98, v124, v34
v_fmac_f32 v99, v124, v35
v_mfma_f32_16x16x32_bf16 v[56:59], a[176:179], a[56:59], v[56:59]
v_fmac_f32 v100, v124, v36
v_fmac_f32 v101, v124, v37
s_waitcnt vmcnt(14) lgkmcnt(0)
v_mfma_f32_16x16x32_bf16 v[8:11], a[192:195], a[0:3], v[8:11]
s_barrier
v_mfma_f32_16x16x32_bf16 v[8:11], a[200:203], a[4:7], v[8:11]
ds_read_b128 a[32:35], v226 offset:8192
ds_read_b128 a[36:39], v226 offset:9216
ds_read_b128 a[40:43], v226 offset:10240
v_mfma_f32_16x16x32_bf16 v[12:15], a[204:207], a[4:7], v[12:15]
buffer_load_dwordx4 a[124:127], v232, s[24:27], s33 offen offset:1024
v_mfma_f32_16x16x32_bf16 v[12:15], a[196:199], a[0:3], v[12:15]
ds_read_b128 a[44:47], v226 offset:11264
v_fmac_f32 v102, v124, v38
v_fmac_f32 v103, v124, v39
v_mfma_f32_16x16x32_bf16 v[28:31], a[196:199], a[8:11], v[28:31]
ds_read_b128 a[48:51], v226 offset:12288
v_max_f32 v96, 0, v96
v_mfma_f32_16x16x32_bf16 v[28:31], a[204:207], a[12:15], v[28:31]
ds_read_b128 a[52:55], v226 offset:13312
v_max_f32 v97, 0, v97
v_mfma_f32_16x16x32_bf16 v[24:27], a[200:203], a[12:15], v[24:27]
ds_read_b128 a[56:59], v226 offset:14336
v_max_f32 v98, 0, v98
v_mfma_f32_16x16x32_bf16 v[24:27], a[192:195], a[8:11], v[24:27]
ds_read_b128 a[60:63], v226 offset:15360
v_max_f32 v99, 0, v99
v_mfma_f32_16x16x32_bf16 v[40:43], a[192:195], a[16:19], v[40:43]
v_max_f32 v100, 0, v100
v_max_f32 v101, 0, v101
v_mfma_f32_16x16x32_bf16 v[40:43], a[200:203], a[20:23], v[40:43]
v_max_f32 v102, 0, v102
v_max_f32 v103, 0, v103
v_mfma_f32_16x16x32_bf16 v[44:47], a[204:207], a[20:23], v[44:47]
v_mul_f32 v96, v96, v96
v_mul_f32 v97, v97, v97
v_mfma_f32_16x16x32_bf16 v[44:47], a[196:199], a[16:19], v[44:47]
v_mul_f32 v98, v98, v98
v_mul_f32 v99, v99, v99
v_mfma_f32_16x16x32_bf16 v[60:63], a[196:199], a[24:27], v[60:63]
v_mul_f32 v100, v100, v100
v_mul_f32 v101, v101, v101
v_mfma_f32_16x16x32_bf16 v[60:63], a[204:207], a[28:31], v[60:63]
v_mul_f32 v102, v102, v102
v_mul_f32 v103, v103, v103
v_mfma_f32_16x16x32_bf16 v[56:59], a[200:203], a[28:31], v[56:59]
v_cvt_pk_bf16_f32 v128, v96, v97
v_cvt_pk_bf16_f32 v129, v98, v99
v_mfma_f32_16x16x32_bf16 v[56:59], a[192:195], a[24:27], v[56:59]
v_cvt_pk_bf16_f32 v130, v100, v101
v_cvt_pk_bf16_f32 v131, v102, v103
s_waitcnt lgkmcnt(0)
v_mfma_f32_16x16x32_bf16 v[8:11], a[208:211], a[32:35], v[8:11]
v_mfma_f32_16x16x32_bf16 v[8:11], a[216:219], a[36:39], v[8:11]
v_mfma_f32_16x16x32_bf16 v[12:15], a[220:223], a[36:39], v[12:15]
buffer_load_dwordx4 a[128:131], v228, s[24:27], s33 offen offset:2048
v_mfma_f32_16x16x32_bf16 v[12:15], a[212:215], a[32:35], v[12:15]
buffer_store_dwordx4 v[128:131], v216, s[8:11], s77 offen sc1
s_add_u32 s77, s77, 110592
v_mfma_f32_16x16x32_bf16 v[28:31], a[212:215], a[40:43], v[28:31]
v_fmac_f32 v104, v126, v48
v_fmac_f32 v105, v126, v49
v_mfma_f32_16x16x32_bf16 v[28:31], a[220:223], a[44:47], v[28:31]
v_fmac_f32 v106, v126, v50
v_fmac_f32 v107, v126, v51
v_fmac_f32 v108, v126, v52
v_mfma_f32_16x16x32_bf16 v[24:27], a[216:219], a[44:47], v[24:27]
v_fmac_f32 v109, v126, v53
v_fmac_f32 v110, v126, v54
v_fmac_f32 v111, v126, v55
v_mfma_f32_16x16x32_bf16 v[24:27], a[208:211], a[40:43], v[24:27]
v_max_f32 v104, 0, v104
v_max_f32 v105, 0, v105
v_mfma_f32_16x16x32_bf16 v[40:43], a[208:211], a[48:51], v[40:43]
v_max_f32 v106, 0, v106
v_max_f32 v107, 0, v107
v_max_f32 v108, 0, v108
v_mfma_f32_16x16x32_bf16 v[40:43], a[216:219], a[52:55], v[40:43]
v_max_f32 v109, 0, v109
v_max_f32 v110, 0, v110
v_mfma_f32_16x16x32_bf16 v[44:47], a[220:223], a[52:55], v[44:47]
v_max_f32 v111, 0, v111
v_mul_f32 v104, v104, v104
v_mul_f32 v105, v105, v105
v_mfma_f32_16x16x32_bf16 v[44:47], a[212:215], a[48:51], v[44:47]
v_mul_f32 v106, v106, v106
v_mul_f32 v107, v107, v107
v_mfma_f32_16x16x32_bf16 v[60:63], a[212:215], a[56:59], v[60:63]
v_mul_f32 v108, v108, v108
v_mul_f32 v109, v109, v109
v_mul_f32 v110, v110, v110
v_mfma_f32_16x16x32_bf16 v[60:63], a[220:223], a[60:63], v[60:63]
v_mul_f32 v111, v111, v111
v_cvt_pk_bf16_f32 v132, v104, v105
v_mfma_f32_16x16x32_bf16 v[56:59], a[216:219], a[60:63], v[56:59]
v_cvt_pk_bf16_f32 v133, v106, v107
v_cvt_pk_bf16_f32 v134, v108, v109
v_cvt_pk_bf16_f32 v135, v110, v111
v_mfma_f32_16x16x32_bf16 v[56:59], a[208:211], a[56:59], v[56:59]
buffer_store_dwordx4 v[132:135], v216, s[8:11], s77 offen sc1
s_sub_u32 s77, s77, 276480
v_pk_fma_f32 v[136:137], v[112:113], v[160:161], v[168:169] op_sel:[1,0,0] op_sel_hi:[1,1,1] neg_lo:[1,0,0] neg_hi:[1,0,0]
v_pk_fma_f32 v[138:139], v[112:113], v[162:163], v[170:171] op_sel:[1,0,0] op_sel_hi:[1,1,1] neg_lo:[1,0,0] neg_hi:[1,0,0]
v_pk_fma_f32 v[140:141], v[112:113], v[164:165], v[172:173] op_sel:[1,0,0] op_sel_hi:[1,1,1] neg_lo:[1,0,0] neg_hi:[1,0,0]
v_pk_fma_f32 v[142:143], v[112:113], v[166:167], v[174:175] op_sel:[1,0,0] op_sel_hi:[1,1,1] neg_lo:[1,0,0] neg_hi:[1,0,0]
v_pk_fma_f32 v[136:137], v[120:121], v[8:9], v[136:137] op_sel:[1,0,0] op_sel_hi:[1,1,1]
v_pk_fma_f32 v[138:139], v[120:121], v[10:11], v[138:139] op_sel:[1,0,0] op_sel_hi:[1,1,1]
v_pk_fma_f32 v[140:141], v[120:121], v[12:13], v[140:141] op_sel:[1,0,0] op_sel_hi:[1,1,1]
v_pk_fma_f32 v[142:143], v[120:121], v[14:15], v[142:143] op_sel:[1,0,0] op_sel_hi:[1,1,1]
v_max_f32 v136, 0, v136
v_max_f32 v137, 0, v137
v_max_f32 v138, 0, v138
v_max_f32 v139, 0, v139
v_max_f32 v140, 0, v140
v_max_f32 v141, 0, v141
v_max_f32 v142, 0, v142
v_max_f32 v143, 0, v143
v_pk_mul_f32 v[136:137], v[136:137], v[136:137]
v_pk_mul_f32 v[138:139], v[138:139], v[138:139]
v_pk_mul_f32 v[140:141], v[140:141], v[140:141]
v_pk_mul_f32 v[142:143], v[142:143], v[142:143]
v_cvt_pk_bf16_f32 v144, v136, v137
v_cvt_pk_bf16_f32 v145, v138, v139
v_cvt_pk_bf16_f32 v146, v140, v141
v_cvt_pk_bf16_f32 v147, v142, v143
buffer_store_dwordx4 v[144:147], v216, s[8:11], s77 offen sc1
s_add_u32 s77, s77, 110592
v_pk_fma_f32 v[136:137], v[114:115], v[160:161], v[168:169] op_sel:[1,0,0] op_sel_hi:[1,1,1] neg_lo:[1,0,0] neg_hi:[1,0,0]
v_pk_fma_f32 v[138:139], v[114:115], v[162:163], v[170:171] op_sel:[1,0,0] op_sel_hi:[1,1,1] neg_lo:[1,0,0] neg_hi:[1,0,0]
v_pk_fma_f32 v[140:141], v[114:115], v[164:165], v[172:173] op_sel:[1,0,0] op_sel_hi:[1,1,1] neg_lo:[1,0,0] neg_hi:[1,0,0]
v_pk_fma_f32 v[142:143], v[114:115], v[166:167], v[174:175] op_sel:[1,0,0] op_sel_hi:[1,1,1] neg_lo:[1,0,0] neg_hi:[1,0,0]
v_pk_fma_f32 v[136:137], v[122:123], v[24:25], v[136:137] op_sel:[1,0,0] op_sel_hi:[1,1,1]
v_pk_fma_f32 v[138:139], v[122:123], v[26:27], v[138:139] op_sel:[1,0,0] op_sel_hi:[1,1,1]
v_pk_fma_f32 v[140:141], v[122:123], v[28:29], v[140:141] op_sel:[1,0,0] op_sel_hi:[1,1,1]
v_pk_fma_f32 v[142:143], v[122:123], v[30:31], v[142:143] op_sel:[1,0,0] op_sel_hi:[1,1,1]
v_max_f32 v136, 0, v136
v_max_f32 v137, 0, v137
v_max_f32 v138, 0, v138
v_max_f32 v139, 0, v139
v_max_f32 v140, 0, v140
v_max_f32 v141, 0, v141
v_max_f32 v142, 0, v142
v_max_f32 v143, 0, v143
v_pk_mul_f32 v[136:137], v[136:137], v[136:137]
v_pk_mul_f32 v[138:139], v[138:139], v[138:139]
v_pk_mul_f32 v[140:141], v[140:141], v[140:141]
v_pk_mul_f32 v[142:143], v[142:143], v[142:143]
v_cvt_pk_bf16_f32 v148, v136, v137
v_cvt_pk_bf16_f32 v149, v138, v139
v_cvt_pk_bf16_f32 v150, v140, v141
v_cvt_pk_bf16_f32 v151, v142, v143
buffer_store_dwordx4 v[148:151], v216, s[8:11], s77 offen sc1
s_add_u32 s77, s77, 110592
v_pk_fma_f32 v[136:137], v[116:117], v[160:161], v[168:169] op_sel:[1,0,0] op_sel_hi:[1,1,1] neg_lo:[1,0,0] neg_hi:[1,0,0]
v_pk_fma_f32 v[138:139], v[116:117], v[162:163], v[170:171] op_sel:[1,0,0] op_sel_hi:[1,1,1] neg_lo:[1,0,0] neg_hi:[1,0,0]
v_pk_fma_f32 v[140:141], v[116:117], v[164:165], v[172:173] op_sel:[1,0,0] op_sel_hi:[1,1,1] neg_lo:[1,0,0] neg_hi:[1,0,0]
v_pk_fma_f32 v[142:143], v[116:117], v[166:167], v[174:175] op_sel:[1,0,0] op_sel_hi:[1,1,1] neg_lo:[1,0,0] neg_hi:[1,0,0]
v_pk_fma_f32 v[136:137], v[124:125], v[40:41], v[136:137] op_sel:[1,0,0] op_sel_hi:[1,1,1]
v_pk_fma_f32 v[138:139], v[124:125], v[42:43], v[138:139] op_sel:[1,0,0] op_sel_hi:[1,1,1]
v_pk_fma_f32 v[140:141], v[124:125], v[44:45], v[140:141] op_sel:[1,0,0] op_sel_hi:[1,1,1]
v_pk_fma_f32 v[142:143], v[124:125], v[46:47], v[142:143] op_sel:[1,0,0] op_sel_hi:[1,1,1]
v_max_f32 v136, 0, v136
v_max_f32 v137, 0, v137
v_max_f32 v138, 0, v138
v_max_f32 v139, 0, v139
v_max_f32 v140, 0, v140
v_max_f32 v141, 0, v141
v_max_f32 v142, 0, v142
v_max_f32 v143, 0, v143
v_pk_mul_f32 v[136:137], v[136:137], v[136:137]
v_pk_mul_f32 v[138:139], v[138:139], v[138:139]
v_pk_mul_f32 v[140:141], v[140:141], v[140:141]
v_pk_mul_f32 v[142:143], v[142:143], v[142:143]
v_cvt_pk_bf16_f32 v144, v136, v137
v_cvt_pk_bf16_f32 v145, v138, v139
v_cvt_pk_bf16_f32 v146, v140, v141
v_cvt_pk_bf16_f32 v147, v142, v143
buffer_store_dwordx4 v[144:147], v216, s[8:11], s77 offen sc1
s_add_u32 s77, s77, 110592
v_pk_fma_f32 v[136:137], v[118:119], v[160:161], v[168:169] op_sel:[1,0,0] op_sel_hi:[1,1,1] neg_lo:[1,0,0] neg_hi:[1,0,0]
v_pk_fma_f32 v[138:139], v[118:119], v[162:163], v[170:171] op_sel:[1,0,0] op_sel_hi:[1,1,1] neg_lo:[1,0,0] neg_hi:[1,0,0]
v_pk_fma_f32 v[140:141], v[118:119], v[164:165], v[172:173] op_sel:[1,0,0] op_sel_hi:[1,1,1] neg_lo:[1,0,0] neg_hi:[1,0,0]
v_pk_fma_f32 v[142:143], v[118:119], v[166:167], v[174:175] op_sel:[1,0,0] op_sel_hi:[1,1,1] neg_lo:[1,0,0] neg_hi:[1,0,0]
v_pk_fma_f32 v[136:137], v[126:127], v[56:57], v[136:137] op_sel:[1,0,0] op_sel_hi:[1,1,1]
v_pk_fma_f32 v[138:139], v[126:127], v[58:59], v[138:139] op_sel:[1,0,0] op_sel_hi:[1,1,1]
v_pk_fma_f32 v[140:141], v[126:127], v[60:61], v[140:141] op_sel:[1,0,0] op_sel_hi:[1,1,1]
v_pk_fma_f32 v[142:143], v[126:127], v[62:63], v[142:143] op_sel:[1,0,0] op_sel_hi:[1,1,1]
v_max_f32 v136, 0, v136
v_max_f32 v137, 0, v137
v_max_f32 v138, 0, v138
v_max_f32 v139, 0, v139
v_max_f32 v140, 0, v140
v_max_f32 v141, 0, v141
v_max_f32 v142, 0, v142
v_max_f32 v143, 0, v143
v_pk_mul_f32 v[136:137], v[136:137], v[136:137]
v_pk_mul_f32 v[138:139], v[138:139], v[138:139]
v_pk_mul_f32 v[140:141], v[140:141], v[140:141]
v_pk_mul_f32 v[142:143], v[142:143], v[142:143]
v_cvt_pk_bf16_f32 v148, v136, v137
v_cvt_pk_bf16_f32 v149, v138, v139
v_cvt_pk_bf16_f32 v150, v140, v141
v_cvt_pk_bf16_f32 v151, v142, v143
buffer_store_dwordx4 v[148:151], v216, s[8:11], s77 offen sc1
s_add_u32 s77, s77, 110592
buffer_load_dwordx4 a[132:135], v229, s[24:27], s33 offen offset:2048
buffer_load_dwordx4 a[136:139], v230, s[24:27], s33 offen offset:2048
buffer_load_dwordx4 a[140:143], v231, s[24:27], s33 offen offset:2048
buffer_load_dwordx4 a[144:147], v232, s[24:27], s33 offen offset:2048
buffer_load_dwordx4 a[148:151], v228, s[24:27], s33 offen offset:3072
buffer_load_dwordx4 a[152:155], v229, s[24:27], s33 offen offset:3072
buffer_load_dwordx4 a[156:159], v230, s[24:27], s33 offen offset:3072
buffer_load_dwordx4 a[160:163], v231, s[24:27], s33 offen offset:3072
buffer_load_dwordx4 a[164:167], v232, s[24:27], s33 offen offset:3072
s_add_u32 s33, s33, 4096
buffer_load_dwordx4 a[168:171], v228, s[24:27], s33 offen offset:0
buffer_load_dwordx4 a[172:175], v229, s[24:27], s33 offen offset:0
buffer_load_dwordx4 a[176:179], v230, s[24:27], s33 offen offset:0
buffer_load_dwordx4 a[180:183], v231, s[24:27], s33 offen offset:0
buffer_load_dwordx4 a[184:187], v232, s[24:27], s33 offen offset:0
buffer_load_dwordx4 a[188:191], v228, s[24:27], s33 offen offset:1024
buffer_load_dwordx4 a[192:195], v229, s[24:27], s33 offen offset:1024
buffer_load_dwordx4 a[196:199], v230, s[24:27], s33 offen offset:1024
buffer_load_dwordx4 a[200:203], v231, s[24:27], s33 offen offset:1024
s_lshl_b32 s6, s58, 8
s_add_u32 s6, s6, 284800
v_min_u32 v241, 13, v234
v_lshl_add_u32 v241, v241, 2, s6
s_andn2_b32 s7, s60, 3
s_add_u32 s6, s3, 0
s_and_b32 s6, s6, 3
s_add_u32 s6, s6, s7
s_mul_i32 s6, s6, 55296
v_add_u32 v224, s6, v216
s_add_u32 s6, s3, 1
s_and_b32 s6, s6, 3
s_add_u32 s6, s6, s7
s_mul_i32 s6, s6, 55296
v_add_u32 v225, s6, v216
s_add_u32 s6, s3, 2
s_and_b32 s6, s6, 3
s_add_u32 s6, s6, s7
s_mul_i32 s6, s6, 55296
v_add_u32 v226, s6, v216
s_add_u32 s6, s3, 3
s_and_b32 s6, s6, 3
s_add_u32 s6, s6, s7
s_mul_i32 s6, s6, 55296
v_add_u32 v227, s6, v216
s_add_u32 s69, s45, 0
s_add_u32 s70, s45, 4096
s_add_u32 s71, s45, 8192
s_add_u32 s72, s45, 12288
s_cmp_ge_u32 s3, 2
s_cselect_b32 s73, 0x40000000, s72
s_add_u32 s28, s66, 23068672
s_addc_u32 s29, s67, 0
s_and_b32 s29, s29, 0xffff
s_mov_b32 s30, 7077888
s_mov_b32 s31, 0x20000
s_mov_b32 s16, s62
s_and_b32 s17, s63, 0xffff
s_mov_b32 s18, 2621440
s_mov_b32 s19, 0x20000
s_mov_b32 s12, s56
s_and_b32 s13, s57, 0xffff
s_mov_b32 s14, 1280
s_mov_b32 s15, 0x20000
s_add_u32 s42, s38, 12800
s_mul_i32 s43, s61, 160
v_lshlrev_b32 v254, 3, v233
v_add_u32 v255, 4096, v255
s_waitcnt vmcnt(18) lgkmcnt(0)
s_barrier
s_cmp_lg_u32 s3, 0
s_cbranch_scc1 Lf6d
s_mov_b64 exec, 1
s_cmp_eq_u32 s68, 1
s_cbranch_scc1 Lf6l
Lf6f:
global_store_dword v255, v223, s[66:67] offset:0 sc1
s_branch Lf6e
Lf6l:
global_store_dword v255, v223, s[66:67] offset:0
Lf6e:
s_mov_b64 exec, -1
Lf6d:
buffer_load_dwordx4 a[204:207], v232, s[24:27], s33 offen offset:1024
Lt4:
s_lshl_b32 s44, s3, 11
s_mov_b32 m0, s44
s_mov_b64 exec, 0xfffff
buffer_load_dwordx4 v216, s[20:23], s42 offen sc1 lds
s_add_u32 m0, s44, 1024
s_mov_b64 exec, 0x3ff
buffer_load_dwordx4 v216, s[12:15], s43 offen lds
s_mov_b64 exec, -1
global_load_dword v242, v241, s[66:67] sc1
s_waitcnt vmcnt(0)
v_cmp_gt_u32 vcc, 1, v242
s_mov_b32 s6, 0
s_cmp_eq_u64 vcc, 0
s_cbranch_scc1 Lok29
Lsp30:
s_sleep 2
global_load_dword v242, v241, s[66:67] sc1
s_waitcnt vmcnt(0)
v_cmp_gt_u32 vcc, 1, v242
s_add_u32 s6, s6, 1
s_cmp_gt_u32 s6, 200000
s_cbranch_scc1 Lok29
s_cmp_lg_u64 vcc, 0
s_cbranch_scc1 Lsp30
Lok29:
buffer_load_dwordx4 v[80:83], v224, s[28:31], s69 offen offset:0
buffer_load_dwordx4 v[84:87], v225, s[28:31], s69 offen offset:0
buffer_load_dwordx4 v[88:91], v226, s[28:31], s69 offen offset:0
buffer_load_dwordx4 v[92:95], v227, s[28:31], s69 offen offset:0
buffer_load_dwordx4 v[96:99], v224, s[28:31], s69 offen offset:1024
buffer_load_dwordx4 v[100:103], v225, s[28:31], s69 offen offset:1024
buffer_load_dwordx4 v[104:107], v226, s[28:31], s69 offen offset:1024
buffer_load_dwordx4 v[108:111], v227, s[28:31], s69 offen offset:1024
buffer_load_dwordx4 v[112:115], v224, s[28:31], s69 offen offset:2048
buffer_load_dwordx4 v[116:119], v225, s[28:31], s69 offen offset:2048
buffer_load_dwordx4 v[120:123], v226, s[28:31], s69 offen offset:2048
buffer_load_dwordx4 v[124:127], v227, s[28:31], s69 offen offset:2048
buffer_load_dwordx4 v[128:131], v224, s[28:31], s69 offen offset:3072
buffer_load_dwordx4 v[132:135], v225, s[28:31], s69 offen offset:3072
buffer_load_dwordx4 v[136:139], v226, s[28:31], s69 offen offset:3072
buffer_load_dwordx4 v[140:143], v227, s[28:31], s69 offen offset:3072
s_waitcnt vmcnt(12)
v_mfma_f32_16x16x32_bf16 v[0:3], a[224:227], v[80:83], 0
buffer_load_dwordx4 a[208:211], v228, s[24:27], s33 offen offset:2048
v_mfma_f32_16x16x32_bf16 v[20:23], a[224:227], v[84:87], 0
v_mfma_f32_16x16x32_bf16 v[40:43], a[224:227], v[88:91], 0
v_mfma_f32_16x16x32_bf16 v[60:63], a[224:227], v[92:95], 0
v_mfma_f32_16x16x32_bf16 v[64:67], a[228:231], v[92:95], 0
buffer_load_dwordx4 a[212:215], v229, s[24:27], s33 offen offset:2048
v_mfma_f32_16x16x32_bf16 v[44:47], a[228:231], v[88:91], 0
v_mfma_f32_16x16x32_bf16 v[24:27], a[228:231], v[84:87], 0
v_mfma_f32_16x16x32_bf16 v[4:7], a[228:231], v[80:83], 0
v_mfma_f32_16x16x32_bf16 v[8:11], a[232:235], v[80:83], 0
v_mfma_f32_16x16x32_bf16 v[28:31], a[232:235], v[84:87], 0
buffer_load_dwordx4 a[216:219], v230, s[24:27], s33 offen offset:2048
v_mfma_f32_16x16x32_bf16 v[48:51], a[232:235], v[88:91], 0
v_mfma_f32_16x16x32_bf16 v[68:71], a[232:235], v[92:95], 0
v_mfma_f32_16x16x32_bf16 v[72:75], a[236:239], v[92:95], 0
v_mfma_f32_16x16x32_bf16 v[52:55], a[236:239], v[88:91], 0
v_mfma_f32_16x16x32_bf16 v[32:35], a[236:239], v[84:87], 0
buffer_load_dwordx4 a[220:223], v231, s[24:27], s33 offen offset:2048
v_mfma_f32_16x16x32_bf16 v[12:15], a[236:239], v[80:83], 0
v_mfma_f32_16x16x32_bf16 v[16:19], a[240:243], v[80:83], 0
v_mfma_f32_16x16x32_bf16 v[36:39], a[240:243], v[84:87], 0
v_mfma_f32_16x16x32_bf16 v[56:59], a[240:243], v[88:91], 0
v_mfma_f32_16x16x32_bf16 v[76:79], a[240:243], v[92:95], 0
s_waitcnt vmcnt(12)
v_mfma_f32_16x16x32_bf16 v[0:3], a[244:247], v[96:99], v[0:3]
buffer_load_dwordx4 v[80:83], v224, s[28:31], s70 offen offset:0
v_mfma_f32_16x16x32_bf16 v[20:23], a[244:247], v[100:103], v[20:23]
v_mfma_f32_16x16x32_bf16 v[40:43], a[244:247], v[104:107], v[40:43]
buffer_load_dwordx4 v[84:87], v225, s[28:31], s70 offen offset:0
v_mfma_f32_16x16x32_bf16 v[60:63], a[244:247], v[108:111], v[60:63]
v_mfma_f32_16x16x32_bf16 v[64:67], a[248:251], v[108:111], v[64:67]
v_mfma_f32_16x16x32_bf16 v[44:47], a[248:251], v[104:107], v[44:47]
buffer_load_dwordx4 v[88:91], v226, s[28:31], s70 offen offset:0
v_mfma_f32_16x16x32_bf16 v[24:27], a[248:251], v[100:103], v[24:27]
v_mfma_f32_16x16x32_bf16 v[4:7], a[248:251], v[96:99], v[4:7]
v_mfma_f32_16x16x32_bf16 v[8:11], a[252:255], v[96:99], v[8:11]
buffer_load_dwordx4 v[92:95], v227, s[28:31], s70 offen offset:0
v_mfma_f32_16x16x32_bf16 v[28:31], a[252:255], v[100:103], v[28:31]
v_mfma_f32_16x16x32_bf16 v[48:51], a[252:255], v[104:107], v[48:51]
buffer_load_dwordx4 a[0:3], v232, s[24:27], s33 offen offset:2048
v_mfma_f32_16x16x32_bf16 v[68:71], a[252:255], v[108:111], v[68:71]
v_mfma_f32_16x16x32_bf16 v[72:75], v[176:179], v[108:111], v[72:75]
v_mfma_f32_16x16x32_bf16 v[52:55], v[176:179], v[104:107], v[52:55]
buffer_load_dwordx4 a[4:7], v228, s[24:27], s33 offen offset:3072
v_mfma_f32_16x16x32_bf16 v[32:35], v[176:179], v[100:103], v[32:35]
v_mfma_f32_16x16x32_bf16 v[12:15], v[176:179], v[96:99], v[12:15]
v_mfma_f32_16x16x32_bf16 v[16:19], v[180:183], v[96:99], v[16:19]
buffer_load_dwordx4 a[8:11], v229, s[24:27], s33 offen offset:3072
v_mfma_f32_16x16x32_bf16 v[36:39], v[180:183], v[100:103], v[36:39]
v_mfma_f32_16x16x32_bf16 v[56:59], v[180:183], v[104:107], v[56:59]
v_mfma_f32_16x16x32_bf16 v[76:79], v[180:183], v[108:111], v[76:79]
s_waitcnt vmcnt(15)
v_mfma_f32_16x16x32_bf16 v[0:3], v[184:187], v[112:115], v[0:3]
buffer_load_dwordx4 v[96:99], v224, s[28:31], s70 offen offset:1024
v_mfma_f32_16x16x32_bf16 v[20:23], v[184:187], v[116:119], v[20:23]
v_add_u32 v221, s44, v236
v_add_u32 v222, s44, v254
v_mfma_f32_16x16x32_bf16 v[40:43], v[184:187], v[120:123], v[40:43]
buffer_load_dwordx4 v[100:103], v225, s[28:31], s70 offen offset:1024
v_mfma_f32_16x16x32_bf16 v[60:63], v[184:187], v[124:127], v[60:63]
ds_read_b128 v[144:147], v221 offset:0
ds_read_b64 v[200:201], v222 offset:1024
v_mfma_f32_16x16x32_bf16 v[64:67], v[188:191], v[124:127], v[64:67]
v_mfma_f32_16x16x32_bf16 v[44:47], v[188:191], v[120:123], v[44:47]
buffer_load_dwordx4 v[104:107], v226, s[28:31], s70 offen offset:1024
v_mfma_f32_16x16x32_bf16 v[24:27], v[188:191], v[116:119], v[24:27]
ds_read_b128 v[148:151], v221 offset:64
ds_read_b64 v[202:203], v222 offset:1056
v_mfma_f32_16x16x32_bf16 v[4:7], v[188:191], v[112:115], v[4:7]
v_mfma_f32_16x16x32_bf16 v[8:11], v[192:195], v[112:115], v[8:11]
buffer_load_dwordx4 v[108:111], v227, s[28:31], s70 offen offset:1024
v_mfma_f32_16x16x32_bf16 v[28:31], v[192:195], v[116:119], v[28:31]
ds_read_b128 v[152:155], v221 offset:128
ds_read_b64 v[204:205], v222 offset:1088
v_mfma_f32_16x16x32_bf16 v[48:51], v[192:195], v[120:123], v[48:51]
buffer_load_dwordx4 a[12:15], v230, s[24:27], s33 offen offset:3072
v_mfma_f32_16x16x32_bf16 v[68:71], v[192:195], v[124:127], v[68:71]
v_mfma_f32_16x16x32_bf16 v[72:75], v[196:199], v[124:127], v[72:75]
ds_read_b128 v[156:159], v221 offset:192
ds_read_b64 v[206:207], v222 offset:1120
v_mfma_f32_16x16x32_bf16 v[52:55], v[196:199], v[120:123], v[52:55]
buffer_load_dwordx4 a[16:19], v231, s[24:27], s33 offen offset:3072
v_mfma_f32_16x16x32_bf16 v[32:35], v[196:199], v[116:119], v[32:35]
v_mfma_f32_16x16x32_bf16 v[12:15], v[196:199], v[112:115], v[12:15]
ds_read_b128 v[160:163], v221 offset:256
ds_read_b64 v[208:209], v222 offset:1152
v_mfma_f32_16x16x32_bf16 v[16:19], a[64:67], v[112:115], v[16:19]
buffer_load_dwordx4 a[20:23], v232, s[24:27], s33 offen offset:3072
v_mfma_f32_16x16x32_bf16 v[36:39], a[64:67], v[116:119], v[36:39]
v_mfma_f32_16x16x32_bf16 v[56:59], a[64:67], v[120:123], v[56:59]
v_mfma_f32_16x16x32_bf16 v[76:79], a[64:67], v[124:127], v[76:79]
s_waitcnt vmcnt(18) lgkmcnt(0)
v_mfma_f32_16x16x32_bf16 v[0:3], a[68:71], v[128:131], v[0:3]
buffer_load_dwordx4 v[112:115], v224, s[28:31], s70 offen offset:2048
v_mfma_f32_16x16x32_bf16 v[20:23], a[68:71], v[132:135], v[20:23]
v_lshlrev_b32 v164, 16, v244
v_and_b32 v165, 0xffff0000, v244
v_mfma_f32_16x16x32_bf16 v[40:43], a[68:71], v[136:139], v[40:43]
v_lshlrev_b32 v221, 16, v200
v_and_b32 v222, 0xffff0000, v200
v_mfma_f32_16x16x32_bf16 v[60:63], a[68:71], v[140:143], v[60:63]
buffer_load_dwordx4 v[116:119], v225, s[28:31], s70 offen offset:2048
v_mfma_f32_16x16x32_bf16 v[64:67], a[72:75], v[140:143], v[64:67]
v_fmac_f32 v164, v144, v221
v_fmac_f32 v165, v145, v222
v_mfma_f32_16x16x32_bf16 v[44:47], a[72:75], v[136:139], v[44:47]
buffer_load_dwordx4 v[120:123], v226, s[28:31], s70 offen offset:2048
v_mfma_f32_16x16x32_bf16 v[24:27], a[72:75], v[132:135], v[24:27]
v_lshlrev_b32 v166, 16, v245
v_and_b32 v167, 0xffff0000, v245
v_mfma_f32_16x16x32_bf16 v[4:7], a[72:75], v[128:131], v[4:7]
v_lshlrev_b32 v221, 16, v201
v_and_b32 v222, 0xffff0000, v201
v_mfma_f32_16x16x32_bf16 v[8:11], a[76:79], v[128:131], v[8:11]
buffer_load_dwordx4 v[124:127], v227, s[28:31], s70 offen offset:2048
v_mfma_f32_16x16x32_bf16 v[28:31], a[76:79], v[132:135], v[28:31]
s_add_u32 s33, s33, 4096
v_fmac_f32 v166, v146, v221
v_fmac_f32 v167, v147, v222
v_mfma_f32_16x16x32_bf16 v[48:51], a[76:79], v[136:139], v[48:51]
v_mfma_f32_16x16x32_bf16 v[68:71], a[76:79], v[140:143], v[68:71]
v_lshlrev_b32 v168, 16, v246
v_and_b32 v169, 0xffff0000, v246
v_mfma_f32_16x16x32_bf16 v[72:75], a[80:83], v[140:143], v[72:75]
v_mfma_f32_16x16x32_bf16 v[52:55], a[80:83], v[136:139], v[52:55]
buffer_load_dwordx4 a[24:27], v228, s[24:27], s33 offen offset:0
v_mfma_f32_16x16x32_bf16 v[32:35], a[80:83], v[132:135], v[32:35]
v_lshlrev_b32 v221, 16, v202
v_and_b32 v222, 0xffff0000, v202
v_mfma_f32_16x16x32_bf16 v[12:15], a[80:83], v[128:131], v[12:15]
v_fmac_f32 v168, v148, v221
v_fmac_f32 v169, v149, v222
v_mfma_f32_16x16x32_bf16 v[16:19], a[84:87], v[128:131], v[16:19]
buffer_load_dwordx4 a[28:31], v229, s[24:27], s33 offen offset:0
v_mfma_f32_16x16x32_bf16 v[36:39], a[84:87], v[132:135], v[36:39]
v_lshlrev_b32 v170, 16, v247
v_and_b32 v171, 0xffff0000, v247
v_mfma_f32_16x16x32_bf16 v[56:59], a[84:87], v[136:139], v[56:59]
v_mfma_f32_16x16x32_bf16 v[76:79], a[84:87], v[140:143], v[76:79]
s_waitcnt vmcnt(16)
v_mfma_f32_16x16x32_bf16 v[0:3], a[88:91], v[80:83], v[0:3]
buffer_load_dwordx4 v[128:131], v224, s[28:31], s70 offen offset:3072
v_mfma_f32_16x16x32_bf16 v[20:23], a[88:91], v[84:87], v[20:23]
v_lshlrev_b32 v221, 16, v203
v_and_b32 v222, 0xffff0000, v203
v_mfma_f32_16x16x32_bf16 v[40:43], a[88:91], v[88:91], v[40:43]
v_fmac_f32 v170, v150, v221
v_fmac_f32 v171, v151, v222
v_mfma_f32_16x16x32_bf16 v[60:63], a[88:91], v[92:95], v[60:63]
buffer_load_dwordx4 v[132:135], v225, s[28:31], s70 offen offset:3072
v_mfma_f32_16x16x32_bf16 v[64:67], a[92:95], v[92:95], v[64:67]
v_lshlrev_b32 v172, 16, v248
v_and_b32 v173, 0xffff0000, v248
v_mfma_f32_16x16x32_bf16 v[44:47], a[92:95], v[88:91], v[44:47]
v_lshlrev_b32 v221, 16, v204
v_and_b32 v222, 0xffff0000, v204
v_mfma_f32_16x16x32_bf16 v[24:27], a[92:95], v[84:87], v[24:27]
buffer_load_dwordx4 v[136:139], v226, s[28:31], s70 offen offset:3072
v_mfma_f32_16x16x32_bf16 v[4:7], a[92:95], v[80:83], v[4:7]
v_fmac_f32 v172, v152, v221
v_fmac_f32 v173, v153, v222
v_mfma_f32_16x16x32_bf16 v[8:11], a[96:99], v[80:83], v[8:11]
v_mfma_f32_16x16x32_bf16 v[28:31], a[96:99], v[84:87], v[28:31]
buffer_load_dwordx4 v[140:143], v227, s[28:31], s70 offen offset:3072
v_mfma_f32_16x16x32_bf16 v[48:51], a[96:99], v[88:91], v[48:51]
v_lshlrev_b32 v174, 16, v249
v_and_b32 v175, 0xffff0000, v249
v_mfma_f32_16x16x32_bf16 v[68:71], a[96:99], v[92:95], v[68:71]
Lpad29:
s_cbranch_execz Lret2
v_lshlrev_b32 v221, 16, v205
v_and_b32 v222, 0xffff0000, v205
v_mfma_f32_16x16x32_bf16 v[72:75], a[100:103], v[92:95], v[72:75]
buffer_load_dwordx4 a[32:35], v230, s[24:27], s33 offen offset:0
v_mfma_f32_16x16x32_bf16 v[52:55], a[100:103], v[88:91], v[52:55]
v_fmac_f32 v174, v154, v221
v_fmac_f32 v175, v155, v222
v_mfma_f32_16x16x32_bf16 v[32:35], a[100:103], v[84:87], v[32:35]
v_mfma_f32_16x16x32_bf16 v[12:15], a[100:103], v[80:83], v[12:15]
buffer_load_dwordx4 a[36:39], v231, s[24:27], s33 offen offset:0
v_mfma_f32_16x16x32_bf16 v[16:19], a[104:107], v[80:83], v[16:19]
v_lshlrev_b32 v210, 16, v250
v_and_b32 v211, 0xffff0000, v250
v_mfma_f32_16x16x32_bf16 v[36:39], a[104:107], v[84:87], v[36:39]
v_lshlrev_b32 v221, 16, v206
v_and_b32 v222, 0xffff0000, v206
v_mfma_f32_16x16x32_bf16 v[56:59], a[104:107], v[88:91], v[56:59]
v_mfma_f32_16x16x32_bf16 v[76:79], a[104:107], v[92:95], v[76:79]
s_waitcnt vmcnt(15)
v_mfma_f32_16x16x32_bf16 v[0:3], a[108:111], v[96:99], v[0:3]
buffer_load_dwordx4 v[80:83], v224, s[28:31], s71 offen offset:0
v_mfma_f32_16x16x32_bf16 v[20:23], a[108:111], v[100:103], v[20:23]
v_fmac_f32 v210, v156, v221
v_fmac_f32 v211, v157, v222
v_mfma_f32_16x16x32_bf16 v[40:43], a[108:111], v[104:107], v[40:43]
v_lshlrev_b32 v212, 16, v251
v_and_b32 v213, 0xffff0000, v251
v_mfma_f32_16x16x32_bf16 v[60:63], a[108:111], v[108:111], v[60:63]
buffer_load_dwordx4 v[84:87], v225, s[28:31], s71 offen offset:0
v_mfma_f32_16x16x32_bf16 v[64:67], a[112:115], v[108:111], v[64:67]
v_lshlrev_b32 v221, 16, v207
v_and_b32 v222, 0xffff0000, v207
v_mfma_f32_16x16x32_bf16 v[44:47], a[112:115], v[104:107], v[44:47]
v_fmac_f32 v212, v158, v221
v_fmac_f32 v213, v159, v222
v_mfma_f32_16x16x32_bf16 v[24:27], a[112:115], v[100:103], v[24:27]
buffer_load_dwordx4 v[88:91], v226, s[28:31], s71 offen offset:0
v_mfma_f32_16x16x32_bf16 v[4:7], a[112:115], v[96:99], v[4:7]
v_lshlrev_b32 v214, 16, v252
v_and_b32 v215, 0xffff0000, v252
v_mfma_f32_16x16x32_bf16 v[8:11], a[116:119], v[96:99], v[8:11]
v_mfma_f32_16x16x32_bf16 v[28:31], a[116:119], v[100:103], v[28:31]
buffer_load_dwordx4 v[92:95], v227, s[28:31], s71 offen offset:0
v_mfma_f32_16x16x32_bf16 v[48:51], a[116:119], v[104:107], v[48:51]
v_lshlrev_b32 v221, 16, v208
v_and_b32 v222, 0xffff0000, v208
v_mfma_f32_16x16x32_bf16 v[68:71], a[116:119], v[108:111], v[68:71]
v_fmac_f32 v214, v160, v221
v_fmac_f32 v215, v161, v222
v_mfma_f32_16x16x32_bf16 v[72:75], a[120:123], v[108:111], v[72:75]
buffer_load_dwordx4 a[40:43], v232, s[24:27], s33 offen offset:0
v_mfma_f32_16x16x32_bf16 v[52:55], a[120:123], v[104:107], v[52:55]
v_lshlrev_b32 v218, 16, v253
v_and_b32 v219, 0xffff0000, v253
v_mfma_f32_16x16x32_bf16 v[32:35], a[120:123], v[100:103], v[32:35]
v_mfma_f32_16x16x32_bf16 v[12:15], a[120:123], v[96:99], v[12:15]
buffer_load_dwordx4 a[44:47], v228, s[24:27], s33 offen offset:1024
v_mfma_f32_16x16x32_bf16 v[16:19], a[124:127], v[96:99], v[16:19]
v_lshlrev_b32 v221, 16, v209
v_and_b32 v222, 0xffff0000, v209
v_mfma_f32_16x16x32_bf16 v[36:39], a[124:127], v[100:103], v[36:39]
v_fmac_f32 v218, v162, v221
v_fmac_f32 v219, v163, v222
v_mfma_f32_16x16x32_bf16 v[56:59], a[124:127], v[104:107], v[56:59]
v_mfma_f32_16x16x32_bf16 v[76:79], a[124:127], v[108:111], v[76:79]
s_waitcnt vmcnt(14)
v_mfma_f32_16x16x32_bf16 v[0:3], a[128:131], v[112:115], v[0:3]
buffer_load_dwordx4 v[96:99], v224, s[28:31], s71 offen offset:1024
v_mfma_f32_16x16x32_bf16 v[20:23], a[128:131], v[116:119], v[20:23]
v_mfma_f32_16x16x32_bf16 v[40:43], a[128:131], v[120:123], v[40:43]
v_mfma_f32_16x16x32_bf16 v[60:63], a[128:131], v[124:127], v[60:63]
buffer_load_dwordx4 v[100:103], v225, s[28:31], s71 offen offset:1024
v_mfma_f32_16x16x32_bf16 v[64:67], a[132:135], v[124:127], v[64:67]
v_mfma_f32_16x16x32_bf16 v[44:47], a[132:135], v[120:123], v[44:47]
v_mfma_f32_16x16x32_bf16 v[24:27], a[132:135], v[116:119], v[24:27]
buffer_load_dwordx4 v[104:107], v226, s[28:31], s71 offen offset:1024
v_mfma_f32_16x16x32_bf16 v[4:7], a[132:135], v[112:115], v[4:7]
v_mfma_f32_16x16x32_bf16 v[8:11], a[136:139], v[112:115], v[8:11]
v_mfma_f32_16x16x32_bf16 v[28:31], a[136:139], v[116:119], v[28:31]
buffer_load_dwordx4 v[108:111], v227, s[28:31], s71 offen offset:1024
v_mfma_f32_16x16x32_bf16 v[48:51], a[136:139], v[120:123], v[48:51]
v_mfma_f32_16x16x32_bf16 v[68:71], a[136:139], v[124:127], v[68:71]
v_mfma_f32_16x16x32_bf16 v[72:75], a[140:143], v[124:127], v[72:75]
buffer_load_dwordx4 a[48:51], v229, s[24:27], s33 offen offset:1024
v_mfma_f32_16x16x32_bf16 v[52:55], a[140:143], v[120:123], v[52:55]
v_mfma_f32_16x16x32_bf16 v[32:35], a[140:143], v[116:119], v[32:35]
v_mfma_f32_16x16x32_bf16 v[12:15], a[140:143], v[112:115], v[12:15]
buffer_load_dwordx4 a[52:55], v230, s[24:27], s33 offen offset:1024
v_mfma_f32_16x16x32_bf16 v[16:19], a[144:147], v[112:115], v[16:19]
v_mfma_f32_16x16x32_bf16 v[36:39], a[144:147], v[116:119], v[36:39]
v_mfma_f32_16x16x32_bf16 v[56:59], a[144:147], v[120:123], v[56:59]
v_mfma_f32_16x16x32_bf16 v[76:79], a[144:147], v[124:127], v[76:79]
s_waitcnt vmcnt(14)
v_mfma_f32_16x16x32_bf16 v[0:3], a[148:151], v[128:131], v[0:3]
buffer_load_dwordx4 v[112:115], v224, s[28:31], s71 offen offset:2048
v_mfma_f32_16x16x32_bf16 v[20:23], a[148:151], v[132:135], v[20:23]
v_mfma_f32_16x16x32_bf16 v[40:43], a[148:151], v[136:139], v[40:43]
v_mfma_f32_16x16x32_bf16 v[60:63], a[148:151], v[140:143], v[60:63]
buffer_load_dwordx4 v[116:119], v225, s[28:31], s71 offen offset:2048
v_mfma_f32_16x16x32_bf16 v[64:67], a[152:155], v[140:143], v[64:67]
v_mfma_f32_16x16x32_bf16 v[44:47], a[152:155], v[136:139], v[44:47]
v_mfma_f32_16x16x32_bf16 v[24:27], a[152:155], v[132:135], v[24:27]
buffer_load_dwordx4 v[120:123], v226, s[28:31], s71 offen offset:2048
v_mfma_f32_16x16x32_bf16 v[4:7], a[152:155], v[128:131], v[4:7]
v_mfma_f32_16x16x32_bf16 v[8:11], a[156:159], v[128:131], v[8:11]
v_mfma_f32_16x16x32_bf16 v[28:31], a[156:159], v[132:135], v[28:31]
buffer_load_dwordx4 v[124:127], v227, s[28:31], s71 offen offset:2048
v_mfma_f32_16x16x32_bf16 v[48:51], a[156:159], v[136:139], v[48:51]
v_mfma_f32_16x16x32_bf16 v[68:71], a[156:159], v[140:143], v[68:71]
v_mfma_f32_16x16x32_bf16 v[72:75], a[160:163], v[140:143], v[72:75]
buffer_load_dwordx4 a[56:59], v231, s[24:27], s33 offen offset:1024
v_mfma_f32_16x16x32_bf16 v[52:55], a[160:163], v[136:139], v[52:55]
v_mfma_f32_16x16x32_bf16 v[32:35], a[160:163], v[132:135], v[32:35]
v_mfma_f32_16x16x32_bf16 v[12:15], a[160:163], v[128:131], v[12:15]
buffer_load_dwordx4 a[60:63], v232, s[24:27], s33 offen offset:1024
v_mfma_f32_16x16x32_bf16 v[16:19], a[164:167], v[128:131], v[16:19]
v_mfma_f32_16x16x32_bf16 v[36:39], a[164:167], v[132:135], v[36:39]
v_mfma_f32_16x16x32_bf16 v[56:59], a[164:167], v[136:139], v[56:59]
v_mfma_f32_16x16x32_bf16 v[76:79], a[164:167], v[140:143], v[76:79]
s_waitcnt vmcnt(14)
v_mfma_f32_16x16x32_bf16 v[0:3], a[168:171], v[80:83], v[0:3]
buffer_load_dwordx4 v[128:131], v225, s[28:31], s71 offen offset:3072
v_mfma_f32_16x16x32_bf16 v[20:23], a[168:171], v[84:87], v[20:23]
v_mfma_f32_16x16x32_bf16 v[40:43], a[168:171], v[88:91], v[40:43]
v_mfma_f32_16x16x32_bf16 v[60:63], a[168:171], v[92:95], v[60:63]
v_mfma_f32_16x16x32_bf16 v[64:67], a[172:175], v[92:95], v[64:67]
buffer_load_dwordx4 v[132:135], v225, s[28:31], s72 offen offset:0
v_mfma_f32_16x16x32_bf16 v[44:47], a[172:175], v[88:91], v[44:47]
v_mfma_f32_16x16x32_bf16 v[24:27], a[172:175], v[84:87], v[24:27]
v_mfma_f32_16x16x32_bf16 v[4:7], a[172:175], v[80:83], v[4:7]
v_mfma_f32_16x16x32_bf16 v[8:11], a[176:179], v[80:83], v[8:11]
v_mfma_f32_16x16x32_bf16 v[28:31], a[176:179], v[84:87], v[28:31]
buffer_load_dwordx4 v[136:139], v225, s[28:31], s73 offen offset:1024
v_mfma_f32_16x16x32_bf16 v[48:51], a[176:179], v[88:91], v[48:51]
v_mfma_f32_16x16x32_bf16 v[68:71], a[176:179], v[92:95], v[68:71]
v_mfma_f32_16x16x32_bf16 v[72:75], a[180:183], v[92:95], v[72:75]
v_mfma_f32_16x16x32_bf16 v[52:55], a[180:183], v[88:91], v[52:55]
v_mfma_f32_16x16x32_bf16 v[32:35], a[180:183], v[84:87], v[32:35]
buffer_load_dwordx4 v[140:143], v226, s[28:31], s71 offen offset:3072
v_mfma_f32_16x16x32_bf16 v[12:15], a[180:183], v[80:83], v[12:15]
v_mfma_f32_16x16x32_bf16 v[16:19], a[184:187], v[80:83], v[16:19]
v_mfma_f32_16x16x32_bf16 v[36:39], a[184:187], v[84:87], v[36:39]
v_mfma_f32_16x16x32_bf16 v[56:59], a[184:187], v[88:91], v[56:59]
v_mfma_f32_16x16x32_bf16 v[76:79], a[184:187], v[92:95], v[76:79]
s_waitcnt vmcnt(12)
v_mfma_f32_16x16x32_bf16 v[0:3], a[188:191], v[96:99], v[0:3]
buffer_load_dwordx4 v[80:83], v226, s[28:31], s72 offen offset:0
v_mfma_f32_16x16x32_bf16 v[20:23], a[188:191], v[100:103], v[20:23]
s_lshl_b32 s6, s3, 12
s_add_u32 s6, s6, 16384
v_mul_u32_u24 v228, 176, v234
v_mfma_f32_16x16x32_bf16 v[40:43], a[188:191], v[104:107], v[40:43]
v_add3_u32 v228, v228, v254, s6
v_add_u32 v221, 0, v220
v_mfma_f32_16x16x32_bf16 v[60:63], a[188:191], v[108:111], v[60:63]
v_mul_u32_u24 v222, 6554, v221
v_lshrrev_b32 v222, 16, v222
v_mfma_f32_16x16x32_bf16 v[64:67], a[192:195], v[108:111], v[64:67]
buffer_load_dwordx4 v[84:87], v226, s[28:31], s73 offen offset:1024
v_mfma_f32_16x16x32_bf16 v[44:47], a[192:195], v[104:107], v[44:47]
v_lshlrev_b32 v221, 4, v221
v_mad_u32_u24 v229, v222, 16, v221
v_mfma_f32_16x16x32_bf16 v[24:27], a[192:195], v[100:103], v[24:27]
v_add_u32 v229, s6, v229
v_mul_u32_u24 v222, 1120, v222
v_mfma_f32_16x16x32_bf16 v[4:7], a[192:195], v[96:99], v[4:7]
v_add_u32 v241, v222, v221
v_add_u32 v221, 64, v220
v_mfma_f32_16x16x32_bf16 v[8:11], a[196:199], v[96:99], v[8:11]
v_mul_u32_u24 v222, 6554, v221
v_lshrrev_b32 v222, 16, v222
v_mfma_f32_16x16x32_bf16 v[28:31], a[196:199], v[100:103], v[28:31]
buffer_load_dwordx4 v[88:91], v227, s[28:31], s71 offen offset:3072
v_mfma_f32_16x16x32_bf16 v[48:51], a[196:199], v[104:107], v[48:51]
v_lshlrev_b32 v221, 4, v221
v_mad_u32_u24 v230, v222, 16, v221
v_mfma_f32_16x16x32_bf16 v[68:71], a[196:199], v[108:111], v[68:71]
v_add_u32 v230, s6, v230
v_mul_u32_u24 v222, 1120, v222
v_mfma_f32_16x16x32_bf16 v[72:75], a[200:203], v[108:111], v[72:75]
v_add_u32 v242, v222, v221
v_add_u32 v221, 128, v220
v_mfma_f32_16x16x32_bf16 v[52:55], a[200:203], v[104:107], v[52:55]
v_mul_u32_u24 v222, 6554, v221
v_lshrrev_b32 v222, 16, v222
v_mfma_f32_16x16x32_bf16 v[32:35], a[200:203], v[100:103], v[32:35]
buffer_load_dwordx4 v[92:95], v227, s[28:31], s72 offen offset:0
v_mfma_f32_16x16x32_bf16 v[12:15], a[200:203], v[96:99], v[12:15]
v_lshlrev_b32 v221, 4, v221
v_mad_u32_u24 v231, v222, 16, v221
v_mfma_f32_16x16x32_bf16 v[16:19], a[204:207], v[96:99], v[16:19]
v_add_u32 v231, s6, v231
v_mul_u32_u24 v222, 1120, v222
v_mfma_f32_16x16x32_bf16 v[36:39], a[204:207], v[100:103], v[36:39]
v_add_u32 v243, v222, v221
v_lshrrev_b32 v221, 5, v220
v_mfma_f32_16x16x32_bf16 v[56:59], a[204:207], v[104:107], v[56:59]
v_lshl_add_u32 v243, v221, 30, v243
v_mfma_f32_16x16x32_bf16 v[76:79], a[204:207], v[108:111], v[76:79]
s_waitcnt vmcnt(10)
v_mfma_f32_16x16x32_bf16 v[0:3], a[208:211], v[112:115], v[0:3]
buffer_load_dwordx4 v[96:99], v227, s[28:31], s73 offen offset:1024
v_mfma_f32_16x16x32_bf16 v[20:23], a[208:211], v[116:119], v[20:23]
v_mfma_f32_16x16x32_bf16 v[40:43], a[208:211], v[120:123], v[40:43]
v_mfma_f32_16x16x32_bf16 v[60:63], a[208:211], v[124:127], v[60:63]
v_mfma_f32_16x16x32_bf16 v[64:67], a[212:215], v[124:127], v[64:67]
buffer_load_dwordx4 v[100:103], v224, s[28:31], s71 offen offset:3072
v_mfma_f32_16x16x32_bf16 v[44:47], a[212:215], v[120:123], v[44:47]
v_mfma_f32_16x16x32_bf16 v[24:27], a[212:215], v[116:119], v[24:27]
v_mfma_f32_16x16x32_bf16 v[4:7], a[212:215], v[112:115], v[4:7]
v_mfma_f32_16x16x32_bf16 v[8:11], a[216:219], v[112:115], v[8:11]
v_mfma_f32_16x16x32_bf16 v[28:31], a[216:219], v[116:119], v[28:31]
buffer_load_dwordx4 v[104:107], v224, s[28:31], s72 offen offset:0
v_mfma_f32_16x16x32_bf16 v[48:51], a[216:219], v[120:123], v[48:51]
v_mfma_f32_16x16x32_bf16 v[68:71], a[216:219], v[124:127], v[68:71]
v_mfma_f32_16x16x32_bf16 v[72:75], a[220:223], v[124:127], v[72:75]
v_mfma_f32_16x16x32_bf16 v[52:55], a[220:223], v[120:123], v[52:55]
v_mfma_f32_16x16x32_bf16 v[32:35], a[220:223], v[116:119], v[32:35]
buffer_load_dwordx4 v[108:111], v224, s[28:31], s73 offen offset:1024
v_mfma_f32_16x16x32_bf16 v[12:15], a[220:223], v[112:115], v[12:15]
v_mfma_f32_16x16x32_bf16 v[16:19], a[0:3], v[112:115], v[16:19]
v_mfma_f32_16x16x32_bf16 v[36:39], a[0:3], v[116:119], v[36:39]
v_mfma_f32_16x16x32_bf16 v[56:59], a[0:3], v[120:123], v[56:59]
v_mfma_f32_16x16x32_bf16 v[76:79], a[0:3], v[124:127], v[76:79]
s_waitcnt vmcnt(9)
v_mfma_f32_16x16x32_bf16 v[20:23], a[4:7], v[128:131], v[20:23]
v_mfma_f32_16x16x32_bf16 v[20:23], a[24:27], v[132:135], v[20:23]
v_mfma_f32_16x16x32_bf16 v[20:23], a[44:47], v[136:139], v[20:23]
v_mfma_f32_16x16x32_bf16 v[24:27], a[48:51], v[136:139], v[24:27]
v_mfma_f32_16x16x32_bf16 v[24:27], a[28:31], v[132:135], v[24:27]
v_mfma_f32_16x16x32_bf16 v[24:27], a[8:11], v[128:131], v[24:27]
v_mfma_f32_16x16x32_bf16 v[28:31], a[12:15], v[128:131], v[28:31]
v_mfma_f32_16x16x32_bf16 v[28:31], a[32:35], v[132:135], v[28:31]
v_mfma_f32_16x16x32_bf16 v[28:31], a[52:55], v[136:139], v[28:31]
v_mfma_f32_16x16x32_bf16 v[32:35], a[56:59], v[136:139], v[32:35]
v_mfma_f32_16x16x32_bf16 v[32:35], a[36:39], v[132:135], v[32:35]
v_mfma_f32_16x16x32_bf16 v[32:35], a[16:19], v[128:131], v[32:35]
v_mfma_f32_16x16x32_bf16 v[36:39], a[20:23], v[128:131], v[36:39]
v_mfma_f32_16x16x32_bf16 v[36:39], a[40:43], v[132:135], v[36:39]
v_mfma_f32_16x16x32_bf16 v[36:39], a[60:63], v[136:139], v[36:39]
s_waitcnt vmcnt(6)
v_mfma_f32_16x16x32_bf16 v[40:43], a[4:7], v[140:143], v[40:43]
v_mfma_f32_16x16x32_bf16 v[40:43], a[24:27], v[80:83], v[40:43]
v_mfma_f32_16x16x32_bf16 v[40:43], a[44:47], v[84:87], v[40:43]
v_mfma_f32_16x16x32_bf16 v[44:47], a[48:51], v[84:87], v[44:47]
ds_write_b128 v238, v[20:23] offset:5120
v_mfma_f32_16x16x32_bf16 v[44:47], a[28:31], v[80:83], v[44:47]
v_mfma_f32_16x16x32_bf16 v[44:47], a[8:11], v[140:143], v[44:47]
ds_write_b128 v238, v[24:27] offset:6144
v_mfma_f32_16x16x32_bf16 v[48:51], a[12:15], v[140:143], v[48:51]
v_mfma_f32_16x16x32_bf16 v[48:51], a[32:35], v[80:83], v[48:51]
ds_write_b128 v238, v[28:31] offset:7168
v_mfma_f32_16x16x32_bf16 v[48:51], a[52:55], v[84:87], v[48:51]
v_mfma_f32_16x16x32_bf16 v[52:55], a[56:59], v[84:87], v[52:55]
v_mfma_f32_16x16x32_bf16 v[52:55], a[36:39], v[80:83], v[52:55]
ds_write_b128 v238, v[32:35] offset:8192
v_mfma_f32_16x16x32_bf16 v[52:55], a[16:19], v[140:143], v[52:55]
v_mfma_f32_16x16x32_bf16 v[56:59], a[20:23], v[140:143], v[56:59]
ds_write_b128 v238, v[36:39] offset:9216
v_mfma_f32_16x16x32_bf16 v[56:59], a[40:43], v[80:83], v[56:59]
v_mfma_f32_16x16x32_bf16 v[56:59], a[60:63], v[84:87], v[56:59]
s_waitcnt vmcnt(3)
v_mfma_f32_16x16x32_bf16 v[60:63], a[4:7], v[88:91], v[60:63]
v_mfma_f32_16x16x32_bf16 v[60:63], a[24:27], v[92:95], v[60:63]
v_mfma_f32_16x16x32_bf16 v[60:63], a[44:47], v[96:99], v[60:63]
v_mfma_f32_16x16x32_bf16 v[64:67], a[48:51], v[96:99], v[64:67]
ds_write_b128 v239, v[40:43] offset:10240
v_mfma_f32_16x16x32_bf16 v[64:67], a[28:31], v[92:95], v[64:67]
v_mfma_f32_16x16x32_bf16 v[64:67], a[8:11], v[88:91], v[64:67]
ds_write_b128 v239, v[44:47] offset:11264
v_mfma_f32_16x16x32_bf16 v[68:71], a[12:15], v[88:91], v[68:71]
v_mfma_f32_16x16x32_bf16 v[68:71], a[32:35], v[92:95], v[68:71]
ds_write_b128 v239, v[48:51] offset:12288
v_mfma_f32_16x16x32_bf16 v[68:71], a[52:55], v[96:99], v[68:71]
v_mfma_f32_16x16x32_bf16 v[72:75], a[56:59], v[96:99], v[72:75]
v_mfma_f32_16x16x32_bf16 v[72:75], a[36:39], v[92:95], v[72:75]
ds_write_b128 v239, v[52:55] offset:13312
v_mfma_f32_16x16x32_bf16 v[72:75], a[16:19], v[88:91], v[72:75]
v_mfma_f32_16x16x32_bf16 v[76:79], a[20:23], v[88:91], v[76:79]
ds_write_b128 v239, v[56:59] offset:14336
v_mfma_f32_16x16x32_bf16 v[76:79], a[40:43], v[92:95], v[76:79]
v_mfma_f32_16x16x32_bf16 v[76:79], a[60:63], v[96:99], v[76:79]
s_waitcnt vmcnt(0)
v_mfma_f32_16x16x32_bf16 v[0:3], a[4:7], v[100:103], v[0:3]
v_mfma_f32_16x16x32_bf16 v[0:3], a[24:27], v[104:107], v[0:3]
v_mfma_f32_16x16x32_bf16 v[0:3], a[44:47], v[108:111], v[0:3]
v_mfma_f32_16x16x32_bf16 v[4:7], a[48:51], v[108:111], v[4:7]
ds_write_b128 v240, v[60:63] offset:15360
v_mfma_f32_16x16x32_bf16 v[4:7], a[28:31], v[104:107], v[4:7]
v_mfma_f32_16x16x32_bf16 v[4:7], a[8:11], v[100:103], v[4:7]
ds_write_b128 v240, v[64:67] offset:16384
v_mfma_f32_16x16x32_bf16 v[8:11], a[12:15], v[100:103], v[8:11]
v_mfma_f32_16x16x32_bf16 v[8:11], a[32:35], v[104:107], v[8:11]
ds_write_b128 v240, v[68:71] offset:17408
v_mfma_f32_16x16x32_bf16 v[8:11], a[52:55], v[108:111], v[8:11]
v_mfma_f32_16x16x32_bf16 v[12:15], a[56:59], v[108:111], v[12:15]
v_mfma_f32_16x16x32_bf16 v[12:15], a[36:39], v[104:107], v[12:15]
ds_write_b128 v240, v[72:75] offset:18432
v_mfma_f32_16x16x32_bf16 v[12:15], a[16:19], v[100:103], v[12:15]
v_mfma_f32_16x16x32_bf16 v[16:19], a[20:23], v[100:103], v[16:19]
ds_write_b128 v240, v[76:79] offset:19456
v_mfma_f32_16x16x32_bf16 v[16:19], a[40:43], v[104:107], v[16:19]
v_mfma_f32_16x16x32_bf16 v[16:19], a[60:63], v[108:111], v[16:19]
s_waitcnt lgkmcnt(0)
s_barrier
ds_read_b128 v[20:23], v237 offset:5120
ds_read_b128 v[24:27], v237 offset:6144
ds_read_b128 v[28:31], v237 offset:7168
ds_read_b128 v[32:35], v237 offset:8192
ds_read_b128 v[36:39], v237 offset:9216
ds_read_b128 v[40:43], v237 offset:10240
ds_read_b128 v[44:47], v237 offset:11264
ds_read_b128 v[48:51], v237 offset:12288
ds_read_b128 v[52:55], v237 offset:13312
ds_read_b128 v[56:59], v237 offset:14336
ds_read_b128 v[60:63], v237 offset:15360
ds_read_b128 v[64:67], v237 offset:16384
ds_read_b128 v[68:71], v237 offset:17408
ds_read_b128 v[72:75], v237 offset:18432
ds_read_b128 v[76:79], v237 offset:19456
s_waitcnt lgkmcnt(10)
v_pk_add_f32 v[0:1], v[0:1], v[20:21]
v_pk_add_f32 v[2:3], v[2:3], v[22:23]
v_pk_add_f32 v[4:5], v[4:5], v[24:25]
v_pk_add_f32 v[6:7], v[6:7], v[26:27]
v_pk_add_f32 v[8:9], v[8:9], v[28:29]
v_pk_add_f32 v[10:11], v[10:11], v[30:31]
v_pk_add_f32 v[12:13], v[12:13], v[32:33]
v_pk_add_f32 v[14:15], v[14:15], v[34:35]
v_pk_add_f32 v[16:17], v[16:17], v[36:37]
v_pk_add_f32 v[18:19], v[18:19], v[38:39]
s_waitcnt lgkmcnt(5)
v_pk_add_f32 v[0:1], v[0:1], v[40:41]
v_pk_add_f32 v[2:3], v[2:3], v[42:43]
v_pk_add_f32 v[4:5], v[4:5], v[44:45]
v_pk_add_f32 v[6:7], v[6:7], v[46:47]
v_pk_add_f32 v[8:9], v[8:9], v[48:49]
v_pk_add_f32 v[10:11], v[10:11], v[50:51]
v_pk_add_f32 v[12:13], v[12:13], v[52:53]
v_pk_add_f32 v[14:15], v[14:15], v[54:55]
v_pk_add_f32 v[16:17], v[16:17], v[56:57]
v_pk_add_f32 v[18:19], v[18:19], v[58:59]
s_waitcnt lgkmcnt(0)
v_pk_add_f32 v[0:1], v[0:1], v[60:61]
v_pk_add_f32 v[2:3], v[2:3], v[62:63]
v_pk_add_f32 v[4:5], v[4:5], v[64:65]
v_pk_add_f32 v[6:7], v[6:7], v[66:67]
v_pk_add_f32 v[8:9], v[8:9], v[68:69]
v_pk_add_f32 v[10:11], v[10:11], v[70:71]
v_pk_add_f32 v[12:13], v[12:13], v[72:73]
v_pk_add_f32 v[14:15], v[14:15], v[74:75]
v_pk_add_f32 v[16:17], v[16:17], v[76:77]
v_pk_add_f32 v[18:19], v[18:19], v[78:79]
v_pk_fma_f32 v[0:1], v[144:145], v[0:1], v[164:165]
v_pk_fma_f32 v[2:3], v[146:147], v[2:3], v[166:167]
v_pk_fma_f32 v[4:5], v[148:149], v[4:5], v[168:169]
v_pk_fma_f32 v[6:7], v[150:151], v[6:7], v[170:171]
v_pk_fma_f32 v[8:9], v[152:153], v[8:9], v[172:173]
v_pk_fma_f32 v[10:11], v[154:155], v[10:11], v[174:175]
v_pk_fma_f32 v[12:13], v[156:157], v[12:13], v[210:211]
v_pk_fma_f32 v[14:15], v[158:159], v[14:15], v[212:213]
v_pk_fma_f32 v[16:17], v[160:161], v[16:17], v[214:215]
v_pk_fma_f32 v[18:19], v[162:163], v[18:19], v[218:219]
v_cvt_pk_bf16_f32 v60, v0, v1
v_cvt_pk_bf16_f32 v61, v2, v3
ds_write_b64 v228, v[60:61] offset:0
v_cvt_pk_bf16_f32 v62, v4, v5
v_cvt_pk_bf16_f32 v63, v6, v7
ds_write_b64 v228, v[62:63] offset:32
v_cvt_pk_bf16_f32 v64, v8, v9
v_cvt_pk_bf16_f32 v65, v10, v11
ds_write_b64 v228, v[64:65] offset:64
v_cvt_pk_bf16_f32 v66, v12, v13
v_cvt_pk_bf16_f32 v67, v14, v15
ds_write_b64 v228, v[66:67] offset:96
v_cvt_pk_bf16_f32 v68, v16, v17
v_cvt_pk_bf16_f32 v69, v18, v19
ds_write_b64 v228, v[68:69] offset:128
s_waitcnt lgkmcnt(0)
ds_read_b128 v[40:43], v229
ds_read_b128 v[44:47], v230
ds_read_b128 v[48:51], v231
s_waitcnt lgkmcnt(2)
buffer_store_dwordx4 v[40:43], v241, s[16:19], s35 offen sc1
s_waitcnt lgkmcnt(1)
buffer_store_dwordx4 v[44:47], v242, s[16:19], s35 offen sc1
s_waitcnt lgkmcnt(0)
buffer_store_dwordx4 v[48:51], v243, s[16:19], s35 offen sc1
s_endpgm
LX2:
Lpad30:
s_cbranch_execz Lret1
v_add_f32 v112, v224, v108
v_add_f32 v113, v225, v109
v_add_f32 v114, v226, v110
v_add_f32 v115, v227, v111
v_add_f32 v116, v228, v108
v_add_f32 v117, v229, v109
v_add_f32 v118, v230, v110
v_add_f32 v119, v231, v111
s_nop 1
v_mfma_f32_16x16x32_bf16 v[36:39], a[224:227], v[176:179], v[112:115]
ds_read_b128 a[192:195], v217 offset:24576
ds_read_b128 a[196:199], v217 offset:25600
v_add_f32 v120, v232, v108
v_mfma_f32_16x16x32_bf16 v[36:39], a[228:231], v[180:183], v[36:39]
ds_read_b128 a[200:203], v217 offset:26624
ds_read_b128 a[204:207], v217 offset:27648
v_add_f32 v121, v233, v109
v_mfma_f32_16x16x32_bf16 v[36:39], a[232:235], v[184:187], v[36:39]
v_add_f32 v122, v234, v110
v_add_f32 v123, v235, v111
v_add_f32 v124, v236, v108
v_mfma_f32_16x16x32_bf16 v[36:39], a[236:239], v[188:191], v[36:39]
s_waitcnt lgkmcnt(4)
ds_read_b128 a[208:211], v217 offset:28672
ds_read_b128 a[212:215], v217 offset:29696
v_add_f32 v125, v237, v109
v_mfma_f32_16x16x32_bf16 v[44:47], a[252:255], v[188:191], v[116:119]
ds_read_b128 a[216:219], v217 offset:30720
ds_read_b128 a[220:223], v217 offset:31744
v_add_f32 v126, v238, v110
v_mfma_f32_16x16x32_bf16 v[44:47], a[248:251], v[184:187], v[44:47]
v_add_f32 v127, v239, v111
v_exp_f32 v208, v0
v_mfma_f32_16x16x32_bf16 v[44:47], a[244:247], v[180:183], v[44:47]
v_exp_f32 v209, v1
v_mfma_f32_16x16x32_bf16 v[44:47], a[240:243], v[176:179], v[44:47]
s_waitcnt lgkmcnt(4)
ds_read_b128 a[224:227], v218 offset:24576
ds_read_b128 a[228:231], v218 offset:25600
ds_read_b128 a[232:235], v218 offset:26624
v_cvt_pk_bf16_f32 v64, v208, v209
v_mfma_f32_16x16x32_bf16 v[52:55], a[192:195], v[176:179], v[120:123]
ds_read_b128 a[236:239], v218 offset:27648
v_exp_f32 v210, v2
v_mfma_f32_16x16x32_bf16 v[52:55], a[196:199], v[180:183], v[52:55]
v_exp_f32 v211, v3
v_mfma_f32_16x16x32_bf16 v[52:55], a[200:203], v[184:187], v[52:55]
v_cvt_pk_bf16_f32 v65, v210, v211
v_exp_f32 v212, v8
v_mfma_f32_16x16x32_bf16 v[52:55], a[204:207], v[188:191], v[52:55]
s_waitcnt lgkmcnt(4)
ds_read_b128 a[240:243], v218 offset:28672
ds_read_b128 a[244:247], v218 offset:29696
ds_read_b128 a[248:251], v218 offset:30720
v_mfma_f32_16x16x32_bf16 v[60:63], a[220:223], v[188:191], v[124:127]
ds_read_b128 a[252:255], v218 offset:31744
v_exp_f32 v213, v9
v_mfma_f32_16x16x32_bf16 v[60:63], a[216:219], v[184:187], v[60:63]
v_xor_b32 v218, 0x8000, v218
v_exp_f32 v214, v10
v_mfma_f32_16x16x32_bf16 v[60:63], a[212:215], v[180:183], v[60:63]
v_cvt_pk_bf16_f32 v66, v212, v213
v_exp_f32 v215, v11
v_mfma_f32_16x16x32_bf16 v[60:63], a[208:211], v[176:179], v[60:63]
v_cvt_pk_bf16_f32 v67, v214, v215
s_waitcnt vmcnt(12) lgkmcnt(4)
s_barrier
v_cmp_gt_u32 vcc, 32, v221
s_mov_b32 s6, 0
s_cmp_eq_u64 vcc, 0
s_cbranch_scc1 Lok19
Lsp20:
s_sleep 10
global_load_dword v221, v197, s[66:67] sc1
s_waitcnt vmcnt(0)
v_cmp_gt_u32 vcc, 32, v221
s_add_u32 s6, s6, 1
s_cmp_gt_u32 s6, 200000
s_cbranch_scc1 Lok19
s_cmp_lg_u64 vcc, 0
s_cbranch_scc1 Lsp20
Lok19:
v_mfma_f32_16x16x32_bf16 a[32:35], a[224:227], v[84:87], a[32:35]
ds_read_b128 a[192:195], v218 offset:0
ds_read_b128 a[196:199], v218 offset:8192
ds_read_b128 a[200:203], v218 offset:1024
v_mfma_f32_16x16x32_bf16 a[36:39], a[228:231], v[84:87], a[36:39]
ds_read_b128 a[204:207], v218 offset:9216
buffer_load_dwordx4 a[180:183], v192, s[24:27], s32 offen offset:2048
v_mfma_f32_16x16x32_bf16 a[68:71], a[228:231], v[88:91], a[68:71]
v_exp_f32 v208, v16
v_mfma_f32_16x16x32_bf16 a[64:67], a[224:227], v[88:91], a[64:67]
buffer_load_dwordx4 a[184:187], v193, s[24:27], s32 offen offset:2048
v_mfma_f32_16x16x32_bf16 a[96:99], a[224:227], v[92:95], a[96:99]
v_exp_f32 v209, v17
v_mfma_f32_16x16x32_bf16 a[100:103], a[228:231], v[92:95], a[100:103]
v_cvt_pk_bf16_f32 v68, v208, v209
v_exp_f32 v210, v18
v_mfma_f32_16x16x32_bf16 a[104:107], a[232:235], v[92:95], a[104:107]
v_exp_f32 v211, v19
v_mfma_f32_16x16x32_bf16 a[108:111], a[236:239], v[92:95], a[108:111]
buffer_load_dwordx4 a[188:191], v194, s[24:27], s32 offen offset:2048
v_exp_f32 v212, v24
v_mfma_f32_16x16x32_bf16 a[76:79], a[236:239], v[88:91], a[76:79]
v_cvt_pk_bf16_f32 v69, v210, v211
v_exp_f32 v213, v25
v_mfma_f32_16x16x32_bf16 a[72:75], a[232:235], v[88:91], a[72:75]
v_cvt_pk_bf16_f32 v70, v212, v213
v_exp_f32 v214, v26
v_mfma_f32_16x16x32_bf16 a[40:43], a[232:235], v[84:87], a[40:43]
buffer_load_dwordx4 a[160:163], v192, s[24:27], s32 offen offset:3072
v_mfma_f32_16x16x32_bf16 a[44:47], a[236:239], v[84:87], a[44:47]
s_waitcnt lgkmcnt(4)
ds_read_b128 a[208:211], v218 offset:2048
ds_read_b128 a[212:215], v218 offset:10240
ds_read_b128 a[216:219], v218 offset:3072
ds_read_b128 a[220:223], v218 offset:11264
v_mfma_f32_16x16x32_bf16 a[48:51], a[240:243], v[84:87], a[48:51]
v_exp_f32 v215, v27
v_mfma_f32_16x16x32_bf16 a[52:55], a[244:247], v[84:87], a[52:55]
v_cvt_pk_bf16_f32 v71, v214, v215
v_exp_f32 v208, v4
v_mfma_f32_16x16x32_bf16 a[84:87], a[244:247], v[88:91], a[84:87]
buffer_load_dwordx4 a[164:167], v193, s[24:27], s32 offen offset:3072
v_exp_f32 v209, v5
v_mfma_f32_16x16x32_bf16 a[80:83], a[240:243], v[88:91], a[80:83]
v_cvt_pk_bf16_f32 v72, v208, v209
v_exp_f32 v210, v6
v_mfma_f32_16x16x32_bf16 a[112:115], a[240:243], v[92:95], a[112:115]
v_exp_f32 v211, v7
v_mfma_f32_16x16x32_bf16 a[116:119], a[244:247], v[92:95], a[116:119]
buffer_load_dwordx4 a[168:171], v194, s[24:27], s32 offen offset:3072
v_exp_f32 v212, v12
v_mfma_f32_16x16x32_bf16 a[120:123], a[248:251], v[92:95], a[120:123]
v_cvt_pk_bf16_f32 v73, v210, v211
v_exp_f32 v213, v13
v_mfma_f32_16x16x32_bf16 a[124:127], a[252:255], v[92:95], a[124:127]
v_exp_f32 v214, v14
v_exp_f32 v215, v15
v_mfma_f32_16x16x32_bf16 a[92:95], a[252:255], v[88:91], a[92:95]
v_cvt_pk_bf16_f32 v74, v212, v213
v_exp_f32 v208, v20
v_mfma_f32_16x16x32_bf16 a[88:91], a[248:251], v[88:91], a[88:91]
buffer_load_dwordx4 a[172:175], v195, s[24:27], s32 offen offset:3072
v_exp_f32 v209, v21
v_mfma_f32_16x16x32_bf16 a[56:59], a[248:251], v[84:87], a[56:59]
v_cvt_pk_bf16_f32 v75, v214, v215
v_exp_f32 v210, v22
v_mfma_f32_16x16x32_bf16 a[60:63], a[252:255], v[84:87], a[60:63]
v_exp_f32 v211, v23
v_exp_f32 v212, v28
v_mfma_f32_16x16x32_bf16 a[132:135], a[144:147], v[84:87], a[132:135]
v_cvt_pk_bf16_f32 v76, v208, v209
v_exp_f32 v213, v29
v_mfma_f32_16x16x32_bf16 a[136:139], a[144:147], v[88:91], a[136:139]
v_cvt_pk_bf16_f32 v77, v210, v211
v_exp_f32 v214, v30
v_mfma_f32_16x16x32_bf16 a[140:143], a[144:147], v[92:95], a[140:143]
s_waitcnt lgkmcnt(4)
v_exp_f32 v215, v31
v_cvt_pk_bf16_f32 v78, v212, v213
s_nop 0
v_cvt_pk_bf16_f32 v79, v214, v215
s_branch LtailB
Lepi01:
Lpad31:
s_cbranch_execz Lret1
s_cmp_eq_u32 s99, 1
s_cbranch_scc1 Lepi1
Lepi0:
v_accvgpr_read_b32 v0, a0
v_accvgpr_read_b32 v1, a1
v_accvgpr_read_b32 v2, a2
v_accvgpr_read_b32 v3, a3
v_accvgpr_read_b32 v4, a4
v_accvgpr_read_b32 v5, a5
v_accvgpr_read_b32 v6, a6
v_accvgpr_read_b32 v7, a7
v_pk_mul_f32 v[0:1], v[0:1], v[208:209] op_sel_hi:[1,0]
v_pk_mul_f32 v[2:3], v[2:3], v[208:209] op_sel_hi:[1,0]
v_pk_mul_f32 v[4:5], v[4:5], v[208:209] op_sel_hi:[1,0]
v_pk_mul_f32 v[6:7], v[6:7], v[208:209] op_sel_hi:[1,0]
v_cvt_pk_bf16_f32 v32, v0, v1
v_cvt_pk_bf16_f32 v33, v2, v3
v_cvt_pk_bf16_f32 v34, v4, v5
v_cvt_pk_bf16_f32 v35, v6, v7
buffer_store_dwordx4 v[32:35], v216, s[28:31], s42 offen offset:0 sc1
v_accvgpr_read_b32 v8, a8
v_accvgpr_read_b32 v9, a9
v_accvgpr_read_b32 v10, a10
v_accvgpr_read_b32 v11, a11
v_accvgpr_read_b32 v12, a12
v_accvgpr_read_b32 v13, a13
v_accvgpr_read_b32 v14, a14
v_accvgpr_read_b32 v15, a15
v_pk_mul_f32 v[8:9], v[8:9], v[208:209] op_sel_hi:[1,0]
v_pk_mul_f32 v[10:11], v[10:11], v[208:209] op_sel_hi:[1,0]
Lpad32:
s_cbranch_execz Lret1
v_pk_mul_f32 v[12:13], v[12:13], v[208:209] op_sel_hi:[1,0]
v_pk_mul_f32 v[14:15], v[14:15], v[208:209] op_sel_hi:[1,0]
v_cvt_pk_bf16_f32 v36, v8, v9
v_cvt_pk_bf16_f32 v37, v10, v11
v_cvt_pk_bf16_f32 v38, v12, v13
v_cvt_pk_bf16_f32 v39, v14, v15
buffer_store_dwordx4 v[36:39], v216, s[28:31], s42 offen offset:1024 sc1
v_accvgpr_read_b32 v16, a16
v_accvgpr_read_b32 v17, a17
v_accvgpr_read_b32 v18, a18
v_accvgpr_read_b32 v19, a19
v_accvgpr_read_b32 v20, a20
v_accvgpr_read_b32 v21, a21
v_accvgpr_read_b32 v22, a22
v_accvgpr_read_b32 v23, a23
v_pk_mul_f32 v[16:17], v[16:17], v[208:209] op_sel_hi:[1,0]
v_pk_mul_f32 v[18:19], v[18:19], v[208:209] op_sel_hi:[1,0]
v_pk_mul_f32 v[20:21], v[20:21], v[208:209] op_sel_hi:[1,0]
v_pk_mul_f32 v[22:23], v[22:23], v[208:209] op_sel_hi:[1,0]
v_cvt_pk_bf16_f32 v40, v16, v17
v_cvt_pk_bf16_f32 v41, v18, v19
v_cvt_pk_bf16_f32 v42, v20, v21
v_cvt_pk_bf16_f32 v43, v22, v23
buffer_store_dwordx4 v[40:43], v216, s[28:31], s42 offen offset:2048 sc1
v_accvgpr_read_b32 v24, a24
v_accvgpr_read_b32 v25, a25
v_accvgpr_read_b32 v26, a26
v_accvgpr_read_b32 v27, a27
v_accvgpr_read_b32 v28, a28
v_accvgpr_read_b32 v29, a29
v_accvgpr_read_b32 v30, a30
v_accvgpr_read_b32 v31, a31
v_pk_mul_f32 v[24:25], v[24:25], v[208:209] op_sel_hi:[1,0]
v_pk_mul_f32 v[26:27], v[26:27], v[208:209] op_sel_hi:[1,0]
v_pk_mul_f32 v[28:29], v[28:29], v[208:209] op_sel_hi:[1,0]
v_pk_mul_f32 v[30:31], v[30:31], v[208:209] op_sel_hi:[1,0]
v_cvt_pk_bf16_f32 v44, v24, v25
v_cvt_pk_bf16_f32 v45, v26, v27
v_cvt_pk_bf16_f32 v46, v28, v29
v_cvt_pk_bf16_f32 v47, v30, v31
buffer_store_dwordx4 v[44:47], v216, s[28:31], s42 offen offset:3072 sc1
Lepi1:
Lpad33:
s_cbranch_execz Lret1
v_accvgpr_read_b32 v0, a32
v_accvgpr_read_b32 v1, a33
v_accvgpr_read_b32 v2, a34
v_accvgpr_read_b32 v3, a35
v_accvgpr_read_b32 v4, a36
v_accvgpr_read_b32 v5, a37
v_accvgpr_read_b32 v6, a38
v_accvgpr_read_b32 v7, a39
v_pk_mul_f32 v[0:1], v[0:1], v[210:211] op_sel_hi:[1,0]
v_pk_mul_f32 v[2:3], v[2:3], v[210:211] op_sel_hi:[1,0]
v_pk_mul_f32 v[4:5], v[4:5], v[210:211] op_sel_hi:[1,0]
v_pk_mul_f32 v[6:7], v[6:7], v[210:211] op_sel_hi:[1,0]
v_cvt_pk_bf16_f32 v32, v0, v1
v_cvt_pk_bf16_f32 v33, v2, v3
v_cvt_pk_bf16_f32 v34, v4, v5
v_cvt_pk_bf16_f32 v35, v6, v7
buffer_store_dwordx4 v[32:35], v216, s[28:31], s43 offen offset:0 sc1
v_accvgpr_read_b32 v8, a40
v_accvgpr_read_b32 v9, a41
v_accvgpr_read_b32 v10, a42
v_accvgpr_read_b32 v11, a43
v_accvgpr_read_b32 v12, a44
v_accvgpr_read_b32 v13, a45
v_accvgpr_read_b32 v14, a46
v_accvgpr_read_b32 v15, a47
v_pk_mul_f32 v[8:9], v[8:9], v[210:211] op_sel_hi:[1,0]
v_pk_mul_f32 v[10:11], v[10:11], v[210:211] op_sel_hi:[1,0]
v_pk_mul_f32 v[12:13], v[12:13], v[210:211] op_sel_hi:[1,0]
v_pk_mul_f32 v[14:15], v[14:15], v[210:211] op_sel_hi:[1,0]
v_cvt_pk_bf16_f32 v36, v8, v9
v_cvt_pk_bf16_f32 v37, v10, v11
v_cvt_pk_bf16_f32 v38, v12, v13
v_cvt_pk_bf16_f32 v39, v14, v15
buffer_store_dwordx4 v[36:39], v216, s[28:31], s43 offen offset:1024 sc1
v_accvgpr_read_b32 v16, a48
v_accvgpr_read_b32 v17, a49
v_accvgpr_read_b32 v18, a50
v_accvgpr_read_b32 v19, a51
v_accvgpr_read_b32 v20, a52
v_accvgpr_read_b32 v21, a53
v_accvgpr_read_b32 v22, a54
v_accvgpr_read_b32 v23, a55
v_pk_mul_f32 v[16:17], v[16:17], v[210:211] op_sel_hi:[1,0]
v_pk_mul_f32 v[18:19], v[18:19], v[210:211] op_sel_hi:[1,0]
v_pk_mul_f32 v[20:21], v[20:21], v[210:211] op_sel_hi:[1,0]
v_pk_mul_f32 v[22:23], v[22:23], v[210:211] op_sel_hi:[1,0]
v_cvt_pk_bf16_f32 v40, v16, v17
v_cvt_pk_bf16_f32 v41, v18, v19
v_cvt_pk_bf16_f32 v42, v20, v21
v_cvt_pk_bf16_f32 v43, v22, v23
buffer_store_dwordx4 v[40:43], v216, s[28:31], s43 offen offset:2048 sc1
v_accvgpr_read_b32 v24, a56
v_accvgpr_read_b32 v25, a57
v_accvgpr_read_b32 v26, a58
v_accvgpr_read_b32 v27, a59
v_accvgpr_read_b32 v28, a60
v_accvgpr_read_b32 v29, a61
v_accvgpr_read_b32 v30, a62
v_accvgpr_read_b32 v31, a63
v_pk_mul_f32 v[24:25], v[24:25], v[210:211] op_sel_hi:[1,0]
v_pk_mul_f32 v[26:27], v[26:27], v[210:211] op_sel_hi:[1,0]
v_pk_mul_f32 v[28:29], v[28:29], v[210:211] op_sel_hi:[1,0]
v_pk_mul_f32 v[30:31], v[30:31], v[210:211] op_sel_hi:[1,0]
v_cvt_pk_bf16_f32 v44, v24, v25
v_cvt_pk_bf16_f32 v45, v26, v27
v_cvt_pk_bf16_f32 v46, v28, v29
v_cvt_pk_bf16_f32 v47, v30, v31
buffer_store_dwordx4 v[44:47], v216, s[28:31], s43 offen offset:3072 sc1
s_branch Lepi2
Lt4pre:
s_waitcnt vmcnt(0) lgkmcnt(0)
s_mul_i32 s6, s61, 276480
v_add_u32 v228, s6, v216
s_add_u32 s6, s6, 55296
v_add_u32 v229, s6, v216
s_add_u32 s6, s6, 55296
v_add_u32 v230, s6, v216
s_add_u32 s6, s6, 55296
v_add_u32 v231, s6, v216
s_add_u32 s6, s6, 55296
v_add_u32 v232, s6, v216
buffer_load_dwordx4 a[224:227], v228, s[24:27], s33 offen offset:0
buffer_load_dwordx4 a[228:231], v229, s[24:27], s33 offen offset:0
buffer_load_dwordx4 a[232:235], v230, s[24:27], s33 offen offset:0
buffer_load_dwordx4 a[236:239], v231, s[24:27], s33 offen offset:0
buffer_load_dwordx4 a[240:243], v232, s[24:27], s33 offen offset:0
buffer_load_dwordx4 a[244:247], v228, s[24:27], s33 offen offset:1024
buffer_load_dwordx4 a[248:251], v229, s[24:27], s33 offen offset:1024
buffer_load_dwordx4 a[252:255], v230, s[24:27], s33 offen offset:1024
buffer_load_dwordx4 v[176:179], v231, s[24:27], s33 offen offset:1024
buffer_load_dwordx4 v[180:183], v232, s[24:27], s33 offen offset:1024
buffer_load_dwordx4 v[184:187], v228, s[24:27], s33 offen offset:2048
buffer_load_dwordx4 v[188:191], v229, s[24:27], s33 offen offset:2048
buffer_load_dwordx4 v[192:195], v230, s[24:27], s33 offen offset:2048
buffer_load_dwordx4 v[196:199], v231, s[24:27], s33 offen offset:2048
buffer_load_dwordx4 a[64:67], v232, s[24:27], s33 offen offset:2048
buffer_load_dwordx4 a[68:71], v228, s[24:27], s33 offen offset:3072
buffer_load_dwordx4 a[72:75], v229, s[24:27], s33 offen offset:3072
buffer_load_dwordx4 a[76:79], v230, s[24:27], s33 offen offset:3072
buffer_load_dwordx4 a[80:83], v231, s[24:27], s33 offen offset:3072
buffer_load_dwordx4 a[84:87], v232, s[24:27], s33 offen offset:3072
s_add_u32 s33, s33, 4096
buffer_load_dwordx4 a[88:91], v228, s[24:27], s33 offen offset:0
buffer_load_dwordx4 a[92:95], v229, s[24:27], s33 offen offset:0
buffer_load_dwordx4 a[96:99], v230, s[24:27], s33 offen offset:0
buffer_load_dwordx4 a[100:103], v231, s[24:27], s33 offen offset:0
buffer_load_dwordx4 a[104:107], v232, s[24:27], s33 offen offset:0
buffer_load_dwordx4 a[108:111], v228, s[24:27], s33 offen offset:1024
buffer_load_dwordx4 a[112:115], v229, s[24:27], s33 offen offset:1024
buffer_load_dwordx4 a[116:119], v230, s[24:27], s33 offen offset:1024
buffer_load_dwordx4 a[120:123], v231, s[24:27], s33 offen offset:1024
buffer_load_dwordx4 a[124:127], v232, s[24:27], s33 offen offset:1024
buffer_load_dwordx4 a[128:131], v228, s[24:27], s33 offen offset:2048
buffer_load_dwordx4 a[132:135], v229, s[24:27], s33 offen offset:2048
buffer_load_dwordx4 a[136:139], v230, s[24:27], s33 offen offset:2048
buffer_load_dwordx4 a[140:143], v231, s[24:27], s33 offen offset:2048
buffer_load_dwordx4 a[144:147], v232, s[24:27], s33 offen offset:2048
buffer_load_dwordx4 a[148:151], v228, s[24:27], s33 offen offset:3072
buffer_load_dwordx4 a[152:155], v229, s[24:27], s33 offen offset:3072
buffer_load_dwordx4 a[156:159], v230, s[24:27], s33 offen offset:3072
buffer_load_dwordx4 a[160:163], v231, s[24:27], s33 offen offset:3072
buffer_load_dwordx4 a[164:167], v232, s[24:27], s33 offen offset:3072
s_add_u32 s33, s33, 4096
buffer_load_dwordx4 a[168:171], v228, s[24:27], s33 offen offset:0
buffer_load_dwordx4 a[172:175], v229, s[24:27], s33 offen offset:0
buffer_load_dwordx4 a[176:179], v230, s[24:27], s33 offen offset:0
buffer_load_dwordx4 a[180:183], v231, s[24:27], s33 offen offset:0
buffer_load_dwordx4 a[184:187], v232, s[24:27], s33 offen offset:0
buffer_load_dwordx4 a[188:191], v228, s[24:27], s33 offen offset:1024
buffer_load_dwordx4 a[192:195], v229, s[24:27], s33 offen offset:1024
buffer_load_dwordx4 a[196:199], v230, s[24:27], s33 offen offset:1024
buffer_load_dwordx4 a[200:203], v231, s[24:27], s33 offen offset:1024
buffer_load_dwordx4 a[204:207], v232, s[24:27], s33 offen offset:1024
s_lshl_b32 s6, s58, 8
s_add_u32 s6, s6, 284800
v_min_u32 v241, 13, v234
v_lshl_add_u32 v241, v241, 2, s6
s_andn2_b32 s7, s60, 3
s_add_u32 s6, s3, 0
s_and_b32 s6, s6, 3
s_add_u32 s6, s6, s7
s_mul_i32 s6, s6, 55296
v_add_u32 v224, s6, v216
s_add_u32 s6, s3, 1
s_and_b32 s6, s6, 3
s_add_u32 s6, s6, s7
s_mul_i32 s6, s6, 55296
v_add_u32 v225, s6, v216
s_add_u32 s6, s3, 2
s_and_b32 s6, s6, 3
s_add_u32 s6, s6, s7
s_mul_i32 s6, s6, 55296
v_add_u32 v226, s6, v216
s_add_u32 s6, s3, 3
s_and_b32 s6, s6, 3
s_add_u32 s6, s6, s7
s_mul_i32 s6, s6, 55296
v_add_u32 v227, s6, v216
s_add_u32 s69, s45, 0
s_add_u32 s70, s45, 4096
s_add_u32 s71, s45, 8192
s_add_u32 s72, s45, 12288
s_cmp_ge_u32 s3, 2
s_cselect_b32 s73, 0x40000000, s72
s_add_u32 s28, s66, 23068672
s_addc_u32 s29, s67, 0
s_and_b32 s29, s29, 0xffff
s_mov_b32 s30, 7077888
s_mov_b32 s31, 0x20000
s_mov_b32 s16, s62
s_and_b32 s17, s63, 0xffff
s_mov_b32 s18, 2621440
s_mov_b32 s19, 0x20000
s_mov_b32 s12, s56
s_and_b32 s13, s57, 0xffff
s_mov_b32 s14, 1280
s_mov_b32 s15, 0x20000
s_add_u32 s42, s38, 12800
s_mul_i32 s43, s61, 160
v_lshlrev_b32 v254, 3, v233
s_waitcnt vmcnt(0)
s_branch Lt4
Lrpdone:
v_and_b32 v219, 0xfffffcff, v221
s_mov_b64 exec, 1
global_atomic_add v219, v223, s[66:67] offset:12 sc1
s_mov_b64 exec, -1
s_branch Lloop1e
Lslow:
v_accvgpr_write_b32 a0, 0
v_accvgpr_write_b32 a1, 0
v_accvgpr_write_b32 a2, 0
v_accvgpr_write_b32 a3, 0
v_accvgpr_write_b32 a4, 0
v_accvgpr_write_b32 a5, 0
v_accvgpr_write_b32 a6, 0
v_accvgpr_write_b32 a7, 0
v_accvgpr_write_b32 a8, 0
v_accvgpr_write_b32 a9, 0
v_accvgpr_write_b32 a10, 0
v_accvgpr_write_b32 a11, 0
v_accvgpr_write_b32 a12, 0
v_accvgpr_write_b32 a13, 0
v_accvgpr_write_b32 a14, 0
v_accvgpr_write_b32 a15, 0
v_accvgpr_write_b32 a16, 0
v_accvgpr_write_b32 a17, 0
v_accvgpr_write_b32 a18, 0
v_accvgpr_write_b32 a19, 0
v_accvgpr_write_b32 a20, 0
v_accvgpr_write_b32 a21, 0
v_accvgpr_write_b32 a22, 0
v_accvgpr_write_b32 a23, 0
v_accvgpr_write_b32 a24, 0
v_accvgpr_write_b32 a25, 0
v_accvgpr_write_b32 a26, 0
v_accvgpr_write_b32 a27, 0
v_accvgpr_write_b32 a28, 0
v_accvgpr_write_b32 a29, 0
v_accvgpr_write_b32 a30, 0
v_accvgpr_write_b32 a31, 0
v_accvgpr_write_b32 a32, 0
v_accvgpr_write_b32 a33, 0
v_accvgpr_write_b32 a34, 0
v_accvgpr_write_b32 a35, 0
v_accvgpr_write_b32 a36, 0
v_accvgpr_write_b32 a37, 0
v_accvgpr_write_b32 a38, 0
v_accvgpr_write_b32 a39, 0
v_accvgpr_write_b32 a40, 0
v_accvgpr_write_b32 a41, 0
v_accvgpr_write_b32 a42, 0
v_accvgpr_write_b32 a43, 0
v_accvgpr_write_b32 a44, 0
v_accvgpr_write_b32 a45, 0
v_accvgpr_write_b32 a46, 0
v_accvgpr_write_b32 a47, 0
v_accvgpr_write_b32 a48, 0
v_accvgpr_write_b32 a49, 0
v_accvgpr_write_b32 a50, 0
v_accvgpr_write_b32 a51, 0
v_accvgpr_write_b32 a52, 0
v_accvgpr_write_b32 a53, 0
v_accvgpr_write_b32 a54, 0
v_accvgpr_write_b32 a55, 0
v_accvgpr_write_b32 a56, 0
v_accvgpr_write_b32 a57, 0
v_accvgpr_write_b32 a58, 0
v_accvgpr_write_b32 a59, 0
v_accvgpr_write_b32 a60, 0
v_accvgpr_write_b32 a61, 0
v_accvgpr_write_b32 a62, 0
v_accvgpr_write_b32 a63, 0
v_accvgpr_write_b32 a64, 0
v_accvgpr_write_b32 a65, 0
v_accvgpr_write_b32 a66, 0
v_accvgpr_write_b32 a67, 0
v_accvgpr_write_b32 a68, 0
v_accvgpr_write_b32 a69, 0
v_accvgpr_write_b32 a70, 0
v_accvgpr_write_b32 a71, 0
v_accvgpr_write_b32 a72, 0
v_accvgpr_write_b32 a73, 0
v_accvgpr_write_b32 a74, 0
v_accvgpr_write_b32 a75, 0
v_accvgpr_write_b32 a76, 0
v_accvgpr_write_b32 a77, 0
v_accvgpr_write_b32 a78, 0
v_accvgpr_write_b32 a79, 0
v_accvgpr_write_b32 a80, 0
v_accvgpr_write_b32 a81, 0
v_accvgpr_write_b32 a82, 0
v_accvgpr_write_b32 a83, 0
v_accvgpr_write_b32 a84, 0
v_accvgpr_write_b32 a85, 0
v_accvgpr_write_b32 a86, 0
v_accvgpr_write_b32 a87, 0
v_accvgpr_write_b32 a88, 0
v_accvgpr_write_b32 a89, 0
v_accvgpr_write_b32 a90, 0
v_accvgpr_write_b32 a91, 0
v_accvgpr_write_b32 a92, 0
v_accvgpr_write_b32 a93, 0
v_accvgpr_write_b32 a94, 0
v_accvgpr_write_b32 a95, 0
v_accvgpr_write_b32 a96, 0
v_accvgpr_write_b32 a97, 0
v_accvgpr_write_b32 a98, 0
v_accvgpr_write_b32 a99, 0
v_accvgpr_write_b32 a100, 0
v_accvgpr_write_b32 a101, 0
v_accvgpr_write_b32 a102, 0
v_accvgpr_write_b32 a103, 0
v_accvgpr_write_b32 a104, 0
v_accvgpr_write_b32 a105, 0
v_accvgpr_write_b32 a106, 0
v_accvgpr_write_b32 a107, 0
v_accvgpr_write_b32 a108, 0
v_accvgpr_write_b32 a109, 0
v_accvgpr_write_b32 a110, 0
v_accvgpr_write_b32 a111, 0
v_accvgpr_write_b32 a112, 0
v_accvgpr_write_b32 a113, 0
v_accvgpr_write_b32 a114, 0
v_accvgpr_write_b32 a115, 0
v_accvgpr_write_b32 a116, 0
v_accvgpr_write_b32 a117, 0
v_accvgpr_write_b32 a118, 0
v_accvgpr_write_b32 a119, 0
v_accvgpr_write_b32 a120, 0
v_accvgpr_write_b32 a121, 0
v_accvgpr_write_b32 a122, 0
v_accvgpr_write_b32 a123, 0
v_accvgpr_write_b32 a124, 0
v_accvgpr_write_b32 a125, 0
v_accvgpr_write_b32 a126, 0
v_accvgpr_write_b32 a127, 0
v_accvgpr_write_b32 a128, 0
v_accvgpr_write_b32 a129, 0
v_accvgpr_write_b32 a130, 0
v_accvgpr_write_b32 a131, 0
v_accvgpr_write_b32 a132, 0
v_accvgpr_write_b32 a133, 0
v_accvgpr_write_b32 a134, 0
v_accvgpr_write_b32 a135, 0
v_accvgpr_write_b32 a136, 0
v_accvgpr_write_b32 a137, 0
v_accvgpr_write_b32 a138, 0
v_accvgpr_write_b32 a139, 0
v_accvgpr_write_b32 a140, 0
v_accvgpr_write_b32 a141, 0
v_accvgpr_write_b32 a142, 0
v_accvgpr_write_b32 a143, 0
v_and_b32 v219, 15, v220
v_mov_b32 v96, 0xf149f2ca
s_lshl_b32 s6, s72, 4
v_add_u32 v100, s6, v219
v_mov_b32 v97, 0xf149f2ca
s_lshl_b32 s6, s73, 4
v_add_u32 v101, s6, v219
v_mov_b32 v98, 0xf149f2ca
s_lshl_b32 s6, s74, 4
v_add_u32 v102, s6, v219
v_mov_b32 v99, 0xf149f2ca
s_lshl_b32 s6, s75, 4
v_add_u32 v103, s6, v219
v_lshrrev_b32 v104, 4, v220
v_lshlrev_b32 v104, 2, v104
v_mov_b32 v105, 0xf149f2ca
s_mov_b32 s68, 0
s_mov_b32 s99, 0
Lslowl:
s_add_u32 s6, s68, 0
buffer_load_dwordx4 a[192:195], v216, s[8:11], s6 offen
s_add_u32 s6, s68, 32768
buffer_load_dwordx4 a[224:227], v216, s[12:15], s6 offen
s_add_u32 s6, s68, 1024
buffer_load_dwordx4 a[196:199], v216, s[8:11], s6 offen
s_add_u32 s6, s68, 33792
buffer_load_dwordx4 a[228:231], v216, s[12:15], s6 offen
s_add_u32 s6, s68, 2048
buffer_load_dwordx4 a[200:203], v216, s[8:11], s6 offen
s_add_u32 s6, s68, 34816
buffer_load_dwordx4 a[232:235], v216, s[12:15], s6 offen
s_add_u32 s6, s68, 3072
buffer_load_dwordx4 a[204:207], v216, s[8:11], s6 offen
s_add_u32 s6, s68, 35840
buffer_load_dwordx4 a[236:239], v216, s[12:15], s6 offen
s_add_u32 s6, s68, 4096
buffer_load_dwordx4 a[208:211], v216, s[8:11], s6 offen
s_add_u32 s6, s68, 36864
buffer_load_dwordx4 a[240:243], v216, s[12:15], s6 offen
s_add_u32 s6, s68, 5120
buffer_load_dwordx4 a[212:215], v216, s[8:11], s6 offen
s_add_u32 s6, s68, 37888
buffer_load_dwordx4 a[244:247], v216, s[12:15], s6 offen
s_add_u32 s6, s68, 6144
buffer_load_dwordx4 a[216:219], v216, s[8:11], s6 offen
s_add_u32 s6, s68, 38912
buffer_load_dwordx4 a[248:251], v216, s[12:15], s6 offen
s_add_u32 s6, s68, 7168
buffer_load_dwordx4 a[220:223], v216, s[8:11], s6 offen
s_add_u32 s6, s68, 39936
buffer_load_dwordx4 a[252:255], v216, s[12:15], s6 offen
s_waitcnt vmcnt(0)
v_mfma_f32_16x16x32_bf16 v[0:3], a[192:195], v[128:131], 0
v_mfma_f32_16x16x32_bf16 v[0:3], a[196:199], v[132:135], v[0:3]
v_mfma_f32_16x16x32_bf16 v[0:3], a[200:203], v[136:139], v[0:3]
v_mfma_f32_16x16x32_bf16 v[0:3], a[204:207], v[140:143], v[0:3]
v_mfma_f32_16x16x32_bf16 v[4:7], a[192:195], v[144:147], 0
v_mfma_f32_16x16x32_bf16 v[4:7], a[196:199], v[148:151], v[4:7]
v_mfma_f32_16x16x32_bf16 v[4:7], a[200:203], v[152:155], v[4:7]
v_mfma_f32_16x16x32_bf16 v[4:7], a[204:207], v[156:159], v[4:7]
v_mfma_f32_16x16x32_bf16 v[8:11], a[192:195], v[160:163], 0
v_mfma_f32_16x16x32_bf16 v[8:11], a[196:199], v[164:167], v[8:11]
v_mfma_f32_16x16x32_bf16 v[8:11], a[200:203], v[168:171], v[8:11]
v_mfma_f32_16x16x32_bf16 v[8:11], a[204:207], v[172:175], v[8:11]
v_mfma_f32_16x16x32_bf16 v[12:15], a[192:195], v[176:179], 0
v_mfma_f32_16x16x32_bf16 v[12:15], a[196:199], v[180:183], v[12:15]
v_mfma_f32_16x16x32_bf16 v[12:15], a[200:203], v[184:187], v[12:15]
v_mfma_f32_16x16x32_bf16 v[12:15], a[204:207], v[188:191], v[12:15]
v_mfma_f32_16x16x32_bf16 v[16:19], a[208:211], v[128:131], 0
v_mfma_f32_16x16x32_bf16 v[16:19], a[212:215], v[132:135], v[16:19]
v_mfma_f32_16x16x32_bf16 v[16:19], a[216:219], v[136:139], v[16:19]
v_mfma_f32_16x16x32_bf16 v[16:19], a[220:223], v[140:143], v[16:19]
v_mfma_f32_16x16x32_bf16 v[20:23], a[208:211], v[144:147], 0
v_mfma_f32_16x16x32_bf16 v[20:23], a[212:215], v[148:151], v[20:23]
v_mfma_f32_16x16x32_bf16 v[20:23], a[216:219], v[152:155], v[20:23]
v_mfma_f32_16x16x32_bf16 v[20:23], a[220:223], v[156:159], v[20:23]
v_mfma_f32_16x16x32_bf16 v[24:27], a[208:211], v[160:163], 0
v_mfma_f32_16x16x32_bf16 v[24:27], a[212:215], v[164:167], v[24:27]
v_mfma_f32_16x16x32_bf16 v[24:27], a[216:219], v[168:171], v[24:27]
v_mfma_f32_16x16x32_bf16 v[24:27], a[220:223], v[172:175], v[24:27]
v_mfma_f32_16x16x32_bf16 v[28:31], a[208:211], v[176:179], 0
v_mfma_f32_16x16x32_bf16 v[28:31], a[212:215], v[180:183], v[28:31]
v_mfma_f32_16x16x32_bf16 v[28:31], a[216:219], v[184:187], v[28:31]
v_mfma_f32_16x16x32_bf16 v[28:31], a[220:223], v[188:191], v[28:31]
s_nop 7
v_sub_u32 v219, v100, v104
v_cmp_gt_i32 vcc, 0, v219
s_nop 1
v_cndmask_b32 v0, v0, v105, vcc
v_cmp_gt_i32 vcc, 1, v219
s_nop 1
v_cndmask_b32 v1, v1, v105, vcc
v_cmp_gt_i32 vcc, 2, v219
s_nop 1
v_cndmask_b32 v2, v2, v105, vcc
v_cmp_gt_i32 vcc, 3, v219
s_nop 1
v_cndmask_b32 v3, v3, v105, vcc
v_cmp_gt_i32 vcc, 16, v219
s_nop 1
v_cndmask_b32 v16, v16, v105, vcc
v_cmp_gt_i32 vcc, 17, v219
s_nop 1
v_cndmask_b32 v17, v17, v105, vcc
v_cmp_gt_i32 vcc, 18, v219
s_nop 1
v_cndmask_b32 v18, v18, v105, vcc
v_cmp_gt_i32 vcc, 19, v219
s_nop 1
v_cndmask_b32 v19, v19, v105, vcc
v_max3_f32 v208, v0, v1, v2
v_max3_f32 v208, v208, v3, v16
v_max3_f32 v208, v208, v17, v18
v_max3_f32 v208, v208, v19, v96
v_sub_u32 v219, v101, v104
v_cmp_gt_i32 vcc, 0, v219
s_nop 1
v_cndmask_b32 v4, v4, v105, vcc
v_cmp_gt_i32 vcc, 1, v219
s_nop 1
v_cndmask_b32 v5, v5, v105, vcc
v_cmp_gt_i32 vcc, 2, v219
s_nop 1
v_cndmask_b32 v6, v6, v105, vcc
v_cmp_gt_i32 vcc, 3, v219
s_nop 1
v_cndmask_b32 v7, v7, v105, vcc
v_cmp_gt_i32 vcc, 16, v219
s_nop 1
v_cndmask_b32 v20, v20, v105, vcc
v_cmp_gt_i32 vcc, 17, v219
s_nop 1
v_cndmask_b32 v21, v21, v105, vcc
v_cmp_gt_i32 vcc, 18, v219
s_nop 1
v_cndmask_b32 v22, v22, v105, vcc
v_cmp_gt_i32 vcc, 19, v219
s_nop 1
v_cndmask_b32 v23, v23, v105, vcc
v_max3_f32 v209, v4, v5, v6
v_max3_f32 v209, v209, v7, v20
v_max3_f32 v209, v209, v21, v22
v_max3_f32 v209, v209, v23, v97
v_sub_u32 v219, v102, v104
v_cmp_gt_i32 vcc, 0, v219
s_nop 1
v_cndmask_b32 v8, v8, v105, vcc
v_cmp_gt_i32 vcc, 1, v219
s_nop 1
v_cndmask_b32 v9, v9, v105, vcc
v_cmp_gt_i32 vcc, 2, v219
s_nop 1
v_cndmask_b32 v10, v10, v105, vcc
v_cmp_gt_i32 vcc, 3, v219
s_nop 1
v_cndmask_b32 v11, v11, v105, vcc
v_cmp_gt_i32 vcc, 16, v219
s_nop 1
v_cndmask_b32 v24, v24, v105, vcc
v_cmp_gt_i32 vcc, 17, v219
s_nop 1
v_cndmask_b32 v25, v25, v105, vcc
v_cmp_gt_i32 vcc, 18, v219
s_nop 1
v_cndmask_b32 v26, v26, v105, vcc
v_cmp_gt_i32 vcc, 19, v219
s_nop 1
v_cndmask_b32 v27, v27, v105, vcc
v_max3_f32 v210, v8, v9, v10
v_max3_f32 v210, v210, v11, v24
v_max3_f32 v210, v210, v25, v26
v_max3_f32 v210, v210, v27, v98
v_sub_u32 v219, v103, v104
v_cmp_gt_i32 vcc, 0, v219
s_nop 1
v_cndmask_b32 v12, v12, v105, vcc
v_cmp_gt_i32 vcc, 1, v219
s_nop 1
v_cndmask_b32 v13, v13, v105, vcc
v_cmp_gt_i32 vcc, 2, v219
s_nop 1
v_cndmask_b32 v14, v14, v105, vcc
v_cmp_gt_i32 vcc, 3, v219
s_nop 1
v_cndmask_b32 v15, v15, v105, vcc
v_cmp_gt_i32 vcc, 16, v219
s_nop 1
v_cndmask_b32 v28, v28, v105, vcc
v_cmp_gt_i32 vcc, 17, v219
s_nop 1
v_cndmask_b32 v29, v29, v105, vcc
v_cmp_gt_i32 vcc, 18, v219
s_nop 1
v_cndmask_b32 v30, v30, v105, vcc
v_cmp_gt_i32 vcc, 19, v219
s_nop 1
v_cndmask_b32 v31, v31, v105, vcc
v_max3_f32 v211, v12, v13, v14
v_max3_f32 v211, v211, v15, v28
v_max3_f32 v211, v211, v29, v30
v_max3_f32 v211, v211, v31, v99
v_mov_b32 v212, v208
v_mov_b32 v213, v209
v_mov_b32 v214, v210
v_mov_b32 v215, v211
s_nop 1
v_permlane32_swap_b32 v208, v212
v_permlane32_swap_b32 v209, v213
v_permlane32_swap_b32 v210, v214
v_permlane32_swap_b32 v211, v215
v_max_f32 v208, v208, v212
v_max_f32 v209, v209, v213
v_max_f32 v210, v210, v214
v_max_f32 v211, v211, v215
v_mov_b32 v212, v208
v_mov_b32 v213, v209
v_mov_b32 v214, v210
v_mov_b32 v215, v211
s_nop 1
v_permlane16_swap_b32 v208, v212
v_permlane16_swap_b32 v209, v213
v_permlane16_swap_b32 v210, v214
v_permlane16_swap_b32 v211, v215
v_max_f32 v208, v208, v212
v_max_f32 v209, v209, v213
v_max_f32 v210, v210, v214
v_max_f32 v211, v211, v215
v_sub_f32 v212, v96, v208
v_mov_b32 v96, v208
v_exp_f32 v212, v212
v_sub_f32 v213, v97, v209
v_mov_b32 v97, v209
v_exp_f32 v213, v213
v_sub_f32 v214, v98, v210
v_mov_b32 v98, v210
v_exp_f32 v214, v214
v_sub_f32 v215, v99, v211
v_mov_b32 v99, v211
v_exp_f32 v215, v215
v_accvgpr_read_b32 v219, a0
v_mul_f32 v219, v212, v219
v_accvgpr_write_b32 a0, v219
v_accvgpr_read_b32 v219, a1
v_mul_f32 v219, v212, v219
v_accvgpr_write_b32 a1, v219
v_accvgpr_read_b32 v219, a2
v_mul_f32 v219, v212, v219
v_accvgpr_write_b32 a2, v219
v_accvgpr_read_b32 v219, a3
v_mul_f32 v219, v212, v219
v_accvgpr_write_b32 a3, v219
v_accvgpr_read_b32 v219, a4
v_mul_f32 v219, v212, v219
v_accvgpr_write_b32 a4, v219
v_accvgpr_read_b32 v219, a5
v_mul_f32 v219, v212, v219
v_accvgpr_write_b32 a5, v219
v_accvgpr_read_b32 v219, a6
v_mul_f32 v219, v212, v219
v_accvgpr_write_b32 a6, v219
v_accvgpr_read_b32 v219, a7
v_mul_f32 v219, v212, v219
v_accvgpr_write_b32 a7, v219
v_accvgpr_read_b32 v219, a8
v_mul_f32 v219, v212, v219
v_accvgpr_write_b32 a8, v219
v_accvgpr_read_b32 v219, a9
v_mul_f32 v219, v212, v219
v_accvgpr_write_b32 a9, v219
v_accvgpr_read_b32 v219, a10
v_mul_f32 v219, v212, v219
v_accvgpr_write_b32 a10, v219
v_accvgpr_read_b32 v219, a11
v_mul_f32 v219, v212, v219
v_accvgpr_write_b32 a11, v219
v_accvgpr_read_b32 v219, a12
v_mul_f32 v219, v212, v219
v_accvgpr_write_b32 a12, v219
v_accvgpr_read_b32 v219, a13
v_mul_f32 v219, v212, v219
v_accvgpr_write_b32 a13, v219
v_accvgpr_read_b32 v219, a14
v_mul_f32 v219, v212, v219
v_accvgpr_write_b32 a14, v219
v_accvgpr_read_b32 v219, a15
v_mul_f32 v219, v212, v219
v_accvgpr_write_b32 a15, v219
v_accvgpr_read_b32 v219, a16
v_mul_f32 v219, v212, v219
v_accvgpr_write_b32 a16, v219
v_accvgpr_read_b32 v219, a17
v_mul_f32 v219, v212, v219
v_accvgpr_write_b32 a17, v219
v_accvgpr_read_b32 v219, a18
v_mul_f32 v219, v212, v219
v_accvgpr_write_b32 a18, v219
v_accvgpr_read_b32 v219, a19
v_mul_f32 v219, v212, v219
v_accvgpr_write_b32 a19, v219
v_accvgpr_read_b32 v219, a20
v_mul_f32 v219, v212, v219
v_accvgpr_write_b32 a20, v219
v_accvgpr_read_b32 v219, a21
v_mul_f32 v219, v212, v219
v_accvgpr_write_b32 a21, v219
v_accvgpr_read_b32 v219, a22
v_mul_f32 v219, v212, v219
v_accvgpr_write_b32 a22, v219
v_accvgpr_read_b32 v219, a23
v_mul_f32 v219, v212, v219
v_accvgpr_write_b32 a23, v219
v_accvgpr_read_b32 v219, a24
v_mul_f32 v219, v212, v219
v_accvgpr_write_b32 a24, v219
v_accvgpr_read_b32 v219, a25
v_mul_f32 v219, v212, v219
v_accvgpr_write_b32 a25, v219
v_accvgpr_read_b32 v219, a26
v_mul_f32 v219, v212, v219
v_accvgpr_write_b32 a26, v219
v_accvgpr_read_b32 v219, a27
v_mul_f32 v219, v212, v219
v_accvgpr_write_b32 a27, v219
v_accvgpr_read_b32 v219, a28
v_mul_f32 v219, v212, v219
v_accvgpr_write_b32 a28, v219
v_accvgpr_read_b32 v219, a29
v_mul_f32 v219, v212, v219
v_accvgpr_write_b32 a29, v219
v_accvgpr_read_b32 v219, a30
v_mul_f32 v219, v212, v219
v_accvgpr_write_b32 a30, v219
v_accvgpr_read_b32 v219, a31
v_mul_f32 v219, v212, v219
v_accvgpr_write_b32 a31, v219
v_accvgpr_read_b32 v219, a128
v_mul_f32 v219, v212, v219
v_accvgpr_write_b32 a128, v219
v_accvgpr_read_b32 v219, a129
v_mul_f32 v219, v212, v219
v_accvgpr_write_b32 a129, v219
v_accvgpr_read_b32 v219, a130
v_mul_f32 v219, v212, v219
v_accvgpr_write_b32 a130, v219
v_accvgpr_read_b32 v219, a131
v_mul_f32 v219, v212, v219
v_accvgpr_write_b32 a131, v219
v_sub_f32 v0, v0, v96
v_sub_f32 v1, v1, v96
v_sub_f32 v2, v2, v96
v_sub_f32 v3, v3, v96
v_exp_f32 v0, v0
v_exp_f32 v1, v1
v_exp_f32 v2, v2
v_exp_f32 v3, v3
s_nop 0
v_cvt_pk_bf16_f32 v64, v0, v1
v_cvt_pk_bf16_f32 v65, v2, v3
v_sub_f32 v16, v16, v96
v_sub_f32 v17, v17, v96
v_sub_f32 v18, v18, v96
v_sub_f32 v19, v19, v96
v_exp_f32 v16, v16
v_exp_f32 v17, v17
v_exp_f32 v18, v18
v_exp_f32 v19, v19
s_nop 0
v_cvt_pk_bf16_f32 v66, v16, v17
v_cvt_pk_bf16_f32 v67, v18, v19
v_accvgpr_read_b32 v219, a32
v_mul_f32 v219, v213, v219
v_accvgpr_write_b32 a32, v219
v_accvgpr_read_b32 v219, a33
v_mul_f32 v219, v213, v219
v_accvgpr_write_b32 a33, v219
v_accvgpr_read_b32 v219, a34
v_mul_f32 v219, v213, v219
v_accvgpr_write_b32 a34, v219
v_accvgpr_read_b32 v219, a35
v_mul_f32 v219, v213, v219
v_accvgpr_write_b32 a35, v219
v_accvgpr_read_b32 v219, a36
v_mul_f32 v219, v213, v219
v_accvgpr_write_b32 a36, v219
v_accvgpr_read_b32 v219, a37
v_mul_f32 v219, v213, v219
v_accvgpr_write_b32 a37, v219
v_accvgpr_read_b32 v219, a38
v_mul_f32 v219, v213, v219
v_accvgpr_write_b32 a38, v219
v_accvgpr_read_b32 v219, a39
v_mul_f32 v219, v213, v219
v_accvgpr_write_b32 a39, v219
v_accvgpr_read_b32 v219, a40
v_mul_f32 v219, v213, v219
v_accvgpr_write_b32 a40, v219
v_accvgpr_read_b32 v219, a41
v_mul_f32 v219, v213, v219
v_accvgpr_write_b32 a41, v219
v_accvgpr_read_b32 v219, a42
v_mul_f32 v219, v213, v219
v_accvgpr_write_b32 a42, v219
v_accvgpr_read_b32 v219, a43
v_mul_f32 v219, v213, v219
v_accvgpr_write_b32 a43, v219
v_accvgpr_read_b32 v219, a44
v_mul_f32 v219, v213, v219
v_accvgpr_write_b32 a44, v219
v_accvgpr_read_b32 v219, a45
v_mul_f32 v219, v213, v219
v_accvgpr_write_b32 a45, v219
v_accvgpr_read_b32 v219, a46
v_mul_f32 v219, v213, v219
v_accvgpr_write_b32 a46, v219
v_accvgpr_read_b32 v219, a47
v_mul_f32 v219, v213, v219
v_accvgpr_write_b32 a47, v219
v_accvgpr_read_b32 v219, a48
v_mul_f32 v219, v213, v219
v_accvgpr_write_b32 a48, v219
v_accvgpr_read_b32 v219, a49
v_mul_f32 v219, v213, v219
v_accvgpr_write_b32 a49, v219
v_accvgpr_read_b32 v219, a50
v_mul_f32 v219, v213, v219
v_accvgpr_write_b32 a50, v219
v_accvgpr_read_b32 v219, a51
v_mul_f32 v219, v213, v219
v_accvgpr_write_b32 a51, v219
v_accvgpr_read_b32 v219, a52
v_mul_f32 v219, v213, v219
v_accvgpr_write_b32 a52, v219
v_accvgpr_read_b32 v219, a53
v_mul_f32 v219, v213, v219
v_accvgpr_write_b32 a53, v219
v_accvgpr_read_b32 v219, a54
v_mul_f32 v219, v213, v219
v_accvgpr_write_b32 a54, v219
v_accvgpr_read_b32 v219, a55
v_mul_f32 v219, v213, v219
v_accvgpr_write_b32 a55, v219
v_accvgpr_read_b32 v219, a56
v_mul_f32 v219, v213, v219
v_accvgpr_write_b32 a56, v219
v_accvgpr_read_b32 v219, a57
v_mul_f32 v219, v213, v219
v_accvgpr_write_b32 a57, v219
v_accvgpr_read_b32 v219, a58
v_mul_f32 v219, v213, v219
v_accvgpr_write_b32 a58, v219
v_accvgpr_read_b32 v219, a59
v_mul_f32 v219, v213, v219
v_accvgpr_write_b32 a59, v219
v_accvgpr_read_b32 v219, a60
v_mul_f32 v219, v213, v219
v_accvgpr_write_b32 a60, v219
v_accvgpr_read_b32 v219, a61
v_mul_f32 v219, v213, v219
v_accvgpr_write_b32 a61, v219
v_accvgpr_read_b32 v219, a62
v_mul_f32 v219, v213, v219
v_accvgpr_write_b32 a62, v219
v_accvgpr_read_b32 v219, a63
v_mul_f32 v219, v213, v219
v_accvgpr_write_b32 a63, v219
v_accvgpr_read_b32 v219, a132
v_mul_f32 v219, v213, v219
v_accvgpr_write_b32 a132, v219
v_accvgpr_read_b32 v219, a133
v_mul_f32 v219, v213, v219
v_accvgpr_write_b32 a133, v219
v_accvgpr_read_b32 v219, a134
v_mul_f32 v219, v213, v219
v_accvgpr_write_b32 a134, v219
v_accvgpr_read_b32 v219, a135
v_mul_f32 v219, v213, v219
v_accvgpr_write_b32 a135, v219
v_sub_f32 v4, v4, v97
v_sub_f32 v5, v5, v97
v_sub_f32 v6, v6, v97
v_sub_f32 v7, v7, v97
v_exp_f32 v4, v4
v_exp_f32 v5, v5
v_exp_f32 v6, v6
v_exp_f32 v7, v7
s_nop 0
v_cvt_pk_bf16_f32 v68, v4, v5
v_cvt_pk_bf16_f32 v69, v6, v7
v_sub_f32 v20, v20, v97
v_sub_f32 v21, v21, v97
v_sub_f32 v22, v22, v97
v_sub_f32 v23, v23, v97
v_exp_f32 v20, v20
v_exp_f32 v21, v21
v_exp_f32 v22, v22
v_exp_f32 v23, v23
s_nop 0
v_cvt_pk_bf16_f32 v70, v20, v21
v_cvt_pk_bf16_f32 v71, v22, v23
v_accvgpr_read_b32 v219, a64
v_mul_f32 v219, v214, v219
v_accvgpr_write_b32 a64, v219
v_accvgpr_read_b32 v219, a65
v_mul_f32 v219, v214, v219
v_accvgpr_write_b32 a65, v219
v_accvgpr_read_b32 v219, a66
v_mul_f32 v219, v214, v219
v_accvgpr_write_b32 a66, v219
v_accvgpr_read_b32 v219, a67
v_mul_f32 v219, v214, v219
v_accvgpr_write_b32 a67, v219
v_accvgpr_read_b32 v219, a68
v_mul_f32 v219, v214, v219
v_accvgpr_write_b32 a68, v219
v_accvgpr_read_b32 v219, a69
v_mul_f32 v219, v214, v219
v_accvgpr_write_b32 a69, v219
v_accvgpr_read_b32 v219, a70
v_mul_f32 v219, v214, v219
v_accvgpr_write_b32 a70, v219
v_accvgpr_read_b32 v219, a71
v_mul_f32 v219, v214, v219
v_accvgpr_write_b32 a71, v219
v_accvgpr_read_b32 v219, a72
v_mul_f32 v219, v214, v219
v_accvgpr_write_b32 a72, v219
v_accvgpr_read_b32 v219, a73
v_mul_f32 v219, v214, v219
v_accvgpr_write_b32 a73, v219
v_accvgpr_read_b32 v219, a74
v_mul_f32 v219, v214, v219
v_accvgpr_write_b32 a74, v219
v_accvgpr_read_b32 v219, a75
v_mul_f32 v219, v214, v219
v_accvgpr_write_b32 a75, v219
v_accvgpr_read_b32 v219, a76
v_mul_f32 v219, v214, v219
v_accvgpr_write_b32 a76, v219
v_accvgpr_read_b32 v219, a77
v_mul_f32 v219, v214, v219
v_accvgpr_write_b32 a77, v219
v_accvgpr_read_b32 v219, a78
v_mul_f32 v219, v214, v219
v_accvgpr_write_b32 a78, v219
v_accvgpr_read_b32 v219, a79
v_mul_f32 v219, v214, v219
v_accvgpr_write_b32 a79, v219
v_accvgpr_read_b32 v219, a80
v_mul_f32 v219, v214, v219
v_accvgpr_write_b32 a80, v219
v_accvgpr_read_b32 v219, a81
v_mul_f32 v219, v214, v219
v_accvgpr_write_b32 a81, v219
v_accvgpr_read_b32 v219, a82
v_mul_f32 v219, v214, v219
v_accvgpr_write_b32 a82, v219
v_accvgpr_read_b32 v219, a83
v_mul_f32 v219, v214, v219
v_accvgpr_write_b32 a83, v219
v_accvgpr_read_b32 v219, a84
v_mul_f32 v219, v214, v219
v_accvgpr_write_b32 a84, v219
v_accvgpr_read_b32 v219, a85
v_mul_f32 v219, v214, v219
v_accvgpr_write_b32 a85, v219
v_accvgpr_read_b32 v219, a86
v_mul_f32 v219, v214, v219
v_accvgpr_write_b32 a86, v219
v_accvgpr_read_b32 v219, a87
v_mul_f32 v219, v214, v219
v_accvgpr_write_b32 a87, v219
v_accvgpr_read_b32 v219, a88
v_mul_f32 v219, v214, v219
v_accvgpr_write_b32 a88, v219
v_accvgpr_read_b32 v219, a89
v_mul_f32 v219, v214, v219
v_accvgpr_write_b32 a89, v219
v_accvgpr_read_b32 v219, a90
v_mul_f32 v219, v214, v219
v_accvgpr_write_b32 a90, v219
v_accvgpr_read_b32 v219, a91
v_mul_f32 v219, v214, v219
v_accvgpr_write_b32 a91, v219
v_accvgpr_read_b32 v219, a92
v_mul_f32 v219, v214, v219
v_accvgpr_write_b32 a92, v219
v_accvgpr_read_b32 v219, a93
v_mul_f32 v219, v214, v219
v_accvgpr_write_b32 a93, v219
v_accvgpr_read_b32 v219, a94
v_mul_f32 v219, v214, v219
v_accvgpr_write_b32 a94, v219
v_accvgpr_read_b32 v219, a95
v_mul_f32 v219, v214, v219
v_accvgpr_write_b32 a95, v219
v_accvgpr_read_b32 v219, a136
v_mul_f32 v219, v214, v219
v_accvgpr_write_b32 a136, v219
v_accvgpr_read_b32 v219, a137
v_mul_f32 v219, v214, v219
v_accvgpr_write_b32 a137, v219
v_accvgpr_read_b32 v219, a138
v_mul_f32 v219, v214, v219
v_accvgpr_write_b32 a138, v219
v_accvgpr_read_b32 v219, a139
v_mul_f32 v219, v214, v219
v_accvgpr_write_b32 a139, v219
v_sub_f32 v8, v8, v98
v_sub_f32 v9, v9, v98
v_sub_f32 v10, v10, v98
v_sub_f32 v11, v11, v98
v_exp_f32 v8, v8
v_exp_f32 v9, v9
v_exp_f32 v10, v10
v_exp_f32 v11, v11
s_nop 0
v_cvt_pk_bf16_f32 v72, v8, v9
v_cvt_pk_bf16_f32 v73, v10, v11
v_sub_f32 v24, v24, v98
v_sub_f32 v25, v25, v98
v_sub_f32 v26, v26, v98
v_sub_f32 v27, v27, v98
v_exp_f32 v24, v24
v_exp_f32 v25, v25
v_exp_f32 v26, v26
v_exp_f32 v27, v27
s_nop 0
v_cvt_pk_bf16_f32 v74, v24, v25
v_cvt_pk_bf16_f32 v75, v26, v27
v_accvgpr_read_b32 v219, a96
v_mul_f32 v219, v215, v219
v_accvgpr_write_b32 a96, v219
v_accvgpr_read_b32 v219, a97
v_mul_f32 v219, v215, v219
v_accvgpr_write_b32 a97, v219
v_accvgpr_read_b32 v219, a98
v_mul_f32 v219, v215, v219
v_accvgpr_write_b32 a98, v219
v_accvgpr_read_b32 v219, a99
v_mul_f32 v219, v215, v219
v_accvgpr_write_b32 a99, v219
v_accvgpr_read_b32 v219, a100
v_mul_f32 v219, v215, v219
v_accvgpr_write_b32 a100, v219
v_accvgpr_read_b32 v219, a101
v_mul_f32 v219, v215, v219
v_accvgpr_write_b32 a101, v219
v_accvgpr_read_b32 v219, a102
v_mul_f32 v219, v215, v219
v_accvgpr_write_b32 a102, v219
v_accvgpr_read_b32 v219, a103
v_mul_f32 v219, v215, v219
v_accvgpr_write_b32 a103, v219
v_accvgpr_read_b32 v219, a104
v_mul_f32 v219, v215, v219
v_accvgpr_write_b32 a104, v219
v_accvgpr_read_b32 v219, a105
v_mul_f32 v219, v215, v219
v_accvgpr_write_b32 a105, v219
v_accvgpr_read_b32 v219, a106
v_mul_f32 v219, v215, v219
v_accvgpr_write_b32 a106, v219
v_accvgpr_read_b32 v219, a107
v_mul_f32 v219, v215, v219
v_accvgpr_write_b32 a107, v219
v_accvgpr_read_b32 v219, a108
v_mul_f32 v219, v215, v219
v_accvgpr_write_b32 a108, v219
v_accvgpr_read_b32 v219, a109
v_mul_f32 v219, v215, v219
v_accvgpr_write_b32 a109, v219
v_accvgpr_read_b32 v219, a110
v_mul_f32 v219, v215, v219
v_accvgpr_write_b32 a110, v219
v_accvgpr_read_b32 v219, a111
v_mul_f32 v219, v215, v219
v_accvgpr_write_b32 a111, v219
v_accvgpr_read_b32 v219, a112
v_mul_f32 v219, v215, v219
v_accvgpr_write_b32 a112, v219
v_accvgpr_read_b32 v219, a113
v_mul_f32 v219, v215, v219
v_accvgpr_write_b32 a113, v219
v_accvgpr_read_b32 v219, a114
v_mul_f32 v219, v215, v219
v_accvgpr_write_b32 a114, v219
v_accvgpr_read_b32 v219, a115
v_mul_f32 v219, v215, v219
v_accvgpr_write_b32 a115, v219
v_accvgpr_read_b32 v219, a116
v_mul_f32 v219, v215, v219
v_accvgpr_write_b32 a116, v219
v_accvgpr_read_b32 v219, a117
v_mul_f32 v219, v215, v219
v_accvgpr_write_b32 a117, v219
v_accvgpr_read_b32 v219, a118
v_mul_f32 v219, v215, v219
v_accvgpr_write_b32 a118, v219
v_accvgpr_read_b32 v219, a119
v_mul_f32 v219, v215, v219
v_accvgpr_write_b32 a119, v219
v_accvgpr_read_b32 v219, a120
v_mul_f32 v219, v215, v219
v_accvgpr_write_b32 a120, v219
v_accvgpr_read_b32 v219, a121
v_mul_f32 v219, v215, v219
v_accvgpr_write_b32 a121, v219
v_accvgpr_read_b32 v219, a122
v_mul_f32 v219, v215, v219
v_accvgpr_write_b32 a122, v219
v_accvgpr_read_b32 v219, a123
v_mul_f32 v219, v215, v219
v_accvgpr_write_b32 a123, v219
v_accvgpr_read_b32 v219, a124
v_mul_f32 v219, v215, v219
v_accvgpr_write_b32 a124, v219
v_accvgpr_read_b32 v219, a125
v_mul_f32 v219, v215, v219
v_accvgpr_write_b32 a125, v219
v_accvgpr_read_b32 v219, a126
v_mul_f32 v219, v215, v219
v_accvgpr_write_b32 a126, v219
v_accvgpr_read_b32 v219, a127
v_mul_f32 v219, v215, v219
v_accvgpr_write_b32 a127, v219
v_accvgpr_read_b32 v219, a140
v_mul_f32 v219, v215, v219
v_accvgpr_write_b32 a140, v219
v_accvgpr_read_b32 v219, a141
v_mul_f32 v219, v215, v219
v_accvgpr_write_b32 a141, v219
v_accvgpr_read_b32 v219, a142
v_mul_f32 v219, v215, v219
v_accvgpr_write_b32 a142, v219
v_accvgpr_read_b32 v219, a143
v_mul_f32 v219, v215, v219
v_accvgpr_write_b32 a143, v219
v_sub_f32 v12, v12, v99
v_sub_f32 v13, v13, v99
v_sub_f32 v14, v14, v99
v_sub_f32 v15, v15, v99
v_exp_f32 v12, v12
v_exp_f32 v13, v13
v_exp_f32 v14, v14
v_exp_f32 v15, v15
s_nop 0
v_cvt_pk_bf16_f32 v76, v12, v13
v_cvt_pk_bf16_f32 v77, v14, v15
v_sub_f32 v28, v28, v99
v_sub_f32 v29, v29, v99
v_sub_f32 v30, v30, v99
v_sub_f32 v31, v31, v99
v_exp_f32 v28, v28
v_exp_f32 v29, v29
v_exp_f32 v30, v30
v_exp_f32 v31, v31
s_nop 0
v_cvt_pk_bf16_f32 v78, v28, v29
v_cvt_pk_bf16_f32 v79, v30, v31
s_nop 1
v_mfma_f32_16x16x32_bf16 a[0:3], a[224:227], v[64:67], a[0:3]
v_mfma_f32_16x16x32_bf16 a[32:35], a[224:227], v[68:71], a[32:35]
v_mfma_f32_16x16x32_bf16 a[64:67], a[224:227], v[72:75], a[64:67]
v_mfma_f32_16x16x32_bf16 a[96:99], a[224:227], v[76:79], a[96:99]
v_mfma_f32_16x16x32_bf16 a[4:7], a[228:231], v[64:67], a[4:7]
v_mfma_f32_16x16x32_bf16 a[36:39], a[228:231], v[68:71], a[36:39]
v_mfma_f32_16x16x32_bf16 a[68:71], a[228:231], v[72:75], a[68:71]
v_mfma_f32_16x16x32_bf16 a[100:103], a[228:231], v[76:79], a[100:103]
v_mfma_f32_16x16x32_bf16 a[8:11], a[232:235], v[64:67], a[8:11]
v_mfma_f32_16x16x32_bf16 a[40:43], a[232:235], v[68:71], a[40:43]
v_mfma_f32_16x16x32_bf16 a[72:75], a[232:235], v[72:75], a[72:75]
v_mfma_f32_16x16x32_bf16 a[104:107], a[232:235], v[76:79], a[104:107]
v_mfma_f32_16x16x32_bf16 a[12:15], a[236:239], v[64:67], a[12:15]
v_mfma_f32_16x16x32_bf16 a[44:47], a[236:239], v[68:71], a[44:47]
v_mfma_f32_16x16x32_bf16 a[76:79], a[236:239], v[72:75], a[76:79]
v_mfma_f32_16x16x32_bf16 a[108:111], a[236:239], v[76:79], a[108:111]
v_mfma_f32_16x16x32_bf16 a[16:19], a[240:243], v[64:67], a[16:19]
v_mfma_f32_16x16x32_bf16 a[48:51], a[240:243], v[68:71], a[48:51]
v_mfma_f32_16x16x32_bf16 a[80:83], a[240:243], v[72:75], a[80:83]
v_mfma_f32_16x16x32_bf16 a[112:115], a[240:243], v[76:79], a[112:115]
v_mfma_f32_16x16x32_bf16 a[20:23], a[244:247], v[64:67], a[20:23]
v_mfma_f32_16x16x32_bf16 a[52:55], a[244:247], v[68:71], a[52:55]
v_mfma_f32_16x16x32_bf16 a[84:87], a[244:247], v[72:75], a[84:87]
v_mfma_f32_16x16x32_bf16 a[116:119], a[244:247], v[76:79], a[116:119]
v_mfma_f32_16x16x32_bf16 a[24:27], a[248:251], v[64:67], a[24:27]
v_mfma_f32_16x16x32_bf16 a[56:59], a[248:251], v[68:71], a[56:59]
v_mfma_f32_16x16x32_bf16 a[88:91], a[248:251], v[72:75], a[88:91]
v_mfma_f32_16x16x32_bf16 a[120:123], a[248:251], v[76:79], a[120:123]
v_mfma_f32_16x16x32_bf16 a[28:31], a[252:255], v[64:67], a[28:31]
v_mfma_f32_16x16x32_bf16 a[60:63], a[252:255], v[68:71], a[60:63]
v_mfma_f32_16x16x32_bf16 a[92:95], a[252:255], v[72:75], a[92:95]
v_mfma_f32_16x16x32_bf16 a[124:127], a[252:255], v[76:79], a[124:127]
v_mfma_f32_16x16x32_bf16 a[128:131], a[144:147], v[64:67], a[128:131]
v_mfma_f32_16x16x32_bf16 a[132:135], a[144:147], v[68:71], a[132:135]
v_mfma_f32_16x16x32_bf16 a[136:139], a[144:147], v[72:75], a[136:139]
v_mfma_f32_16x16x32_bf16 a[140:143], a[144:147], v[76:79], a[140:143]
v_add_u32 v104, 32, v104
s_add_u32 s68, s68, 8192
s_cmp_lt_u32 s68, s10
s_nop 7
s_cbranch_scc1 Lslowl
s_branch Lepi
Lend:
s_endpgm
.section .rodata,"a"
.p2align 6
.amdhsa_kernel adaLN_cond__compressed_kv_cla__dense_activation_squared_relu__prompt_kernel
  .amdhsa_next_free_vgpr 512
  .amdhsa_next_free_sgpr 102
  .amdhsa_accum_offset 256
  .amdhsa_group_segment_fixed_size 0
  .amdhsa_kernarg_size 128
  .amdhsa_user_sgpr_count 2
  .amdhsa_user_sgpr_kernarg_segment_ptr 1
  .amdhsa_system_sgpr_workgroup_id_x 1
  .amdhsa_float_denorm_mode_32 3
  .amdhsa_float_denorm_mode_16_64 3
.end_amdhsa_kernel
```
